```python
import torch

def _softmax(x, axis=-1):
    return torch.softmax(x, dim=axis)

def _gelu(x):
    return torch.nn.functional.gelu(x, approximate='tanh')

def _silu(x):
    return torch.nn.functional.silu(x)

def _sigmoid(x):
    return torch.sigmoid(x)

def _layernorm(x, axis=-1, eps=1e-05):
    m = x.mean(dim=axis, keepdim=True)
    v = x.var(dim=axis, keepdim=True, unbiased=False)
    return (x - m) / torch.sqrt(v + eps)

def _scatter_add(tgt, idx, src, axis=0):
    return tgt.clone().index_add_(axis, idx, src)

def _segment_sum(src, seg, n):
    out = torch.zeros((n,) + src.shape[1:], dtype=src.dtype)
    return out.index_add_(0, seg, src)

def _pad(x, pw):
    flat = tuple((v for pair in reversed(pw) for v in pair))
    return torch.nn.functional.pad(x, flat)
kernel_name = 'adaLN_cond__compressed_kv_cla__mixer_channel_mlp__prompt'

def setup_inputs():

    _w = lambda a: (lambda t: t.to(torch.bfloat16) if t.is_floating_point() else t)(torch.as_tensor(a))

    def _A_setup():
        B, H, Sq, Sk, D, M = (1, 32, 2048, 2048, 128, 512)
        Dc = 4 * D
        return {'x': _w((lambda *s: torch.randn(*s, dtype=torch.bfloat16) * 0.05)(B, Sq, M)), 'c_kv': _w((lambda *s: torch.randn(*s, dtype=torch.bfloat16) * 0.4)(B, Sk, Dc)), 'w_q': _w((lambda *s: torch.randn(*s, dtype=torch.bfloat16) * 3.2)(M, H, D) * M ** (-0.5)), 'w_uk': _w((lambda *s: torch.randn(*s, dtype=torch.bfloat16) * 3.2)(Dc, H, D) * Dc ** (-0.5)), 'w_uv': _w((lambda *s: torch.randn(*s, dtype=torch.bfloat16) * 0.4)(Dc, H, D) * Dc ** (-0.5)), 'w_o': _w((lambda *s: torch.randn(*s, dtype=torch.bfloat16) * 0.4)(H, D, M) * (H * D) ** (-0.5))}
    _A_in = _A_setup()

    def _B_setup():
        B, S, D, F = (1, 2048, 512, 1792)
        return {'x': _w((lambda *s: torch.randn(*s, dtype=torch.bfloat16) * 0.05)(B, S, D)), 'w1': _w((lambda *s: torch.randn(*s, dtype=torch.bfloat16) * 1.6)(D, F) * D ** (-0.5)), 'b1': _w((lambda *s: torch.randn(*s, dtype=torch.bfloat16) * 0.4)(F)), 'w2': _w((lambda *s: torch.randn(*s, dtype=torch.bfloat16) * 0.05)(F, D) * F ** (-0.5)), 'b2': _w((lambda *s: torch.randn(*s, dtype=torch.bfloat16) * 0.05)(D))}
    _B_in = _B_setup()
    return {'A_x': _A_in['x'], 'A_c_kv': _A_in['c_kv'], 'A_w_q': _A_in['w_q'], 'A_w_uk': _A_in['w_uk'], 'A_w_uv': _A_in['w_uv'], 'A_w_o': _A_in['w_o'], 'B_x': _B_in['x'], 'B_w1': _B_in['w1'], 'B_b1': _B_in['b1'], 'B_w2': _B_in['w2'], 'B_b2': _B_in['b2'], 'c': _w((lambda *s: torch.randn(*s, dtype=torch.bfloat16) * 0.1)(1, 512) * 8.0), 'w_mod': _w((lambda *s: torch.randn(*s, dtype=torch.bfloat16) * 0.1)(512, 6 * 512) * 512 ** (-0.5) * 8.0)}

def reference(A_x, A_c_kv, A_w_q, A_w_uk, A_w_uv, A_w_o, B_x, B_w1, B_b1, B_w2, B_b2, c, w_mod):

    def _A_ref(x, c_kv, w_q, w_uk, w_uv, w_o):
        B, Sq, M = (x.shape[0], x.shape[1], x.shape[2])
        Sk = c_kv.shape[1]
        H, D = (w_q.shape[1], w_q.shape[2])
        q = torch.einsum('bqm,mhd->bhqd', x, w_q)
        k = torch.einsum('bkc,chd->bhkd', c_kv, w_uk)
        v = torch.einsum('bkc,chd->bhkd', c_kv, w_uv)
        scores = torch.einsum('bhqd,bhkd->bhqk', q, k) * D ** (-0.5)
        off = Sk - Sq
        qi = torch.arange(Sq)[:, None]
        kj = torch.arange(Sk)[None, :]
        cmask = kj <= qi + off
        scores = torch.where(cmask[None, None], scores, -1000000000.0)
        p = _softmax(scores, axis=-1)
        ctx = torch.einsum('bhqk,bhkd->bhqd', p, v)
        return torch.einsum('bhqd,hdm->bqm', ctx, w_o)

    def _B_ref(x, w1, b1, w2, b2):
        y = _layernorm(x, axis=-1)
        h = _gelu(torch.einsum('bsd,df->bsf', y, w1) + b1)
        return torch.einsum('bsf,fd->bsd', h, w2) + b2
    x = A_x
    mod = (_silu(c) @ w_mod).reshape(c.shape[0], 6, 1, -1)
    sa, ca, ga, sb, cb, gb = (mod[:, 0].clone(), mod[:, 1].clone(), mod[:, 2].clone(), mod[:, 3].clone(), mod[:, 4].clone(), mod[:, 5].clone())
    h = _layernorm(x, axis=-1) * (1 + ca) + sa
    x = x + ga * _A_ref(h, A_c_kv, A_w_q, A_w_uk, A_w_uv, A_w_o)
    h = _layernorm(x, axis=-1) * (1 + cb) + sb
    x = x + gb * _B_ref(h, B_w1, B_b1, B_w2, B_b2)
    return x
```

```asm
; @launch grid=(256,1,1) block=(256,1,1) lds=163840
.amdgcn_target "amdgcn-amd-amdhsa--gfx950"
.text
.globl adaLN_cond__compressed_kv_cla__mixer_channel_mlp__prompt_kernel
.p2align 8
.type adaLN_cond__compressed_kv_cla__mixer_channel_mlp__prompt_kernel,@function
adaLN_cond__compressed_kv_cla__mixer_channel_mlp__prompt_kernel:
  s_cmp_ge_u32 s2, 256
  s_cbranch_scc1 Lend_f
  s_load_dwordx16 s[44:59], s[0:1], 0
  s_load_dwordx16 s[60:75], s[0:1], 64
  s_getpc_b64 s[40:41]
Lpc_f:
  s_mov_b32 s42, Lcode_end_f-Lpc_f
  s_mov_b32 s43, 0x20000
  v_lshlrev_b32 v16, 7, v0
  s_lshr_b32 s76, s2, 3
  s_mul_i32 s76, s76, 3072
  v_cmp_gt_u32 vcc, 24, v0
  v_mov_b32 v17, 134217728
  s_nop 0
  v_cndmask_b32 v16, v17, v16, vcc
  buffer_load_dword v17, v16, s[40:43], s76 offen
  v_lshrrev_b32 v18, 6, v0
  v_and_b32 v0, 63, v0
  v_readfirstlane_b32 s3, v18
  v_lshlrev_b32 v1, 4, v0
  s_and_b32 s4, s2, 7
  s_lshl_b32 s4, s4, 2
  s_bfe_u32 s76, s2, 0x20003
  s_add_u32 s4, s4, s76
  s_lshr_b32 s5, s2, 5
  s_and_b32 s6, s2, 31
  v_lshrrev_b32 v18, 3, v0
  v_and_b32 v19, 7, v0
  v_mul_u32_u24 v20, 6144, v18
  v_lshl_add_u32 v20, v19, 4, v20
  v_lshlrev_b32 v21, 1, v18
  v_lshrrev_b32 v22, 1, v18
  v_xor_b32 v22, v22, v19
  v_lshlrev_b32 v22, 4, v22
  v_lshl_add_u32 v10, v18, 10, v22
  v_xor_b32 v11, 64, v10
  v_add_u32 v11, 7168, v11
  v_add_u32 v12, 14336, v10
  v_add_u32 v13, 14336, v11
  v_and_b32 v22, 2, v18
  v_xor_b32 v22, v22, v19
  v_lshlrev_b32 v22, 4, v22
  v_lshl_add_u32 v2, v18, 13, v22
  v_xor_b32 v3, 64, v2
  v_add_u32 v3, 64512, v3
  v_add_u32 v4, 129024, v2
  v_add_u32 v5, 129024, v3
  s_and_b32 s76, s2, 3
  s_lshl_b32 s76, s76, 7
  s_lshl_b32 s77, s3, 5
  s_add_u32 s88, s76, s77
  s_lshl_b32 s89, s88, 1
  s_mul_i32 s88, s88, 6144
  s_lshr_b32 s85, s2, 2
  s_lshl_b32 s85, s85, 7
  s_add_u32 s88, s88, s85
  s_lshl_b32 s78, s5, 18
  s_lshl_b32 s76, s3, 16
  s_add_u32 s78, s78, s76
  s_mul_i32 s83, s3, 24576
  s_add_u32 s83, s83, 65536
  s_and_b32 s76, s3, 1
  s_lshl_b32 s79, s76, 18
  s_lshr_b32 s77, s3, 1
  s_lshl_b32 s77, s77, 7
  s_add_u32 s79, s79, s77
  s_lshl_b32 s77, s4, 8
  s_add_u32 s79, s79, s77
  s_lshl_b32 s80, s3, 18
  s_add_u32 s80, s80, s77
  s_lshl_b32 s84, s3, 12
  s_waitcnt lgkmcnt(0)
  s_mov_b32 s24, s68
  s_mov_b32 s25, s69
  s_mov_b32 s26, 0x300000
  s_mov_b32 s27, 0x20000
  s_mov_b32 s28, s66
  s_mov_b32 s29, s67
  s_mov_b32 s30, 0x400
  s_mov_b32 s31, 0x20000
  s_cmp_lt_u32 s2, 192
  s_cselect_b32 s26, s26, 0
  buffer_load_ushort v80, v21, s[28:31], s89 offen offset:0
  buffer_load_ushort v81, v21, s[28:31], s89 offen offset:16
  buffer_load_ushort v82, v21, s[28:31], s89 offen offset:32
  buffer_load_ushort v83, v21, s[28:31], s89 offen offset:48
  buffer_load_dwordx4 v[64:67], v20, s[24:27], s88 offen nt
  s_add_u32 s88, s88, 49152
  buffer_load_dwordx4 v[68:71], v20, s[24:27], s88 offen nt
  s_add_u32 s88, s88, 49152
  buffer_load_dwordx4 v[72:75], v20, s[24:27], s88 offen nt
  s_add_u32 s88, s88, 49152
  buffer_load_dwordx4 v[76:79], v20, s[24:27], s88 offen nt
  s_mov_b32 s12, s46
  s_mov_b32 s13, s47
  s_mov_b32 s14, 0x200000
  s_mov_b32 s15, 0x20000
  s_mov_b32 s16, s50
  s_mov_b32 s17, s51
  s_mov_b32 s18, 0x400000
  s_mov_b32 s19, 0x20000
  s_add_u32 m0, s83, 0
  s_add_u32 s91, s78, 0
  buffer_load_dwordx4 v10, s[12:15], s91 offen offset:0 lds
  buffer_load_dwordx4 v11, s[12:15], s91 offen offset:1024 lds
  buffer_load_dwordx4 v12, s[12:15], s91 offen offset:2048 lds
  buffer_load_dwordx4 v13, s[12:15], s91 offen offset:3072 lds
  s_add_u32 m0, s83, 4096
  s_add_u32 s91, s78, 32768
  buffer_load_dwordx4 v10, s[12:15], s91 offen offset:0 lds
  buffer_load_dwordx4 v11, s[12:15], s91 offen offset:1024 lds
  buffer_load_dwordx4 v12, s[12:15], s91 offen offset:2048 lds
  buffer_load_dwordx4 v13, s[12:15], s91 offen offset:3072 lds
  s_add_u32 m0, s84, 0
  s_add_u32 s7, s79, 0
  buffer_load_dwordx4 v2, s[16:19], s7 offen offset:0 nt lds
  buffer_load_dwordx4 v3, s[16:19], s7 offen offset:1024 nt lds
  buffer_load_dwordx4 v4, s[16:19], s7 offen offset:2048 nt lds
  buffer_load_dwordx4 v5, s[16:19], s7 offen offset:3072 nt lds
  s_mov_b32 s20, s52
  s_mov_b32 s21, s53
  s_mov_b32 s22, 0x400000
  s_mov_b32 s23, 0x20000
  v_lshrrev_b32 v97, 4, v0
  v_and_b32 v96, 15, v0
  v_lshlrev_b32 v96, 4, v96
  v_lshl_add_u32 v98, v97, 13, v96
  v_lshl_add_u32 v96, v97, 10, v96
  v_mov_b32 v97, v98
  s_add_u32 m0, s83, 8192
  s_add_u32 s91, s78, 128
  buffer_load_dwordx4 v10, s[12:15], s91 offen offset:0 lds
  buffer_load_dwordx4 v11, s[12:15], s91 offen offset:1024 lds
  buffer_load_dwordx4 v12, s[12:15], s91 offen offset:2048 lds
  buffer_load_dwordx4 v13, s[12:15], s91 offen offset:3072 lds
  s_add_u32 m0, s83, 12288
  s_add_u32 s91, s78, 32896
  buffer_load_dwordx4 v10, s[12:15], s91 offen offset:0 lds
  buffer_load_dwordx4 v11, s[12:15], s91 offen offset:1024 lds
  buffer_load_dwordx4 v12, s[12:15], s91 offen offset:2048 lds
  buffer_load_dwordx4 v13, s[12:15], s91 offen offset:3072 lds
  s_add_u32 m0, s84, 16384
  s_add_u32 s7, s79, 524288
  buffer_load_dwordx4 v2, s[16:19], s7 offen offset:0 nt lds
  buffer_load_dwordx4 v3, s[16:19], s7 offen offset:1024 nt lds
  buffer_load_dwordx4 v4, s[16:19], s7 offen offset:2048 nt lds
  buffer_load_dwordx4 v5, s[16:19], s7 offen offset:3072 nt lds
  s_mov_b32 s8, s74
  s_mov_b32 s9, s75
  s_mov_b32 s10, 0x4800000
  s_mov_b32 s11, 0x20000
  v_lshlrev_b32 v30, 13, v0
  s_lshl_b32 s76, s2, 5
  s_add_u32 s76, s76, 8192
  v_add_u32 v30, s76, v30
  s_lshl_b32 s76, s4, 5
  s_lshl_b32 s77, s5, 2
  s_add_u32 s76, s76, s77
  v_writelane_b32 v30, s76, 0
  s_add_u32 s76, s76, 5120
  v_writelane_b32 v30, s76, 5
  s_lshl_b32 s76, s2, 2
  s_add_u32 s76, s76, 6144
  v_writelane_b32 v30, s76, 6
  v_mov_b32 v31, 134217728
  v_cmp_gt_u32 vcc, 7, v0
  s_nop 1
  v_cndmask_b32 v30, v31, v30, vcc
  v_mov_b32 v31, 0
  s_mov_b32 s90, 39059456
  s_cmp_eq_u32 s3, 0
  s_cselect_b32 s90, s90, 0x7ff00000
  buffer_store_dword v31, v30, s[8:11], s90 offen sc1
  s_mov_b32 s32, s44
  s_mov_b32 s33, s45
  s_mov_b32 s34, 0x200000
  s_mov_b32 s35, 0x20000
  s_mov_b32 s36, s72
  s_mov_b32 s37, s73
  s_mov_b32 s38, 0x100
  s_mov_b32 s39, 0x20000
  s_mov_b32 s24, s48
  s_mov_b32 s25, s49
  s_mov_b32 s26, 0x400000
  s_mov_b32 s27, 0x20000
  s_mov_b32 s28, s54
  s_mov_b32 s29, s55
  s_mov_b32 s30, 0x400000
  s_mov_b32 s31, 0x20000
  s_mov_b32 s40, s58
  s_mov_b32 s41, s59
  s_mov_b32 s42, 0x1c0000
  s_mov_b32 s43, 0x20000
  s_mov_b64 s[100:101], s[62:63]
  s_mov_b64 s[92:93], s[44:45]
  s_mov_b64 s[94:95], s[60:61]
  s_mov_b64 s[96:97], s[64:65]
  s_mov_b64 s[98:99], s[70:71]
  v_lshrrev_b32 v22, 4, v0
  v_bfe_u32 v23, v0, 2, 2
  v_lshl_add_u32 v24, v22, 3, v23
  v_lshlrev_b32 v24, 7, v24
  v_and_b32 v25, 3, v0
  v_lshl_add_u32 v24, v25, 3, v24
  v_and_b32 v25, 1, v22
  v_lshlrev_b32 v25, 1, v25
  v_lshrrev_b32 v26, 1, v23
  v_or_b32 v25, v25, v26
  v_lshl_add_u32 v6, v25, 5, v24
  v_xor_b32 v7, 32, v6
  v_xor_b32 v8, 64, v6
  v_xor_b32 v9, 0x60, v6
  v_and_b32 v23, 15, v0
  v_lshrrev_b32 v24, 1, v23
  v_xor_b32 v24, v24, v22
  v_lshlrev_b32 v24, 4, v24
  v_lshl_add_u32 v24, v23, 7, v24
  v_add_u32 v14, s83, v24
  v_xor_b32 v15, 64, v14
  s_lshl_b32 s81, s4, 20
  s_lshl_b32 s76, s5, 17
  s_add_u32 s81, s81, s76
  s_lshl_b32 s76, s3, 15
  s_add_u32 s81, s81, s76
  s_add_u32 s82, s81, 16384
  s_and_b32 s76, s2, 3
  s_mul_i32 s76, s76, 12288
  s_lshl_b32 s85, s85, 1
  s_add_u32 s85, s85, s76
  s_add_u32 s85, s85, 38797312
  s_cmp_lt_u32 s2, 192
  s_cselect_b32 s76, s3, 1
  s_cmp_eq_u32 s76, 0
  s_cselect_b32 s85, s85, 0x7ff00000
  s_and_b32 s86, s2, 63
  s_lshl_b32 s86, s86, 2
  s_cmp_eq_u32 s3, 0
  s_cselect_b32 s86, s86, 256
  s_cmp_ge_u32 s3, 2
  s_cselect_b32 s87, 1.0, 0
  s_waitcnt vmcnt(29)
  v_lshlrev_b32 v80, 16, v80
  v_lshlrev_b32 v81, 16, v81
  v_lshlrev_b32 v82, 16, v82
  v_lshlrev_b32 v83, 16, v83
  v_mul_f32 v92, 0xbfb8aa3b, v80
  v_mul_f32 v93, 0xbfb8aa3b, v81
  v_mul_f32 v94, 0xbfb8aa3b, v82
  v_mul_f32 v95, 0xbfb8aa3b, v83
  v_exp_f32 v92, v92
  v_exp_f32 v93, v93
  v_exp_f32 v94, v94
  v_exp_f32 v95, v95
  v_add_f32 v92, 1.0, v92
  v_add_f32 v93, 1.0, v93
  v_add_f32 v94, 1.0, v94
  v_add_f32 v95, 1.0, v95
  v_rcp_f32 v92, v92
  v_rcp_f32 v93, v93
  v_rcp_f32 v94, v94
  v_rcp_f32 v95, v95
  v_mul_f32 v80, v80, v92
  v_mul_f32 v81, v81, v93
  v_mul_f32 v82, v82, v94
  v_mul_f32 v83, v83, v95
  v_cvt_pk_bf16_f32 v80, v80, v80
  v_cvt_pk_bf16_f32 v81, v81, v81
  v_cvt_pk_bf16_f32 v82, v82, v82
  v_cvt_pk_bf16_f32 v83, v83, v83
  v_lshlrev_b32 v80, 16, v80
  v_lshlrev_b32 v81, 16, v81
  v_lshlrev_b32 v82, 16, v82
  v_lshlrev_b32 v83, 16, v83
  s_waitcnt vmcnt(28)
  v_lshlrev_b32 v92, 16, v64
  v_and_b32 v93, 0xffff0000, v64
  v_mul_f32 v84, v80, v92
  v_mul_f32 v85, v80, v93
  v_lshlrev_b32 v92, 16, v65
  v_and_b32 v93, 0xffff0000, v65
  v_mul_f32 v86, v80, v92
  v_mul_f32 v87, v80, v93
  v_lshlrev_b32 v92, 16, v66
  v_and_b32 v93, 0xffff0000, v66
  v_mul_f32 v88, v80, v92
  v_mul_f32 v89, v80, v93
  v_lshlrev_b32 v92, 16, v67
  v_and_b32 v93, 0xffff0000, v67
  v_mul_f32 v90, v80, v92
  v_mul_f32 v91, v80, v93
  s_waitcnt vmcnt(27)
  v_lshlrev_b32 v92, 16, v68
  v_and_b32 v93, 0xffff0000, v68
  v_fmac_f32 v84, v81, v92
  v_fmac_f32 v85, v81, v93
  v_lshlrev_b32 v92, 16, v69
  v_and_b32 v93, 0xffff0000, v69
  v_fmac_f32 v86, v81, v92
  v_fmac_f32 v87, v81, v93
  v_lshlrev_b32 v92, 16, v70
  v_and_b32 v93, 0xffff0000, v70
  v_fmac_f32 v88, v81, v92
  v_fmac_f32 v89, v81, v93
  v_lshlrev_b32 v92, 16, v71
  v_and_b32 v93, 0xffff0000, v71
  v_fmac_f32 v90, v81, v92
  v_fmac_f32 v91, v81, v93
  s_waitcnt vmcnt(26)
  v_lshlrev_b32 v92, 16, v72
  v_and_b32 v93, 0xffff0000, v72
  v_fmac_f32 v84, v82, v92
  v_fmac_f32 v85, v82, v93
  v_lshlrev_b32 v92, 16, v73
  v_and_b32 v93, 0xffff0000, v73
  v_fmac_f32 v86, v82, v92
  v_fmac_f32 v87, v82, v93
  v_lshlrev_b32 v92, 16, v74
  v_and_b32 v93, 0xffff0000, v74
  v_fmac_f32 v88, v82, v92
  v_fmac_f32 v89, v82, v93
  v_lshlrev_b32 v92, 16, v75
  v_and_b32 v93, 0xffff0000, v75
  v_fmac_f32 v90, v82, v92
  v_fmac_f32 v91, v82, v93
  s_waitcnt vmcnt(25)
  v_lshlrev_b32 v92, 16, v76
  v_and_b32 v93, 0xffff0000, v76
  v_fmac_f32 v84, v83, v92
  v_fmac_f32 v85, v83, v93
  v_lshlrev_b32 v92, 16, v77
  v_and_b32 v93, 0xffff0000, v77
  v_fmac_f32 v86, v83, v92
  v_fmac_f32 v87, v83, v93
  v_lshlrev_b32 v92, 16, v78
  v_and_b32 v93, 0xffff0000, v78
  v_fmac_f32 v88, v83, v92
  v_fmac_f32 v89, v83, v93
  v_lshlrev_b32 v92, 16, v79
  v_and_b32 v93, 0xffff0000, v79
  v_fmac_f32 v90, v83, v92
  v_fmac_f32 v91, v83, v93
  v_add_f32_dpp v84, v84, v84 row_ror:8 row_mask:0xf bank_mask:0xf
  v_add_f32_dpp v85, v85, v85 row_ror:8 row_mask:0xf bank_mask:0xf
  v_add_f32_dpp v86, v86, v86 row_ror:8 row_mask:0xf bank_mask:0xf
  v_add_f32_dpp v87, v87, v87 row_ror:8 row_mask:0xf bank_mask:0xf
  v_add_f32_dpp v88, v88, v88 row_ror:8 row_mask:0xf bank_mask:0xf
  v_add_f32_dpp v89, v89, v89 row_ror:8 row_mask:0xf bank_mask:0xf
  v_add_f32_dpp v90, v90, v90 row_ror:8 row_mask:0xf bank_mask:0xf
  v_add_f32_dpp v91, v91, v91 row_ror:8 row_mask:0xf bank_mask:0xf
  v_permlane16_swap_b32 v84, v85
  v_permlane16_swap_b32 v86, v87
  v_permlane16_swap_b32 v88, v89
  v_permlane16_swap_b32 v90, v91
  v_add_f32 v84, v84, v85
  v_add_f32 v86, v86, v87
  v_add_f32 v88, v88, v89
  v_add_f32 v90, v90, v91
  v_permlane32_swap_b32 v84, v86
  s_nop 0
  v_permlane32_swap_b32 v88, v90
  v_add_f32 v84, v84, v86
  v_add_f32 v88, v88, v90
  v_lshrrev_b32 v92, 4, v0
  v_lshl_add_u32 v92, v19, 3, v92
  v_lshlrev_b32 v92, 2, v92
  s_lshl_b32 s76, s3, 8
  v_add_u32 v92, s76, v92
  ds_write_b32 v92, v84 offset:49152
  ds_write_b32 v92, v88 offset:49168
  v_lshlrev_b32 v20, 2, v0
  v_lshlrev_b32 v21, 8, v0
  v_mov_b32 v22, 1
  s_waitcnt vmcnt(17)
  ds_read_b128 a[0:3], v14 offset:0
  ds_read_b128 a[4:7], v14 offset:2048
  ds_read_b128 a[8:11], v14 offset:4096
  ds_read_b128 a[12:15], v14 offset:6144
  ds_read_b128 a[16:19], v15 offset:0
  ds_read_b128 a[20:23], v15 offset:2048
  ds_read_b128 a[24:27], v15 offset:4096
  ds_read_b128 a[28:31], v15 offset:6144
  s_waitcnt vmcnt(13) lgkmcnt(8)
  s_barrier
  ds_read_b64_tr_b16 v[32:33], v6 offset:0
  ds_read_b64_tr_b16 v[34:35], v6 offset:512
  ds_read_b64_tr_b16 v[36:37], v6 offset:4096
  ds_read_b64_tr_b16 v[38:39], v6 offset:4608
  ds_read_b64_tr_b16 v[40:41], v7 offset:0
  ds_read_b64_tr_b16 v[42:43], v7 offset:512
  ds_read_b64_tr_b16 v[44:45], v7 offset:4096
  ds_read_b64_tr_b16 v[46:47], v7 offset:4608
  s_waitcnt lgkmcnt(4)
  v_mfma_f32_16x16x32_bf16 v[128:131], v[32:35], a[0:3], 0
  ds_read_b64_tr_b16 v[48:49], v8 offset:0
  v_mfma_f32_16x16x32_bf16 v[128:131], v[36:39], a[16:19], v[128:131]
  ds_read_b64_tr_b16 v[50:51], v8 offset:512
  v_mfma_f32_16x16x32_bf16 v[132:135], v[32:35], a[4:7], 0
  s_add_u32 m0, s83, 16384
  s_add_u32 s91, s78, 256
  buffer_load_dwordx4 v10, s[12:15], s91 offen offset:0 lds
  v_mfma_f32_16x16x32_bf16 v[132:135], v[36:39], a[20:23], v[132:135]
  ds_read2st64_b32 v[24:25], v20 offset0:192 offset1:193
  v_mfma_f32_16x16x32_bf16 v[136:139], v[32:35], a[8:11], 0
  ds_read_b64_tr_b16 v[52:53], v8 offset:4096
  v_mfma_f32_16x16x32_bf16 v[136:139], v[36:39], a[24:27], v[136:139]
  ds_read_b64_tr_b16 v[54:55], v8 offset:4608
  v_mfma_f32_16x16x32_bf16 v[140:143], v[32:35], a[12:15], 0
  buffer_load_dwordx4 v11, s[12:15], s91 offen offset:1024 lds
  v_mfma_f32_16x16x32_bf16 v[140:143], v[36:39], a[28:31], v[140:143]
  ds_read2st64_b32 v[26:27], v20 offset0:194 offset1:195
  s_waitcnt lgkmcnt(6)
  v_mfma_f32_16x16x32_bf16 v[144:147], v[40:43], a[0:3], 0
  ds_read_b64_tr_b16 v[56:57], v9 offset:0
  v_mfma_f32_16x16x32_bf16 v[144:147], v[44:47], a[16:19], v[144:147]
  ds_read_b64_tr_b16 v[58:59], v9 offset:512
  v_mfma_f32_16x16x32_bf16 v[148:151], v[40:43], a[4:7], 0
  buffer_load_dwordx4 v12, s[12:15], s91 offen offset:2048 lds
  v_mfma_f32_16x16x32_bf16 v[148:151], v[44:47], a[20:23], v[148:151]
  v_mfma_f32_16x16x32_bf16 v[152:155], v[40:43], a[8:11], 0
  ds_read_b64_tr_b16 v[60:61], v9 offset:4096
  v_mfma_f32_16x16x32_bf16 v[152:155], v[44:47], a[24:27], v[152:155]
  ds_read_b64_tr_b16 v[62:63], v9 offset:4608
  v_mfma_f32_16x16x32_bf16 v[156:159], v[40:43], a[12:15], 0
  s_waitcnt lgkmcnt(4)
  v_add_f32 v24, v24, v25
  v_add_f32 v26, v26, v27
  v_add_f32 v24, v24, v26
  buffer_store_dword v24, v20, s[8:11], s85 offen sc1
  v_mfma_f32_16x16x32_bf16 v[156:159], v[44:47], a[28:31], v[156:159]
  v_mfma_f32_16x16x32_bf16 v[160:163], v[48:51], a[0:3], 0
  ds_read_b64_tr_b16 v[32:33], v6 offset:8192
  v_mfma_f32_16x16x32_bf16 v[160:163], v[52:55], a[16:19], v[160:163]
  ds_read_b64_tr_b16 v[34:35], v6 offset:8704
  v_mfma_f32_16x16x32_bf16 v[164:167], v[48:51], a[4:7], 0
  buffer_load_dwordx4 v13, s[12:15], s91 offen offset:3072 lds
  v_mfma_f32_16x16x32_bf16 v[164:167], v[52:55], a[20:23], v[164:167]
  v_mfma_f32_16x16x32_bf16 v[168:171], v[48:51], a[8:11], 0
  ds_read_b64_tr_b16 v[36:37], v6 offset:12288
  s_sub_u32 s89, 15, s5
  v_mfma_f32_16x16x32_bf16 v[168:171], v[52:55], a[24:27], v[168:171]
  ds_read_b64_tr_b16 v[38:39], v6 offset:12800
  v_mfma_f32_16x16x32_bf16 v[172:175], v[48:51], a[12:15], 0
  s_add_u32 m0, s83, 20480
  s_add_u32 s91, s78, 33024
  buffer_load_dwordx4 v10, s[12:15], s91 offen offset:0 lds
  v_mfma_f32_16x16x32_bf16 v[172:175], v[52:55], a[28:31], v[172:175]
  s_waitcnt vmcnt(11)
  ds_read_b128 a[32:35], v14 offset:8192
  s_waitcnt lgkmcnt(5)
  v_mfma_f32_16x16x32_bf16 v[176:179], v[56:59], a[0:3], 0
  ds_read_b64_tr_b16 v[40:41], v7 offset:8192
  v_mfma_f32_16x16x32_bf16 v[176:179], v[60:63], a[16:19], v[176:179]
  ds_read_b64_tr_b16 v[42:43], v7 offset:8704
  v_mfma_f32_16x16x32_bf16 v[180:183], v[56:59], a[4:7], 0
  buffer_load_dwordx4 v11, s[12:15], s91 offen offset:1024 lds
  v_mfma_f32_16x16x32_bf16 v[180:183], v[60:63], a[20:23], v[180:183]
  ds_read_b128 a[36:39], v14 offset:10240
  v_mfma_f32_16x16x32_bf16 v[184:187], v[56:59], a[8:11], 0
  ds_read_b64_tr_b16 v[44:45], v7 offset:12288
  v_mfma_f32_16x16x32_bf16 v[184:187], v[60:63], a[24:27], v[184:187]
  ds_read_b64_tr_b16 v[46:47], v7 offset:12800
  v_mfma_f32_16x16x32_bf16 v[188:191], v[56:59], a[12:15], 0
  buffer_load_dwordx4 v12, s[12:15], s91 offen offset:2048 lds
  v_mfma_f32_16x16x32_bf16 v[188:191], v[60:63], a[28:31], v[188:191]
  ds_read_b128 a[40:43], v14 offset:12288
  s_waitcnt lgkmcnt(7)
  v_mfma_f32_16x16x32_bf16 v[192:195], v[32:35], a[0:3], 0
  ds_read_b64_tr_b16 v[48:49], v8 offset:8192
  s_cmp_lt_u32 s6, 16
  s_cselect_b32 s89, s5, s89
  v_mfma_f32_16x16x32_bf16 v[192:195], v[36:39], a[16:19], v[192:195]
  ds_read_b64_tr_b16 v[50:51], v8 offset:8704
  s_lshl_b32 s89, s89, 4
  v_mfma_f32_16x16x32_bf16 v[196:199], v[32:35], a[4:7], 0
  buffer_load_dwordx4 v13, s[12:15], s91 offen offset:3072 lds
  s_and_b32 s88, s6, 15
  v_mfma_f32_16x16x32_bf16 v[196:199], v[36:39], a[20:23], v[196:199]
  ds_read_b128 a[44:47], v14 offset:14336
  s_add_u32 s89, s89, s88
  v_mfma_f32_16x16x32_bf16 v[200:203], v[32:35], a[8:11], 0
  ds_read_b64_tr_b16 v[52:53], v8 offset:12288
  s_lshl_b32 s88, s89, 13
  v_mfma_f32_16x16x32_bf16 v[200:203], v[36:39], a[24:27], v[200:203]
  ds_read_b64_tr_b16 v[54:55], v8 offset:12800
  s_lshl_b32 s90, s3, 11
  v_mfma_f32_16x16x32_bf16 v[204:207], v[32:35], a[12:15], 0
  s_add_u32 m0, s84, 32768
  s_add_u32 s7, s79, 1048576
  buffer_load_dwordx4 v2, s[16:19], s7 offen offset:0 nt lds
  v_mfma_f32_16x16x32_bf16 v[204:207], v[36:39], a[28:31], v[204:207]
  ds_read_b128 a[48:51], v15 offset:8192
  s_waitcnt lgkmcnt(7)
  v_mfma_f32_16x16x32_bf16 v[208:211], v[40:43], a[0:3], 0
  ds_read_b64_tr_b16 v[56:57], v9 offset:8192
  s_add_u32 s88, s88, s90
  v_mfma_f32_16x16x32_bf16 v[208:211], v[44:47], a[16:19], v[208:211]
  ds_read_b64_tr_b16 v[58:59], v9 offset:8704
  v_mfma_f32_16x16x32_bf16 v[212:215], v[40:43], a[4:7], 0
  buffer_load_dwordx4 v3, s[16:19], s7 offen offset:1024 nt lds
  v_mfma_f32_16x16x32_bf16 v[212:215], v[44:47], a[20:23], v[212:215]
  ds_read_b128 a[52:55], v15 offset:10240
  v_mfma_f32_16x16x32_bf16 v[216:219], v[40:43], a[8:11], 0
  ds_read_b64_tr_b16 v[60:61], v9 offset:12288
  v_mfma_f32_16x16x32_bf16 v[216:219], v[44:47], a[24:27], v[216:219]
  ds_read_b64_tr_b16 v[62:63], v9 offset:12800
  v_mfma_f32_16x16x32_bf16 v[220:223], v[40:43], a[12:15], 0
  buffer_load_dwordx4 v4, s[16:19], s7 offen offset:2048 nt lds
  v_mfma_f32_16x16x32_bf16 v[220:223], v[44:47], a[28:31], v[220:223]
  ds_read_b128 a[56:59], v15 offset:12288
  s_waitcnt vmcnt(13)
  s_barrier
  s_waitcnt lgkmcnt(7)
  v_mfma_f32_16x16x32_bf16 v[224:227], v[48:51], a[0:3], 0
  ds_read_b64_tr_b16 v[32:33], v6 offset:16384
  v_mfma_f32_16x16x32_bf16 v[224:227], v[52:55], a[16:19], v[224:227]
  ds_read_b64_tr_b16 v[34:35], v6 offset:16896
  v_mfma_f32_16x16x32_bf16 v[228:231], v[48:51], a[4:7], 0
  buffer_load_dwordx4 v5, s[16:19], s7 offen offset:3072 nt lds
  v_mfma_f32_16x16x32_bf16 v[228:231], v[52:55], a[20:23], v[228:231]
  ds_read_b128 a[60:63], v15 offset:14336
  v_mfma_f32_16x16x32_bf16 v[232:235], v[48:51], a[8:11], 0
  ds_read_b64_tr_b16 v[36:37], v6 offset:20480
  v_mfma_f32_16x16x32_bf16 v[232:235], v[52:55], a[24:27], v[232:235]
  ds_read_b64_tr_b16 v[38:39], v6 offset:20992
  v_mfma_f32_16x16x32_bf16 v[236:239], v[48:51], a[12:15], 0
  s_add_u32 m0, s83, 0
  s_add_u32 s91, s78, 384
  buffer_load_dwordx4 v10, s[12:15], s91 offen offset:0 lds
  v_mfma_f32_16x16x32_bf16 v[236:239], v[52:55], a[28:31], v[236:239]
  s_waitcnt lgkmcnt(6)
  v_mfma_f32_16x16x32_bf16 v[240:243], v[56:59], a[0:3], 0
  ds_read_b64_tr_b16 v[40:41], v7 offset:16384
  v_mfma_f32_16x16x32_bf16 v[240:243], v[60:63], a[16:19], v[240:243]
  ds_read_b64_tr_b16 v[42:43], v7 offset:16896
  v_mfma_f32_16x16x32_bf16 v[244:247], v[56:59], a[4:7], 0
  buffer_load_dwordx4 v11, s[12:15], s91 offen offset:1024 lds
  v_mfma_f32_16x16x32_bf16 v[244:247], v[60:63], a[20:23], v[244:247]
  v_mfma_f32_16x16x32_bf16 v[248:251], v[56:59], a[8:11], 0
  ds_read_b64_tr_b16 v[44:45], v7 offset:20480
  v_mfma_f32_16x16x32_bf16 v[248:251], v[60:63], a[24:27], v[248:251]
  ds_read_b64_tr_b16 v[46:47], v7 offset:20992
  v_mfma_f32_16x16x32_bf16 v[252:255], v[56:59], a[12:15], 0
  buffer_load_dwordx4 v12, s[12:15], s91 offen offset:2048 lds
  v_mfma_f32_16x16x32_bf16 v[252:255], v[60:63], a[28:31], v[252:255]
  s_waitcnt lgkmcnt(4)
  v_mfma_f32_16x16x32_bf16 v[128:131], v[32:35], a[32:35], v[128:131]
  ds_read_b64_tr_b16 v[48:49], v8 offset:16384
  v_mfma_f32_16x16x32_bf16 v[128:131], v[36:39], a[48:51], v[128:131]
  ds_read_b64_tr_b16 v[50:51], v8 offset:16896
  v_mfma_f32_16x16x32_bf16 v[132:135], v[32:35], a[36:39], v[132:135]
  buffer_load_dwordx4 v13, s[12:15], s91 offen offset:3072 lds
  v_mfma_f32_16x16x32_bf16 v[132:135], v[36:39], a[52:55], v[132:135]
  v_mfma_f32_16x16x32_bf16 v[136:139], v[32:35], a[40:43], v[136:139]
  ds_read_b64_tr_b16 v[52:53], v8 offset:20480
  v_mfma_f32_16x16x32_bf16 v[136:139], v[36:39], a[56:59], v[136:139]
  ds_read_b64_tr_b16 v[54:55], v8 offset:20992
  v_mfma_f32_16x16x32_bf16 v[140:143], v[32:35], a[44:47], v[140:143]
  s_add_u32 m0, s83, 4096
  s_add_u32 s91, s78, 33152
  buffer_load_dwordx4 v10, s[12:15], s91 offen offset:0 lds
  v_mfma_f32_16x16x32_bf16 v[140:143], v[36:39], a[60:63], v[140:143]
  s_waitcnt lgkmcnt(4)
  v_mfma_f32_16x16x32_bf16 v[144:147], v[40:43], a[32:35], v[144:147]
  ds_read_b64_tr_b16 v[56:57], v9 offset:16384
  v_mfma_f32_16x16x32_bf16 v[144:147], v[44:47], a[48:51], v[144:147]
  ds_read_b64_tr_b16 v[58:59], v9 offset:16896
  v_mfma_f32_16x16x32_bf16 v[148:151], v[40:43], a[36:39], v[148:151]
  buffer_load_dwordx4 v11, s[12:15], s91 offen offset:1024 lds
  v_mfma_f32_16x16x32_bf16 v[148:151], v[44:47], a[52:55], v[148:151]
  v_mfma_f32_16x16x32_bf16 v[152:155], v[40:43], a[40:43], v[152:155]
  ds_read_b64_tr_b16 v[60:61], v9 offset:20480
  v_mfma_f32_16x16x32_bf16 v[152:155], v[44:47], a[56:59], v[152:155]
  ds_read_b64_tr_b16 v[62:63], v9 offset:20992
  v_mfma_f32_16x16x32_bf16 v[156:159], v[40:43], a[44:47], v[156:159]
  buffer_load_dwordx4 v12, s[12:15], s91 offen offset:2048 lds
  v_mfma_f32_16x16x32_bf16 v[156:159], v[44:47], a[60:63], v[156:159]
  s_waitcnt lgkmcnt(4)
  v_mfma_f32_16x16x32_bf16 v[160:163], v[48:51], a[32:35], v[160:163]
  ds_read_b64_tr_b16 v[32:33], v6 offset:24576
  v_mfma_f32_16x16x32_bf16 v[160:163], v[52:55], a[48:51], v[160:163]
  ds_read_b64_tr_b16 v[34:35], v6 offset:25088
  v_mfma_f32_16x16x32_bf16 v[164:167], v[48:51], a[36:39], v[164:167]
  buffer_load_dwordx4 v13, s[12:15], s91 offen offset:3072 lds
  v_mfma_f32_16x16x32_bf16 v[164:167], v[52:55], a[52:55], v[164:167]
  v_mfma_f32_16x16x32_bf16 v[168:171], v[48:51], a[40:43], v[168:171]
  ds_read_b64_tr_b16 v[36:37], v6 offset:28672
  v_mfma_f32_16x16x32_bf16 v[168:171], v[52:55], a[56:59], v[168:171]
  ds_read_b64_tr_b16 v[38:39], v6 offset:29184
  v_mfma_f32_16x16x32_bf16 v[172:175], v[48:51], a[44:47], v[172:175]
  s_add_u32 m0, s84, 49152
  s_add_u32 s77, s79, 1572864
  buffer_load_dwordx4 v2, s[16:19], s77 offen offset:0 nt lds
  v_mfma_f32_16x16x32_bf16 v[172:175], v[52:55], a[60:63], v[172:175]
  s_waitcnt vmcnt(13)
  ds_read_b128 a[64:67], v14 offset:16384
  s_waitcnt lgkmcnt(5)
  v_mfma_f32_16x16x32_bf16 v[176:179], v[56:59], a[32:35], v[176:179]
  ds_read_b64_tr_b16 v[40:41], v7 offset:24576
  v_mfma_f32_16x16x32_bf16 v[176:179], v[60:63], a[48:51], v[176:179]
  ds_read_b64_tr_b16 v[42:43], v7 offset:25088
  v_mfma_f32_16x16x32_bf16 v[180:183], v[56:59], a[36:39], v[180:183]
  buffer_load_dwordx4 v3, s[16:19], s77 offen offset:1024 nt lds
  v_mfma_f32_16x16x32_bf16 v[180:183], v[60:63], a[52:55], v[180:183]
  ds_read_b128 a[68:71], v14 offset:18432
  v_mfma_f32_16x16x32_bf16 v[184:187], v[56:59], a[40:43], v[184:187]
  ds_read_b64_tr_b16 v[44:45], v7 offset:28672
  v_mfma_f32_16x16x32_bf16 v[184:187], v[60:63], a[56:59], v[184:187]
  ds_read_b64_tr_b16 v[46:47], v7 offset:29184
  v_mfma_f32_16x16x32_bf16 v[188:191], v[56:59], a[44:47], v[188:191]
  buffer_load_dwordx4 v4, s[16:19], s77 offen offset:2048 nt lds
  v_mfma_f32_16x16x32_bf16 v[188:191], v[60:63], a[60:63], v[188:191]
  ds_read_b128 a[72:75], v14 offset:20480
  s_waitcnt lgkmcnt(7)
  v_mfma_f32_16x16x32_bf16 v[192:195], v[32:35], a[32:35], v[192:195]
  ds_read_b64_tr_b16 v[48:49], v8 offset:24576
  v_mfma_f32_16x16x32_bf16 v[192:195], v[36:39], a[48:51], v[192:195]
  ds_read_b64_tr_b16 v[50:51], v8 offset:25088
  v_mfma_f32_16x16x32_bf16 v[196:199], v[32:35], a[36:39], v[196:199]
  buffer_load_dwordx4 v5, s[16:19], s77 offen offset:3072 nt lds
  v_mfma_f32_16x16x32_bf16 v[196:199], v[36:39], a[52:55], v[196:199]
  ds_read_b128 a[76:79], v14 offset:22528
  v_mfma_f32_16x16x32_bf16 v[200:203], v[32:35], a[40:43], v[200:203]
  ds_read_b64_tr_b16 v[52:53], v8 offset:28672
  v_mfma_f32_16x16x32_bf16 v[200:203], v[36:39], a[56:59], v[200:203]
  ds_read_b64_tr_b16 v[54:55], v8 offset:29184
  v_mfma_f32_16x16x32_bf16 v[204:207], v[32:35], a[44:47], v[204:207]
  buffer_atomic_add v22, v21, s[36:39], s86 offen sc1
  v_mfma_f32_16x16x32_bf16 v[204:207], v[36:39], a[60:63], v[204:207]
  ds_read_b128 a[80:83], v15 offset:16384
  s_waitcnt lgkmcnt(7)
  v_mfma_f32_16x16x32_bf16 v[208:211], v[40:43], a[32:35], v[208:211]
  ds_read_b64_tr_b16 v[56:57], v9 offset:24576
  v_mfma_f32_16x16x32_bf16 v[208:211], v[44:47], a[48:51], v[208:211]
  ds_read_b64_tr_b16 v[58:59], v9 offset:25088
  v_mfma_f32_16x16x32_bf16 v[212:215], v[40:43], a[36:39], v[212:215]
  buffer_load_dwordx4 v[64:67], v1, s[32:35], s88 offen offset:0
  v_mfma_f32_16x16x32_bf16 v[212:215], v[44:47], a[52:55], v[212:215]
  ds_read_b128 a[84:87], v15 offset:18432
  v_mfma_f32_16x16x32_bf16 v[216:219], v[40:43], a[40:43], v[216:219]
  ds_read_b64_tr_b16 v[60:61], v9 offset:28672
  v_mfma_f32_16x16x32_bf16 v[216:219], v[44:47], a[56:59], v[216:219]
  ds_read_b64_tr_b16 v[62:63], v9 offset:29184
  v_mfma_f32_16x16x32_bf16 v[220:223], v[40:43], a[44:47], v[220:223]
  buffer_load_dwordx4 v[68:71], v1, s[32:35], s88 offen offset:1024
  v_mfma_f32_16x16x32_bf16 v[220:223], v[44:47], a[60:63], v[220:223]
  ds_read_b128 a[88:91], v15 offset:20480
  s_waitcnt vmcnt(15)
  s_barrier
  s_waitcnt lgkmcnt(7)
  v_mfma_f32_16x16x32_bf16 v[224:227], v[48:51], a[32:35], v[224:227]
  ds_read_b64_tr_b16 v[32:33], v6 offset:32768
  v_mfma_f32_16x16x32_bf16 v[224:227], v[52:55], a[48:51], v[224:227]
  ds_read_b64_tr_b16 v[34:35], v6 offset:33280
  v_mfma_f32_16x16x32_bf16 v[228:231], v[48:51], a[36:39], v[228:231]
  s_add_u32 m0, s83, 8192
  s_add_u32 s91, s78, 512
  buffer_load_dwordx4 v10, s[12:15], s91 offen offset:0 lds
  v_mfma_f32_16x16x32_bf16 v[228:231], v[52:55], a[52:55], v[228:231]
  ds_read_b128 a[92:95], v15 offset:22528
  v_mfma_f32_16x16x32_bf16 v[232:235], v[48:51], a[40:43], v[232:235]
  ds_read_b64_tr_b16 v[36:37], v6 offset:36864
  v_mfma_f32_16x16x32_bf16 v[232:235], v[52:55], a[56:59], v[232:235]
  ds_read_b64_tr_b16 v[38:39], v6 offset:37376
  v_mfma_f32_16x16x32_bf16 v[236:239], v[48:51], a[44:47], v[236:239]
  buffer_load_dwordx4 v11, s[12:15], s91 offen offset:1024 lds
  v_mfma_f32_16x16x32_bf16 v[236:239], v[52:55], a[60:63], v[236:239]
  s_waitcnt lgkmcnt(6)
  v_mfma_f32_16x16x32_bf16 v[240:243], v[56:59], a[32:35], v[240:243]
  ds_read_b64_tr_b16 v[40:41], v7 offset:32768
  v_mfma_f32_16x16x32_bf16 v[240:243], v[60:63], a[48:51], v[240:243]
  ds_read_b64_tr_b16 v[42:43], v7 offset:33280
  v_mfma_f32_16x16x32_bf16 v[244:247], v[56:59], a[36:39], v[244:247]
  buffer_load_dwordx4 v12, s[12:15], s91 offen offset:2048 lds
  v_mfma_f32_16x16x32_bf16 v[244:247], v[60:63], a[52:55], v[244:247]
  v_mfma_f32_16x16x32_bf16 v[248:251], v[56:59], a[40:43], v[248:251]
  ds_read_b64_tr_b16 v[44:45], v7 offset:36864
  v_mfma_f32_16x16x32_bf16 v[248:251], v[60:63], a[56:59], v[248:251]
  ds_read_b64_tr_b16 v[46:47], v7 offset:37376
  v_mfma_f32_16x16x32_bf16 v[252:255], v[56:59], a[44:47], v[252:255]
  buffer_load_dwordx4 v13, s[12:15], s91 offen offset:3072 lds
  v_mfma_f32_16x16x32_bf16 v[252:255], v[60:63], a[60:63], v[252:255]
  s_waitcnt lgkmcnt(4)
  v_mfma_f32_16x16x32_bf16 v[128:131], v[32:35], a[64:67], v[128:131]
  ds_read_b64_tr_b16 v[48:49], v8 offset:32768
  v_mfma_f32_16x16x32_bf16 v[128:131], v[36:39], a[80:83], v[128:131]
  ds_read_b64_tr_b16 v[50:51], v8 offset:33280
  v_mfma_f32_16x16x32_bf16 v[132:135], v[32:35], a[68:71], v[132:135]
  s_add_u32 m0, s83, 12288
  s_add_u32 s91, s78, 33280
  buffer_load_dwordx4 v10, s[12:15], s91 offen offset:0 lds
  v_mfma_f32_16x16x32_bf16 v[132:135], v[36:39], a[84:87], v[132:135]
  v_mfma_f32_16x16x32_bf16 v[136:139], v[32:35], a[72:75], v[136:139]
  ds_read_b64_tr_b16 v[52:53], v8 offset:36864
  v_mfma_f32_16x16x32_bf16 v[136:139], v[36:39], a[88:91], v[136:139]
  ds_read_b64_tr_b16 v[54:55], v8 offset:37376
  v_mfma_f32_16x16x32_bf16 v[140:143], v[32:35], a[76:79], v[140:143]
  buffer_load_dwordx4 v11, s[12:15], s91 offen offset:1024 lds
  v_mfma_f32_16x16x32_bf16 v[140:143], v[36:39], a[92:95], v[140:143]
  s_waitcnt lgkmcnt(4)
  v_mfma_f32_16x16x32_bf16 v[144:147], v[40:43], a[64:67], v[144:147]
  ds_read_b64_tr_b16 v[56:57], v9 offset:32768
  v_mfma_f32_16x16x32_bf16 v[144:147], v[44:47], a[80:83], v[144:147]
  ds_read_b64_tr_b16 v[58:59], v9 offset:33280
  v_mfma_f32_16x16x32_bf16 v[148:151], v[40:43], a[68:71], v[148:151]
  buffer_load_dwordx4 v12, s[12:15], s91 offen offset:2048 lds
  v_mfma_f32_16x16x32_bf16 v[148:151], v[44:47], a[84:87], v[148:151]
  v_mfma_f32_16x16x32_bf16 v[152:155], v[40:43], a[72:75], v[152:155]
  ds_read_b64_tr_b16 v[60:61], v9 offset:36864
  v_mfma_f32_16x16x32_bf16 v[152:155], v[44:47], a[88:91], v[152:155]
  ds_read_b64_tr_b16 v[62:63], v9 offset:37376
  v_mfma_f32_16x16x32_bf16 v[156:159], v[40:43], a[76:79], v[156:159]
  buffer_load_dwordx4 v13, s[12:15], s91 offen offset:3072 lds
  v_mfma_f32_16x16x32_bf16 v[156:159], v[44:47], a[92:95], v[156:159]
  s_waitcnt lgkmcnt(4)
  v_mfma_f32_16x16x32_bf16 v[160:163], v[48:51], a[64:67], v[160:163]
  ds_read_b64_tr_b16 v[32:33], v6 offset:40960
  v_mfma_f32_16x16x32_bf16 v[160:163], v[52:55], a[80:83], v[160:163]
  ds_read_b64_tr_b16 v[34:35], v6 offset:41472
  v_mfma_f32_16x16x32_bf16 v[164:167], v[48:51], a[68:71], v[164:167]
  s_add_u32 m0, s84, 0
  s_add_u32 s77, s79, 2097152
  buffer_load_dwordx4 v2, s[16:19], s77 offen offset:0 nt lds
  v_mfma_f32_16x16x32_bf16 v[164:167], v[52:55], a[84:87], v[164:167]
  v_mfma_f32_16x16x32_bf16 v[168:171], v[48:51], a[72:75], v[168:171]
  ds_read_b64_tr_b16 v[36:37], v6 offset:45056
  v_mfma_f32_16x16x32_bf16 v[168:171], v[52:55], a[88:91], v[168:171]
  ds_read_b64_tr_b16 v[38:39], v6 offset:45568
  v_mfma_f32_16x16x32_bf16 v[172:175], v[48:51], a[76:79], v[172:175]
  buffer_load_dwordx4 v3, s[16:19], s77 offen offset:1024 nt lds
  v_mfma_f32_16x16x32_bf16 v[172:175], v[52:55], a[92:95], v[172:175]
  s_waitcnt vmcnt(17)
  ds_read_b128 a[96:99], v14 offset:0
  s_waitcnt lgkmcnt(5)
  v_mfma_f32_16x16x32_bf16 v[176:179], v[56:59], a[64:67], v[176:179]
  ds_read_b64_tr_b16 v[40:41], v7 offset:40960
  v_mfma_f32_16x16x32_bf16 v[176:179], v[60:63], a[80:83], v[176:179]
  ds_read_b64_tr_b16 v[42:43], v7 offset:41472
  v_mfma_f32_16x16x32_bf16 v[180:183], v[56:59], a[68:71], v[180:183]
  buffer_load_dwordx4 v4, s[16:19], s77 offen offset:2048 nt lds
  v_mfma_f32_16x16x32_bf16 v[180:183], v[60:63], a[84:87], v[180:183]
  ds_read_b128 a[100:103], v14 offset:2048
  v_mfma_f32_16x16x32_bf16 v[184:187], v[56:59], a[72:75], v[184:187]
  ds_read_b64_tr_b16 v[44:45], v7 offset:45056
  v_mfma_f32_16x16x32_bf16 v[184:187], v[60:63], a[88:91], v[184:187]
  ds_read_b64_tr_b16 v[46:47], v7 offset:45568
  v_mfma_f32_16x16x32_bf16 v[188:191], v[56:59], a[76:79], v[188:191]
  buffer_load_dwordx4 v5, s[16:19], s77 offen offset:3072 nt lds
  v_mfma_f32_16x16x32_bf16 v[188:191], v[60:63], a[92:95], v[188:191]
  ds_read_b128 a[104:107], v14 offset:4096
  s_waitcnt lgkmcnt(7)
  v_mfma_f32_16x16x32_bf16 v[192:195], v[32:35], a[64:67], v[192:195]
  ds_read_b64_tr_b16 v[48:49], v8 offset:40960
  v_mfma_f32_16x16x32_bf16 v[192:195], v[36:39], a[80:83], v[192:195]
  ds_read_b64_tr_b16 v[50:51], v8 offset:41472
  v_mfma_f32_16x16x32_bf16 v[196:199], v[32:35], a[68:71], v[196:199]
  s_add_u32 m0, s83, 16384
  s_add_u32 s91, s78, 640
  buffer_load_dwordx4 v10, s[12:15], s91 offen offset:0 lds
  v_mfma_f32_16x16x32_bf16 v[196:199], v[36:39], a[84:87], v[196:199]
  ds_read_b128 a[108:111], v14 offset:6144
  v_mfma_f32_16x16x32_bf16 v[200:203], v[32:35], a[72:75], v[200:203]
  ds_read_b64_tr_b16 v[52:53], v8 offset:45056
  v_mfma_f32_16x16x32_bf16 v[200:203], v[36:39], a[88:91], v[200:203]
  ds_read_b64_tr_b16 v[54:55], v8 offset:45568
  v_mfma_f32_16x16x32_bf16 v[204:207], v[32:35], a[76:79], v[204:207]
  buffer_load_dwordx4 v11, s[12:15], s91 offen offset:1024 lds
  v_mfma_f32_16x16x32_bf16 v[204:207], v[36:39], a[92:95], v[204:207]
  ds_read_b128 a[112:115], v15 offset:0
  s_waitcnt lgkmcnt(7)
  v_mfma_f32_16x16x32_bf16 v[208:211], v[40:43], a[64:67], v[208:211]
  ds_read_b64_tr_b16 v[56:57], v9 offset:40960
  v_mfma_f32_16x16x32_bf16 v[208:211], v[44:47], a[80:83], v[208:211]
  ds_read_b64_tr_b16 v[58:59], v9 offset:41472
  v_mfma_f32_16x16x32_bf16 v[212:215], v[40:43], a[68:71], v[212:215]
  buffer_load_dwordx4 v12, s[12:15], s91 offen offset:2048 lds
  v_mfma_f32_16x16x32_bf16 v[212:215], v[44:47], a[84:87], v[212:215]
  ds_read_b128 a[116:119], v15 offset:2048
  v_mfma_f32_16x16x32_bf16 v[216:219], v[40:43], a[72:75], v[216:219]
  ds_read_b64_tr_b16 v[60:61], v9 offset:45056
  v_mfma_f32_16x16x32_bf16 v[216:219], v[44:47], a[88:91], v[216:219]
  ds_read_b64_tr_b16 v[62:63], v9 offset:45568
  v_mfma_f32_16x16x32_bf16 v[220:223], v[40:43], a[76:79], v[220:223]
  buffer_load_dwordx4 v13, s[12:15], s91 offen offset:3072 lds
  v_mfma_f32_16x16x32_bf16 v[220:223], v[44:47], a[92:95], v[220:223]
  ds_read_b128 a[120:123], v15 offset:4096
  s_waitcnt vmcnt(19)
  s_barrier
  s_waitcnt lgkmcnt(7)
  v_mfma_f32_16x16x32_bf16 v[224:227], v[48:51], a[64:67], v[224:227]
  ds_read_b64_tr_b16 v[32:33], v6 offset:49152
  v_mfma_f32_16x16x32_bf16 v[224:227], v[52:55], a[80:83], v[224:227]
  ds_read_b64_tr_b16 v[34:35], v6 offset:49664
  v_mfma_f32_16x16x32_bf16 v[228:231], v[48:51], a[68:71], v[228:231]
  s_add_u32 m0, s83, 20480
  s_add_u32 s91, s78, 33408
  buffer_load_dwordx4 v10, s[12:15], s91 offen offset:0 lds
  v_mfma_f32_16x16x32_bf16 v[228:231], v[52:55], a[84:87], v[228:231]
  ds_read_b128 a[124:127], v15 offset:6144
  v_mfma_f32_16x16x32_bf16 v[232:235], v[48:51], a[72:75], v[232:235]
  ds_read_b64_tr_b16 v[36:37], v6 offset:53248
  v_mfma_f32_16x16x32_bf16 v[232:235], v[52:55], a[88:91], v[232:235]
  ds_read_b64_tr_b16 v[38:39], v6 offset:53760
  v_mfma_f32_16x16x32_bf16 v[236:239], v[48:51], a[76:79], v[236:239]
  buffer_load_dwordx4 v11, s[12:15], s91 offen offset:1024 lds
  v_mfma_f32_16x16x32_bf16 v[236:239], v[52:55], a[92:95], v[236:239]
  s_waitcnt lgkmcnt(6)
  v_mfma_f32_16x16x32_bf16 v[240:243], v[56:59], a[64:67], v[240:243]
  ds_read_b64_tr_b16 v[40:41], v7 offset:49152
  v_mfma_f32_16x16x32_bf16 v[240:243], v[60:63], a[80:83], v[240:243]
  ds_read_b64_tr_b16 v[42:43], v7 offset:49664
  v_mfma_f32_16x16x32_bf16 v[244:247], v[56:59], a[68:71], v[244:247]
  buffer_load_dwordx4 v12, s[12:15], s91 offen offset:2048 lds
  v_mfma_f32_16x16x32_bf16 v[244:247], v[60:63], a[84:87], v[244:247]
  v_mfma_f32_16x16x32_bf16 v[248:251], v[56:59], a[72:75], v[248:251]
  ds_read_b64_tr_b16 v[44:45], v7 offset:53248
  v_mfma_f32_16x16x32_bf16 v[248:251], v[60:63], a[88:91], v[248:251]
  ds_read_b64_tr_b16 v[46:47], v7 offset:53760
  v_mfma_f32_16x16x32_bf16 v[252:255], v[56:59], a[76:79], v[252:255]
  buffer_load_dwordx4 v13, s[12:15], s91 offen offset:3072 lds
  v_mfma_f32_16x16x32_bf16 v[252:255], v[60:63], a[92:95], v[252:255]
  s_waitcnt lgkmcnt(4)
  v_mfma_f32_16x16x32_bf16 v[128:131], v[32:35], a[96:99], v[128:131]
  ds_read_b64_tr_b16 v[48:49], v8 offset:49152
  v_mfma_f32_16x16x32_bf16 v[128:131], v[36:39], a[112:115], v[128:131]
  ds_read_b64_tr_b16 v[50:51], v8 offset:49664
  v_mfma_f32_16x16x32_bf16 v[132:135], v[32:35], a[100:103], v[132:135]
  s_add_u32 m0, s84, 16384
  s_add_u32 s77, s79, 2621440
  buffer_load_dwordx4 v2, s[16:19], s77 offen offset:0 nt lds
  v_mfma_f32_16x16x32_bf16 v[132:135], v[36:39], a[116:119], v[132:135]
  v_mfma_f32_16x16x32_bf16 v[136:139], v[32:35], a[104:107], v[136:139]
  ds_read_b64_tr_b16 v[52:53], v8 offset:53248
  v_mfma_f32_16x16x32_bf16 v[136:139], v[36:39], a[120:123], v[136:139]
  ds_read_b64_tr_b16 v[54:55], v8 offset:53760
  v_mfma_f32_16x16x32_bf16 v[140:143], v[32:35], a[108:111], v[140:143]
  buffer_load_dwordx4 v3, s[16:19], s77 offen offset:1024 nt lds
  v_mfma_f32_16x16x32_bf16 v[140:143], v[36:39], a[124:127], v[140:143]
  s_waitcnt lgkmcnt(4)
  v_mfma_f32_16x16x32_bf16 v[144:147], v[40:43], a[96:99], v[144:147]
  ds_read_b64_tr_b16 v[56:57], v9 offset:49152
  v_mfma_f32_16x16x32_bf16 v[144:147], v[44:47], a[112:115], v[144:147]
  ds_read_b64_tr_b16 v[58:59], v9 offset:49664
  v_mfma_f32_16x16x32_bf16 v[148:151], v[40:43], a[100:103], v[148:151]
  buffer_load_dwordx4 v4, s[16:19], s77 offen offset:2048 nt lds
  v_mfma_f32_16x16x32_bf16 v[148:151], v[44:47], a[116:119], v[148:151]
  s_waitcnt vmcnt(23)
  v_lshlrev_b32 v72, 16, v64
  v_mfma_f32_16x16x32_bf16 v[152:155], v[40:43], a[104:107], v[152:155]
  ds_read_b64_tr_b16 v[60:61], v9 offset:53248
  v_and_b32 v73, 0xffff0000, v64
  v_mfma_f32_16x16x32_bf16 v[152:155], v[44:47], a[120:123], v[152:155]
  ds_read_b64_tr_b16 v[62:63], v9 offset:53760
  v_lshlrev_b32 v80, 16, v68
  v_mfma_f32_16x16x32_bf16 v[156:159], v[40:43], a[108:111], v[156:159]
  buffer_load_dwordx4 v5, s[16:19], s77 offen offset:3072 nt lds
  v_and_b32 v81, 0xffff0000, v68
  v_mfma_f32_16x16x32_bf16 v[156:159], v[44:47], a[124:127], v[156:159]
  v_lshlrev_b32 v74, 16, v65
  s_waitcnt lgkmcnt(4)
  v_mfma_f32_16x16x32_bf16 v[160:163], v[48:51], a[96:99], v[160:163]
  ds_read_b64_tr_b16 v[32:33], v6 offset:57344
  v_and_b32 v75, 0xffff0000, v65
  v_mfma_f32_16x16x32_bf16 v[160:163], v[52:55], a[112:115], v[160:163]
  ds_read_b64_tr_b16 v[34:35], v6 offset:57856
  v_lshlrev_b32 v82, 16, v69
  v_mfma_f32_16x16x32_bf16 v[164:167], v[48:51], a[100:103], v[164:167]
  s_add_u32 m0, s83, 0
  s_add_u32 s91, s78, 768
  buffer_load_dwordx4 v10, s[12:15], s91 offen offset:0 lds
  v_mfma_f32_16x16x32_bf16 v[164:167], v[52:55], a[116:119], v[164:167]
  v_and_b32 v83, 0xffff0000, v69
  v_lshlrev_b32 v76, 16, v66
  v_mfma_f32_16x16x32_bf16 v[168:171], v[48:51], a[104:107], v[168:171]
  ds_read_b64_tr_b16 v[36:37], v6 offset:61440
  v_and_b32 v77, 0xffff0000, v66
  v_mfma_f32_16x16x32_bf16 v[168:171], v[52:55], a[120:123], v[168:171]
  ds_read_b64_tr_b16 v[38:39], v6 offset:61952
  v_mfma_f32_16x16x32_bf16 v[172:175], v[48:51], a[108:111], v[172:175]
  buffer_load_dwordx4 v11, s[12:15], s91 offen offset:1024 lds
  v_lshlrev_b32 v84, 16, v70
  v_mfma_f32_16x16x32_bf16 v[172:175], v[52:55], a[124:127], v[172:175]
  s_waitcnt vmcnt(18)
  ds_read_b128 a[128:131], v14 offset:8192
  s_waitcnt lgkmcnt(5)
  v_mfma_f32_16x16x32_bf16 v[176:179], v[56:59], a[96:99], v[176:179]
  ds_read_b64_tr_b16 v[40:41], v7 offset:57344
  v_and_b32 v85, 0xffff0000, v70
  v_mfma_f32_16x16x32_bf16 v[176:179], v[60:63], a[112:115], v[176:179]
  ds_read_b64_tr_b16 v[42:43], v7 offset:57856
  v_lshlrev_b32 v78, 16, v67
  v_mfma_f32_16x16x32_bf16 v[180:183], v[56:59], a[100:103], v[180:183]
  buffer_load_dwordx4 v12, s[12:15], s91 offen offset:2048 lds
  v_and_b32 v79, 0xffff0000, v67
  v_mfma_f32_16x16x32_bf16 v[180:183], v[60:63], a[116:119], v[180:183]
  ds_read_b128 a[132:135], v14 offset:10240
  v_mfma_f32_16x16x32_bf16 v[184:187], v[56:59], a[104:107], v[184:187]
  ds_read_b64_tr_b16 v[44:45], v7 offset:61440
  v_lshlrev_b32 v86, 16, v71
  v_mfma_f32_16x16x32_bf16 v[184:187], v[60:63], a[120:123], v[184:187]
  ds_read_b64_tr_b16 v[46:47], v7 offset:61952
  v_and_b32 v87, 0xffff0000, v71
  v_mfma_f32_16x16x32_bf16 v[188:191], v[56:59], a[108:111], v[188:191]
  buffer_load_dwordx4 v13, s[12:15], s91 offen offset:3072 lds
  v_add_f32 v88, v72, v73
  v_mfma_f32_16x16x32_bf16 v[188:191], v[60:63], a[124:127], v[188:191]
  ds_read_b128 a[136:139], v14 offset:12288
  s_waitcnt lgkmcnt(7)
  v_mfma_f32_16x16x32_bf16 v[192:195], v[32:35], a[96:99], v[192:195]
  ds_read_b64_tr_b16 v[48:49], v8 offset:57344
  v_add_f32 v89, v80, v81
  v_mfma_f32_16x16x32_bf16 v[192:195], v[36:39], a[112:115], v[192:195]
  ds_read_b64_tr_b16 v[50:51], v8 offset:57856
  v_add_f32 v88, v88, v74
  v_mfma_f32_16x16x32_bf16 v[196:199], v[32:35], a[100:103], v[196:199]
  buffer_load_dword v24, v20, s[36:39], 0 offen sc1
  v_mfma_f32_16x16x32_bf16 v[196:199], v[36:39], a[116:119], v[196:199]
  ds_read_b128 a[140:143], v14 offset:14336
  v_add_f32 v89, v89, v82
  v_mfma_f32_16x16x32_bf16 v[200:203], v[32:35], a[104:107], v[200:203]
  ds_read_b64_tr_b16 v[52:53], v8 offset:61440
  v_add_f32 v88, v88, v75
  v_mfma_f32_16x16x32_bf16 v[200:203], v[36:39], a[120:123], v[200:203]
  ds_read_b64_tr_b16 v[54:55], v8 offset:61952
  v_mfma_f32_16x16x32_bf16 v[204:207], v[32:35], a[108:111], v[204:207]
  s_add_u32 m0, s83, 4096
  s_add_u32 s91, s78, 33536
  buffer_load_dwordx4 v10, s[12:15], s91 offen offset:0 lds
  v_mfma_f32_16x16x32_bf16 v[204:207], v[36:39], a[124:127], v[204:207]
  ds_read_b128 a[144:147], v15 offset:8192
  s_waitcnt lgkmcnt(7)
  v_mfma_f32_16x16x32_bf16 v[208:211], v[40:43], a[96:99], v[208:211]
  ds_read_b64_tr_b16 v[56:57], v9 offset:57344
  v_add_f32 v89, v89, v83
  v_mfma_f32_16x16x32_bf16 v[208:211], v[44:47], a[112:115], v[208:211]
  ds_read_b64_tr_b16 v[58:59], v9 offset:57856
  v_add_f32 v88, v88, v76
  v_mfma_f32_16x16x32_bf16 v[212:215], v[40:43], a[100:103], v[212:215]
  buffer_load_dwordx4 v11, s[12:15], s91 offen offset:1024 lds
  v_add_f32 v89, v89, v84
  v_mfma_f32_16x16x32_bf16 v[212:215], v[44:47], a[116:119], v[212:215]
  ds_read_b128 a[148:151], v15 offset:10240
  v_add_f32 v88, v88, v77
  v_mfma_f32_16x16x32_bf16 v[216:219], v[40:43], a[104:107], v[216:219]
  ds_read_b64_tr_b16 v[60:61], v9 offset:61440
  v_add_f32 v89, v89, v85
  v_mfma_f32_16x16x32_bf16 v[216:219], v[44:47], a[120:123], v[216:219]
  ds_read_b64_tr_b16 v[62:63], v9 offset:61952
  v_add_f32 v88, v88, v78
  v_mfma_f32_16x16x32_bf16 v[220:223], v[40:43], a[108:111], v[220:223]
  buffer_load_dwordx4 v12, s[12:15], s91 offen offset:2048 lds
  v_add_f32 v89, v89, v86
  v_mfma_f32_16x16x32_bf16 v[220:223], v[44:47], a[124:127], v[220:223]
  ds_read_b128 a[152:155], v15 offset:12288
  s_waitcnt vmcnt(20)
  s_barrier
  s_waitcnt lgkmcnt(7)
  v_mfma_f32_16x16x32_bf16 v[224:227], v[48:51], a[96:99], v[224:227]
  ds_read_b64_tr_b16 v[32:33], v6 offset:0
  v_add_f32 v88, v88, v79
  v_mfma_f32_16x16x32_bf16 v[224:227], v[52:55], a[112:115], v[224:227]
  ds_read_b64_tr_b16 v[34:35], v6 offset:512
  v_add_f32 v89, v89, v87
  v_mfma_f32_16x16x32_bf16 v[228:231], v[48:51], a[100:103], v[228:231]
  buffer_load_dwordx4 v13, s[12:15], s91 offen offset:3072 lds
  v_add_f32_dpp v88, v88, v88 quad_perm:[1,0,3,2] row_mask:0xf bank_mask:0xf
  v_mfma_f32_16x16x32_bf16 v[228:231], v[52:55], a[116:119], v[228:231]
  ds_read_b128 a[156:159], v15 offset:14336
  v_mfma_f32_16x16x32_bf16 v[232:235], v[48:51], a[104:107], v[232:235]
  ds_read_b64_tr_b16 v[36:37], v6 offset:4096
  v_add_f32_dpp v89, v89, v89 quad_perm:[1,0,3,2] row_mask:0xf bank_mask:0xf
  v_mfma_f32_16x16x32_bf16 v[232:235], v[52:55], a[120:123], v[232:235]
  ds_read_b64_tr_b16 v[38:39], v6 offset:4608
  v_add_f32_dpp v88, v88, v88 quad_perm:[2,3,0,1] row_mask:0xf bank_mask:0xf
  v_mfma_f32_16x16x32_bf16 v[236:239], v[48:51], a[108:111], v[236:239]
  s_add_u32 m0, s84, 32768
  s_add_u32 s77, s79, 3145728
  buffer_load_dwordx4 v2, s[16:19], s77 offen offset:0 nt lds
  v_mfma_f32_16x16x32_bf16 v[236:239], v[52:55], a[124:127], v[236:239]
  v_add_f32_dpp v89, v89, v89 quad_perm:[2,3,0,1] row_mask:0xf bank_mask:0xf
  s_waitcnt lgkmcnt(6)
  v_mfma_f32_16x16x32_bf16 v[240:243], v[56:59], a[96:99], v[240:243]
  ds_read_b64_tr_b16 v[40:41], v7 offset:0
  v_add_f32_dpp v88, v88, v88 row_ror:4 row_mask:0xf bank_mask:0xf
  v_mfma_f32_16x16x32_bf16 v[240:243], v[60:63], a[112:115], v[240:243]
  ds_read_b64_tr_b16 v[42:43], v7 offset:512
  v_mfma_f32_16x16x32_bf16 v[244:247], v[56:59], a[100:103], v[244:247]
  buffer_load_dwordx4 v3, s[16:19], s77 offen offset:1024 nt lds
  v_add_f32_dpp v89, v89, v89 row_ror:4 row_mask:0xf bank_mask:0xf
  v_mfma_f32_16x16x32_bf16 v[244:247], v[60:63], a[116:119], v[244:247]
  v_add_f32_dpp v88, v88, v88 row_ror:8 row_mask:0xf bank_mask:0xf
  v_mfma_f32_16x16x32_bf16 v[248:251], v[56:59], a[104:107], v[248:251]
  ds_read_b64_tr_b16 v[44:45], v7 offset:4096
  v_add_f32_dpp v89, v89, v89 row_ror:8 row_mask:0xf bank_mask:0xf
  v_mfma_f32_16x16x32_bf16 v[248:251], v[60:63], a[120:123], v[248:251]
  ds_read_b64_tr_b16 v[46:47], v7 offset:4608
  v_mfma_f32_16x16x32_bf16 v[252:255], v[56:59], a[108:111], v[252:255]
  buffer_load_dwordx4 v4, s[16:19], s77 offen offset:2048 nt lds
  v_permlane16_swap_b32 v88, v89
  v_mfma_f32_16x16x32_bf16 v[252:255], v[60:63], a[124:127], v[252:255]
  s_waitcnt lgkmcnt(4)
  v_mfma_f32_16x16x32_bf16 v[128:131], v[32:35], a[128:131], v[128:131]
  ds_read_b64_tr_b16 v[48:49], v8 offset:0
  v_add_f32 v88, v88, v89
  v_mfma_f32_16x16x32_bf16 v[128:131], v[36:39], a[144:147], v[128:131]
  ds_read_b64_tr_b16 v[50:51], v8 offset:512
  v_mov_b32 v89, v88
  v_mfma_f32_16x16x32_bf16 v[132:135], v[32:35], a[132:135], v[132:135]
  buffer_load_dwordx4 v5, s[16:19], s77 offen offset:3072 nt lds
  v_permlane32_swap_b32 v88, v89
  v_mfma_f32_16x16x32_bf16 v[132:135], v[36:39], a[148:151], v[132:135]
  v_mfma_f32_16x16x32_bf16 v[136:139], v[32:35], a[136:139], v[136:139]
  ds_read_b64_tr_b16 v[52:53], v8 offset:4096
  v_add_f32 v88, v88, v89
  v_mfma_f32_16x16x32_bf16 v[136:139], v[36:39], a[152:155], v[136:139]
  ds_read_b64_tr_b16 v[54:55], v8 offset:4608
  v_mul_f32 v88, 0x3b000000, v88
  v_mfma_f32_16x16x32_bf16 v[140:143], v[32:35], a[140:143], v[140:143]
  s_add_u32 m0, s83, 8192
  s_add_u32 s91, s78, 896
  buffer_load_dwordx4 v10, s[12:15], s91 offen offset:0 lds
  v_mfma_f32_16x16x32_bf16 v[140:143], v[36:39], a[156:159], v[140:143]
  v_readlane_b32 s85, v88, 0
  s_waitcnt lgkmcnt(4)
  v_mfma_f32_16x16x32_bf16 v[144:147], v[40:43], a[128:131], v[144:147]
  ds_read_b64_tr_b16 v[56:57], v9 offset:0
  v_readlane_b32 s86, v88, 16
  v_mfma_f32_16x16x32_bf16 v[144:147], v[44:47], a[144:147], v[144:147]
  ds_read_b64_tr_b16 v[58:59], v9 offset:512
  v_subrev_f32 v72, s85, v72
  v_mfma_f32_16x16x32_bf16 v[148:151], v[40:43], a[132:135], v[148:151]
  buffer_load_dwordx4 v11, s[12:15], s91 offen offset:1024 lds
  v_mfma_f32_16x16x32_bf16 v[148:151], v[44:47], a[148:151], v[148:151]
  v_subrev_f32 v80, s86, v80
  v_mfma_f32_16x16x32_bf16 v[152:155], v[40:43], a[136:139], v[152:155]
  ds_read_b64_tr_b16 v[60:61], v9 offset:4096
  v_subrev_f32 v73, s85, v73
  v_mfma_f32_16x16x32_bf16 v[152:155], v[44:47], a[152:155], v[152:155]
  ds_read_b64_tr_b16 v[62:63], v9 offset:4608
  v_mfma_f32_16x16x32_bf16 v[156:159], v[40:43], a[140:143], v[156:159]
  buffer_load_dwordx4 v12, s[12:15], s91 offen offset:2048 lds
  v_subrev_f32 v81, s86, v81
  v_mfma_f32_16x16x32_bf16 v[156:159], v[44:47], a[156:159], v[156:159]
  v_subrev_f32 v74, s85, v74
  s_waitcnt lgkmcnt(4)
  v_mfma_f32_16x16x32_bf16 v[160:163], v[48:51], a[128:131], v[160:163]
  ds_read_b64_tr_b16 v[32:33], v6 offset:8192
  v_subrev_f32 v82, s86, v82
  v_mfma_f32_16x16x32_bf16 v[160:163], v[52:55], a[144:147], v[160:163]
  ds_read_b64_tr_b16 v[34:35], v6 offset:8704
  v_mfma_f32_16x16x32_bf16 v[164:167], v[48:51], a[132:135], v[164:167]
  buffer_load_dwordx4 v13, s[12:15], s91 offen offset:3072 lds
  v_subrev_f32 v75, s85, v75
  v_mfma_f32_16x16x32_bf16 v[164:167], v[52:55], a[148:151], v[164:167]
  v_subrev_f32 v83, s86, v83
  v_mfma_f32_16x16x32_bf16 v[168:171], v[48:51], a[136:139], v[168:171]
  ds_read_b64_tr_b16 v[36:37], v6 offset:12288
  v_mfma_f32_16x16x32_bf16 v[168:171], v[52:55], a[152:155], v[168:171]
  ds_read_b64_tr_b16 v[38:39], v6 offset:12800
  v_subrev_f32 v76, s85, v76
  v_mfma_f32_16x16x32_bf16 v[172:175], v[48:51], a[140:143], v[172:175]
  s_add_u32 m0, s83, 12288
  s_add_u32 s91, s78, 33664
  buffer_load_dwordx4 v10, s[12:15], s91 offen offset:0 lds
  v_mfma_f32_16x16x32_bf16 v[172:175], v[52:55], a[156:159], v[172:175]
  s_waitcnt vmcnt(22)
  ds_read_b128 a[160:163], v14 offset:16384
  s_waitcnt lgkmcnt(5)
  v_mfma_f32_16x16x32_bf16 v[176:179], v[56:59], a[128:131], v[176:179]
  ds_read_b64_tr_b16 v[40:41], v7 offset:8192
  v_subrev_f32 v84, s86, v84
  v_mfma_f32_16x16x32_bf16 v[176:179], v[60:63], a[144:147], v[176:179]
  ds_read_b64_tr_b16 v[42:43], v7 offset:8704
  v_subrev_f32 v77, s85, v77
  v_mfma_f32_16x16x32_bf16 v[180:183], v[56:59], a[132:135], v[180:183]
  buffer_load_dwordx4 v11, s[12:15], s91 offen offset:1024 lds
  v_subrev_f32 v85, s86, v85
  v_mfma_f32_16x16x32_bf16 v[180:183], v[60:63], a[148:151], v[180:183]
  ds_read_b128 a[164:167], v14 offset:18432
  v_subrev_f32 v78, s85, v78
  v_mfma_f32_16x16x32_bf16 v[184:187], v[56:59], a[136:139], v[184:187]
  ds_read_b64_tr_b16 v[44:45], v7 offset:12288
  v_subrev_f32 v86, s86, v86
  v_mfma_f32_16x16x32_bf16 v[184:187], v[60:63], a[152:155], v[184:187]
  ds_read_b64_tr_b16 v[46:47], v7 offset:12800
  v_subrev_f32 v79, s85, v79
  v_mfma_f32_16x16x32_bf16 v[188:191], v[56:59], a[140:143], v[188:191]
  buffer_load_dwordx4 v12, s[12:15], s91 offen offset:2048 lds
  v_mfma_f32_16x16x32_bf16 v[188:191], v[60:63], a[156:159], v[188:191]
  ds_read_b128 a[168:171], v14 offset:20480
  s_waitcnt lgkmcnt(7)
  v_mfma_f32_16x16x32_bf16 v[192:195], v[32:35], a[128:131], v[192:195]
  ds_read_b64_tr_b16 v[48:49], v8 offset:8192
  v_subrev_f32 v87, s86, v87
  v_mfma_f32_16x16x32_bf16 v[192:195], v[36:39], a[144:147], v[192:195]
  ds_read_b64_tr_b16 v[50:51], v8 offset:8704
  v_mul_f32 v88, v72, v72
  v_mfma_f32_16x16x32_bf16 v[196:199], v[32:35], a[132:135], v[196:199]
  buffer_load_dwordx4 v13, s[12:15], s91 offen offset:3072 lds
  v_mul_f32 v89, v80, v80
  v_mfma_f32_16x16x32_bf16 v[196:199], v[36:39], a[148:151], v[196:199]
  ds_read_b128 a[172:175], v14 offset:22528
  v_fmac_f32 v88, v73, v73
  v_mfma_f32_16x16x32_bf16 v[200:203], v[32:35], a[136:139], v[200:203]
  ds_read_b64_tr_b16 v[52:53], v8 offset:12288
  v_fmac_f32 v89, v81, v81
  v_mfma_f32_16x16x32_bf16 v[200:203], v[36:39], a[152:155], v[200:203]
  ds_read_b64_tr_b16 v[54:55], v8 offset:12800
  v_mfma_f32_16x16x32_bf16 v[204:207], v[32:35], a[140:143], v[204:207]
  v_fmac_f32 v88, v74, v74
  v_mfma_f32_16x16x32_bf16 v[204:207], v[36:39], a[156:159], v[204:207]
  ds_read_b128 a[176:179], v15 offset:16384
  s_waitcnt lgkmcnt(7)
  v_mfma_f32_16x16x32_bf16 v[208:211], v[40:43], a[128:131], v[208:211]
  ds_read_b64_tr_b16 v[56:57], v9 offset:8192
  v_fmac_f32 v89, v82, v82
  v_mfma_f32_16x16x32_bf16 v[208:211], v[44:47], a[144:147], v[208:211]
  ds_read_b64_tr_b16 v[58:59], v9 offset:8704
  s_lshl_b32 s88, s3, 10
  v_mfma_f32_16x16x32_bf16 v[212:215], v[40:43], a[132:135], v[212:215]
  v_fmac_f32 v88, v75, v75
  s_add_u32 s88, s88, 38797312
  v_mfma_f32_16x16x32_bf16 v[212:215], v[44:47], a[148:151], v[212:215]
  ds_read_b128 a[180:183], v15 offset:18432
  v_fmac_f32 v89, v83, v83
  v_mfma_f32_16x16x32_bf16 v[216:219], v[40:43], a[136:139], v[216:219]
  ds_read_b64_tr_b16 v[60:61], v9 offset:12288
  v_fmac_f32 v88, v76, v76
  v_mfma_f32_16x16x32_bf16 v[216:219], v[44:47], a[152:155], v[216:219]
  ds_read_b64_tr_b16 v[62:63], v9 offset:12800
  v_fmac_f32 v89, v84, v84
  v_mfma_f32_16x16x32_bf16 v[220:223], v[40:43], a[140:143], v[220:223]
  v_fmac_f32 v88, v77, v77
  v_mfma_f32_16x16x32_bf16 v[220:223], v[44:47], a[156:159], v[220:223]
  ds_read_b128 a[184:187], v15 offset:20480
  s_waitcnt vmcnt(16)
  s_cmp_lg_u32 s3, 0
  s_cbranch_scc1 Lokf_1
  v_cmp_gt_u32 vcc, 4, v24
  s_nop 0
  s_cmp_lg_u64 vcc, 0
  s_cbranch_scc0 Lokf_1
  s_mov_b32 s90, 0x80000
Lspf_1:
  s_sub_u32 s90, s90, 1
  s_cbranch_scc1 Lokf_1
  s_sleep 1
  buffer_load_dword v24, v20, s[36:39], 0 offen sc1
  s_waitcnt vmcnt(0)
  v_cmp_gt_u32 vcc, 4, v24
  s_nop 0
  s_cmp_lg_u64 vcc, 0
  s_cbranch_scc1 Lspf_1
Lokf_1:
  s_barrier
  s_waitcnt lgkmcnt(7)
  v_mfma_f32_16x16x32_bf16 v[224:227], v[48:51], a[128:131], v[224:227]
  ds_read_b64_tr_b16 v[32:33], v6 offset:16384
  v_fmac_f32 v89, v85, v85
  v_mfma_f32_16x16x32_bf16 v[224:227], v[52:55], a[144:147], v[224:227]
  ds_read_b64_tr_b16 v[34:35], v6 offset:16896
  v_fmac_f32 v88, v78, v78
  v_mfma_f32_16x16x32_bf16 v[228:231], v[48:51], a[132:135], v[228:231]
  buffer_load_dwordx4 v[108:111], v1, s[8:11], s88 offen sc1
  s_add_u32 s88, s88, 12288
  v_mfma_f32_16x16x32_bf16 v[228:231], v[52:55], a[148:151], v[228:231]
  ds_read_b128 a[188:191], v15 offset:22528
  v_fmac_f32 v89, v86, v86
  v_mfma_f32_16x16x32_bf16 v[232:235], v[48:51], a[136:139], v[232:235]
  ds_read_b64_tr_b16 v[36:37], v6 offset:20480
  v_fmac_f32 v88, v79, v79
  v_mfma_f32_16x16x32_bf16 v[232:235], v[52:55], a[152:155], v[232:235]
  ds_read_b64_tr_b16 v[38:39], v6 offset:20992
  v_mfma_f32_16x16x32_bf16 v[236:239], v[48:51], a[140:143], v[236:239]
  buffer_load_dwordx4 v[112:115], v1, s[8:11], s88 offen sc1
  s_add_u32 s88, s88, 12288
  v_mfma_f32_16x16x32_bf16 v[236:239], v[52:55], a[156:159], v[236:239]
  v_fmac_f32 v89, v87, v87
  s_waitcnt lgkmcnt(6)
  v_mfma_f32_16x16x32_bf16 v[240:243], v[56:59], a[128:131], v[240:243]
  ds_read_b64_tr_b16 v[40:41], v7 offset:16384
  v_add_f32_dpp v88, v88, v88 quad_perm:[1,0,3,2] row_mask:0xf bank_mask:0xf
  v_mfma_f32_16x16x32_bf16 v[240:243], v[60:63], a[144:147], v[240:243]
  ds_read_b64_tr_b16 v[42:43], v7 offset:16896
  v_add_f32_dpp v89, v89, v89 quad_perm:[1,0,3,2] row_mask:0xf bank_mask:0xf
  v_mfma_f32_16x16x32_bf16 v[244:247], v[56:59], a[132:135], v[244:247]
  buffer_load_dwordx4 v[116:119], v1, s[8:11], s88 offen sc1
  s_add_u32 s88, s88, 12288
  v_mfma_f32_16x16x32_bf16 v[244:247], v[60:63], a[148:151], v[244:247]
  v_add_f32_dpp v88, v88, v88 quad_perm:[2,3,0,1] row_mask:0xf bank_mask:0xf
  v_add_f32_dpp v89, v89, v89 quad_perm:[2,3,0,1] row_mask:0xf bank_mask:0xf
  v_mfma_f32_16x16x32_bf16 v[248:251], v[56:59], a[136:139], v[248:251]
  ds_read_b64_tr_b16 v[44:45], v7 offset:20480
  v_mfma_f32_16x16x32_bf16 v[248:251], v[60:63], a[152:155], v[248:251]
  ds_read_b64_tr_b16 v[46:47], v7 offset:20992
  v_add_f32_dpp v88, v88, v88 row_ror:4 row_mask:0xf bank_mask:0xf
  v_mfma_f32_16x16x32_bf16 v[252:255], v[56:59], a[140:143], v[252:255]
  buffer_load_dwordx4 v[120:123], v1, s[8:11], s88 offen sc1
  s_add_u32 s88, s88, 12288
  v_mfma_f32_16x16x32_bf16 v[252:255], v[60:63], a[156:159], v[252:255]
  s_waitcnt lgkmcnt(4)
  v_mfma_f32_16x16x32_bf16 v[128:131], v[32:35], a[160:163], v[128:131]
  ds_read_b64_tr_b16 v[48:49], v8 offset:16384
  v_add_f32_dpp v89, v89, v89 row_ror:4 row_mask:0xf bank_mask:0xf
  v_mfma_f32_16x16x32_bf16 v[128:131], v[36:39], a[176:179], v[128:131]
  ds_read_b64_tr_b16 v[50:51], v8 offset:16896
  v_add_f32_dpp v88, v88, v88 row_ror:8 row_mask:0xf bank_mask:0xf
  v_mfma_f32_16x16x32_bf16 v[132:135], v[32:35], a[164:167], v[132:135]
  s_lshl_b32 s88, s6, 10
  s_lshl_b32 s90, s3, 8
  s_add_u32 s88, s88, s90
  s_mul_i32 s90, s5, 12288
  s_add_u32 s90, s90, s88
  s_add_u32 s90, s90, 38862848
  s_add_u32 s88, s88, 38797312
  s_cmp_lt_u32 s6, 12
  s_cselect_b32 s88, s88, 0x7ff00000
  s_cselect_b32 s90, s90, 0x7ff00000
  buffer_load_dword v124, v20, s[8:11], s88 offen sc1
  s_add_u32 s88, s88, 12288
  v_mfma_f32_16x16x32_bf16 v[132:135], v[36:39], a[180:183], v[132:135]
  v_add_f32_dpp v89, v89, v89 row_ror:8 row_mask:0xf bank_mask:0xf
  s_nop 1
  v_permlane16_swap_b32 v88, v89
  v_mfma_f32_16x16x32_bf16 v[136:139], v[32:35], a[168:171], v[136:139]
  ds_read_b64_tr_b16 v[52:53], v8 offset:20480
  v_add_f32 v88, v88, v89
  v_mfma_f32_16x16x32_bf16 v[136:139], v[36:39], a[184:187], v[136:139]
  ds_read_b64_tr_b16 v[54:55], v8 offset:20992
  v_mov_b32 v89, v88
  v_mfma_f32_16x16x32_bf16 v[140:143], v[32:35], a[172:175], v[140:143]
  buffer_load_dword v125, v20, s[8:11], s88 offen sc1
  s_add_u32 s88, s88, 12288
  v_mfma_f32_16x16x32_bf16 v[140:143], v[36:39], a[188:191], v[140:143]
  v_permlane32_swap_b32 v88, v89
  s_waitcnt lgkmcnt(4)
  v_mfma_f32_16x16x32_bf16 v[144:147], v[40:43], a[160:163], v[144:147]
  ds_read_b64_tr_b16 v[56:57], v9 offset:16384
  v_add_f32 v88, v88, v89
  v_mfma_f32_16x16x32_bf16 v[144:147], v[44:47], a[176:179], v[144:147]
  ds_read_b64_tr_b16 v[58:59], v9 offset:16896
  v_mfma_f32_16x16x32_bf16 v[148:151], v[40:43], a[164:167], v[148:151]
  buffer_load_dword v126, v20, s[8:11], s88 offen sc1
  s_add_u32 s88, s88, 12288
  v_mfma_f32_16x16x32_bf16 v[148:151], v[44:47], a[180:183], v[148:151]
  v_mov_b32 v89, 0x3727c5ac
  v_fmac_f32 v89, 0x3b000000, v88
  v_mfma_f32_16x16x32_bf16 v[152:155], v[40:43], a[168:171], v[152:155]
  ds_read_b64_tr_b16 v[60:61], v9 offset:20480
  v_mfma_f32_16x16x32_bf16 v[152:155], v[44:47], a[184:187], v[152:155]
  ds_read_b64_tr_b16 v[62:63], v9 offset:20992
  v_mfma_f32_16x16x32_bf16 v[156:159], v[40:43], a[172:175], v[156:159]
  buffer_load_dword v127, v20, s[8:11], s88 offen sc1
  s_add_u32 s88, s88, 12288
  v_mfma_f32_16x16x32_bf16 v[156:159], v[44:47], a[188:191], v[156:159]
  s_waitcnt lgkmcnt(4)
  v_mfma_f32_16x16x32_bf16 v[160:163], v[48:51], a[160:163], v[160:163]
  ds_read_b64_tr_b16 v[32:33], v6 offset:24576
  v_mfma_f32_16x16x32_bf16 v[160:163], v[52:55], a[176:179], v[160:163]
  ds_read_b64_tr_b16 v[34:35], v6 offset:25088
  v_mfma_f32_16x16x32_bf16 v[164:167], v[48:51], a[164:167], v[164:167]
  s_add_u32 m0, s84, 49152
  s_add_u32 s77, s79, 3670016
  buffer_load_dwordx4 v2, s[16:19], s77 offen offset:0 nt lds
  v_mfma_f32_16x16x32_bf16 v[164:167], v[52:55], a[180:183], v[164:167]
  v_rsq_f32 v88, v89
  v_mfma_f32_16x16x32_bf16 v[168:171], v[48:51], a[168:171], v[168:171]
  ds_read_b64_tr_b16 v[36:37], v6 offset:28672
  v_readlane_b32 s91, v88, 0
  v_mfma_f32_16x16x32_bf16 v[168:171], v[52:55], a[184:187], v[168:171]
  ds_read_b64_tr_b16 v[38:39], v6 offset:29184
  v_readlane_b32 s7, v88, 16
  v_mfma_f32_16x16x32_bf16 v[172:175], v[48:51], a[172:175], v[172:175]
  buffer_load_dwordx4 v3, s[16:19], s77 offen offset:1024 nt lds
  v_mul_f32 v72, s91, v72
  v_mfma_f32_16x16x32_bf16 v[172:175], v[52:55], a[188:191], v[172:175]
  s_waitcnt vmcnt(22)
  ds_read_b128 a[192:195], v14 offset:0
  s_waitcnt lgkmcnt(5)
  v_mfma_f32_16x16x32_bf16 v[176:179], v[56:59], a[160:163], v[176:179]
  ds_read_b64_tr_b16 v[40:41], v7 offset:24576
  v_mul_f32 v80, s7, v80
  v_mfma_f32_16x16x32_bf16 v[176:179], v[60:63], a[176:179], v[176:179]
  ds_read_b64_tr_b16 v[42:43], v7 offset:25088
  v_mul_f32 v73, s91, v73
  v_mfma_f32_16x16x32_bf16 v[180:183], v[56:59], a[164:167], v[180:183]
  buffer_load_dwordx4 v4, s[16:19], s77 offen offset:2048 nt lds
  v_mul_f32 v81, s7, v81
  v_mfma_f32_16x16x32_bf16 v[180:183], v[60:63], a[180:183], v[180:183]
  ds_read_b128 a[196:199], v14 offset:2048
  v_mul_f32 v74, s91, v74
  v_mfma_f32_16x16x32_bf16 v[184:187], v[56:59], a[168:171], v[184:187]
  ds_read_b64_tr_b16 v[44:45], v7 offset:28672
  v_mul_f32 v82, s7, v82
  v_mfma_f32_16x16x32_bf16 v[184:187], v[60:63], a[184:187], v[184:187]
  ds_read_b64_tr_b16 v[46:47], v7 offset:29184
  v_mul_f32 v75, s91, v75
  v_mfma_f32_16x16x32_bf16 v[188:191], v[56:59], a[172:175], v[188:191]
  buffer_load_dwordx4 v5, s[16:19], s77 offen offset:3072 nt lds
  v_mul_f32 v83, s7, v83
  v_mfma_f32_16x16x32_bf16 v[188:191], v[60:63], a[188:191], v[188:191]
  ds_read_b128 a[200:203], v14 offset:4096
  s_waitcnt lgkmcnt(7)
  v_mfma_f32_16x16x32_bf16 v[192:195], v[32:35], a[160:163], v[192:195]
  ds_read_b64_tr_b16 v[48:49], v8 offset:24576
  v_mul_f32 v76, s91, v76
  v_mfma_f32_16x16x32_bf16 v[192:195], v[36:39], a[176:179], v[192:195]
  ds_read_b64_tr_b16 v[50:51], v8 offset:25088
  v_mul_f32 v84, s7, v84
  v_mfma_f32_16x16x32_bf16 v[196:199], v[32:35], a[164:167], v[196:199]
  s_add_u32 m0, s83, 22528
  s_lshr_b32 s32, s3, 1
  s_lshl_b32 s32, s32, 3
  s_add_u32 s32, s32, s5
  s_lshl_b32 s32, s32, 1
  s_and_b32 s33, s3, 1
  s_add_u32 s32, s32, s33
  s_lshl_b32 s32, s32, 15
  s_lshl_b32 s33, s4, 8
  s_add_u32 s32, s32, s33
  s_add_u32 s33, s32, 0
  buffer_load_dwordx4 v97, s[20:23], s33 offen lds
  v_mfma_f32_16x16x32_bf16 v[196:199], v[36:39], a[180:183], v[196:199]
  ds_read_b128 a[204:207], v14 offset:6144
  v_mul_f32 v77, s91, v77
  v_mfma_f32_16x16x32_bf16 v[200:203], v[32:35], a[168:171], v[200:203]
  ds_read_b64_tr_b16 v[52:53], v8 offset:28672
  v_mul_f32 v85, s7, v85
  v_mfma_f32_16x16x32_bf16 v[200:203], v[36:39], a[184:187], v[200:203]
  ds_read_b64_tr_b16 v[54:55], v8 offset:29184
  v_mul_f32 v78, s91, v78
  v_mfma_f32_16x16x32_bf16 v[204:207], v[32:35], a[172:175], v[204:207]
  s_add_u32 s33, s32, 1048576
  buffer_load_dwordx4 v97, s[20:23], s33 offen lds
  v_mfma_f32_16x16x32_bf16 v[204:207], v[36:39], a[188:191], v[204:207]
  ds_read_b128 a[208:211], v15 offset:0
  s_waitcnt lgkmcnt(7)
  v_mfma_f32_16x16x32_bf16 v[208:211], v[40:43], a[160:163], v[208:211]
  ds_read_b64_tr_b16 v[56:57], v9 offset:24576
  v_mul_f32 v86, s7, v86
  v_mfma_f32_16x16x32_bf16 v[208:211], v[44:47], a[176:179], v[208:211]
  ds_read_b64_tr_b16 v[58:59], v9 offset:25088
  v_mul_f32 v79, s91, v79
  v_mfma_f32_16x16x32_bf16 v[212:215], v[40:43], a[164:167], v[212:215]
  s_add_u32 s33, s32, 2097152
  buffer_load_dwordx4 v97, s[20:23], s33 offen lds
  v_mfma_f32_16x16x32_bf16 v[212:215], v[44:47], a[180:183], v[212:215]
  ds_read_b128 a[212:215], v15 offset:2048
  v_mul_f32 v87, s7, v87
  v_mfma_f32_16x16x32_bf16 v[216:219], v[40:43], a[168:171], v[216:219]
  ds_read_b64_tr_b16 v[60:61], v9 offset:28672
  v_mfma_f32_16x16x32_bf16 v[216:219], v[44:47], a[184:187], v[216:219]
  ds_read_b64_tr_b16 v[62:63], v9 offset:29184
  v_mfma_f32_16x16x32_bf16 v[220:223], v[40:43], a[172:175], v[220:223]
  s_add_u32 s33, s32, 3145728
  buffer_load_dwordx4 v97, s[20:23], s33 offen lds
  v_mfma_f32_16x16x32_bf16 v[220:223], v[44:47], a[188:191], v[220:223]
  ds_read_b128 a[216:219], v15 offset:4096
  s_waitcnt vmcnt(24)
  s_barrier
  s_waitcnt lgkmcnt(7)
  v_mfma_f32_16x16x32_bf16 v[224:227], v[48:51], a[160:163], v[224:227]
  ds_read_b64_tr_b16 v[32:33], v6 offset:32768
  v_mfma_f32_16x16x32_bf16 v[224:227], v[52:55], a[176:179], v[224:227]
  ds_read_b64_tr_b16 v[34:35], v6 offset:33280
  v_mfma_f32_16x16x32_bf16 v[228:231], v[48:51], a[164:167], v[228:231]
  s_add_u32 m0, s84, 0
  s_add_u32 s77, s80, 0
  buffer_load_dwordx4 v2, s[20:23], s77 offen offset:0 lds
  v_mfma_f32_16x16x32_bf16 v[228:231], v[52:55], a[180:183], v[228:231]
  ds_read_b128 a[220:223], v15 offset:6144
  v_mfma_f32_16x16x32_bf16 v[232:235], v[48:51], a[168:171], v[232:235]
  ds_read_b64_tr_b16 v[36:37], v6 offset:36864
  v_mfma_f32_16x16x32_bf16 v[232:235], v[52:55], a[184:187], v[232:235]
  ds_read_b64_tr_b16 v[38:39], v6 offset:37376
  v_mfma_f32_16x16x32_bf16 v[236:239], v[48:51], a[172:175], v[236:239]
  buffer_load_dwordx4 v3, s[20:23], s77 offen offset:1024 lds
  v_mfma_f32_16x16x32_bf16 v[236:239], v[52:55], a[188:191], v[236:239]
  s_waitcnt lgkmcnt(6)
  v_mfma_f32_16x16x32_bf16 v[240:243], v[56:59], a[160:163], v[240:243]
  ds_read_b64_tr_b16 v[40:41], v7 offset:32768
  v_mfma_f32_16x16x32_bf16 v[240:243], v[60:63], a[176:179], v[240:243]
  ds_read_b64_tr_b16 v[42:43], v7 offset:33280
  v_mfma_f32_16x16x32_bf16 v[244:247], v[56:59], a[164:167], v[244:247]
  buffer_load_dwordx4 v4, s[20:23], s77 offen offset:2048 lds
  v_mfma_f32_16x16x32_bf16 v[244:247], v[60:63], a[180:183], v[244:247]
  s_waitcnt vmcnt(15)
  v_add_f32 v108, v108, v112
  v_mfma_f32_16x16x32_bf16 v[248:251], v[56:59], a[168:171], v[248:251]
  ds_read_b64_tr_b16 v[44:45], v7 offset:36864
  v_add_f32 v109, v109, v113
  v_mfma_f32_16x16x32_bf16 v[248:251], v[60:63], a[184:187], v[248:251]
  ds_read_b64_tr_b16 v[46:47], v7 offset:37376
  v_add_f32 v110, v110, v114
  v_mfma_f32_16x16x32_bf16 v[252:255], v[56:59], a[172:175], v[252:255]
  buffer_load_dwordx4 v5, s[20:23], s77 offen offset:3072 lds
  v_add_f32 v111, v111, v115
  v_mfma_f32_16x16x32_bf16 v[252:255], v[60:63], a[188:191], v[252:255]
  s_waitcnt lgkmcnt(4)
  v_mfma_f32_16x16x32_bf16 v[128:131], v[32:35], a[192:195], v[128:131]
  ds_read_b64_tr_b16 v[48:49], v8 offset:32768
  v_add_f32 v116, v116, v120
  v_mfma_f32_16x16x32_bf16 v[128:131], v[36:39], a[208:211], v[128:131]
  ds_read_b64_tr_b16 v[50:51], v8 offset:33280
  v_add_f32 v117, v117, v121
  v_mfma_f32_16x16x32_bf16 v[132:135], v[32:35], a[196:199], v[132:135]
  v_add_f32 v118, v118, v122
  v_add_f32 v119, v119, v123
  v_mfma_f32_16x16x32_bf16 v[132:135], v[36:39], a[212:215], v[132:135]
  v_add_f32 v108, v108, v116
  v_add_f32 v109, v109, v117
  v_mfma_f32_16x16x32_bf16 v[136:139], v[32:35], a[200:203], v[136:139]
  ds_read_b64_tr_b16 v[52:53], v8 offset:36864
  v_add_f32 v110, v110, v118
  v_mfma_f32_16x16x32_bf16 v[136:139], v[36:39], a[216:219], v[136:139]
  ds_read_b64_tr_b16 v[54:55], v8 offset:37376
  v_add_f32 v111, v111, v119
  v_mfma_f32_16x16x32_bf16 v[140:143], v[32:35], a[204:207], v[140:143]
  v_cvt_pk_bf16_f32 v112, v108, v109
  v_lshlrev_b32 v108, 16, v112
  v_mfma_f32_16x16x32_bf16 v[140:143], v[36:39], a[220:223], v[140:143]
  v_and_b32 v109, 0xffff0000, v112
  s_waitcnt lgkmcnt(4)
  v_mfma_f32_16x16x32_bf16 v[144:147], v[40:43], a[192:195], v[144:147]
  ds_read_b64_tr_b16 v[56:57], v9 offset:32768
  v_cvt_pk_bf16_f32 v113, v110, v111
  v_mfma_f32_16x16x32_bf16 v[144:147], v[44:47], a[208:211], v[144:147]
  ds_read_b64_tr_b16 v[58:59], v9 offset:33280
  v_lshlrev_b32 v110, 16, v113
  v_mfma_f32_16x16x32_bf16 v[148:151], v[40:43], a[196:199], v[148:151]
  v_and_b32 v111, 0xffff0000, v113
  v_add_f32 v108, s87, v108
  v_mfma_f32_16x16x32_bf16 v[148:151], v[44:47], a[212:215], v[148:151]
  v_add_f32 v109, s87, v109
  v_mfma_f32_16x16x32_bf16 v[152:155], v[40:43], a[200:203], v[152:155]
  ds_read_b64_tr_b16 v[60:61], v9 offset:36864
  v_add_f32 v110, s87, v110
  v_mfma_f32_16x16x32_bf16 v[152:155], v[44:47], a[216:219], v[152:155]
  ds_read_b64_tr_b16 v[62:63], v9 offset:37376
  v_mfma_f32_16x16x32_bf16 v[156:159], v[40:43], a[204:207], v[156:159]
  v_add_f32 v111, s87, v111
  v_mfma_f32_16x16x32_bf16 v[156:159], v[44:47], a[220:223], v[156:159]
  v_cvt_pk_bf16_f32 v112, v108, v109
  s_waitcnt lgkmcnt(4)
  v_mfma_f32_16x16x32_bf16 v[160:163], v[48:51], a[192:195], v[160:163]
  ds_read_b64_tr_b16 v[32:33], v6 offset:40960
  v_mov_b32 v28, v97
  v_mfma_f32_16x16x32_bf16 v[160:163], v[52:55], a[208:211], v[160:163]
  ds_read_b64_tr_b16 v[34:35], v6 offset:41472
  v_lshlrev_b32 v108, 16, v112
  v_mfma_f32_16x16x32_bf16 v[164:167], v[48:51], a[196:199], v[164:167]
  v_and_b32 v109, 0xffff0000, v112
  v_cvt_pk_bf16_f32 v113, v110, v111
  v_mfma_f32_16x16x32_bf16 v[164:167], v[52:55], a[212:215], v[164:167]
  v_mfma_f32_16x16x32_bf16 v[168:171], v[48:51], a[200:203], v[168:171]
  ds_read_b64_tr_b16 v[36:37], v6 offset:45056
  v_lshlrev_b32 v110, 16, v113
  v_mfma_f32_16x16x32_bf16 v[168:171], v[52:55], a[216:219], v[168:171]
  ds_read_b64_tr_b16 v[38:39], v6 offset:45568
  v_and_b32 v111, 0xffff0000, v113
  v_mfma_f32_16x16x32_bf16 v[172:175], v[48:51], a[204:207], v[172:175]
  v_mul_f32 v108, 0x3e0293ee, v108
  v_mfma_f32_16x16x32_bf16 v[172:175], v[52:55], a[220:223], v[172:175]
  ds_read_b128 a[224:227], v14 offset:8192
  s_waitcnt lgkmcnt(5)
  v_mfma_f32_16x16x32_bf16 v[176:179], v[56:59], a[192:195], v[176:179]
  ds_read_b64_tr_b16 v[40:41], v7 offset:40960
  v_mul_f32 v109, 0x3e0293ee, v109
  v_mfma_f32_16x16x32_bf16 v[176:179], v[60:63], a[208:211], v[176:179]
  ds_read_b64_tr_b16 v[42:43], v7 offset:41472
  v_mul_f32 v110, 0x3e0293ee, v110
  v_mfma_f32_16x16x32_bf16 v[180:183], v[56:59], a[196:199], v[180:183]
  v_mul_f32 v111, 0x3e0293ee, v111
  v_mfma_f32_16x16x32_bf16 v[180:183], v[60:63], a[212:215], v[180:183]
  ds_read_b128 a[228:231], v14 offset:10240
  s_lshl_b32 s88, s3, 10
  v_mfma_f32_16x16x32_bf16 v[184:187], v[56:59], a[200:203], v[184:187]
  ds_read_b64_tr_b16 v[44:45], v7 offset:45056
  s_add_u32 s88, s88, 81920
  v_mfma_f32_16x16x32_bf16 v[184:187], v[60:63], a[216:219], v[184:187]
  ds_read_b64_tr_b16 v[46:47], v7 offset:45568
  v_mfma_f32_16x16x32_bf16 v[188:191], v[56:59], a[204:207], v[188:191]
  v_add_u32 v112, s88, v1
  v_mfma_f32_16x16x32_bf16 v[188:191], v[60:63], a[220:223], v[188:191]
  ds_read_b128 a[232:235], v14 offset:12288
  s_waitcnt lgkmcnt(7)
  v_mfma_f32_16x16x32_bf16 v[192:195], v[32:35], a[192:195], v[192:195]
  ds_read_b64_tr_b16 v[48:49], v8 offset:40960
  v_lshlrev_b32 v88, 5, v0
  v_mfma_f32_16x16x32_bf16 v[192:195], v[36:39], a[208:211], v[192:195]
  ds_read_b64_tr_b16 v[50:51], v8 offset:41472
  v_add_u32 v88, 81920, v88
  v_mfma_f32_16x16x32_bf16 v[196:199], v[32:35], a[196:199], v[196:199]
  s_waitcnt vmcnt(12)
  v_add_f32 v124, v124, v125
  v_mfma_f32_16x16x32_bf16 v[196:199], v[36:39], a[212:215], v[196:199]
  ds_read_b128 a[236:239], v14 offset:14336
  v_add_f32 v126, v126, v127
  v_mfma_f32_16x16x32_bf16 v[200:203], v[32:35], a[200:203], v[200:203]
  ds_read_b64_tr_b16 v[52:53], v8 offset:45056
  v_add_f32 v124, v124, v126
  v_mfma_f32_16x16x32_bf16 v[200:203], v[36:39], a[216:219], v[200:203]
  ds_read_b64_tr_b16 v[54:55], v8 offset:45568
  v_cvt_pk_bf16_f32 v124, v124, v124
  v_mfma_f32_16x16x32_bf16 v[204:207], v[32:35], a[204:207], v[204:207]
  v_lshlrev_b32 v27, 16, v124
  v_mfma_f32_16x16x32_bf16 v[204:207], v[36:39], a[220:223], v[204:207]
  ds_read_b128 a[240:243], v15 offset:8192
  s_waitcnt lgkmcnt(7)
  v_mfma_f32_16x16x32_bf16 v[208:211], v[40:43], a[192:195], v[208:211]
  ds_read_b64_tr_b16 v[56:57], v9 offset:40960
  v_mfma_f32_16x16x32_bf16 v[208:211], v[44:47], a[208:211], v[208:211]
  ds_read_b64_tr_b16 v[58:59], v9 offset:41472
  v_mfma_f32_16x16x32_bf16 v[212:215], v[40:43], a[196:199], v[212:215]
  v_mfma_f32_16x16x32_bf16 v[212:215], v[44:47], a[212:215], v[212:215]
  ds_read_b128 a[244:247], v15 offset:10240
  ds_write_b128 v112, v[108:111]
  v_mfma_f32_16x16x32_bf16 v[216:219], v[40:43], a[200:203], v[216:219]
  ds_read_b64_tr_b16 v[60:61], v9 offset:45056
  v_mfma_f32_16x16x32_bf16 v[216:219], v[44:47], a[216:219], v[216:219]
  ds_read_b64_tr_b16 v[62:63], v9 offset:45568
  v_mfma_f32_16x16x32_bf16 v[220:223], v[40:43], a[204:207], v[220:223]
  v_mfma_f32_16x16x32_bf16 v[220:223], v[44:47], a[220:223], v[220:223]
  ds_read_b128 a[248:251], v15 offset:12288
  s_waitcnt lgkmcnt(3)
  s_waitcnt vmcnt(8)
  s_barrier
  v_mfma_f32_16x16x32_bf16 v[224:227], v[48:51], a[192:195], v[224:227]
  ds_read_b64_tr_b16 v[32:33], v6 offset:49152
  ds_read_b128 v[100:103], v88 offset:0
  v_mfma_f32_16x16x32_bf16 v[224:227], v[52:55], a[208:211], v[224:227]
  ds_read_b64_tr_b16 v[34:35], v6 offset:49664
  v_mfma_f32_16x16x32_bf16 v[228:231], v[48:51], a[196:199], v[228:231]
  s_add_u32 m0, s84, 16384
  s_add_u32 s77, s80, 1048576
  buffer_load_dwordx4 v2, s[20:23], s77 offen offset:0 lds
  ds_read_b128 v[104:107], v88 offset:16
  v_mfma_f32_16x16x32_bf16 v[228:231], v[52:55], a[212:215], v[228:231]
  ds_read_b128 a[252:255], v15 offset:14336
  v_mfma_f32_16x16x32_bf16 v[232:235], v[48:51], a[200:203], v[232:235]
  ds_read_b64_tr_b16 v[36:37], v6 offset:53248
  ds_read_b128 v[92:95], v88 offset:2048
  v_mfma_f32_16x16x32_bf16 v[232:235], v[52:55], a[216:219], v[232:235]
  ds_read_b64_tr_b16 v[38:39], v6 offset:53760
  v_mfma_f32_16x16x32_bf16 v[236:239], v[48:51], a[204:207], v[236:239]
  buffer_load_dwordx4 v3, s[20:23], s77 offen offset:1024 lds
  ds_read_b128 v[96:99], v88 offset:2064
  v_mfma_f32_16x16x32_bf16 v[236:239], v[52:55], a[220:223], v[236:239]
  s_waitcnt lgkmcnt(10)
  v_mfma_f32_16x16x32_bf16 v[240:243], v[56:59], a[192:195], v[240:243]
  ds_read_b64_tr_b16 v[40:41], v7 offset:49152
  v_mfma_f32_16x16x32_bf16 v[240:243], v[60:63], a[208:211], v[240:243]
  ds_read_b64_tr_b16 v[42:43], v7 offset:49664
  v_mfma_f32_16x16x32_bf16 v[244:247], v[56:59], a[196:199], v[244:247]
  buffer_load_dwordx4 v4, s[20:23], s77 offen offset:2048 lds
  v_mfma_f32_16x16x32_bf16 v[244:247], v[60:63], a[212:215], v[244:247]
  s_waitcnt lgkmcnt(2)
  v_fma_f32 v72, v72, v92, v100
  v_mfma_f32_16x16x32_bf16 v[248:251], v[56:59], a[200:203], v[248:251]
  ds_read_b64_tr_b16 v[44:45], v7 offset:53248
  v_fma_f32 v80, v80, v92, v100
  v_mfma_f32_16x16x32_bf16 v[248:251], v[60:63], a[216:219], v[248:251]
  ds_read_b64_tr_b16 v[46:47], v7 offset:53760
  v_fma_f32 v73, v73, v93, v101
  v_mfma_f32_16x16x32_bf16 v[252:255], v[56:59], a[204:207], v[252:255]
  buffer_load_dwordx4 v5, s[20:23], s77 offen offset:3072 lds
  v_fma_f32 v81, v81, v93, v101
  v_mfma_f32_16x16x32_bf16 v[252:255], v[60:63], a[220:223], v[252:255]
  v_mfma_f32_16x16x32_bf16 v[128:131], v[32:35], a[224:227], v[128:131]
  ds_read_b64_tr_b16 v[48:49], v8 offset:49152
  v_fma_f32 v74, v74, v94, v102
  v_mfma_f32_16x16x32_bf16 v[128:131], v[36:39], a[240:243], v[128:131]
  ds_read_b64_tr_b16 v[50:51], v8 offset:49664
  v_fma_f32 v82, v82, v94, v102
  v_mfma_f32_16x16x32_bf16 v[132:135], v[32:35], a[228:231], v[132:135]
  s_add_u32 m0, s83, 22528
  s_lshr_b32 s32, s3, 1
  s_lshl_b32 s32, s32, 3
  s_add_u32 s32, s32, s5
  s_lshl_b32 s32, s32, 1
  s_and_b32 s33, s3, 1
  s_add_u32 s32, s32, s33
  s_lshl_b32 s32, s32, 15
  s_lshl_b32 s33, s4, 8
  s_add_u32 s32, s32, s33
  s_add_u32 s33, s32, 0
  buffer_load_dwordx4 v28, s[24:27], s33 offen lds
  v_mfma_f32_16x16x32_bf16 v[132:135], v[36:39], a[244:247], v[132:135]
  v_fma_f32 v75, v75, v95, v103
  v_fma_f32 v83, v83, v95, v103
  v_mfma_f32_16x16x32_bf16 v[136:139], v[32:35], a[232:235], v[136:139]
  ds_read_b64_tr_b16 v[52:53], v8 offset:53248
  v_fma_f32 v76, v76, v96, v104
  v_mfma_f32_16x16x32_bf16 v[136:139], v[36:39], a[248:251], v[136:139]
  ds_read_b64_tr_b16 v[54:55], v8 offset:53760
  v_fma_f32 v84, v84, v96, v104
  v_mfma_f32_16x16x32_bf16 v[140:143], v[32:35], a[236:239], v[140:143]
  s_add_u32 s33, s32, 1048576
  buffer_load_dwordx4 v28, s[24:27], s33 offen lds
  v_mfma_f32_16x16x32_bf16 v[140:143], v[36:39], a[252:255], v[140:143]
  v_fma_f32 v77, v77, v97, v105
  s_waitcnt lgkmcnt(4)
  v_mfma_f32_16x16x32_bf16 v[144:147], v[40:43], a[224:227], v[144:147]
  ds_read_b64_tr_b16 v[56:57], v9 offset:49152
  v_fma_f32 v85, v85, v97, v105
  v_mfma_f32_16x16x32_bf16 v[144:147], v[44:47], a[240:243], v[144:147]
  ds_read_b64_tr_b16 v[58:59], v9 offset:49664
  v_fma_f32 v78, v78, v98, v106
  v_mfma_f32_16x16x32_bf16 v[148:151], v[40:43], a[228:231], v[148:151]
  s_add_u32 s33, s32, 2097152
  buffer_load_dwordx4 v28, s[24:27], s33 offen lds
  v_mfma_f32_16x16x32_bf16 v[148:151], v[44:47], a[244:247], v[148:151]
  v_fma_f32 v86, v86, v98, v106
  v_fma_f32 v79, v79, v99, v107
  v_mfma_f32_16x16x32_bf16 v[152:155], v[40:43], a[232:235], v[152:155]
  ds_read_b64_tr_b16 v[60:61], v9 offset:53248
  v_fma_f32 v87, v87, v99, v107
  v_mfma_f32_16x16x32_bf16 v[152:155], v[44:47], a[248:251], v[152:155]
  ds_read_b64_tr_b16 v[62:63], v9 offset:53760
  v_cvt_pk_bf16_f32 v64, v72, v73
  v_mfma_f32_16x16x32_bf16 v[156:159], v[40:43], a[236:239], v[156:159]
  s_add_u32 s33, s32, 3145728
  buffer_load_dwordx4 v28, s[24:27], s33 offen lds
  v_mfma_f32_16x16x32_bf16 v[156:159], v[44:47], a[252:255], v[156:159]
  v_cvt_pk_bf16_f32 v68, v80, v81
  s_waitcnt lgkmcnt(4)
  v_mfma_f32_16x16x32_bf16 v[160:163], v[48:51], a[224:227], v[160:163]
  ds_read_b64_tr_b16 v[32:33], v6 offset:57344
  v_cvt_pk_bf16_f32 v65, v74, v75
  v_mfma_f32_16x16x32_bf16 v[160:163], v[52:55], a[240:243], v[160:163]
  ds_read_b64_tr_b16 v[34:35], v6 offset:57856
  v_cvt_pk_bf16_f32 v69, v82, v83
  v_mfma_f32_16x16x32_bf16 v[164:167], v[48:51], a[228:231], v[164:167]
  v_cvt_pk_bf16_f32 v66, v76, v77
  v_cvt_pk_bf16_f32 v70, v84, v85
  v_mfma_f32_16x16x32_bf16 v[164:167], v[52:55], a[244:247], v[164:167]
  v_cvt_pk_bf16_f32 v67, v78, v79
  v_cvt_pk_bf16_f32 v71, v86, v87
  v_mfma_f32_16x16x32_bf16 v[168:171], v[48:51], a[232:235], v[168:171]
  ds_read_b64_tr_b16 v[36:37], v6 offset:61440
  s_lshr_b32 s88, s3, 1
  v_mfma_f32_16x16x32_bf16 v[168:171], v[52:55], a[248:251], v[168:171]
  ds_read_b64_tr_b16 v[38:39], v6 offset:61952
  s_mul_i32 s88, s88, 20416
  v_mfma_f32_16x16x32_bf16 v[172:175], v[48:51], a[236:239], v[172:175]
  s_mul_i32 s87, s3, 2080
  s_add_u32 s88, s88, s87
  v_mfma_f32_16x16x32_bf16 v[172:175], v[52:55], a[252:255], v[172:175]
  s_add_u32 s88, s88, 106496
  s_waitcnt lgkmcnt(4)
  v_mfma_f32_16x16x32_bf16 v[176:179], v[56:59], a[224:227], v[176:179]
  ds_read_b64_tr_b16 v[40:41], v7 offset:57344
  v_add_u32 v88, s88, v1
  v_mfma_f32_16x16x32_bf16 v[176:179], v[60:63], a[240:243], v[176:179]
  ds_read_b64_tr_b16 v[42:43], v7 offset:57856
  v_and_b32 v19, 7, v0
  v_mfma_f32_16x16x32_bf16 v[180:183], v[56:59], a[228:231], v[180:183]
  v_lshrrev_b32 v90, 3, v0
  v_mul_u32_u24 v18, 1040, v19
  v_mfma_f32_16x16x32_bf16 v[180:183], v[60:63], a[244:247], v[180:183]
  v_lshrrev_b32 v91, 2, v19
  v_mul_u32_u24 v91, 20416, v91
  v_mfma_f32_16x16x32_bf16 v[184:187], v[56:59], a[232:235], v[184:187]
  ds_read_b64_tr_b16 v[44:45], v7 offset:61440
  v_add_u32 v18, v18, v91
  v_mfma_f32_16x16x32_bf16 v[184:187], v[60:63], a[248:251], v[184:187]
  ds_read_b64_tr_b16 v[46:47], v7 offset:61952
  v_lshl_add_u32 v18, v90, 4, v18
  v_mfma_f32_16x16x32_bf16 v[188:191], v[56:59], a[236:239], v[188:191]
  s_lshl_b32 s88, s3, 8
  s_add_u32 s88, s88, 106496
  v_mfma_f32_16x16x32_bf16 v[188:191], v[60:63], a[252:255], v[188:191]
  v_add_u32 v18, s88, v18
  s_waitcnt lgkmcnt(4)
  v_mfma_f32_16x16x32_bf16 v[192:195], v[32:35], a[224:227], v[192:195]
  ds_read_b64_tr_b16 v[48:49], v8 offset:57344
  v_lshlrev_b32 v19, 4, v19
  v_mfma_f32_16x16x32_bf16 v[192:195], v[36:39], a[240:243], v[192:195]
  ds_read_b64_tr_b16 v[50:51], v8 offset:57856
  v_and_b32 v91, 3, v90
  v_mfma_f32_16x16x32_bf16 v[196:199], v[32:35], a[228:231], v[196:199]
  v_lshl_add_u32 v19, v91, 8, v19
  v_lshrrev_b32 v90, 2, v90
  v_mfma_f32_16x16x32_bf16 v[196:199], v[36:39], a[244:247], v[196:199]
  v_lshl_add_u32 v19, v90, 10, v19
  s_and_b32 s88, s89, 1
  v_mfma_f32_16x16x32_bf16 v[200:203], v[32:35], a[232:235], v[200:203]
  ds_read_b64_tr_b16 v[52:53], v8 offset:61440
  s_lshr_b32 s89, s89, 1
  v_mfma_f32_16x16x32_bf16 v[200:203], v[36:39], a[248:251], v[200:203]
  ds_read_b64_tr_b16 v[54:55], v8 offset:61952
  s_lshl_b32 s89, s89, 14
  v_mfma_f32_16x16x32_bf16 v[204:207], v[32:35], a[236:239], v[204:207]
  s_lshl_b32 s88, s88, 7
  s_add_u32 s89, s89, s88
  v_mfma_f32_16x16x32_bf16 v[204:207], v[36:39], a[252:255], v[204:207]
  s_lshl_b32 s88, s3, 12
  s_waitcnt lgkmcnt(4)
  v_mfma_f32_16x16x32_bf16 v[208:211], v[40:43], a[224:227], v[208:211]
  ds_read_b64_tr_b16 v[56:57], v9 offset:57344
  s_add_u32 s89, s89, s88
  v_mfma_f32_16x16x32_bf16 v[208:211], v[44:47], a[240:243], v[208:211]
  ds_read_b64_tr_b16 v[58:59], v9 offset:57856
  ds_write_b128 v88, v[64:67] offset:0
  v_mfma_f32_16x16x32_bf16 v[212:215], v[40:43], a[228:231], v[212:215]
  s_add_u32 s89, s89, 33554432
  v_mfma_f32_16x16x32_bf16 v[212:215], v[44:47], a[244:247], v[212:215]
  ds_write_b128 v88, v[68:71] offset:1040
  v_mfma_f32_16x16x32_bf16 v[216:219], v[40:43], a[232:235], v[216:219]
  ds_read_b64_tr_b16 v[60:61], v9 offset:61440
  v_mfma_f32_16x16x32_bf16 v[216:219], v[44:47], a[248:251], v[216:219]
  ds_read_b64_tr_b16 v[62:63], v9 offset:61952
  v_mfma_f32_16x16x32_bf16 v[220:223], v[40:43], a[236:239], v[220:223]
  v_mfma_f32_16x16x32_bf16 v[220:223], v[44:47], a[252:255], v[220:223]
  s_waitcnt lgkmcnt(2)
  s_waitcnt vmcnt(8)
  s_barrier
  v_mfma_f32_16x16x32_bf16 v[224:227], v[48:51], a[224:227], v[224:227]
  ds_read_b64_tr_b16 v[32:33], v6 offset:0
  ds_read_b128 v[120:123], v18 offset:0
  v_mfma_f32_16x16x32_bf16 v[224:227], v[52:55], a[240:243], v[224:227]
  ds_read_b64_tr_b16 v[34:35], v6 offset:512
  ds_read_b128 v[124:127], v18 offset:128
  v_mfma_f32_16x16x32_bf16 v[228:231], v[48:51], a[228:231], v[228:231]
  buffer_store_dword v27, v20, s[8:11], s90 offen sc1
  v_mfma_f32_16x16x32_bf16 v[228:231], v[52:55], a[244:247], v[228:231]
  v_mfma_f32_16x16x32_bf16 v[232:235], v[48:51], a[232:235], v[232:235]
  ds_read_b64_tr_b16 v[36:37], v6 offset:4096
  v_mfma_f32_16x16x32_bf16 v[232:235], v[52:55], a[248:251], v[232:235]
  ds_read_b64_tr_b16 v[38:39], v6 offset:4608
  v_mfma_f32_16x16x32_bf16 v[236:239], v[48:51], a[236:239], v[236:239]
  s_waitcnt lgkmcnt(2)
  buffer_store_dwordx4 v[120:123], v19, s[8:11], s89 offen offset:0 sc1
  v_mfma_f32_16x16x32_bf16 v[236:239], v[52:55], a[252:255], v[236:239]
  v_mfma_f32_16x16x32_bf16 v[240:243], v[56:59], a[224:227], v[240:243]
  ds_read_b64_tr_b16 v[40:41], v7 offset:0
  v_mfma_f32_16x16x32_bf16 v[240:243], v[60:63], a[240:243], v[240:243]
  ds_read_b64_tr_b16 v[42:43], v7 offset:512
  v_mfma_f32_16x16x32_bf16 v[244:247], v[56:59], a[228:231], v[244:247]
  buffer_store_dwordx4 v[124:127], v19, s[8:11], s89 offen offset:2048 sc1
  v_mfma_f32_16x16x32_bf16 v[244:247], v[60:63], a[244:247], v[244:247]
  v_mfma_f32_16x16x32_bf16 v[248:251], v[56:59], a[232:235], v[248:251]
  ds_read_b64_tr_b16 v[44:45], v7 offset:4096
  v_mfma_f32_16x16x32_bf16 v[248:251], v[60:63], a[248:251], v[248:251]
  ds_read_b64_tr_b16 v[46:47], v7 offset:4608
  v_mfma_f32_16x16x32_bf16 v[252:255], v[56:59], a[236:239], v[252:255]
  s_add_u32 m0, s84, 32768
  s_add_u32 s77, s80, 2097152
  buffer_load_dwordx4 v2, s[20:23], s77 offen offset:0 lds
  v_mfma_f32_16x16x32_bf16 v[252:255], v[60:63], a[252:255], v[252:255]
  s_waitcnt lgkmcnt(4)
  v_mfma_f32_16x16x32_bf16 v[64:67], a[0:3], v[32:35], 0
  ds_read_b64_tr_b16 v[48:49], v8 offset:0
  v_mfma_f32_16x16x32_bf16 v[64:67], a[16:19], v[36:39], v[64:67]
  ds_read_b64_tr_b16 v[50:51], v8 offset:512
  v_mfma_f32_16x16x32_bf16 v[68:71], a[4:7], v[32:35], 0
  buffer_load_dwordx4 v3, s[20:23], s77 offen offset:1024 lds
  v_cvt_pk_bf16_f32 v192, v192, v193
  v_mfma_f32_16x16x32_bf16 v[68:71], a[20:23], v[36:39], v[68:71]
  v_mfma_f32_16x16x32_bf16 v[72:75], a[8:11], v[32:35], 0
  ds_read_b64_tr_b16 v[52:53], v8 offset:4096
  v_cvt_pk_bf16_f32 v193, v194, v195
  v_mfma_f32_16x16x32_bf16 v[72:75], a[24:27], v[36:39], v[72:75]
  ds_read_b64_tr_b16 v[54:55], v8 offset:4608
  v_mfma_f32_16x16x32_bf16 v[76:79], a[12:15], v[32:35], 0
  buffer_load_dwordx4 v4, s[20:23], s77 offen offset:2048 lds
  v_cvt_pk_bf16_f32 v194, v208, v209
  v_mfma_f32_16x16x32_bf16 v[76:79], a[28:31], v[36:39], v[76:79]
  s_waitcnt lgkmcnt(4)
  v_mfma_f32_16x16x32_bf16 v[80:83], a[0:3], v[40:43], 0
  ds_read_b64_tr_b16 v[56:57], v9 offset:0
  v_and_b32 v10, 0xffff, v6
  v_mfma_f32_16x16x32_bf16 v[80:83], a[16:19], v[44:47], v[80:83]
  ds_read_b64_tr_b16 v[58:59], v9 offset:512
  v_cvt_pk_bf16_f32 v195, v210, v211
  v_mfma_f32_16x16x32_bf16 v[84:87], a[4:7], v[40:43], 0
  buffer_load_dwordx4 v5, s[20:23], s77 offen offset:3072 lds
  v_and_b32 v11, 0xffff, v7
  v_mfma_f32_16x16x32_bf16 v[84:87], a[20:23], v[44:47], v[84:87]
  v_mfma_f32_16x16x32_bf16 v[88:91], a[8:11], v[40:43], 0
  ds_read_b64_tr_b16 v[60:61], v9 offset:4096
  v_mfma_f32_16x16x32_bf16 v[88:91], a[24:27], v[44:47], v[88:91]
  ds_read_b64_tr_b16 v[62:63], v9 offset:4608
  v_and_b32 v12, 0xffff, v8
  v_mfma_f32_16x16x32_bf16 v[92:95], a[12:15], v[40:43], 0
  v_mfma_f32_16x16x32_bf16 v[92:95], a[28:31], v[44:47], v[92:95]
  v_and_b32 v13, 0xffff, v9
  s_waitcnt lgkmcnt(4)
  v_mfma_f32_16x16x32_bf16 v[96:99], a[0:3], v[48:51], 0
  ds_read_b64_tr_b16 v[32:33], v6 offset:8192
  v_mfma_f32_16x16x32_bf16 v[96:99], a[16:19], v[52:55], v[96:99]
  ds_read_b64_tr_b16 v[34:35], v6 offset:8704
  v_mfma_f32_16x16x32_bf16 v[100:103], a[4:7], v[48:51], 0
  s_add_u32 s76, s81, 0
  buffer_store_dwordx4 v[192:195], v1, s[8:11], s76 offen offset:2048 sc1
  v_mfma_f32_16x16x32_bf16 v[100:103], a[20:23], v[52:55], v[100:103]
  v_or_b32 v10, 0x20000, v10
  v_mfma_f32_16x16x32_bf16 v[104:107], a[8:11], v[48:51], 0
  ds_read_b64_tr_b16 v[36:37], v6 offset:12288
  v_or_b32 v11, 0x20000, v11
  v_mfma_f32_16x16x32_bf16 v[104:107], a[24:27], v[52:55], v[104:107]
  ds_read_b64_tr_b16 v[38:39], v6 offset:12800
  v_mfma_f32_16x16x32_bf16 v[108:111], a[12:15], v[48:51], 0
  v_mfma_f32_16x16x32_bf16 v[108:111], a[28:31], v[52:55], v[108:111]
  v_or_b32 v12, 0x20000, v12
  s_waitcnt lgkmcnt(4)
  v_mfma_f32_16x16x32_bf16 v[112:115], a[0:3], v[56:59], 0
  ds_read_b64_tr_b16 v[40:41], v7 offset:8192
  v_cvt_pk_bf16_f32 v196, v196, v197
  v_mfma_f32_16x16x32_bf16 v[112:115], a[16:19], v[60:63], v[112:115]
  ds_read_b64_tr_b16 v[42:43], v7 offset:8704
  v_or_b32 v13, 0x20000, v13
  v_mfma_f32_16x16x32_bf16 v[116:119], a[4:7], v[56:59], 0
  v_cvt_pk_bf16_f32 v197, v198, v199
  v_mfma_f32_16x16x32_bf16 v[116:119], a[20:23], v[60:63], v[116:119]
  v_mfma_f32_16x16x32_bf16 v[120:123], a[8:11], v[56:59], 0
  ds_read_b64_tr_b16 v[44:45], v7 offset:12288
  v_cvt_pk_bf16_f32 v198, v212, v213
  v_mfma_f32_16x16x32_bf16 v[120:123], a[24:27], v[60:63], v[120:123]
  ds_read_b64_tr_b16 v[46:47], v7 offset:12800
  v_mfma_f32_16x16x32_bf16 v[124:127], a[12:15], v[56:59], 0
  v_cvt_pk_bf16_f32 v199, v214, v215
  v_mfma_f32_16x16x32_bf16 v[124:127], a[28:31], v[60:63], v[124:127]
  s_waitcnt lgkmcnt(4)
  v_mfma_f32_16x16x32_bf16 v[64:67], a[32:35], v[32:35], v[64:67]
  ds_read_b64_tr_b16 v[48:49], v8 offset:8192
  v_mfma_f32_16x16x32_bf16 v[64:67], a[48:51], v[36:39], v[64:67]
  ds_read_b64_tr_b16 v[50:51], v8 offset:8704
  v_mfma_f32_16x16x32_bf16 v[68:71], a[36:39], v[32:35], v[68:71]
  v_mfma_f32_16x16x32_bf16 v[68:71], a[52:55], v[36:39], v[68:71]
  v_mfma_f32_16x16x32_bf16 v[72:75], a[40:43], v[32:35], v[72:75]
  ds_read_b64_tr_b16 v[52:53], v8 offset:12288
  v_mfma_f32_16x16x32_bf16 v[72:75], a[56:59], v[36:39], v[72:75]
  ds_read_b64_tr_b16 v[54:55], v8 offset:12800
  v_mfma_f32_16x16x32_bf16 v[76:79], a[44:47], v[32:35], v[76:79]
  v_mfma_f32_16x16x32_bf16 v[76:79], a[60:63], v[36:39], v[76:79]
  s_waitcnt lgkmcnt(4)
  v_mfma_f32_16x16x32_bf16 v[80:83], a[32:35], v[40:43], v[80:83]
  ds_read_b64_tr_b16 v[56:57], v9 offset:8192
  v_mfma_f32_16x16x32_bf16 v[80:83], a[48:51], v[44:47], v[80:83]
  ds_read_b64_tr_b16 v[58:59], v9 offset:8704
  v_mfma_f32_16x16x32_bf16 v[84:87], a[36:39], v[40:43], v[84:87]
  s_add_u32 s76, s81, 4096
  buffer_store_dwordx4 v[196:199], v1, s[8:11], s76 offen offset:2048 sc1
  v_mfma_f32_16x16x32_bf16 v[84:87], a[52:55], v[44:47], v[84:87]
  v_mfma_f32_16x16x32_bf16 v[88:91], a[40:43], v[40:43], v[88:91]
  ds_read_b64_tr_b16 v[60:61], v9 offset:12288
  v_mfma_f32_16x16x32_bf16 v[88:91], a[56:59], v[44:47], v[88:91]
  ds_read_b64_tr_b16 v[62:63], v9 offset:12800
  v_mfma_f32_16x16x32_bf16 v[92:95], a[44:47], v[40:43], v[92:95]
  v_cvt_pk_bf16_f32 v200, v200, v201
  v_mfma_f32_16x16x32_bf16 v[92:95], a[60:63], v[44:47], v[92:95]
  s_waitcnt vmcnt(13)
  s_barrier
  s_waitcnt lgkmcnt(4)
  v_mfma_f32_16x16x32_bf16 v[96:99], a[32:35], v[48:51], v[96:99]
  ds_read_b64_tr_b16 v[32:33], v6 offset:16384
  v_cvt_pk_bf16_f32 v201, v202, v203
  v_mfma_f32_16x16x32_bf16 v[96:99], a[48:51], v[52:55], v[96:99]
  ds_read_b64_tr_b16 v[34:35], v6 offset:16896
  v_mfma_f32_16x16x32_bf16 v[100:103], a[36:39], v[48:51], v[100:103]
  v_cvt_pk_bf16_f32 v202, v216, v217
  v_mfma_f32_16x16x32_bf16 v[100:103], a[52:55], v[52:55], v[100:103]
  v_mfma_f32_16x16x32_bf16 v[104:107], a[40:43], v[48:51], v[104:107]
  ds_read_b64_tr_b16 v[36:37], v6 offset:20480
  v_cvt_pk_bf16_f32 v203, v218, v219
  v_mfma_f32_16x16x32_bf16 v[104:107], a[56:59], v[52:55], v[104:107]
  ds_read_b64_tr_b16 v[38:39], v6 offset:20992
  v_mfma_f32_16x16x32_bf16 v[108:111], a[44:47], v[48:51], v[108:111]
  s_add_u32 m0, s84, 49152
  s_add_u32 s77, s80, 3145728
  buffer_load_dwordx4 v2, s[20:23], s77 offen offset:0 lds
  v_mfma_f32_16x16x32_bf16 v[108:111], a[60:63], v[52:55], v[108:111]
  s_waitcnt lgkmcnt(4)
  v_mfma_f32_16x16x32_bf16 v[112:115], a[32:35], v[56:59], v[112:115]
  ds_read_b64_tr_b16 v[40:41], v7 offset:16384
  v_mfma_f32_16x16x32_bf16 v[112:115], a[48:51], v[60:63], v[112:115]
  ds_read_b64_tr_b16 v[42:43], v7 offset:16896
  v_mfma_f32_16x16x32_bf16 v[116:119], a[36:39], v[56:59], v[116:119]
  buffer_load_dwordx4 v3, s[20:23], s77 offen offset:1024 lds
  v_cvt_pk_bf16_f32 v204, v204, v205
  v_mfma_f32_16x16x32_bf16 v[116:119], a[52:55], v[60:63], v[116:119]
  v_mfma_f32_16x16x32_bf16 v[120:123], a[40:43], v[56:59], v[120:123]
  ds_read_b64_tr_b16 v[44:45], v7 offset:20480
  v_cvt_pk_bf16_f32 v205, v206, v207
  v_mfma_f32_16x16x32_bf16 v[120:123], a[56:59], v[60:63], v[120:123]
  ds_read_b64_tr_b16 v[46:47], v7 offset:20992
  v_mfma_f32_16x16x32_bf16 v[124:127], a[44:47], v[56:59], v[124:127]
  buffer_load_dwordx4 v4, s[20:23], s77 offen offset:2048 lds
  v_cvt_pk_bf16_f32 v206, v220, v221
  v_mfma_f32_16x16x32_bf16 v[124:127], a[60:63], v[60:63], v[124:127]
  s_waitcnt lgkmcnt(4)
  v_mfma_f32_16x16x32_bf16 v[64:67], a[64:67], v[32:35], v[64:67]
  ds_read_b64_tr_b16 v[48:49], v8 offset:16384
  v_cvt_pk_bf16_f32 v207, v222, v223
  v_mfma_f32_16x16x32_bf16 v[64:67], a[80:83], v[36:39], v[64:67]
  ds_read_b64_tr_b16 v[50:51], v8 offset:16896
  v_mfma_f32_16x16x32_bf16 v[68:71], a[68:71], v[32:35], v[68:71]
  buffer_load_dwordx4 v5, s[20:23], s77 offen offset:3072 lds
  v_mfma_f32_16x16x32_bf16 v[68:71], a[84:87], v[36:39], v[68:71]
  v_mfma_f32_16x16x32_bf16 v[72:75], a[72:75], v[32:35], v[72:75]
  ds_read_b64_tr_b16 v[52:53], v8 offset:20480
  v_mfma_f32_16x16x32_bf16 v[72:75], a[88:91], v[36:39], v[72:75]
  ds_read_b64_tr_b16 v[54:55], v8 offset:20992
  v_mfma_f32_16x16x32_bf16 v[76:79], a[76:79], v[32:35], v[76:79]
  s_add_u32 m0, s83, 0
  s_add_u32 s77, s80, 128
  buffer_load_dwordx4 v2, s[20:23], s77 offen offset:0 lds
  v_mfma_f32_16x16x32_bf16 v[76:79], a[92:95], v[36:39], v[76:79]
  v_cvt_pk_bf16_f32 v224, v224, v225
  s_waitcnt lgkmcnt(4)
  v_mfma_f32_16x16x32_bf16 v[80:83], a[64:67], v[40:43], v[80:83]
  ds_read_b64_tr_b16 v[56:57], v9 offset:16384
  v_cvt_pk_bf16_f32 v225, v226, v227
  v_mfma_f32_16x16x32_bf16 v[80:83], a[80:83], v[44:47], v[80:83]
  ds_read_b64_tr_b16 v[58:59], v9 offset:16896
  v_mfma_f32_16x16x32_bf16 v[84:87], a[68:71], v[40:43], v[84:87]
  buffer_load_dwordx4 v3, s[20:23], s77 offen offset:1024 lds
  v_cvt_pk_bf16_f32 v226, v240, v241
  v_mfma_f32_16x16x32_bf16 v[84:87], a[84:87], v[44:47], v[84:87]
  v_mfma_f32_16x16x32_bf16 v[88:91], a[72:75], v[40:43], v[88:91]
  ds_read_b64_tr_b16 v[60:61], v9 offset:20480
  v_cvt_pk_bf16_f32 v227, v242, v243
  v_mfma_f32_16x16x32_bf16 v[88:91], a[88:91], v[44:47], v[88:91]
  ds_read_b64_tr_b16 v[62:63], v9 offset:20992
  v_mfma_f32_16x16x32_bf16 v[92:95], a[76:79], v[40:43], v[92:95]
  buffer_load_dwordx4 v4, s[20:23], s77 offen offset:2048 lds
  v_mfma_f32_16x16x32_bf16 v[92:95], a[92:95], v[44:47], v[92:95]
  s_waitcnt lgkmcnt(4)
  v_mfma_f32_16x16x32_bf16 v[96:99], a[64:67], v[48:51], v[96:99]
  ds_read_b64_tr_b16 v[32:33], v6 offset:24576
  v_mfma_f32_16x16x32_bf16 v[96:99], a[80:83], v[52:55], v[96:99]
  ds_read_b64_tr_b16 v[34:35], v6 offset:25088
  v_mfma_f32_16x16x32_bf16 v[100:103], a[68:71], v[48:51], v[100:103]
  buffer_load_dwordx4 v5, s[20:23], s77 offen offset:3072 lds
  v_cvt_pk_bf16_f32 v228, v228, v229
  v_mfma_f32_16x16x32_bf16 v[100:103], a[84:87], v[52:55], v[100:103]
  v_mfma_f32_16x16x32_bf16 v[104:107], a[72:75], v[48:51], v[104:107]
  ds_read_b64_tr_b16 v[36:37], v6 offset:28672
  v_cvt_pk_bf16_f32 v229, v230, v231
  v_mfma_f32_16x16x32_bf16 v[104:107], a[88:91], v[52:55], v[104:107]
  ds_read_b64_tr_b16 v[38:39], v6 offset:29184
  v_mfma_f32_16x16x32_bf16 v[108:111], a[76:79], v[48:51], v[108:111]
  s_add_u32 m0, s83, 4096
  s_add_u32 s77, s80, 1048704
  buffer_load_dwordx4 v2, s[20:23], s77 offen offset:0 lds
  v_mfma_f32_16x16x32_bf16 v[108:111], a[92:95], v[52:55], v[108:111]
  v_cvt_pk_bf16_f32 v230, v244, v245
  s_waitcnt lgkmcnt(4)
  v_mfma_f32_16x16x32_bf16 v[112:115], a[64:67], v[56:59], v[112:115]
  ds_read_b64_tr_b16 v[40:41], v7 offset:24576
  v_cvt_pk_bf16_f32 v231, v246, v247
  v_mfma_f32_16x16x32_bf16 v[112:115], a[80:83], v[60:63], v[112:115]
  ds_read_b64_tr_b16 v[42:43], v7 offset:25088
  v_mfma_f32_16x16x32_bf16 v[116:119], a[68:71], v[56:59], v[116:119]
  buffer_load_dwordx4 v3, s[20:23], s77 offen offset:1024 lds
  v_mfma_f32_16x16x32_bf16 v[116:119], a[84:87], v[60:63], v[116:119]
  v_mfma_f32_16x16x32_bf16 v[120:123], a[72:75], v[56:59], v[120:123]
  ds_read_b64_tr_b16 v[44:45], v7 offset:28672
  v_mfma_f32_16x16x32_bf16 v[120:123], a[88:91], v[60:63], v[120:123]
  ds_read_b64_tr_b16 v[46:47], v7 offset:29184
  v_mfma_f32_16x16x32_bf16 v[124:127], a[76:79], v[56:59], v[124:127]
  buffer_load_dwordx4 v4, s[20:23], s77 offen offset:2048 lds
  v_cvt_pk_bf16_f32 v232, v232, v233
  v_mfma_f32_16x16x32_bf16 v[124:127], a[92:95], v[60:63], v[124:127]
  s_waitcnt lgkmcnt(4)
  v_mfma_f32_16x16x32_bf16 v[64:67], a[96:99], v[32:35], v[64:67]
  ds_read_b64_tr_b16 v[48:49], v8 offset:24576
  v_cvt_pk_bf16_f32 v233, v234, v235
  v_mfma_f32_16x16x32_bf16 v[64:67], a[112:115], v[36:39], v[64:67]
  ds_read_b64_tr_b16 v[50:51], v8 offset:25088
  v_mfma_f32_16x16x32_bf16 v[68:71], a[100:103], v[32:35], v[68:71]
  buffer_load_dwordx4 v5, s[20:23], s77 offen offset:3072 lds
  v_cvt_pk_bf16_f32 v234, v248, v249
  v_mfma_f32_16x16x32_bf16 v[68:71], a[116:119], v[36:39], v[68:71]
  s_lshl_b32 s88, s5, 10
  s_add_u32 s88, s88, 39075840
  v_mfma_f32_16x16x32_bf16 v[72:75], a[104:107], v[32:35], v[72:75]
  ds_read_b64_tr_b16 v[52:53], v8 offset:28672
  s_lshl_b32 s76, s6, 5
  v_mfma_f32_16x16x32_bf16 v[72:75], a[120:123], v[36:39], v[72:75]
  ds_read_b64_tr_b16 v[54:55], v8 offset:29184
  s_add_u32 s88, s88, s76
  v_mfma_f32_16x16x32_bf16 v[76:79], a[108:111], v[32:35], v[76:79]
  s_add_u32 m0, s83, 8192
  s_add_u32 s77, s80, 2097280
  buffer_load_dwordx4 v2, s[20:23], s77 offen offset:0 lds
  v_mfma_f32_16x16x32_bf16 v[76:79], a[124:127], v[36:39], v[76:79]
  s_waitcnt lgkmcnt(4)
  v_mfma_f32_16x16x32_bf16 v[80:83], a[96:99], v[40:43], v[80:83]
  ds_read_b64_tr_b16 v[56:57], v9 offset:24576
  v_mfma_f32_16x16x32_bf16 v[80:83], a[112:115], v[44:47], v[80:83]
  ds_read_b64_tr_b16 v[58:59], v9 offset:25088
  v_mfma_f32_16x16x32_bf16 v[84:87], a[100:103], v[40:43], v[84:87]
  buffer_load_dwordx4 v3, s[20:23], s77 offen offset:1024 lds
  v_mfma_f32_16x16x32_bf16 v[84:87], a[116:119], v[44:47], v[84:87]
  s_cmp_eq_u32 s3, 0
  s_cselect_b32 s88, s88, 0x7ff00000
  v_mfma_f32_16x16x32_bf16 v[88:91], a[104:107], v[40:43], v[88:91]
  ds_read_b64_tr_b16 v[60:61], v9 offset:28672
  v_cvt_pk_bf16_f32 v235, v250, v251
  v_mfma_f32_16x16x32_bf16 v[88:91], a[120:123], v[44:47], v[88:91]
  ds_read_b64_tr_b16 v[62:63], v9 offset:29184
  v_cvt_pk_bf16_f32 v236, v236, v237
  v_mfma_f32_16x16x32_bf16 v[92:95], a[108:111], v[40:43], v[92:95]
  buffer_load_dwordx4 v4, s[20:23], s77 offen offset:2048 lds
  v_cvt_pk_bf16_f32 v237, v238, v239
  v_mfma_f32_16x16x32_bf16 v[92:95], a[124:127], v[44:47], v[92:95]
  v_cvt_pk_bf16_f32 v238, v252, v253
  s_waitcnt vmcnt(21)
  s_waitcnt vmcnt(17)
  s_barrier
  s_waitcnt lgkmcnt(4)
  v_mfma_f32_16x16x32_bf16 v[96:99], a[96:99], v[48:51], v[96:99]
  ds_read_b64_tr_b16 v[32:33], v6 offset:32768
  v_cvt_pk_bf16_f32 v239, v254, v255
  v_mfma_f32_16x16x32_bf16 v[96:99], a[112:115], v[52:55], v[96:99]
  ds_read_b64_tr_b16 v[34:35], v6 offset:33280
  v_mfma_f32_16x16x32_bf16 v[100:103], a[100:103], v[48:51], v[100:103]
  buffer_load_dwordx4 v5, s[20:23], s77 offen offset:3072 lds
  v_mfma_f32_16x16x32_bf16 v[100:103], a[116:119], v[52:55], v[100:103]
  v_mfma_f32_16x16x32_bf16 v[104:107], a[104:107], v[48:51], v[104:107]
  ds_read_b64_tr_b16 v[36:37], v6 offset:36864
  v_mfma_f32_16x16x32_bf16 v[104:107], a[120:123], v[52:55], v[104:107]
  ds_read_b64_tr_b16 v[38:39], v6 offset:37376
  v_mfma_f32_16x16x32_bf16 v[108:111], a[108:111], v[48:51], v[108:111]
  s_add_u32 m0, s83, 12288
  s_add_u32 s77, s80, 3145856
  buffer_load_dwordx4 v2, s[20:23], s77 offen offset:0 lds
  v_mfma_f32_16x16x32_bf16 v[108:111], a[124:127], v[52:55], v[108:111]
  v_cvt_pk_bf16_f32 v208, v128, v129
  s_waitcnt lgkmcnt(4)
  v_mfma_f32_16x16x32_bf16 v[112:115], a[96:99], v[56:59], v[112:115]
  ds_read_b64_tr_b16 v[40:41], v7 offset:32768
  v_cvt_pk_bf16_f32 v209, v130, v131
  v_mfma_f32_16x16x32_bf16 v[112:115], a[112:115], v[60:63], v[112:115]
  ds_read_b64_tr_b16 v[42:43], v7 offset:33280
  v_mfma_f32_16x16x32_bf16 v[116:119], a[100:103], v[56:59], v[116:119]
  buffer_load_dwordx4 v3, s[20:23], s77 offen offset:1024 lds
  v_cvt_pk_bf16_f32 v210, v144, v145
  v_mfma_f32_16x16x32_bf16 v[116:119], a[116:119], v[60:63], v[116:119]
  v_mfma_f32_16x16x32_bf16 v[120:123], a[104:107], v[56:59], v[120:123]
  ds_read_b64_tr_b16 v[44:45], v7 offset:36864
  v_cvt_pk_bf16_f32 v211, v146, v147
  v_mfma_f32_16x16x32_bf16 v[120:123], a[120:123], v[60:63], v[120:123]
  ds_read_b64_tr_b16 v[46:47], v7 offset:37376
  v_mfma_f32_16x16x32_bf16 v[124:127], a[108:111], v[56:59], v[124:127]
  buffer_load_dwordx4 v4, s[20:23], s77 offen offset:2048 lds
  v_mfma_f32_16x16x32_bf16 v[124:127], a[124:127], v[60:63], v[124:127]
  s_waitcnt lgkmcnt(4)
  v_mfma_f32_16x16x32_bf16 v[64:67], a[128:131], v[32:35], v[64:67]
  ds_read_b64_tr_b16 v[48:49], v8 offset:32768
  v_mfma_f32_16x16x32_bf16 v[64:67], a[144:147], v[36:39], v[64:67]
  ds_read_b64_tr_b16 v[50:51], v8 offset:33280
  v_mfma_f32_16x16x32_bf16 v[68:71], a[132:135], v[32:35], v[68:71]
  buffer_load_dwordx4 v5, s[20:23], s77 offen offset:3072 lds
  v_cvt_pk_bf16_f32 v212, v132, v133
  v_mfma_f32_16x16x32_bf16 v[68:71], a[148:151], v[36:39], v[68:71]
  v_mfma_f32_16x16x32_bf16 v[72:75], a[136:139], v[32:35], v[72:75]
  ds_read_b64_tr_b16 v[52:53], v8 offset:36864
  v_cvt_pk_bf16_f32 v213, v134, v135
  v_mfma_f32_16x16x32_bf16 v[72:75], a[152:155], v[36:39], v[72:75]
  ds_read_b64_tr_b16 v[54:55], v8 offset:37376
  v_mfma_f32_16x16x32_bf16 v[76:79], a[140:143], v[32:35], v[76:79]
  v_min_u32 v18, 1, v0
  v_lshlrev_b32 v18, 27, v18
  v_mov_b32 v19, 1
  buffer_store_dword v19, v18, s[8:11], s88 offen sc1
  v_mfma_f32_16x16x32_bf16 v[76:79], a[156:159], v[36:39], v[76:79]
  v_cvt_pk_bf16_f32 v214, v148, v149
  s_waitcnt lgkmcnt(4)
  v_mfma_f32_16x16x32_bf16 v[80:83], a[128:131], v[40:43], v[80:83]
  ds_read_b64_tr_b16 v[56:57], v9 offset:32768
  v_cvt_pk_bf16_f32 v215, v150, v151
  v_mfma_f32_16x16x32_bf16 v[80:83], a[144:147], v[44:47], v[80:83]
  ds_read_b64_tr_b16 v[58:59], v9 offset:33280
  v_mfma_f32_16x16x32_bf16 v[84:87], a[132:135], v[40:43], v[84:87]
  s_add_u32 s76, s81, 8192
  buffer_store_dwordx4 v[200:203], v1, s[8:11], s76 offen offset:2048 sc1
  v_mfma_f32_16x16x32_bf16 v[84:87], a[148:151], v[44:47], v[84:87]
  v_mfma_f32_16x16x32_bf16 v[88:91], a[136:139], v[40:43], v[88:91]
  ds_read_b64_tr_b16 v[60:61], v9 offset:36864
  v_mfma_f32_16x16x32_bf16 v[88:91], a[152:155], v[44:47], v[88:91]
  ds_read_b64_tr_b16 v[62:63], v9 offset:37376
  v_mfma_f32_16x16x32_bf16 v[92:95], a[140:143], v[40:43], v[92:95]
  s_add_u32 s76, s81, 12288
  buffer_store_dwordx4 v[204:207], v1, s[8:11], s76 offen offset:2048 sc1
  v_mfma_f32_16x16x32_bf16 v[92:95], a[156:159], v[44:47], v[92:95]
  v_cvt_pk_bf16_f32 v216, v136, v137
  s_waitcnt lgkmcnt(4)
  v_mfma_f32_16x16x32_bf16 v[96:99], a[128:131], v[48:51], v[96:99]
  ds_read_b64_tr_b16 v[32:33], v6 offset:40960
  v_cvt_pk_bf16_f32 v217, v138, v139
  v_mfma_f32_16x16x32_bf16 v[96:99], a[144:147], v[52:55], v[96:99]
  ds_read_b64_tr_b16 v[34:35], v6 offset:41472
  v_mfma_f32_16x16x32_bf16 v[100:103], a[132:135], v[48:51], v[100:103]
  s_add_u32 s76, s81, 0
  buffer_store_dwordx4 v[224:227], v1, s[8:11], s76 offen offset:3072 sc1
  v_mfma_f32_16x16x32_bf16 v[100:103], a[148:151], v[52:55], v[100:103]
  v_cvt_pk_bf16_f32 v218, v152, v153
  v_mfma_f32_16x16x32_bf16 v[104:107], a[136:139], v[48:51], v[104:107]
  ds_read_b64_tr_b16 v[36:37], v6 offset:45056
  v_cvt_pk_bf16_f32 v219, v154, v155
  v_mfma_f32_16x16x32_bf16 v[104:107], a[152:155], v[52:55], v[104:107]
  ds_read_b64_tr_b16 v[38:39], v6 offset:45568
  v_mfma_f32_16x16x32_bf16 v[108:111], a[140:143], v[48:51], v[108:111]
  s_add_u32 s76, s81, 4096
  buffer_store_dwordx4 v[228:231], v1, s[8:11], s76 offen offset:3072 sc1
  v_mfma_f32_16x16x32_bf16 v[108:111], a[156:159], v[52:55], v[108:111]
  s_waitcnt lgkmcnt(4)
  v_mfma_f32_16x16x32_bf16 v[112:115], a[128:131], v[56:59], v[112:115]
  ds_read_b64_tr_b16 v[40:41], v7 offset:40960
  v_mfma_f32_16x16x32_bf16 v[112:115], a[144:147], v[60:63], v[112:115]
  ds_read_b64_tr_b16 v[42:43], v7 offset:41472
  v_mfma_f32_16x16x32_bf16 v[116:119], a[132:135], v[56:59], v[116:119]
  s_add_u32 s76, s81, 8192
  buffer_store_dwordx4 v[232:235], v1, s[8:11], s76 offen offset:3072 sc1
  v_mfma_f32_16x16x32_bf16 v[116:119], a[148:151], v[60:63], v[116:119]
  v_cvt_pk_bf16_f32 v220, v140, v141
  v_mfma_f32_16x16x32_bf16 v[120:123], a[136:139], v[56:59], v[120:123]
  ds_read_b64_tr_b16 v[44:45], v7 offset:45056
  v_cvt_pk_bf16_f32 v221, v142, v143
  v_mfma_f32_16x16x32_bf16 v[120:123], a[152:155], v[60:63], v[120:123]
  ds_read_b64_tr_b16 v[46:47], v7 offset:45568
  v_mfma_f32_16x16x32_bf16 v[124:127], a[140:143], v[56:59], v[124:127]
  v_cvt_pk_bf16_f32 v222, v156, v157
  v_mfma_f32_16x16x32_bf16 v[124:127], a[156:159], v[60:63], v[124:127]
  s_waitcnt lgkmcnt(4)
  v_mfma_f32_16x16x32_bf16 v[64:67], a[160:163], v[32:35], v[64:67]
  ds_read_b64_tr_b16 v[48:49], v8 offset:40960
  v_cvt_pk_bf16_f32 v223, v158, v159
  v_mfma_f32_16x16x32_bf16 v[64:67], a[176:179], v[36:39], v[64:67]
  ds_read_b64_tr_b16 v[50:51], v8 offset:41472
  v_mfma_f32_16x16x32_bf16 v[68:71], a[164:167], v[32:35], v[68:71]
  v_mfma_f32_16x16x32_bf16 v[68:71], a[180:183], v[36:39], v[68:71]
  v_mfma_f32_16x16x32_bf16 v[72:75], a[168:171], v[32:35], v[72:75]
  ds_read_b64_tr_b16 v[52:53], v8 offset:45056
  v_mfma_f32_16x16x32_bf16 v[72:75], a[184:187], v[36:39], v[72:75]
  ds_read_b64_tr_b16 v[54:55], v8 offset:45568
  v_mfma_f32_16x16x32_bf16 v[76:79], a[172:175], v[32:35], v[76:79]
  s_add_u32 s76, s81, 12288
  buffer_store_dwordx4 v[236:239], v1, s[8:11], s76 offen offset:3072 sc1
  v_mfma_f32_16x16x32_bf16 v[76:79], a[188:191], v[36:39], v[76:79]
  v_cvt_pk_bf16_f32 v240, v160, v161
  s_waitcnt lgkmcnt(4)
  v_mfma_f32_16x16x32_bf16 v[80:83], a[160:163], v[40:43], v[80:83]
  ds_read_b64_tr_b16 v[56:57], v9 offset:40960
  v_cvt_pk_bf16_f32 v241, v162, v163
  v_mfma_f32_16x16x32_bf16 v[80:83], a[176:179], v[44:47], v[80:83]
  ds_read_b64_tr_b16 v[58:59], v9 offset:41472
  v_mfma_f32_16x16x32_bf16 v[84:87], a[164:167], v[40:43], v[84:87]
  v_cvt_pk_bf16_f32 v242, v176, v177
  v_mfma_f32_16x16x32_bf16 v[84:87], a[180:183], v[44:47], v[84:87]
  v_mfma_f32_16x16x32_bf16 v[88:91], a[168:171], v[40:43], v[88:91]
  ds_read_b64_tr_b16 v[60:61], v9 offset:45056
  v_cvt_pk_bf16_f32 v243, v178, v179
  v_mfma_f32_16x16x32_bf16 v[88:91], a[184:187], v[44:47], v[88:91]
  ds_read_b64_tr_b16 v[62:63], v9 offset:45568
  v_mfma_f32_16x16x32_bf16 v[92:95], a[172:175], v[40:43], v[92:95]
  v_mfma_f32_16x16x32_bf16 v[92:95], a[188:191], v[44:47], v[92:95]
  s_waitcnt vmcnt(23)
  s_barrier
  s_waitcnt lgkmcnt(4)
  v_mfma_f32_16x16x32_bf16 v[96:99], a[160:163], v[48:51], v[96:99]
  ds_read_b64_tr_b16 v[32:33], v6 offset:49152
  v_mfma_f32_16x16x32_bf16 v[96:99], a[176:179], v[52:55], v[96:99]
  ds_read_b64_tr_b16 v[34:35], v6 offset:49664
  v_mfma_f32_16x16x32_bf16 v[100:103], a[164:167], v[48:51], v[100:103]
  v_cvt_pk_bf16_f32 v244, v164, v165
  v_mfma_f32_16x16x32_bf16 v[100:103], a[180:183], v[52:55], v[100:103]
  v_mfma_f32_16x16x32_bf16 v[104:107], a[168:171], v[48:51], v[104:107]
  ds_read_b64_tr_b16 v[36:37], v6 offset:53248
  v_cvt_pk_bf16_f32 v245, v166, v167
  v_mfma_f32_16x16x32_bf16 v[104:107], a[184:187], v[52:55], v[104:107]
  ds_read_b64_tr_b16 v[38:39], v6 offset:53760
  v_mfma_f32_16x16x32_bf16 v[108:111], a[172:175], v[48:51], v[108:111]
  s_add_u32 m0, s84, 0
  s_add_u32 s77, s79, 0
  buffer_load_dwordx4 v2, s[24:27], s77 offen offset:0 lds
  v_mfma_f32_16x16x32_bf16 v[108:111], a[188:191], v[52:55], v[108:111]
  v_cvt_pk_bf16_f32 v246, v180, v181
  s_waitcnt lgkmcnt(4)
  v_mfma_f32_16x16x32_bf16 v[112:115], a[160:163], v[56:59], v[112:115]
  ds_read_b64_tr_b16 v[40:41], v7 offset:49152
  v_cvt_pk_bf16_f32 v247, v182, v183
  v_mfma_f32_16x16x32_bf16 v[112:115], a[176:179], v[60:63], v[112:115]
  ds_read_b64_tr_b16 v[42:43], v7 offset:49664
  v_mfma_f32_16x16x32_bf16 v[116:119], a[164:167], v[56:59], v[116:119]
  s_add_u32 s76, s81, 0
  buffer_store_dwordx4 v[208:211], v1, s[8:11], s76 offen offset:0 sc1
  v_mfma_f32_16x16x32_bf16 v[116:119], a[180:183], v[60:63], v[116:119]
  v_mfma_f32_16x16x32_bf16 v[120:123], a[168:171], v[56:59], v[120:123]
  ds_read_b64_tr_b16 v[44:45], v7 offset:53248
  v_mfma_f32_16x16x32_bf16 v[120:123], a[184:187], v[60:63], v[120:123]
  ds_read_b64_tr_b16 v[46:47], v7 offset:53760
  v_mfma_f32_16x16x32_bf16 v[124:127], a[172:175], v[56:59], v[124:127]
  buffer_load_dwordx4 v3, s[24:27], s77 offen offset:1024 lds
  v_cvt_pk_bf16_f32 v248, v168, v169
  v_mfma_f32_16x16x32_bf16 v[124:127], a[188:191], v[60:63], v[124:127]
  s_waitcnt lgkmcnt(4)
  v_mfma_f32_16x16x32_bf16 v[64:67], a[192:195], v[32:35], v[64:67]
  ds_read_b64_tr_b16 v[48:49], v8 offset:49152
  v_cvt_pk_bf16_f32 v249, v170, v171
  v_mfma_f32_16x16x32_bf16 v[64:67], a[208:211], v[36:39], v[64:67]
  ds_read_b64_tr_b16 v[50:51], v8 offset:49664
  v_mfma_f32_16x16x32_bf16 v[68:71], a[196:199], v[32:35], v[68:71]
  buffer_load_dwordx4 v4, s[24:27], s77 offen offset:2048 lds
  v_cvt_pk_bf16_f32 v250, v184, v185
  v_mfma_f32_16x16x32_bf16 v[68:71], a[212:215], v[36:39], v[68:71]
  v_mfma_f32_16x16x32_bf16 v[72:75], a[200:203], v[32:35], v[72:75]
  ds_read_b64_tr_b16 v[52:53], v8 offset:53248
  v_cvt_pk_bf16_f32 v251, v186, v187
  v_mfma_f32_16x16x32_bf16 v[72:75], a[216:219], v[36:39], v[72:75]
  ds_read_b64_tr_b16 v[54:55], v8 offset:53760
  v_mfma_f32_16x16x32_bf16 v[76:79], a[204:207], v[32:35], v[76:79]
  buffer_load_dwordx4 v5, s[24:27], s77 offen offset:3072 lds
  v_mfma_f32_16x16x32_bf16 v[76:79], a[220:223], v[36:39], v[76:79]
  s_waitcnt lgkmcnt(4)
  v_mfma_f32_16x16x32_bf16 v[80:83], a[192:195], v[40:43], v[80:83]
  ds_read_b64_tr_b16 v[56:57], v9 offset:49152
  v_mfma_f32_16x16x32_bf16 v[80:83], a[208:211], v[44:47], v[80:83]
  ds_read_b64_tr_b16 v[58:59], v9 offset:49664
  v_mfma_f32_16x16x32_bf16 v[84:87], a[196:199], v[40:43], v[84:87]
  v_cvt_pk_bf16_f32 v252, v172, v173
  v_mfma_f32_16x16x32_bf16 v[84:87], a[212:215], v[44:47], v[84:87]
  v_mfma_f32_16x16x32_bf16 v[88:91], a[200:203], v[40:43], v[88:91]
  ds_read_b64_tr_b16 v[60:61], v9 offset:53248
  v_cvt_pk_bf16_f32 v253, v174, v175
  v_mfma_f32_16x16x32_bf16 v[88:91], a[216:219], v[44:47], v[88:91]
  ds_read_b64_tr_b16 v[62:63], v9 offset:53760
  v_mfma_f32_16x16x32_bf16 v[92:95], a[204:207], v[40:43], v[92:95]
  s_add_u32 m0, s84, 16384
  s_add_u32 s77, s79, 524288
  buffer_load_dwordx4 v2, s[24:27], s77 offen offset:0 lds
  v_mfma_f32_16x16x32_bf16 v[92:95], a[220:223], v[44:47], v[92:95]
  v_cvt_pk_bf16_f32 v254, v188, v189
  s_waitcnt lgkmcnt(4)
  v_mfma_f32_16x16x32_bf16 v[96:99], a[192:195], v[48:51], v[96:99]
  ds_read_b64_tr_b16 v[32:33], v6 offset:57344
  v_cvt_pk_bf16_f32 v255, v190, v191
  v_mfma_f32_16x16x32_bf16 v[96:99], a[208:211], v[52:55], v[96:99]
  ds_read_b64_tr_b16 v[34:35], v6 offset:57856
  v_mfma_f32_16x16x32_bf16 v[100:103], a[196:199], v[48:51], v[100:103]
  s_add_u32 s76, s81, 4096
  buffer_store_dwordx4 v[212:215], v1, s[8:11], s76 offen offset:0 sc1
  v_mfma_f32_16x16x32_bf16 v[100:103], a[212:215], v[52:55], v[100:103]
  v_mfma_f32_16x16x32_bf16 v[104:107], a[200:203], v[48:51], v[104:107]
  ds_read_b64_tr_b16 v[36:37], v6 offset:61440
  v_mfma_f32_16x16x32_bf16 v[104:107], a[216:219], v[52:55], v[104:107]
  ds_read_b64_tr_b16 v[38:39], v6 offset:61952
  v_mfma_f32_16x16x32_bf16 v[108:111], a[204:207], v[48:51], v[108:111]
  buffer_load_dwordx4 v3, s[24:27], s77 offen offset:1024 lds
  v_mfma_f32_16x16x32_bf16 v[108:111], a[220:223], v[52:55], v[108:111]
  s_waitcnt lgkmcnt(4)
  v_mfma_f32_16x16x32_bf16 v[112:115], a[192:195], v[56:59], v[112:115]
  ds_read_b64_tr_b16 v[40:41], v7 offset:57344
  v_mfma_f32_16x16x32_bf16 v[112:115], a[208:211], v[60:63], v[112:115]
  ds_read_b64_tr_b16 v[42:43], v7 offset:57856
  v_mfma_f32_16x16x32_bf16 v[116:119], a[196:199], v[56:59], v[116:119]
  buffer_load_dwordx4 v4, s[24:27], s77 offen offset:2048 lds
  v_mfma_f32_16x16x32_bf16 v[116:119], a[212:215], v[60:63], v[116:119]
  v_mfma_f32_16x16x32_bf16 v[120:123], a[200:203], v[56:59], v[120:123]
  ds_read_b64_tr_b16 v[44:45], v7 offset:61440
  v_mfma_f32_16x16x32_bf16 v[120:123], a[216:219], v[60:63], v[120:123]
  ds_read_b64_tr_b16 v[46:47], v7 offset:61952
  v_mfma_f32_16x16x32_bf16 v[124:127], a[204:207], v[56:59], v[124:127]
  buffer_load_dwordx4 v5, s[24:27], s77 offen offset:3072 lds
  v_mfma_f32_16x16x32_bf16 v[124:127], a[220:223], v[60:63], v[124:127]
  s_waitcnt lgkmcnt(4)
  v_mfma_f32_16x16x32_bf16 v[64:67], a[224:227], v[32:35], v[64:67]
  ds_read_b64_tr_b16 v[48:49], v8 offset:57344
  v_mfma_f32_16x16x32_bf16 v[64:67], a[240:243], v[36:39], v[64:67]
  ds_read_b64_tr_b16 v[50:51], v8 offset:57856
  v_mfma_f32_16x16x32_bf16 v[68:71], a[228:231], v[32:35], v[68:71]
  v_mfma_f32_16x16x32_bf16 v[68:71], a[244:247], v[36:39], v[68:71]
  v_mfma_f32_16x16x32_bf16 v[72:75], a[232:235], v[32:35], v[72:75]
  ds_read_b64_tr_b16 v[52:53], v8 offset:61440
  v_mfma_f32_16x16x32_bf16 v[72:75], a[248:251], v[36:39], v[72:75]
  ds_read_b64_tr_b16 v[54:55], v8 offset:61952
  v_mfma_f32_16x16x32_bf16 v[76:79], a[236:239], v[32:35], v[76:79]
  s_add_u32 s76, s81, 8192
  buffer_store_dwordx4 v[216:219], v1, s[8:11], s76 offen offset:0 sc1
  v_mfma_f32_16x16x32_bf16 v[76:79], a[252:255], v[36:39], v[76:79]
  s_waitcnt lgkmcnt(4)
  v_mfma_f32_16x16x32_bf16 v[80:83], a[224:227], v[40:43], v[80:83]
  ds_read_b64_tr_b16 v[56:57], v9 offset:57344
  v_mfma_f32_16x16x32_bf16 v[80:83], a[240:243], v[44:47], v[80:83]
  ds_read_b64_tr_b16 v[58:59], v9 offset:57856
  v_mfma_f32_16x16x32_bf16 v[84:87], a[228:231], v[40:43], v[84:87]
  v_mfma_f32_16x16x32_bf16 v[84:87], a[244:247], v[44:47], v[84:87]
  v_mfma_f32_16x16x32_bf16 v[88:91], a[232:235], v[40:43], v[88:91]
  ds_read_b64_tr_b16 v[60:61], v9 offset:61440
  v_mfma_f32_16x16x32_bf16 v[88:91], a[248:251], v[44:47], v[88:91]
  ds_read_b64_tr_b16 v[62:63], v9 offset:61952
  v_mfma_f32_16x16x32_bf16 v[92:95], a[236:239], v[40:43], v[92:95]
  v_mfma_f32_16x16x32_bf16 v[92:95], a[252:255], v[44:47], v[92:95]
  s_waitcnt vmcnt(18)
  s_barrier
  v_xor_b32 v6, 0x10000, v6
  v_xor_b32 v7, 0x10000, v7
  v_xor_b32 v8, 0x10000, v8
  v_xor_b32 v9, 0x10000, v9
  s_waitcnt lgkmcnt(4)
  v_mfma_f32_16x16x32_bf16 v[96:99], a[224:227], v[48:51], v[96:99]
  ds_read_b64_tr_b16 v[32:33], v6 offset:0
  v_mfma_f32_16x16x32_bf16 v[96:99], a[240:243], v[52:55], v[96:99]
  ds_read_b64_tr_b16 v[34:35], v6 offset:512
  v_mfma_f32_16x16x32_bf16 v[100:103], a[228:231], v[48:51], v[100:103]
  s_add_u32 m0, s84, 32768
  s_add_u32 s77, s79, 1048576
  buffer_load_dwordx4 v2, s[24:27], s77 offen offset:0 lds
  v_mfma_f32_16x16x32_bf16 v[100:103], a[244:247], v[52:55], v[100:103]
  v_mfma_f32_16x16x32_bf16 v[104:107], a[232:235], v[48:51], v[104:107]
  ds_read_b64_tr_b16 v[36:37], v6 offset:24576
  v_mfma_f32_16x16x32_bf16 v[104:107], a[248:251], v[52:55], v[104:107]
  ds_read_b64_tr_b16 v[38:39], v6 offset:25088
  v_mfma_f32_16x16x32_bf16 v[108:111], a[236:239], v[48:51], v[108:111]
  buffer_load_dwordx4 v3, s[24:27], s77 offen offset:1024 lds
  v_mfma_f32_16x16x32_bf16 v[108:111], a[252:255], v[52:55], v[108:111]
  s_waitcnt lgkmcnt(4)
  v_mfma_f32_16x16x32_bf16 v[112:115], a[224:227], v[56:59], v[112:115]
  ds_read_b64_tr_b16 v[40:41], v7 offset:0
  v_mfma_f32_16x16x32_bf16 v[112:115], a[240:243], v[60:63], v[112:115]
  ds_read_b64_tr_b16 v[42:43], v7 offset:512
  v_mfma_f32_16x16x32_bf16 v[116:119], a[228:231], v[56:59], v[116:119]
  s_add_u32 s76, s81, 12288
  buffer_store_dwordx4 v[220:223], v1, s[8:11], s76 offen offset:0 sc1
  v_mfma_f32_16x16x32_bf16 v[116:119], a[244:247], v[60:63], v[116:119]
  v_mfma_f32_16x16x32_bf16 v[120:123], a[232:235], v[56:59], v[120:123]
  ds_read_b64_tr_b16 v[44:45], v7 offset:24576
  v_mfma_f32_16x16x32_bf16 v[120:123], a[248:251], v[60:63], v[120:123]
  ds_read_b64_tr_b16 v[46:47], v7 offset:25088
  v_mfma_f32_16x16x32_bf16 v[124:127], a[236:239], v[56:59], v[124:127]
  buffer_load_dwordx4 v4, s[24:27], s77 offen offset:2048 lds
  v_mfma_f32_16x16x32_bf16 v[124:127], a[252:255], v[60:63], v[124:127]
  s_waitcnt lgkmcnt(4)
  v_mfma_f32_16x16x32_bf16 v[128:131], a[0:3], v[32:35], 0
  ds_read_b64_tr_b16 v[48:49], v6 offset:49152
  v_mfma_f32_16x16x32_bf16 v[128:131], a[16:19], v[36:39], v[128:131]
  ds_read_b64_tr_b16 v[50:51], v6 offset:49664
  v_mfma_f32_16x16x32_bf16 v[132:135], a[4:7], v[32:35], 0
  buffer_load_dwordx4 v5, s[24:27], s77 offen offset:3072 lds
  v_mfma_f32_16x16x32_bf16 v[132:135], a[20:23], v[36:39], v[132:135]
  v_mfma_f32_16x16x32_bf16 v[136:139], a[8:11], v[32:35], 0
  ds_read_b64_tr_b16 v[52:53], v10 offset:8192
  v_mfma_f32_16x16x32_bf16 v[136:139], a[24:27], v[36:39], v[136:139]
  ds_read_b64_tr_b16 v[54:55], v10 offset:8704
  v_mfma_f32_16x16x32_bf16 v[140:143], a[12:15], v[32:35], 0
  v_mfma_f32_16x16x32_bf16 v[140:143], a[28:31], v[36:39], v[140:143]
  s_waitcnt lgkmcnt(4)
  v_mfma_f32_16x16x32_bf16 v[144:147], a[0:3], v[40:43], 0
  ds_read_b64_tr_b16 v[56:57], v7 offset:49152
  v_mfma_f32_16x16x32_bf16 v[144:147], a[16:19], v[44:47], v[144:147]
  ds_read_b64_tr_b16 v[58:59], v7 offset:49664
  v_mfma_f32_16x16x32_bf16 v[148:151], a[4:7], v[40:43], 0
  v_mfma_f32_16x16x32_bf16 v[148:151], a[20:23], v[44:47], v[148:151]
  v_mfma_f32_16x16x32_bf16 v[152:155], a[8:11], v[40:43], 0
  ds_read_b64_tr_b16 v[60:61], v11 offset:8192
  s_lshl_b32 s90, s5, 10
  v_mfma_f32_16x16x32_bf16 v[152:155], a[24:27], v[44:47], v[152:155]
  ds_read_b64_tr_b16 v[62:63], v11 offset:8704
  v_cvt_pk_bf16_f32 v64, v64, v65
  v_mfma_f32_16x16x32_bf16 v[156:159], a[12:15], v[40:43], 0
  s_add_u32 s76, s81, 0
  buffer_store_dwordx4 v[240:243], v1, s[8:11], s76 offen offset:1024 sc1
  v_mfma_f32_16x16x32_bf16 v[156:159], a[28:31], v[44:47], v[156:159]
  v_cvt_pk_bf16_f32 v65, v66, v67
  s_waitcnt lgkmcnt(4)
  v_mfma_f32_16x16x32_bf16 v[128:131], a[32:35], v[48:51], v[128:131]
  ds_read_b64_tr_b16 v[32:33], v6 offset:4096
  s_add_u32 s90, s90, 39075840
  v_mfma_f32_16x16x32_bf16 v[128:131], a[48:51], v[52:55], v[128:131]
  ds_read_b64_tr_b16 v[34:35], v6 offset:4608
  v_cvt_pk_bf16_f32 v66, v68, v69
  v_mfma_f32_16x16x32_bf16 v[132:135], a[36:39], v[48:51], v[132:135]
  v_cvt_pk_bf16_f32 v67, v70, v71
  v_mfma_f32_16x16x32_bf16 v[132:135], a[52:55], v[52:55], v[132:135]
  v_mfma_f32_16x16x32_bf16 v[136:139], a[40:43], v[48:51], v[136:139]
  ds_read_b64_tr_b16 v[36:37], v6 offset:28672
  v_mfma_f32_16x16x32_bf16 v[136:139], a[56:59], v[52:55], v[136:139]
  ds_read_b64_tr_b16 v[38:39], v6 offset:29184
  v_mfma_f32_16x16x32_bf16 v[140:143], a[44:47], v[48:51], v[140:143]
  s_cmp_eq_u32 s3, 0
  s_cselect_b32 s90, s90, 0x7ff00000
  v_mfma_f32_16x16x32_bf16 v[140:143], a[60:63], v[52:55], v[140:143]
  v_cvt_pk_bf16_f32 v72, v72, v73
  s_waitcnt lgkmcnt(4)
  v_mfma_f32_16x16x32_bf16 v[144:147], a[32:35], v[56:59], v[144:147]
  ds_read_b64_tr_b16 v[40:41], v7 offset:4096
  v_and_b32 v18, 31, v0
  v_mfma_f32_16x16x32_bf16 v[144:147], a[48:51], v[60:63], v[144:147]
  ds_read_b64_tr_b16 v[42:43], v7 offset:4608
  v_cvt_pk_bf16_f32 v73, v74, v75
  v_mfma_f32_16x16x32_bf16 v[148:151], a[36:39], v[56:59], v[148:151]
  v_cvt_pk_bf16_f32 v74, v76, v77
  v_mfma_f32_16x16x32_bf16 v[148:151], a[52:55], v[60:63], v[148:151]
  v_mfma_f32_16x16x32_bf16 v[152:155], a[40:43], v[56:59], v[152:155]
  ds_read_b64_tr_b16 v[44:45], v7 offset:28672
  v_lshlrev_b32 v18, 5, v18
  v_mfma_f32_16x16x32_bf16 v[152:155], a[56:59], v[60:63], v[152:155]
  ds_read_b64_tr_b16 v[46:47], v7 offset:29184
  v_cvt_pk_bf16_f32 v75, v78, v79
  v_mfma_f32_16x16x32_bf16 v[156:159], a[44:47], v[56:59], v[156:159]
  v_mfma_f32_16x16x32_bf16 v[156:159], a[60:63], v[60:63], v[156:159]
  s_waitcnt lgkmcnt(4)
  v_mfma_f32_16x16x32_bf16 v[128:131], a[64:67], v[32:35], v[128:131]
  ds_read_b64_tr_b16 v[48:49], v6 offset:53248
  v_cvt_pk_bf16_f32 v80, v80, v81
  v_mfma_f32_16x16x32_bf16 v[128:131], a[80:83], v[36:39], v[128:131]
  ds_read_b64_tr_b16 v[50:51], v6 offset:53760
  v_mfma_f32_16x16x32_bf16 v[132:135], a[68:71], v[32:35], v[132:135]
  v_cvt_pk_bf16_f32 v81, v82, v83
  v_mfma_f32_16x16x32_bf16 v[132:135], a[84:87], v[36:39], v[132:135]
  v_mfma_f32_16x16x32_bf16 v[136:139], a[72:75], v[32:35], v[136:139]
  ds_read_b64_tr_b16 v[52:53], v10 offset:12288
  v_cvt_pk_bf16_f32 v82, v84, v85
  v_mfma_f32_16x16x32_bf16 v[136:139], a[88:91], v[36:39], v[136:139]
  ds_read_b64_tr_b16 v[54:55], v10 offset:12800
  v_mfma_f32_16x16x32_bf16 v[140:143], a[76:79], v[32:35], v[140:143]
  s_add_u32 s76, s81, 4096
  buffer_store_dwordx4 v[244:247], v1, s[8:11], s76 offen offset:1024 sc1
  v_mfma_f32_16x16x32_bf16 v[140:143], a[92:95], v[36:39], v[140:143]
  v_cvt_pk_bf16_f32 v83, v86, v87
  s_waitcnt lgkmcnt(4)
  v_mfma_f32_16x16x32_bf16 v[144:147], a[64:67], v[40:43], v[144:147]
  ds_read_b64_tr_b16 v[56:57], v7 offset:53248
  v_mfma_f32_16x16x32_bf16 v[144:147], a[80:83], v[44:47], v[144:147]
  ds_read_b64_tr_b16 v[58:59], v7 offset:53760
  v_mfma_f32_16x16x32_bf16 v[148:151], a[68:71], v[40:43], v[148:151]
  v_cvt_pk_bf16_f32 v88, v88, v89
  v_mfma_f32_16x16x32_bf16 v[148:151], a[84:87], v[44:47], v[148:151]
  v_mfma_f32_16x16x32_bf16 v[152:155], a[72:75], v[40:43], v[152:155]
  ds_read_b64_tr_b16 v[60:61], v11 offset:12288
  v_cvt_pk_bf16_f32 v89, v90, v91
  v_mfma_f32_16x16x32_bf16 v[152:155], a[88:91], v[44:47], v[152:155]
  ds_read_b64_tr_b16 v[62:63], v11 offset:12800
  v_mfma_f32_16x16x32_bf16 v[156:159], a[76:79], v[40:43], v[156:159]
  v_cvt_pk_bf16_f32 v90, v92, v93
  v_mfma_f32_16x16x32_bf16 v[156:159], a[92:95], v[44:47], v[156:159]
  s_barrier
  s_waitcnt lgkmcnt(4)
  v_mfma_f32_16x16x32_bf16 v[128:131], a[96:99], v[48:51], v[128:131]
  ds_read_b64_tr_b16 v[32:33], v6 offset:8192
  v_cvt_pk_bf16_f32 v91, v94, v95
  v_mfma_f32_16x16x32_bf16 v[128:131], a[112:115], v[52:55], v[128:131]
  ds_read_b64_tr_b16 v[34:35], v6 offset:8704
  v_mfma_f32_16x16x32_bf16 v[132:135], a[100:103], v[48:51], v[132:135]
  s_add_u32 m0, s84, 49152
  s_add_u32 s77, s79, 1572864
  buffer_load_dwordx4 v2, s[24:27], s77 offen offset:0 lds
  v_mfma_f32_16x16x32_bf16 v[132:135], a[116:119], v[52:55], v[132:135]
  v_mfma_f32_16x16x32_bf16 v[136:139], a[104:107], v[48:51], v[136:139]
  ds_read_b64_tr_b16 v[36:37], v6 offset:32768
  v_cvt_pk_bf16_f32 v96, v96, v97
  v_mfma_f32_16x16x32_bf16 v[136:139], a[120:123], v[52:55], v[136:139]
  ds_read_b64_tr_b16 v[38:39], v6 offset:33280
  v_mfma_f32_16x16x32_bf16 v[140:143], a[108:111], v[48:51], v[140:143]
  buffer_load_dwordx4 v3, s[24:27], s77 offen offset:1024 lds
  v_cvt_pk_bf16_f32 v97, v98, v99
  v_mfma_f32_16x16x32_bf16 v[140:143], a[124:127], v[52:55], v[140:143]
  s_waitcnt lgkmcnt(4)
  v_mfma_f32_16x16x32_bf16 v[144:147], a[96:99], v[56:59], v[144:147]
  ds_read_b64_tr_b16 v[40:41], v7 offset:8192
  v_cvt_pk_bf16_f32 v98, v100, v101
  v_mfma_f32_16x16x32_bf16 v[144:147], a[112:115], v[60:63], v[144:147]
  ds_read_b64_tr_b16 v[42:43], v7 offset:8704
  v_mfma_f32_16x16x32_bf16 v[148:151], a[100:103], v[56:59], v[148:151]
  s_add_u32 s76, s81, 8192
  buffer_store_dwordx4 v[248:251], v1, s[8:11], s76 offen offset:1024 sc1
  v_mfma_f32_16x16x32_bf16 v[148:151], a[116:119], v[60:63], v[148:151]
  v_cvt_pk_bf16_f32 v99, v102, v103
  v_mfma_f32_16x16x32_bf16 v[152:155], a[104:107], v[56:59], v[152:155]
  ds_read_b64_tr_b16 v[44:45], v7 offset:32768
  v_mfma_f32_16x16x32_bf16 v[152:155], a[120:123], v[60:63], v[152:155]
  ds_read_b64_tr_b16 v[46:47], v7 offset:33280
  v_mfma_f32_16x16x32_bf16 v[156:159], a[108:111], v[56:59], v[156:159]
  buffer_load_dwordx4 v4, s[24:27], s77 offen offset:2048 lds
  v_cvt_pk_bf16_f32 v104, v104, v105
  v_mfma_f32_16x16x32_bf16 v[156:159], a[124:127], v[60:63], v[156:159]
  s_waitcnt lgkmcnt(4)
  v_mfma_f32_16x16x32_bf16 v[128:131], a[128:131], v[32:35], v[128:131]
  ds_read_b64_tr_b16 v[48:49], v6 offset:57344
  v_cvt_pk_bf16_f32 v105, v106, v107
  v_mfma_f32_16x16x32_bf16 v[128:131], a[144:147], v[36:39], v[128:131]
  ds_read_b64_tr_b16 v[50:51], v6 offset:57856
  v_mfma_f32_16x16x32_bf16 v[132:135], a[132:135], v[32:35], v[132:135]
  buffer_load_dwordx4 v5, s[24:27], s77 offen offset:3072 lds
  v_cvt_pk_bf16_f32 v106, v108, v109
  v_mfma_f32_16x16x32_bf16 v[132:135], a[148:151], v[36:39], v[132:135]
  v_mfma_f32_16x16x32_bf16 v[136:139], a[136:139], v[32:35], v[136:139]
  ds_read_b64_tr_b16 v[52:53], v10 offset:16384
  v_cvt_pk_bf16_f32 v107, v110, v111
  v_mfma_f32_16x16x32_bf16 v[136:139], a[152:155], v[36:39], v[136:139]
  ds_read_b64_tr_b16 v[54:55], v10 offset:16896
  v_mfma_f32_16x16x32_bf16 v[140:143], a[140:143], v[32:35], v[140:143]
  buffer_load_dword v19, v18, s[8:11], s90 offen sc1
  v_mfma_f32_16x16x32_bf16 v[140:143], a[156:159], v[36:39], v[140:143]
  s_waitcnt lgkmcnt(4)
  v_mfma_f32_16x16x32_bf16 v[144:147], a[128:131], v[40:43], v[144:147]
  ds_read_b64_tr_b16 v[56:57], v7 offset:57344
  v_cvt_pk_bf16_f32 v112, v112, v113
  v_mfma_f32_16x16x32_bf16 v[144:147], a[144:147], v[44:47], v[144:147]
  ds_read_b64_tr_b16 v[58:59], v7 offset:57856
  v_mfma_f32_16x16x32_bf16 v[148:151], a[132:135], v[40:43], v[148:151]
  v_cvt_pk_bf16_f32 v113, v114, v115
  v_mfma_f32_16x16x32_bf16 v[148:151], a[148:151], v[44:47], v[148:151]
  v_mfma_f32_16x16x32_bf16 v[152:155], a[136:139], v[40:43], v[152:155]
  ds_read_b64_tr_b16 v[60:61], v11 offset:16384
  v_cvt_pk_bf16_f32 v114, v116, v117
  v_mfma_f32_16x16x32_bf16 v[152:155], a[152:155], v[44:47], v[152:155]
  ds_read_b64_tr_b16 v[62:63], v11 offset:16896
  v_mfma_f32_16x16x32_bf16 v[156:159], a[140:143], v[40:43], v[156:159]
  s_add_u32 s76, s81, 12288
  buffer_store_dwordx4 v[252:255], v1, s[8:11], s76 offen offset:1024 sc1
  v_mfma_f32_16x16x32_bf16 v[156:159], a[156:159], v[44:47], v[156:159]
  v_cvt_pk_bf16_f32 v115, v118, v119
  s_waitcnt lgkmcnt(4)
  v_mfma_f32_16x16x32_bf16 v[128:131], a[160:163], v[48:51], v[128:131]
  ds_read_b64_tr_b16 v[32:33], v6 offset:12288
  v_mfma_f32_16x16x32_bf16 v[128:131], a[176:179], v[52:55], v[128:131]
  ds_read_b64_tr_b16 v[34:35], v6 offset:12800
  v_mfma_f32_16x16x32_bf16 v[132:135], a[164:167], v[48:51], v[132:135]
  s_lshl_b32 s88, s5, 2
  v_cvt_pk_bf16_f32 v120, v120, v121
  v_mfma_f32_16x16x32_bf16 v[132:135], a[180:183], v[52:55], v[132:135]
  v_mfma_f32_16x16x32_bf16 v[136:139], a[168:171], v[48:51], v[136:139]
  ds_read_b64_tr_b16 v[36:37], v6 offset:36864
  s_sub_u32 s89, 60, s88
  v_mfma_f32_16x16x32_bf16 v[136:139], a[184:187], v[52:55], v[136:139]
  ds_read_b64_tr_b16 v[38:39], v6 offset:37376
  v_cvt_pk_bf16_f32 v121, v122, v123
  v_mfma_f32_16x16x32_bf16 v[140:143], a[172:175], v[48:51], v[140:143]
  v_cvt_pk_bf16_f32 v122, v124, v125
  v_mfma_f32_16x16x32_bf16 v[140:143], a[188:191], v[52:55], v[140:143]
  s_add_u32 s88, s88, s3
  s_waitcnt lgkmcnt(4)
  v_mfma_f32_16x16x32_bf16 v[144:147], a[160:163], v[56:59], v[144:147]
  ds_read_b64_tr_b16 v[40:41], v7 offset:12288
  v_cvt_pk_bf16_f32 v123, v126, v127
  v_mfma_f32_16x16x32_bf16 v[144:147], a[176:179], v[60:63], v[144:147]
  ds_read_b64_tr_b16 v[42:43], v7 offset:12800
  s_add_u32 s89, s89, s3
  v_mfma_f32_16x16x32_bf16 v[148:151], a[164:167], v[56:59], v[148:151]
  v_mfma_f32_16x16x32_bf16 v[148:151], a[180:183], v[60:63], v[148:151]
  v_mfma_f32_16x16x32_bf16 v[152:155], a[168:171], v[56:59], v[152:155]
  ds_read_b64_tr_b16 v[44:45], v7 offset:36864
  s_lshl_b32 s32, s89, 15
  v_mfma_f32_16x16x32_bf16 v[152:155], a[184:187], v[60:63], v[152:155]
  ds_read_b64_tr_b16 v[46:47], v7 offset:37376
  v_mfma_f32_16x16x32_bf16 v[156:159], a[172:175], v[56:59], v[156:159]
  v_mfma_f32_16x16x32_bf16 v[156:159], a[188:191], v[60:63], v[156:159]
  s_add_u32 s32, s32, 33554432
  s_waitcnt lgkmcnt(4)
  v_mfma_f32_16x16x32_bf16 v[128:131], a[192:195], v[32:35], v[128:131]
  ds_read_b64_tr_b16 v[48:49], v6 offset:61440
  v_mfma_f32_16x16x32_bf16 v[128:131], a[208:211], v[36:39], v[128:131]
  ds_read_b64_tr_b16 v[50:51], v6 offset:61952
  s_add_u32 s33, s32, 16384
  v_mfma_f32_16x16x32_bf16 v[132:135], a[196:199], v[32:35], v[132:135]
  v_mfma_f32_16x16x32_bf16 v[132:135], a[212:215], v[36:39], v[132:135]
  v_mfma_f32_16x16x32_bf16 v[136:139], a[200:203], v[32:35], v[136:139]
  ds_read_b64_tr_b16 v[52:53], v10 offset:20480
  s_lshl_b32 s34, s88, 15
  v_mfma_f32_16x16x32_bf16 v[136:139], a[216:219], v[36:39], v[136:139]
  ds_read_b64_tr_b16 v[54:55], v10 offset:20992
  v_mfma_f32_16x16x32_bf16 v[140:143], a[204:207], v[32:35], v[140:143]
  s_add_u32 s34, s34, 33554432
  v_mfma_f32_16x16x32_bf16 v[140:143], a[220:223], v[36:39], v[140:143]
  s_waitcnt lgkmcnt(4)
  v_mfma_f32_16x16x32_bf16 v[144:147], a[192:195], v[40:43], v[144:147]
  ds_read_b64_tr_b16 v[56:57], v7 offset:61440
  v_mfma_f32_16x16x32_bf16 v[144:147], a[208:211], v[44:47], v[144:147]
  ds_read_b64_tr_b16 v[58:59], v7 offset:61952
  s_add_u32 s35, s34, 16384
  v_mfma_f32_16x16x32_bf16 v[148:151], a[196:199], v[40:43], v[148:151]
  s_add_u32 s76, s82, 0
  buffer_store_dwordx4 v[64:67], v1, s[8:11], s76 offen offset:0 sc1
  v_mfma_f32_16x16x32_bf16 v[148:151], a[212:215], v[44:47], v[148:151]
  v_mfma_f32_16x16x32_bf16 v[152:155], a[200:203], v[40:43], v[152:155]
  ds_read_b64_tr_b16 v[60:61], v11 offset:20480
  v_mfma_f32_16x16x32_bf16 v[152:155], a[216:219], v[44:47], v[152:155]
  ds_read_b64_tr_b16 v[62:63], v11 offset:20992
  v_mfma_f32_16x16x32_bf16 v[156:159], a[204:207], v[40:43], v[156:159]
  v_mfma_f32_16x16x32_bf16 v[156:159], a[220:223], v[44:47], v[156:159]
  s_waitcnt lgkmcnt(4)
  v_mfma_f32_16x16x32_bf16 v[128:131], a[224:227], v[48:51], v[128:131]
  ds_read_b64_tr_b16 v[32:33], v8 offset:0
  v_mfma_f32_16x16x32_bf16 v[128:131], a[240:243], v[52:55], v[128:131]
  ds_read_b64_tr_b16 v[34:35], v8 offset:512
  v_mfma_f32_16x16x32_bf16 v[132:135], a[228:231], v[48:51], v[132:135]
  v_mfma_f32_16x16x32_bf16 v[132:135], a[244:247], v[52:55], v[132:135]
  s_waitcnt vmcnt(2)
  s_cmp_lg_u32 s3, 0
  s_cbranch_scc1 Lokf_2
  v_cmp_ne_u32 vcc, 1, v19
  s_nop 0
  s_cmp_lg_u64 vcc, 0
  s_cbranch_scc0 Lokf_2
  s_mov_b32 s87, 0x80000
Lspf_2:
  s_sub_u32 s87, s87, 1
  s_cbranch_scc1 Lokf_2
  s_sleep 1
  buffer_load_dword v19, v18, s[8:11], s90 offen sc1
  s_waitcnt vmcnt(0)
  v_cmp_ne_u32 vcc, 1, v19
  s_nop 0
  s_cmp_lg_u64 vcc, 0
  s_cbranch_scc1 Lspf_2
Lokf_2:
  s_barrier
  v_mfma_f32_16x16x32_bf16 v[136:139], a[232:235], v[48:51], v[136:139]
  ds_read_b64_tr_b16 v[36:37], v8 offset:24576
  v_mfma_f32_16x16x32_bf16 v[136:139], a[248:251], v[52:55], v[136:139]
  ds_read_b64_tr_b16 v[38:39], v8 offset:25088
  v_mfma_f32_16x16x32_bf16 v[140:143], a[236:239], v[48:51], v[140:143]
  buffer_load_dwordx4 v[192:195], v1, s[8:11], s32 offen offset:0 sc1
  v_mfma_f32_16x16x32_bf16 v[140:143], a[252:255], v[52:55], v[140:143]
  s_waitcnt lgkmcnt(4)
  v_mfma_f32_16x16x32_bf16 v[144:147], a[224:227], v[56:59], v[144:147]
  ds_read_b64_tr_b16 v[40:41], v9 offset:0
  v_mfma_f32_16x16x32_bf16 v[144:147], a[240:243], v[60:63], v[144:147]
  ds_read_b64_tr_b16 v[42:43], v9 offset:512
  v_mfma_f32_16x16x32_bf16 v[148:151], a[228:231], v[56:59], v[148:151]
  buffer_load_dwordx4 v[196:199], v1, s[8:11], s33 offen offset:0 sc1
  v_mfma_f32_16x16x32_bf16 v[148:151], a[244:247], v[60:63], v[148:151]
  v_mfma_f32_16x16x32_bf16 v[152:155], a[232:235], v[56:59], v[152:155]
  ds_read_b64_tr_b16 v[44:45], v9 offset:24576
  v_mfma_f32_16x16x32_bf16 v[152:155], a[248:251], v[60:63], v[152:155]
  ds_read_b64_tr_b16 v[46:47], v9 offset:25088
  v_mfma_f32_16x16x32_bf16 v[156:159], a[236:239], v[56:59], v[156:159]
  s_add_u32 s76, s82, 8192
  buffer_store_dwordx4 v[72:75], v1, s[8:11], s76 offen offset:0 sc1
  v_mfma_f32_16x16x32_bf16 v[156:159], a[252:255], v[60:63], v[156:159]
  s_waitcnt lgkmcnt(4)
  v_mfma_f32_16x16x32_bf16 v[160:163], a[0:3], v[32:35], 0
  ds_read_b64_tr_b16 v[48:49], v8 offset:49152
  v_mfma_f32_16x16x32_bf16 v[160:163], a[16:19], v[36:39], v[160:163]
  ds_read_b64_tr_b16 v[50:51], v8 offset:49664
  v_mfma_f32_16x16x32_bf16 v[164:167], a[4:7], v[32:35], 0
  buffer_load_dwordx4 v[200:203], v1, s[8:11], s34 offen offset:0 sc1
  v_mfma_f32_16x16x32_bf16 v[164:167], a[20:23], v[36:39], v[164:167]
  v_mfma_f32_16x16x32_bf16 v[168:171], a[8:11], v[32:35], 0
  ds_read_b64_tr_b16 v[52:53], v12 offset:8192
  v_mfma_f32_16x16x32_bf16 v[168:171], a[24:27], v[36:39], v[168:171]
  ds_read_b64_tr_b16 v[54:55], v12 offset:8704
  v_mfma_f32_16x16x32_bf16 v[172:175], a[12:15], v[32:35], 0
  buffer_load_dwordx4 v[204:207], v1, s[8:11], s35 offen offset:0 sc1
  v_mfma_f32_16x16x32_bf16 v[172:175], a[28:31], v[36:39], v[172:175]
  s_waitcnt lgkmcnt(4)
  v_mfma_f32_16x16x32_bf16 v[176:179], a[0:3], v[40:43], 0
  ds_read_b64_tr_b16 v[56:57], v9 offset:49152
  v_mfma_f32_16x16x32_bf16 v[176:179], a[16:19], v[44:47], v[176:179]
  ds_read_b64_tr_b16 v[58:59], v9 offset:49664
  v_mfma_f32_16x16x32_bf16 v[180:183], a[4:7], v[40:43], 0
  buffer_load_dwordx4 v[208:211], v1, s[8:11], s32 offen offset:1024 sc1
  v_mfma_f32_16x16x32_bf16 v[180:183], a[20:23], v[44:47], v[180:183]
  v_mfma_f32_16x16x32_bf16 v[184:187], a[8:11], v[40:43], 0
  ds_read_b64_tr_b16 v[60:61], v13 offset:8192
  v_mfma_f32_16x16x32_bf16 v[184:187], a[24:27], v[44:47], v[184:187]
  ds_read_b64_tr_b16 v[62:63], v13 offset:8704
  v_mfma_f32_16x16x32_bf16 v[188:191], a[12:15], v[40:43], 0
  s_add_u32 s76, s82, 0
  buffer_store_dwordx4 v[80:83], v1, s[8:11], s76 offen offset:1024 sc1
  v_mfma_f32_16x16x32_bf16 v[188:191], a[28:31], v[44:47], v[188:191]
  s_waitcnt lgkmcnt(4)
  v_mfma_f32_16x16x32_bf16 v[160:163], a[32:35], v[48:51], v[160:163]
  ds_read_b64_tr_b16 v[32:33], v8 offset:4096
  v_mfma_f32_16x16x32_bf16 v[160:163], a[48:51], v[52:55], v[160:163]
  ds_read_b64_tr_b16 v[34:35], v8 offset:4608
  v_mfma_f32_16x16x32_bf16 v[164:167], a[36:39], v[48:51], v[164:167]
  buffer_load_dwordx4 v[212:215], v1, s[8:11], s33 offen offset:1024 sc1
  v_mfma_f32_16x16x32_bf16 v[164:167], a[52:55], v[52:55], v[164:167]
  v_mfma_f32_16x16x32_bf16 v[168:171], a[40:43], v[48:51], v[168:171]
  ds_read_b64_tr_b16 v[36:37], v8 offset:28672
  v_mfma_f32_16x16x32_bf16 v[168:171], a[56:59], v[52:55], v[168:171]
  ds_read_b64_tr_b16 v[38:39], v8 offset:29184
  v_mfma_f32_16x16x32_bf16 v[172:175], a[44:47], v[48:51], v[172:175]
  buffer_load_dwordx4 v[216:219], v1, s[8:11], s34 offen offset:1024 sc1
  v_mfma_f32_16x16x32_bf16 v[172:175], a[60:63], v[52:55], v[172:175]
  s_waitcnt lgkmcnt(4)
  v_mfma_f32_16x16x32_bf16 v[176:179], a[32:35], v[56:59], v[176:179]
  ds_read_b64_tr_b16 v[40:41], v9 offset:4096
  v_mfma_f32_16x16x32_bf16 v[176:179], a[48:51], v[60:63], v[176:179]
  ds_read_b64_tr_b16 v[42:43], v9 offset:4608
  v_mfma_f32_16x16x32_bf16 v[180:183], a[36:39], v[56:59], v[180:183]
  buffer_load_dwordx4 v[220:223], v1, s[8:11], s35 offen offset:1024 sc1
  v_mfma_f32_16x16x32_bf16 v[180:183], a[52:55], v[60:63], v[180:183]
  v_mfma_f32_16x16x32_bf16 v[184:187], a[40:43], v[56:59], v[184:187]
  ds_read_b64_tr_b16 v[44:45], v9 offset:28672
  v_mfma_f32_16x16x32_bf16 v[184:187], a[56:59], v[60:63], v[184:187]
  ds_read_b64_tr_b16 v[46:47], v9 offset:29184
  v_mfma_f32_16x16x32_bf16 v[188:191], a[44:47], v[56:59], v[188:191]
  buffer_load_dwordx4 v[224:227], v1, s[8:11], s32 offen offset:2048 sc1
  v_mfma_f32_16x16x32_bf16 v[188:191], a[60:63], v[60:63], v[188:191]
  s_waitcnt lgkmcnt(4)
  v_mfma_f32_16x16x32_bf16 v[160:163], a[64:67], v[32:35], v[160:163]
  ds_read_b64_tr_b16 v[48:49], v8 offset:53248
  v_mfma_f32_16x16x32_bf16 v[160:163], a[80:83], v[36:39], v[160:163]
  ds_read_b64_tr_b16 v[50:51], v8 offset:53760
  v_mfma_f32_16x16x32_bf16 v[164:167], a[68:71], v[32:35], v[164:167]
  s_add_u32 s76, s82, 8192
  buffer_store_dwordx4 v[88:91], v1, s[8:11], s76 offen offset:1024 sc1
  v_mfma_f32_16x16x32_bf16 v[164:167], a[84:87], v[36:39], v[164:167]
  v_mfma_f32_16x16x32_bf16 v[168:171], a[72:75], v[32:35], v[168:171]
  ds_read_b64_tr_b16 v[52:53], v12 offset:12288
  v_mfma_f32_16x16x32_bf16 v[168:171], a[88:91], v[36:39], v[168:171]
  ds_read_b64_tr_b16 v[54:55], v12 offset:12800
  v_mfma_f32_16x16x32_bf16 v[172:175], a[76:79], v[32:35], v[172:175]
  buffer_load_dwordx4 v[228:231], v1, s[8:11], s33 offen offset:2048 sc1
  v_mfma_f32_16x16x32_bf16 v[172:175], a[92:95], v[36:39], v[172:175]
  s_waitcnt lgkmcnt(4)
  v_mfma_f32_16x16x32_bf16 v[176:179], a[64:67], v[40:43], v[176:179]
  ds_read_b64_tr_b16 v[56:57], v9 offset:53248
  v_mfma_f32_16x16x32_bf16 v[176:179], a[80:83], v[44:47], v[176:179]
  ds_read_b64_tr_b16 v[58:59], v9 offset:53760
  v_mfma_f32_16x16x32_bf16 v[180:183], a[68:71], v[40:43], v[180:183]
  buffer_load_dwordx4 v[232:235], v1, s[8:11], s34 offen offset:2048 sc1
  v_mfma_f32_16x16x32_bf16 v[180:183], a[84:87], v[44:47], v[180:183]
  v_mfma_f32_16x16x32_bf16 v[184:187], a[72:75], v[40:43], v[184:187]
  ds_read_b64_tr_b16 v[60:61], v13 offset:12288
  v_mfma_f32_16x16x32_bf16 v[184:187], a[88:91], v[44:47], v[184:187]
  ds_read_b64_tr_b16 v[62:63], v13 offset:12800
  v_mfma_f32_16x16x32_bf16 v[188:191], a[76:79], v[40:43], v[188:191]
  buffer_load_dwordx4 v[236:239], v1, s[8:11], s35 offen offset:2048 sc1
  v_mfma_f32_16x16x32_bf16 v[188:191], a[92:95], v[44:47], v[188:191]
  s_waitcnt lgkmcnt(4)
  v_mfma_f32_16x16x32_bf16 v[160:163], a[96:99], v[48:51], v[160:163]
  ds_read_b64_tr_b16 v[32:33], v8 offset:8192
  v_mfma_f32_16x16x32_bf16 v[160:163], a[112:115], v[52:55], v[160:163]
  ds_read_b64_tr_b16 v[34:35], v8 offset:8704
  v_mfma_f32_16x16x32_bf16 v[164:167], a[100:103], v[48:51], v[164:167]
  buffer_load_dwordx4 v[240:243], v1, s[8:11], s32 offen offset:3072 sc1
  s_add_u32 s32, s32, 4096
  v_mfma_f32_16x16x32_bf16 v[164:167], a[116:119], v[52:55], v[164:167]
  v_mfma_f32_16x16x32_bf16 v[168:171], a[104:107], v[48:51], v[168:171]
  ds_read_b64_tr_b16 v[36:37], v8 offset:32768
  v_mfma_f32_16x16x32_bf16 v[168:171], a[120:123], v[52:55], v[168:171]
  ds_read_b64_tr_b16 v[38:39], v8 offset:33280
  v_mfma_f32_16x16x32_bf16 v[172:175], a[108:111], v[48:51], v[172:175]
  s_add_u32 s76, s82, 0
  buffer_store_dwordx4 v[96:99], v1, s[8:11], s76 offen offset:2048 sc1
  v_mfma_f32_16x16x32_bf16 v[172:175], a[124:127], v[52:55], v[172:175]
  s_waitcnt lgkmcnt(4)
  v_mfma_f32_16x16x32_bf16 v[176:179], a[96:99], v[56:59], v[176:179]
  ds_read_b64_tr_b16 v[40:41], v9 offset:8192
  v_mfma_f32_16x16x32_bf16 v[176:179], a[112:115], v[60:63], v[176:179]
  ds_read_b64_tr_b16 v[42:43], v9 offset:8704
  v_mfma_f32_16x16x32_bf16 v[180:183], a[100:103], v[56:59], v[180:183]
  buffer_load_dwordx4 v[244:247], v1, s[8:11], s33 offen offset:3072 sc1
  s_add_u32 s33, s33, 4096
  v_mfma_f32_16x16x32_bf16 v[180:183], a[116:119], v[60:63], v[180:183]
  v_mfma_f32_16x16x32_bf16 v[184:187], a[104:107], v[56:59], v[184:187]
  ds_read_b64_tr_b16 v[44:45], v9 offset:32768
  v_mfma_f32_16x16x32_bf16 v[184:187], a[120:123], v[60:63], v[184:187]
  ds_read_b64_tr_b16 v[46:47], v9 offset:33280
  v_mfma_f32_16x16x32_bf16 v[188:191], a[108:111], v[56:59], v[188:191]
  buffer_load_dwordx4 v[248:251], v1, s[8:11], s34 offen offset:3072 sc1
  s_add_u32 s34, s34, 4096
  v_mfma_f32_16x16x32_bf16 v[188:191], a[124:127], v[60:63], v[188:191]
  s_waitcnt lgkmcnt(4)
  v_mfma_f32_16x16x32_bf16 v[160:163], a[128:131], v[32:35], v[160:163]
  ds_read_b64_tr_b16 v[48:49], v8 offset:57344
  v_mfma_f32_16x16x32_bf16 v[160:163], a[144:147], v[36:39], v[160:163]
  ds_read_b64_tr_b16 v[50:51], v8 offset:57856
  v_mfma_f32_16x16x32_bf16 v[164:167], a[132:135], v[32:35], v[164:167]
  buffer_load_dwordx4 v[252:255], v1, s[8:11], s35 offen offset:3072 sc1
  s_add_u32 s35, s35, 4096
  v_mfma_f32_16x16x32_bf16 v[164:167], a[148:151], v[36:39], v[164:167]
  v_mfma_f32_16x16x32_bf16 v[168:171], a[136:139], v[32:35], v[168:171]
  ds_read_b64_tr_b16 v[52:53], v12 offset:16384
  v_mfma_f32_16x16x32_bf16 v[168:171], a[152:155], v[36:39], v[168:171]
  ds_read_b64_tr_b16 v[54:55], v12 offset:16896
  v_mfma_f32_16x16x32_bf16 v[172:175], a[140:143], v[32:35], v[172:175]
  v_mfma_f32_16x16x32_bf16 v[172:175], a[156:159], v[36:39], v[172:175]
  s_waitcnt lgkmcnt(4)
  v_mfma_f32_16x16x32_bf16 v[176:179], a[128:131], v[40:43], v[176:179]
  ds_read_b64_tr_b16 v[56:57], v9 offset:57344
  v_mfma_f32_16x16x32_bf16 v[176:179], a[144:147], v[44:47], v[176:179]
  ds_read_b64_tr_b16 v[58:59], v9 offset:57856
  v_mfma_f32_16x16x32_bf16 v[180:183], a[132:135], v[40:43], v[180:183]
  s_add_u32 s76, s82, 8192
  buffer_store_dwordx4 v[104:107], v1, s[8:11], s76 offen offset:2048 sc1
  v_mfma_f32_16x16x32_bf16 v[180:183], a[148:151], v[44:47], v[180:183]
  v_mfma_f32_16x16x32_bf16 v[184:187], a[136:139], v[40:43], v[184:187]
  ds_read_b64_tr_b16 v[60:61], v13 offset:16384
  v_mfma_f32_16x16x32_bf16 v[184:187], a[152:155], v[44:47], v[184:187]
  ds_read_b64_tr_b16 v[62:63], v13 offset:16896
  v_mfma_f32_16x16x32_bf16 v[188:191], a[140:143], v[40:43], v[188:191]
  v_mfma_f32_16x16x32_bf16 v[188:191], a[156:159], v[44:47], v[188:191]
  s_waitcnt lgkmcnt(4)
  v_mfma_f32_16x16x32_bf16 v[160:163], a[160:163], v[48:51], v[160:163]
  ds_read_b64_tr_b16 v[32:33], v8 offset:12288
  v_mfma_f32_16x16x32_bf16 v[160:163], a[176:179], v[52:55], v[160:163]
  ds_read_b64_tr_b16 v[34:35], v8 offset:12800
  v_mfma_f32_16x16x32_bf16 v[164:167], a[164:167], v[48:51], v[164:167]
  v_mfma_f32_16x16x32_bf16 v[164:167], a[180:183], v[52:55], v[164:167]
  v_mfma_f32_16x16x32_bf16 v[168:171], a[168:171], v[48:51], v[168:171]
  ds_read_b64_tr_b16 v[36:37], v8 offset:36864
  v_mfma_f32_16x16x32_bf16 v[168:171], a[184:187], v[52:55], v[168:171]
  ds_read_b64_tr_b16 v[38:39], v8 offset:37376
  v_mfma_f32_16x16x32_bf16 v[172:175], a[172:175], v[48:51], v[172:175]
  v_mfma_f32_16x16x32_bf16 v[172:175], a[188:191], v[52:55], v[172:175]
  s_waitcnt lgkmcnt(4)
  v_mfma_f32_16x16x32_bf16 v[176:179], a[160:163], v[56:59], v[176:179]
  ds_read_b64_tr_b16 v[40:41], v9 offset:12288
  v_mfma_f32_16x16x32_bf16 v[176:179], a[176:179], v[60:63], v[176:179]
  ds_read_b64_tr_b16 v[42:43], v9 offset:12800
  v_mfma_f32_16x16x32_bf16 v[180:183], a[164:167], v[56:59], v[180:183]
  s_add_u32 s76, s82, 0
  buffer_store_dwordx4 v[112:115], v1, s[8:11], s76 offen offset:3072 sc1
  v_mfma_f32_16x16x32_bf16 v[180:183], a[180:183], v[60:63], v[180:183]
  v_mfma_f32_16x16x32_bf16 v[184:187], a[168:171], v[56:59], v[184:187]
  ds_read_b64_tr_b16 v[44:45], v9 offset:36864
  v_mfma_f32_16x16x32_bf16 v[184:187], a[184:187], v[60:63], v[184:187]
  ds_read_b64_tr_b16 v[46:47], v9 offset:37376
  v_mfma_f32_16x16x32_bf16 v[188:191], a[172:175], v[56:59], v[188:191]
  v_mfma_f32_16x16x32_bf16 v[188:191], a[188:191], v[60:63], v[188:191]
  s_waitcnt lgkmcnt(4)
  v_mfma_f32_16x16x32_bf16 v[160:163], a[192:195], v[32:35], v[160:163]
  ds_read_b64_tr_b16 v[48:49], v8 offset:61440
  v_mfma_f32_16x16x32_bf16 v[160:163], a[208:211], v[36:39], v[160:163]
  ds_read_b64_tr_b16 v[50:51], v8 offset:61952
  v_mfma_f32_16x16x32_bf16 v[164:167], a[196:199], v[32:35], v[164:167]
  v_mfma_f32_16x16x32_bf16 v[164:167], a[212:215], v[36:39], v[164:167]
  s_lshl_b32 s90, s4, 5
  s_add_u32 s90, s90, 39059456
  v_mfma_f32_16x16x32_bf16 v[168:171], a[200:203], v[32:35], v[168:171]
  ds_read_b64_tr_b16 v[52:53], v12 offset:20480
  s_lshl_b32 s76, s5, 2
  v_mfma_f32_16x16x32_bf16 v[168:171], a[216:219], v[36:39], v[168:171]
  ds_read_b64_tr_b16 v[54:55], v12 offset:20992
  s_add_u32 s90, s90, s76
  v_mfma_f32_16x16x32_bf16 v[172:175], a[204:207], v[32:35], v[172:175]
  s_cmp_eq_u32 s3, 0
  s_cselect_b32 s90, s90, 0x7ff00000
  v_mfma_f32_16x16x32_bf16 v[172:175], a[220:223], v[36:39], v[172:175]
  s_waitcnt lgkmcnt(4)
  v_mfma_f32_16x16x32_bf16 v[176:179], a[192:195], v[40:43], v[176:179]
  ds_read_b64_tr_b16 v[56:57], v9 offset:61440
  v_mfma_f32_16x16x32_bf16 v[176:179], a[208:211], v[44:47], v[176:179]
  ds_read_b64_tr_b16 v[58:59], v9 offset:61952
  v_mfma_f32_16x16x32_bf16 v[180:183], a[196:199], v[40:43], v[180:183]
  v_mfma_f32_16x16x32_bf16 v[180:183], a[212:215], v[44:47], v[180:183]
  v_mfma_f32_16x16x32_bf16 v[184:187], a[200:203], v[40:43], v[184:187]
  ds_read_b64_tr_b16 v[60:61], v13 offset:20480
  v_mfma_f32_16x16x32_bf16 v[184:187], a[216:219], v[44:47], v[184:187]
  ds_read_b64_tr_b16 v[62:63], v13 offset:20992
  v_mfma_f32_16x16x32_bf16 v[188:191], a[204:207], v[40:43], v[188:191]
  s_add_u32 s76, s82, 8192
  buffer_store_dwordx4 v[120:123], v1, s[8:11], s76 offen offset:3072 sc1
  v_mfma_f32_16x16x32_bf16 v[188:191], a[220:223], v[44:47], v[188:191]
  s_waitcnt vmcnt(24)
  s_barrier
  v_xor_b32 v6, 0x10000, v6
  v_xor_b32 v7, 0x10000, v7
  v_xor_b32 v8, 0x10000, v8
  v_xor_b32 v9, 0x10000, v9
  s_waitcnt lgkmcnt(4)
  v_mfma_f32_16x16x32_bf16 v[160:163], a[224:227], v[48:51], v[160:163]
  ds_read_b64_tr_b16 a[160:161], v6 offset:0
  v_mfma_f32_16x16x32_bf16 v[160:163], a[240:243], v[52:55], v[160:163]
  ds_read_b64_tr_b16 a[162:163], v6 offset:512
  v_mfma_f32_16x16x32_bf16 v[164:167], a[228:231], v[48:51], v[164:167]
  v_min_u32 v18, 1, v0
  v_lshlrev_b32 v18, 27, v18
  v_mov_b32 v19, 1
  buffer_store_dword v19, v18, s[8:11], s90 offen sc1
  v_mfma_f32_16x16x32_bf16 v[164:167], a[244:247], v[52:55], v[164:167]
  v_mfma_f32_16x16x32_bf16 v[168:171], a[232:235], v[48:51], v[168:171]
  ds_read_b64_tr_b16 a[164:165], v6 offset:4096
  v_mfma_f32_16x16x32_bf16 v[168:171], a[248:251], v[52:55], v[168:171]
  ds_read_b64_tr_b16 a[166:167], v6 offset:4608
  v_mfma_f32_16x16x32_bf16 v[172:175], a[236:239], v[48:51], v[172:175]
  v_mfma_f32_16x16x32_bf16 v[172:175], a[252:255], v[52:55], v[172:175]
  s_waitcnt lgkmcnt(4)
  v_mfma_f32_16x16x32_bf16 v[176:179], a[224:227], v[56:59], v[176:179]
  ds_read_b64_tr_b16 a[168:169], v7 offset:0
  v_mfma_f32_16x16x32_bf16 v[176:179], a[240:243], v[60:63], v[176:179]
  ds_read_b64_tr_b16 a[170:171], v7 offset:512
  v_mfma_f32_16x16x32_bf16 v[180:183], a[228:231], v[56:59], v[180:183]
  v_mfma_f32_16x16x32_bf16 v[180:183], a[244:247], v[60:63], v[180:183]
  v_mfma_f32_16x16x32_bf16 v[184:187], a[232:235], v[56:59], v[184:187]
  ds_read_b64_tr_b16 a[172:173], v7 offset:4096
  v_mfma_f32_16x16x32_bf16 v[184:187], a[248:251], v[60:63], v[184:187]
  ds_read_b64_tr_b16 a[174:175], v7 offset:4608
  v_mfma_f32_16x16x32_bf16 v[188:191], a[236:239], v[56:59], v[188:191]
  v_mfma_f32_16x16x32_bf16 v[188:191], a[252:255], v[60:63], v[188:191]
  s_waitcnt lgkmcnt(4)
  s_waitcnt vmcnt(14)
  v_mfma_f32_16x16x32_bf16 v[64:67], a[160:163], v[192:195], 0
  ds_read_b64_tr_b16 a[176:177], v8 offset:0
  v_cvt_pk_bf16_f32 v32, v128, v129
  v_mfma_f32_16x16x32_bf16 v[64:67], a[164:167], v[208:211], v[64:67]
  ds_read_b64_tr_b16 a[178:179], v8 offset:512
  v_cvt_pk_bf16_f32 v33, v130, v131
  v_mfma_f32_16x16x32_bf16 v[68:71], a[160:163], v[196:199], 0
  v_cvt_pk_bf16_f32 v34, v132, v133
  v_mfma_f32_16x16x32_bf16 v[68:71], a[164:167], v[212:215], v[68:71]
  v_cvt_pk_bf16_f32 v35, v134, v135
  v_cvt_pk_bf16_f32 v36, v136, v137
  v_mfma_f32_16x16x32_bf16 v[72:75], a[160:163], v[200:203], 0
  ds_read_b64_tr_b16 a[180:181], v8 offset:4096
  v_cvt_pk_bf16_f32 v37, v138, v139
  v_mfma_f32_16x16x32_bf16 v[72:75], a[164:167], v[216:219], v[72:75]
  ds_read_b64_tr_b16 a[182:183], v8 offset:4608
  v_cvt_pk_bf16_f32 v38, v140, v141
  v_mfma_f32_16x16x32_bf16 v[76:79], a[160:163], v[204:207], 0
  v_cvt_pk_bf16_f32 v39, v142, v143
  v_cvt_pk_bf16_f32 v40, v144, v145
  v_mfma_f32_16x16x32_bf16 v[76:79], a[164:167], v[220:223], v[76:79]
  v_cvt_pk_bf16_f32 v41, v146, v147
  s_waitcnt lgkmcnt(4)
  v_mfma_f32_16x16x32_bf16 v[80:83], a[168:171], v[192:195], 0
  ds_read_b64_tr_b16 a[184:185], v9 offset:0
  v_cvt_pk_bf16_f32 v42, v148, v149
  v_mfma_f32_16x16x32_bf16 v[80:83], a[172:175], v[208:211], v[80:83]
  ds_read_b64_tr_b16 a[186:187], v9 offset:512
  v_cvt_pk_bf16_f32 v43, v150, v151
  v_mfma_f32_16x16x32_bf16 v[84:87], a[168:171], v[196:199], 0
  buffer_load_dwordx4 a[192:195], v1, s[8:11], s32 offen offset:0 sc1
  v_cvt_pk_bf16_f32 v44, v152, v153
  v_mfma_f32_16x16x32_bf16 v[84:87], a[172:175], v[212:215], v[84:87]
  v_cvt_pk_bf16_f32 v45, v154, v155
  v_cvt_pk_bf16_f32 v46, v156, v157
  v_mfma_f32_16x16x32_bf16 v[88:91], a[168:171], v[200:203], 0
  ds_read_b64_tr_b16 a[188:189], v9 offset:4096
  v_cvt_pk_bf16_f32 v47, v158, v159
  v_mfma_f32_16x16x32_bf16 v[88:91], a[172:175], v[216:219], v[88:91]
  ds_read_b64_tr_b16 a[190:191], v9 offset:4608
  v_cvt_pk_bf16_f32 v48, v160, v161
  v_mfma_f32_16x16x32_bf16 v[92:95], a[168:171], v[204:207], 0
  buffer_load_dwordx4 a[196:199], v1, s[8:11], s33 offen offset:0 sc1
  v_cvt_pk_bf16_f32 v49, v162, v163
  v_mfma_f32_16x16x32_bf16 v[92:95], a[172:175], v[220:223], v[92:95]
  v_cvt_pk_bf16_f32 v50, v164, v165
  s_waitcnt lgkmcnt(4)
  v_mfma_f32_16x16x32_bf16 v[96:99], a[176:179], v[192:195], 0
  ds_read_b64_tr_b16 a[160:161], v6 offset:8192
  v_cvt_pk_bf16_f32 v51, v166, v167
  v_mfma_f32_16x16x32_bf16 v[96:99], a[180:183], v[208:211], v[96:99]
  ds_read_b64_tr_b16 a[162:163], v6 offset:8704
  v_cvt_pk_bf16_f32 v52, v168, v169
  v_mfma_f32_16x16x32_bf16 v[100:103], a[176:179], v[196:199], 0
  buffer_load_dwordx4 a[200:203], v1, s[8:11], s34 offen offset:0 sc1
  v_cvt_pk_bf16_f32 v53, v170, v171
  v_mfma_f32_16x16x32_bf16 v[100:103], a[180:183], v[212:215], v[100:103]
  v_cvt_pk_bf16_f32 v54, v172, v173
  v_cvt_pk_bf16_f32 v55, v174, v175
  v_mfma_f32_16x16x32_bf16 v[104:107], a[176:179], v[200:203], 0
  ds_read_b64_tr_b16 a[164:165], v6 offset:12288
  v_cvt_pk_bf16_f32 v56, v176, v177
  v_mfma_f32_16x16x32_bf16 v[104:107], a[180:183], v[216:219], v[104:107]
  ds_read_b64_tr_b16 a[166:167], v6 offset:12800
  v_cvt_pk_bf16_f32 v57, v178, v179
  v_mfma_f32_16x16x32_bf16 v[108:111], a[176:179], v[204:207], 0
  buffer_load_dwordx4 a[204:207], v1, s[8:11], s35 offen offset:0 sc1
  v_cvt_pk_bf16_f32 v58, v180, v181
  v_mfma_f32_16x16x32_bf16 v[108:111], a[180:183], v[220:223], v[108:111]
  v_cvt_pk_bf16_f32 v59, v182, v183
  s_waitcnt lgkmcnt(4)
  v_mfma_f32_16x16x32_bf16 v[112:115], a[184:187], v[192:195], 0
  ds_read_b64_tr_b16 a[168:169], v7 offset:8192
  v_cvt_pk_bf16_f32 v60, v184, v185
  v_mfma_f32_16x16x32_bf16 v[112:115], a[188:191], v[208:211], v[112:115]
  ds_read_b64_tr_b16 a[170:171], v7 offset:8704
  v_cvt_pk_bf16_f32 v61, v186, v187
  v_mfma_f32_16x16x32_bf16 v[116:119], a[184:187], v[196:199], 0
  s_add_u32 s76, s82, 4096
  buffer_store_dwordx4 v[32:35], v1, s[8:11], s76 offen offset:0 sc1
  v_mfma_f32_16x16x32_bf16 v[116:119], a[188:191], v[212:215], v[116:119]
  v_cvt_pk_bf16_f32 v62, v188, v189
  v_cvt_pk_bf16_f32 v63, v190, v191
  v_mfma_f32_16x16x32_bf16 v[120:123], a[184:187], v[200:203], 0
  ds_read_b64_tr_b16 a[172:173], v7 offset:12288
  v_mfma_f32_16x16x32_bf16 v[120:123], a[188:191], v[216:219], v[120:123]
  ds_read_b64_tr_b16 a[174:175], v7 offset:12800
  v_mfma_f32_16x16x32_bf16 v[124:127], a[184:187], v[204:207], 0
  buffer_load_dwordx4 a[208:211], v1, s[8:11], s32 offen offset:1024 sc1
  v_mfma_f32_16x16x32_bf16 v[124:127], a[188:191], v[220:223], v[124:127]
  s_waitcnt lgkmcnt(4)
  v_mfma_f32_16x16x32_bf16 v[128:131], a[160:163], v[192:195], 0
  ds_read_b64_tr_b16 a[176:177], v8 offset:8192
  v_mfma_f32_16x16x32_bf16 v[128:131], a[164:167], v[208:211], v[128:131]
  ds_read_b64_tr_b16 a[178:179], v8 offset:8704
  v_mfma_f32_16x16x32_bf16 v[132:135], a[160:163], v[196:199], 0
  buffer_load_dwordx4 a[212:215], v1, s[8:11], s33 offen offset:1024 sc1
  v_mfma_f32_16x16x32_bf16 v[132:135], a[164:167], v[212:215], v[132:135]
  v_mfma_f32_16x16x32_bf16 v[136:139], a[160:163], v[200:203], 0
  ds_read_b64_tr_b16 a[180:181], v8 offset:12288
  v_mfma_f32_16x16x32_bf16 v[136:139], a[164:167], v[216:219], v[136:139]
  ds_read_b64_tr_b16 a[182:183], v8 offset:12800
  v_mfma_f32_16x16x32_bf16 v[140:143], a[160:163], v[204:207], 0
  buffer_load_dwordx4 a[216:219], v1, s[8:11], s34 offen offset:1024 sc1
  v_mfma_f32_16x16x32_bf16 v[140:143], a[164:167], v[220:223], v[140:143]
  s_waitcnt lgkmcnt(4)
  v_mfma_f32_16x16x32_bf16 v[144:147], a[168:171], v[192:195], 0
  ds_read_b64_tr_b16 a[184:185], v9 offset:8192
  v_accvgpr_write_b32 a0, 0
  v_mfma_f32_16x16x32_bf16 v[144:147], a[172:175], v[208:211], v[144:147]
  ds_read_b64_tr_b16 a[186:187], v9 offset:8704
  v_accvgpr_write_b32 a1, 0
  v_mfma_f32_16x16x32_bf16 v[148:151], a[168:171], v[196:199], 0
  buffer_load_dwordx4 a[220:223], v1, s[8:11], s35 offen offset:1024 sc1
  v_mfma_f32_16x16x32_bf16 v[148:151], a[172:175], v[212:215], v[148:151]
  v_accvgpr_write_b32 a2, 0
  v_mfma_f32_16x16x32_bf16 v[152:155], a[168:171], v[200:203], 0
  ds_read_b64_tr_b16 a[188:189], v9 offset:12288
  v_mfma_f32_16x16x32_bf16 v[152:155], a[172:175], v[216:219], v[152:155]
  ds_read_b64_tr_b16 a[190:191], v9 offset:12800
  v_accvgpr_write_b32 a3, 0
  v_mfma_f32_16x16x32_bf16 v[156:159], a[168:171], v[204:207], 0
  s_add_u32 s76, s82, 12288
  buffer_store_dwordx4 v[36:39], v1, s[8:11], s76 offen offset:0 sc1
  v_mfma_f32_16x16x32_bf16 v[156:159], a[172:175], v[220:223], v[156:159]
  s_barrier
  v_accvgpr_write_b32 a4, 0
  s_waitcnt lgkmcnt(4)
  v_mfma_f32_16x16x32_bf16 v[160:163], a[176:179], v[192:195], 0
  ds_read_b64_tr_b16 a[160:161], v6 offset:16384
  v_mfma_f32_16x16x32_bf16 v[160:163], a[180:183], v[208:211], v[160:163]
  ds_read_b64_tr_b16 a[162:163], v6 offset:16896
  v_accvgpr_write_b32 a5, 0
  v_mfma_f32_16x16x32_bf16 v[164:167], a[176:179], v[196:199], 0
  v_mfma_f32_16x16x32_bf16 v[164:167], a[180:183], v[212:215], v[164:167]
  v_accvgpr_write_b32 a6, 0
  v_mfma_f32_16x16x32_bf16 v[168:171], a[176:179], v[200:203], 0
  ds_read_b64_tr_b16 a[164:165], v6 offset:20480
  v_mfma_f32_16x16x32_bf16 v[168:171], a[180:183], v[216:219], v[168:171]
  ds_read_b64_tr_b16 a[166:167], v6 offset:20992
  v_accvgpr_write_b32 a7, 0
  v_mfma_f32_16x16x32_bf16 v[172:175], a[176:179], v[204:207], 0
  v_mfma_f32_16x16x32_bf16 v[172:175], a[180:183], v[220:223], v[172:175]
  v_accvgpr_write_b32 a8, 0
  s_waitcnt lgkmcnt(4)
  v_mfma_f32_16x16x32_bf16 v[176:179], a[184:187], v[192:195], 0
  ds_read_b64_tr_b16 a[168:169], v7 offset:16384
  v_mfma_f32_16x16x32_bf16 v[176:179], a[188:191], v[208:211], v[176:179]
  ds_read_b64_tr_b16 a[170:171], v7 offset:16896
  v_accvgpr_write_b32 a9, 0
  v_mfma_f32_16x16x32_bf16 v[180:183], a[184:187], v[196:199], 0
  v_mfma_f32_16x16x32_bf16 v[180:183], a[188:191], v[212:215], v[180:183]
  v_accvgpr_write_b32 a10, 0
  v_mfma_f32_16x16x32_bf16 v[184:187], a[184:187], v[200:203], 0
  ds_read_b64_tr_b16 a[172:173], v7 offset:20480
  v_mfma_f32_16x16x32_bf16 v[184:187], a[188:191], v[216:219], v[184:187]
  ds_read_b64_tr_b16 a[174:175], v7 offset:20992
  v_accvgpr_write_b32 a11, 0
  v_mfma_f32_16x16x32_bf16 v[188:191], a[184:187], v[204:207], 0
  v_mfma_f32_16x16x32_bf16 v[188:191], a[188:191], v[220:223], v[188:191]
  s_waitcnt lgkmcnt(4)
  s_waitcnt vmcnt(14)
  v_mfma_f32_16x16x32_bf16 v[64:67], a[160:163], v[224:227], v[64:67]
  ds_read_b64_tr_b16 a[176:177], v8 offset:16384
  v_accvgpr_write_b32 a12, 0
  v_mfma_f32_16x16x32_bf16 v[64:67], a[164:167], v[240:243], v[64:67]
  ds_read_b64_tr_b16 a[178:179], v8 offset:16896
  v_accvgpr_write_b32 a13, 0
  v_mfma_f32_16x16x32_bf16 v[68:71], a[160:163], v[228:231], v[68:71]
  s_add_u32 s76, s82, 4096
  buffer_store_dwordx4 v[40:43], v1, s[8:11], s76 offen offset:1024 sc1
  v_mfma_f32_16x16x32_bf16 v[68:71], a[164:167], v[244:247], v[68:71]
  v_accvgpr_write_b32 a14, 0
  v_mfma_f32_16x16x32_bf16 v[72:75], a[160:163], v[232:235], v[72:75]
  ds_read_b64_tr_b16 a[180:181], v8 offset:20480
  v_accvgpr_write_b32 a15, 0
  v_mfma_f32_16x16x32_bf16 v[72:75], a[164:167], v[248:251], v[72:75]
  ds_read_b64_tr_b16 a[182:183], v8 offset:20992
  v_mfma_f32_16x16x32_bf16 v[76:79], a[160:163], v[236:239], v[76:79]
  v_accvgpr_write_b32 a16, 0
  v_mfma_f32_16x16x32_bf16 v[76:79], a[164:167], v[252:255], v[76:79]
  s_waitcnt lgkmcnt(4)
  v_mfma_f32_16x16x32_bf16 v[80:83], a[168:171], v[224:227], v[80:83]
  ds_read_b64_tr_b16 a[184:185], v9 offset:16384
  v_accvgpr_write_b32 a17, 0
  v_mfma_f32_16x16x32_bf16 v[80:83], a[172:175], v[240:243], v[80:83]
  ds_read_b64_tr_b16 a[186:187], v9 offset:16896
  v_mfma_f32_16x16x32_bf16 v[84:87], a[168:171], v[228:231], v[84:87]
  buffer_load_dwordx4 a[224:227], v1, s[8:11], s32 offen offset:2048 sc1
  v_accvgpr_write_b32 a18, 0
  v_mfma_f32_16x16x32_bf16 v[84:87], a[172:175], v[244:247], v[84:87]
  v_mfma_f32_16x16x32_bf16 v[88:91], a[168:171], v[232:235], v[88:91]
  ds_read_b64_tr_b16 a[188:189], v9 offset:20480
  v_accvgpr_write_b32 a19, 0
  v_mfma_f32_16x16x32_bf16 v[88:91], a[172:175], v[248:251], v[88:91]
  ds_read_b64_tr_b16 a[190:191], v9 offset:20992
  v_mfma_f32_16x16x32_bf16 v[92:95], a[168:171], v[236:239], v[92:95]
  buffer_load_dwordx4 a[228:231], v1, s[8:11], s33 offen offset:2048 sc1
  v_accvgpr_write_b32 a20, 0
  v_mfma_f32_16x16x32_bf16 v[92:95], a[172:175], v[252:255], v[92:95]
  s_waitcnt lgkmcnt(4)
  v_mfma_f32_16x16x32_bf16 v[96:99], a[176:179], v[224:227], v[96:99]
  ds_read_b64_tr_b16 a[160:161], v6 offset:24576
  v_accvgpr_write_b32 a21, 0
  v_mfma_f32_16x16x32_bf16 v[96:99], a[180:183], v[240:243], v[96:99]
  ds_read_b64_tr_b16 a[162:163], v6 offset:25088
  v_mfma_f32_16x16x32_bf16 v[100:103], a[176:179], v[228:231], v[100:103]
  buffer_load_dwordx4 a[232:235], v1, s[8:11], s34 offen offset:2048 sc1
  v_accvgpr_write_b32 a22, 0
  v_mfma_f32_16x16x32_bf16 v[100:103], a[180:183], v[244:247], v[100:103]
  v_mfma_f32_16x16x32_bf16 v[104:107], a[176:179], v[232:235], v[104:107]
  ds_read_b64_tr_b16 a[164:165], v6 offset:28672
  v_accvgpr_write_b32 a23, 0
  v_mfma_f32_16x16x32_bf16 v[104:107], a[180:183], v[248:251], v[104:107]
  ds_read_b64_tr_b16 a[166:167], v6 offset:29184
  v_mfma_f32_16x16x32_bf16 v[108:111], a[176:179], v[236:239], v[108:111]
  s_add_u32 s76, s82, 12288
  buffer_store_dwordx4 v[44:47], v1, s[8:11], s76 offen offset:1024 sc1
  v_mfma_f32_16x16x32_bf16 v[108:111], a[180:183], v[252:255], v[108:111]
  v_accvgpr_write_b32 a24, 0
  s_waitcnt lgkmcnt(4)
  v_mfma_f32_16x16x32_bf16 v[112:115], a[184:187], v[224:227], v[112:115]
  ds_read_b64_tr_b16 a[168:169], v7 offset:24576
  v_accvgpr_write_b32 a25, 0
  v_mfma_f32_16x16x32_bf16 v[112:115], a[188:191], v[240:243], v[112:115]
  ds_read_b64_tr_b16 a[170:171], v7 offset:25088
  v_mfma_f32_16x16x32_bf16 v[116:119], a[184:187], v[228:231], v[116:119]
  buffer_load_dwordx4 a[236:239], v1, s[8:11], s35 offen offset:2048 sc1
  v_accvgpr_write_b32 a26, 0
  v_mfma_f32_16x16x32_bf16 v[116:119], a[188:191], v[244:247], v[116:119]
  v_mfma_f32_16x16x32_bf16 v[120:123], a[184:187], v[232:235], v[120:123]
  ds_read_b64_tr_b16 a[172:173], v7 offset:28672
  v_accvgpr_write_b32 a27, 0
  v_mfma_f32_16x16x32_bf16 v[120:123], a[188:191], v[248:251], v[120:123]
  ds_read_b64_tr_b16 a[174:175], v7 offset:29184
  v_mfma_f32_16x16x32_bf16 v[124:127], a[184:187], v[236:239], v[124:127]
  buffer_load_dwordx4 a[240:243], v1, s[8:11], s32 offen offset:3072 sc1
  s_add_u32 s32, s32, 4096
  v_mfma_f32_16x16x32_bf16 v[124:127], a[188:191], v[252:255], v[124:127]
  v_accvgpr_write_b32 a28, 0
  s_waitcnt lgkmcnt(4)
  v_mfma_f32_16x16x32_bf16 v[128:131], a[160:163], v[224:227], v[128:131]
  ds_read_b64_tr_b16 a[176:177], v8 offset:24576
  v_accvgpr_write_b32 a29, 0
  v_mfma_f32_16x16x32_bf16 v[128:131], a[164:167], v[240:243], v[128:131]
  ds_read_b64_tr_b16 a[178:179], v8 offset:25088
  v_accvgpr_write_b32 a30, 0
  v_mfma_f32_16x16x32_bf16 v[132:135], a[160:163], v[228:231], v[132:135]
  buffer_load_dwordx4 a[244:247], v1, s[8:11], s33 offen offset:3072 sc1
  s_add_u32 s33, s33, 4096
  v_mfma_f32_16x16x32_bf16 v[132:135], a[164:167], v[244:247], v[132:135]
  v_accvgpr_write_b32 a31, 0
  v_mfma_f32_16x16x32_bf16 v[136:139], a[160:163], v[232:235], v[136:139]
  ds_read_b64_tr_b16 a[180:181], v8 offset:28672
  v_mfma_f32_16x16x32_bf16 v[136:139], a[164:167], v[248:251], v[136:139]
  ds_read_b64_tr_b16 a[182:183], v8 offset:29184
  v_accvgpr_write_b32 a32, 0
  v_mfma_f32_16x16x32_bf16 v[140:143], a[160:163], v[236:239], v[140:143]
  buffer_load_dwordx4 a[248:251], v1, s[8:11], s34 offen offset:3072 sc1
  s_add_u32 s34, s34, 4096
  v_mfma_f32_16x16x32_bf16 v[140:143], a[164:167], v[252:255], v[140:143]
  v_accvgpr_write_b32 a33, 0
  s_waitcnt lgkmcnt(4)
  v_mfma_f32_16x16x32_bf16 v[144:147], a[168:171], v[224:227], v[144:147]
  ds_read_b64_tr_b16 a[184:185], v9 offset:24576
  v_mfma_f32_16x16x32_bf16 v[144:147], a[172:175], v[240:243], v[144:147]
  ds_read_b64_tr_b16 a[186:187], v9 offset:25088
  v_accvgpr_write_b32 a34, 0
  v_mfma_f32_16x16x32_bf16 v[148:151], a[168:171], v[228:231], v[148:151]
  s_add_u32 s76, s82, 4096
  buffer_store_dwordx4 v[48:51], v1, s[8:11], s76 offen offset:2048 sc1
  v_mfma_f32_16x16x32_bf16 v[148:151], a[172:175], v[244:247], v[148:151]
  v_accvgpr_write_b32 a35, 0
  v_mfma_f32_16x16x32_bf16 v[152:155], a[168:171], v[232:235], v[152:155]
  ds_read_b64_tr_b16 a[188:189], v9 offset:28672
  v_mfma_f32_16x16x32_bf16 v[152:155], a[172:175], v[248:251], v[152:155]
  ds_read_b64_tr_b16 a[190:191], v9 offset:29184
  v_accvgpr_write_b32 a36, 0
  v_mfma_f32_16x16x32_bf16 v[156:159], a[168:171], v[236:239], v[156:159]
  buffer_load_dwordx4 a[252:255], v1, s[8:11], s35 offen offset:3072 sc1
  s_add_u32 s35, s35, 4096
  v_mfma_f32_16x16x32_bf16 v[156:159], a[172:175], v[252:255], v[156:159]
  s_barrier
  v_accvgpr_write_b32 a37, 0
  s_waitcnt lgkmcnt(4)
  v_mfma_f32_16x16x32_bf16 v[160:163], a[176:179], v[224:227], v[160:163]
  ds_read_b64_tr_b16 a[160:161], v6 offset:32768
  v_mfma_f32_16x16x32_bf16 v[160:163], a[180:183], v[240:243], v[160:163]
  ds_read_b64_tr_b16 a[162:163], v6 offset:33280
  v_accvgpr_write_b32 a38, 0
  v_mfma_f32_16x16x32_bf16 v[164:167], a[176:179], v[228:231], v[164:167]
  v_mfma_f32_16x16x32_bf16 v[164:167], a[180:183], v[244:247], v[164:167]
  v_accvgpr_write_b32 a39, 0
  v_mfma_f32_16x16x32_bf16 v[168:171], a[176:179], v[232:235], v[168:171]
  ds_read_b64_tr_b16 a[164:165], v6 offset:36864
  v_mfma_f32_16x16x32_bf16 v[168:171], a[180:183], v[248:251], v[168:171]
  ds_read_b64_tr_b16 a[166:167], v6 offset:37376
  v_accvgpr_write_b32 a40, 0
  v_mfma_f32_16x16x32_bf16 v[172:175], a[176:179], v[236:239], v[172:175]
  v_mfma_f32_16x16x32_bf16 v[172:175], a[180:183], v[252:255], v[172:175]
  v_accvgpr_write_b32 a41, 0
  s_waitcnt lgkmcnt(4)
  v_mfma_f32_16x16x32_bf16 v[176:179], a[184:187], v[224:227], v[176:179]
  ds_read_b64_tr_b16 a[168:169], v7 offset:32768
  v_mfma_f32_16x16x32_bf16 v[176:179], a[188:191], v[240:243], v[176:179]
  ds_read_b64_tr_b16 a[170:171], v7 offset:33280
  v_accvgpr_write_b32 a42, 0
  v_mfma_f32_16x16x32_bf16 v[180:183], a[184:187], v[228:231], v[180:183]
  s_add_u32 m0, s84, 65536
  s_add_u32 s77, s79, 2097152
  buffer_load_dwordx4 v2, s[24:27], s77 offen offset:0 lds
  v_mfma_f32_16x16x32_bf16 v[180:183], a[188:191], v[244:247], v[180:183]
  v_accvgpr_write_b32 a43, 0
  v_mfma_f32_16x16x32_bf16 v[184:187], a[184:187], v[232:235], v[184:187]
  ds_read_b64_tr_b16 a[172:173], v7 offset:36864
  v_mfma_f32_16x16x32_bf16 v[184:187], a[188:191], v[248:251], v[184:187]
  ds_read_b64_tr_b16 a[174:175], v7 offset:37376
  v_accvgpr_write_b32 a44, 0
  v_mfma_f32_16x16x32_bf16 v[188:191], a[184:187], v[236:239], v[188:191]
  s_add_u32 s76, s82, 12288
  buffer_store_dwordx4 v[52:55], v1, s[8:11], s76 offen offset:2048 sc1
  v_mfma_f32_16x16x32_bf16 v[188:191], a[188:191], v[252:255], v[188:191]
  s_waitcnt lgkmcnt(4)
  s_waitcnt vmcnt(14)
  v_mfma_f32_16x16x32_bf16 v[64:67], a[160:163], a[192:195], v[64:67]
  ds_read_b64_tr_b16 a[176:177], v8 offset:32768
  v_accvgpr_write_b32 a45, 0
  v_mfma_f32_16x16x32_bf16 v[64:67], a[164:167], a[208:211], v[64:67]
  ds_read_b64_tr_b16 a[178:179], v8 offset:33280
  v_accvgpr_write_b32 a46, 0
  v_mfma_f32_16x16x32_bf16 v[68:71], a[160:163], a[196:199], v[68:71]
  buffer_load_dwordx4 v3, s[24:27], s77 offen offset:1024 lds
  v_accvgpr_write_b32 a47, 0
  v_mfma_f32_16x16x32_bf16 v[68:71], a[164:167], a[212:215], v[68:71]
  v_mfma_f32_16x16x32_bf16 v[72:75], a[160:163], a[200:203], v[72:75]
  ds_read_b64_tr_b16 a[180:181], v8 offset:36864
  v_accvgpr_write_b32 a48, 0
  v_mfma_f32_16x16x32_bf16 v[72:75], a[164:167], a[216:219], v[72:75]
  ds_read_b64_tr_b16 a[182:183], v8 offset:37376
  v_mfma_f32_16x16x32_bf16 v[76:79], a[160:163], a[204:207], v[76:79]
  buffer_load_dwordx4 v4, s[24:27], s77 offen offset:2048 lds
  v_accvgpr_write_b32 a49, 0
  v_mfma_f32_16x16x32_bf16 v[76:79], a[164:167], a[220:223], v[76:79]
  s_waitcnt lgkmcnt(4)
  v_mfma_f32_16x16x32_bf16 v[80:83], a[168:171], a[192:195], v[80:83]
  ds_read_b64_tr_b16 a[184:185], v9 offset:32768
  v_accvgpr_write_b32 a50, 0
  v_mfma_f32_16x16x32_bf16 v[80:83], a[172:175], a[208:211], v[80:83]
  ds_read_b64_tr_b16 a[186:187], v9 offset:33280
  v_mfma_f32_16x16x32_bf16 v[84:87], a[168:171], a[196:199], v[84:87]
  buffer_load_dwordx4 v5, s[24:27], s77 offen offset:3072 lds
  v_accvgpr_write_b32 a51, 0
  v_mfma_f32_16x16x32_bf16 v[84:87], a[172:175], a[212:215], v[84:87]
  v_mfma_f32_16x16x32_bf16 v[88:91], a[168:171], a[200:203], v[88:91]
  ds_read_b64_tr_b16 a[188:189], v9 offset:36864
  v_accvgpr_write_b32 a52, 0
  v_mfma_f32_16x16x32_bf16 v[88:91], a[172:175], a[216:219], v[88:91]
  ds_read_b64_tr_b16 a[190:191], v9 offset:37376
  v_mfma_f32_16x16x32_bf16 v[92:95], a[168:171], a[204:207], v[92:95]
  buffer_load_dwordx4 v[192:195], v1, s[8:11], s32 offen offset:0 sc1
  v_accvgpr_write_b32 a53, 0
  v_mfma_f32_16x16x32_bf16 v[92:95], a[172:175], a[220:223], v[92:95]
  s_waitcnt lgkmcnt(4)
  v_mfma_f32_16x16x32_bf16 v[96:99], a[176:179], a[192:195], v[96:99]
  ds_read_b64_tr_b16 a[160:161], v6 offset:40960
  v_accvgpr_write_b32 a54, 0
  v_mfma_f32_16x16x32_bf16 v[96:99], a[180:183], a[208:211], v[96:99]
  ds_read_b64_tr_b16 a[162:163], v6 offset:41472
  v_mfma_f32_16x16x32_bf16 v[100:103], a[176:179], a[196:199], v[100:103]
  s_add_u32 s76, s82, 4096
  buffer_store_dwordx4 v[56:59], v1, s[8:11], s76 offen offset:3072 sc1
  v_mfma_f32_16x16x32_bf16 v[100:103], a[180:183], a[212:215], v[100:103]
  v_accvgpr_write_b32 a55, 0
  v_mfma_f32_16x16x32_bf16 v[104:107], a[176:179], a[200:203], v[104:107]
  ds_read_b64_tr_b16 a[164:165], v6 offset:45056
  v_accvgpr_write_b32 a56, 0
  v_mfma_f32_16x16x32_bf16 v[104:107], a[180:183], a[216:219], v[104:107]
  ds_read_b64_tr_b16 a[166:167], v6 offset:45568
  v_mfma_f32_16x16x32_bf16 v[108:111], a[176:179], a[204:207], v[108:111]
  buffer_load_dwordx4 v[196:199], v1, s[8:11], s33 offen offset:0 sc1
  v_accvgpr_write_b32 a57, 0
  v_mfma_f32_16x16x32_bf16 v[108:111], a[180:183], a[220:223], v[108:111]
  s_waitcnt lgkmcnt(4)
  v_mfma_f32_16x16x32_bf16 v[112:115], a[184:187], a[192:195], v[112:115]
  ds_read_b64_tr_b16 a[168:169], v7 offset:40960
  v_accvgpr_write_b32 a58, 0
  v_mfma_f32_16x16x32_bf16 v[112:115], a[188:191], a[208:211], v[112:115]
  ds_read_b64_tr_b16 a[170:171], v7 offset:41472
  v_accvgpr_write_b32 a59, 0
  v_mfma_f32_16x16x32_bf16 v[116:119], a[184:187], a[196:199], v[116:119]
  buffer_load_dwordx4 v[200:203], v1, s[8:11], s34 offen offset:0 sc1
  v_mfma_f32_16x16x32_bf16 v[116:119], a[188:191], a[212:215], v[116:119]
  s_lshl_b32 s90, s4, 5
  v_accvgpr_write_b32 a60, 0
  v_mfma_f32_16x16x32_bf16 v[120:123], a[184:187], a[200:203], v[120:123]
  ds_read_b64_tr_b16 a[172:173], v7 offset:45056
  v_mfma_f32_16x16x32_bf16 v[120:123], a[188:191], a[216:219], v[120:123]
  ds_read_b64_tr_b16 a[174:175], v7 offset:45568
  v_accvgpr_write_b32 a61, 0
  v_mfma_f32_16x16x32_bf16 v[124:127], a[184:187], a[204:207], v[124:127]
  buffer_load_dwordx4 v[204:207], v1, s[8:11], s35 offen offset:0 sc1
  s_add_u32 s90, s90, 39059456
  v_mfma_f32_16x16x32_bf16 v[124:127], a[188:191], a[220:223], v[124:127]
  v_accvgpr_write_b32 a62, 0
  s_waitcnt lgkmcnt(4)
  v_mfma_f32_16x16x32_bf16 v[128:131], a[160:163], a[192:195], v[128:131]
  ds_read_b64_tr_b16 a[176:177], v8 offset:40960
  v_mfma_f32_16x16x32_bf16 v[128:131], a[164:167], a[208:211], v[128:131]
  ds_read_b64_tr_b16 a[178:179], v8 offset:41472
  v_mfma_f32_16x16x32_bf16 v[132:135], a[160:163], a[196:199], v[132:135]
  buffer_load_dwordx4 v[208:211], v1, s[8:11], s32 offen offset:1024 sc1
  v_mfma_f32_16x16x32_bf16 v[132:135], a[164:167], a[212:215], v[132:135]
  s_cmp_eq_u32 s3, 0
  s_cselect_b32 s90, s90, 0x7ff00000
  v_mfma_f32_16x16x32_bf16 v[136:139], a[160:163], a[200:203], v[136:139]
  ds_read_b64_tr_b16 a[180:181], v8 offset:45056
  v_accvgpr_write_b32 a63, 0
  v_mfma_f32_16x16x32_bf16 v[136:139], a[164:167], a[216:219], v[136:139]
  ds_read_b64_tr_b16 a[182:183], v8 offset:45568
  v_accvgpr_write_b32 a64, 0
  v_mfma_f32_16x16x32_bf16 v[140:143], a[160:163], a[204:207], v[140:143]
  s_add_u32 s76, s82, 12288
  buffer_store_dwordx4 v[60:63], v1, s[8:11], s76 offen offset:3072 sc1
  v_mfma_f32_16x16x32_bf16 v[140:143], a[164:167], a[220:223], v[140:143]
  v_and_b32 v16, 7, v0
  s_waitcnt lgkmcnt(4)
  v_mfma_f32_16x16x32_bf16 v[144:147], a[168:171], a[192:195], v[144:147]
  ds_read_b64_tr_b16 a[184:185], v9 offset:40960
  v_accvgpr_write_b32 a65, 0
  v_mfma_f32_16x16x32_bf16 v[144:147], a[172:175], a[208:211], v[144:147]
  ds_read_b64_tr_b16 a[186:187], v9 offset:41472
  v_lshlrev_b32 v16, 2, v16
  v_mfma_f32_16x16x32_bf16 v[148:151], a[168:171], a[196:199], v[148:151]
  buffer_load_dwordx4 v[212:215], v1, s[8:11], s33 offen offset:1024 sc1
  v_accvgpr_write_b32 a66, 0
  v_mfma_f32_16x16x32_bf16 v[148:151], a[172:175], a[212:215], v[148:151]
  v_accvgpr_write_b32 a67, 0
  v_accvgpr_write_b32 a68, 0
  v_mfma_f32_16x16x32_bf16 v[152:155], a[168:171], a[200:203], v[152:155]
  ds_read_b64_tr_b16 a[188:189], v9 offset:45056
  v_mfma_f32_16x16x32_bf16 v[152:155], a[172:175], a[216:219], v[152:155]
  ds_read_b64_tr_b16 a[190:191], v9 offset:45568
  v_accvgpr_write_b32 a69, 0
  v_mfma_f32_16x16x32_bf16 v[156:159], a[168:171], a[204:207], v[156:159]
  buffer_load_dwordx4 v[216:219], v1, s[8:11], s34 offen offset:1024 sc1
  v_mfma_f32_16x16x32_bf16 v[156:159], a[172:175], a[220:223], v[156:159]
  s_barrier
  v_accvgpr_write_b32 a70, 0
  s_waitcnt lgkmcnt(4)
  v_mfma_f32_16x16x32_bf16 v[160:163], a[176:179], a[192:195], v[160:163]
  ds_read_b64_tr_b16 a[160:161], v6 offset:49152
  v_mfma_f32_16x16x32_bf16 v[160:163], a[180:183], a[208:211], v[160:163]
  ds_read_b64_tr_b16 a[162:163], v6 offset:49664
  v_accvgpr_write_b32 a71, 0
  v_mfma_f32_16x16x32_bf16 v[164:167], a[176:179], a[196:199], v[164:167]
  buffer_load_dword v17, v16, s[8:11], s90 offen sc1
  v_mfma_f32_16x16x32_bf16 v[164:167], a[180:183], a[212:215], v[164:167]
  v_accvgpr_write_b32 a72, 0
  v_mfma_f32_16x16x32_bf16 v[168:171], a[176:179], a[200:203], v[168:171]
  ds_read_b64_tr_b16 a[164:165], v6 offset:53248
  v_mfma_f32_16x16x32_bf16 v[168:171], a[180:183], a[216:219], v[168:171]
  ds_read_b64_tr_b16 a[166:167], v6 offset:53760
  v_accvgpr_write_b32 a73, 0
  v_mfma_f32_16x16x32_bf16 v[172:175], a[176:179], a[204:207], v[172:175]
  buffer_load_dwordx4 v[220:223], v1, s[8:11], s35 offen offset:1024 sc1
  v_accvgpr_write_b32 a74, 0
  v_mfma_f32_16x16x32_bf16 v[172:175], a[180:183], a[220:223], v[172:175]
  s_waitcnt lgkmcnt(4)
  v_mfma_f32_16x16x32_bf16 v[176:179], a[184:187], a[192:195], v[176:179]
  ds_read_b64_tr_b16 a[168:169], v7 offset:49152
  v_accvgpr_write_b32 a75, 0
  v_mfma_f32_16x16x32_bf16 v[176:179], a[188:191], a[208:211], v[176:179]
  ds_read_b64_tr_b16 a[170:171], v7 offset:49664
  v_mfma_f32_16x16x32_bf16 v[180:183], a[184:187], a[196:199], v[180:183]
  s_add_u32 m0, s84, 81920
  s_add_u32 s77, s79, 2621440
  buffer_load_dwordx4 v2, s[24:27], s77 offen offset:0 lds
  v_mfma_f32_16x16x32_bf16 v[180:183], a[188:191], a[212:215], v[180:183]
  v_accvgpr_write_b32 a76, 0
  v_mfma_f32_16x16x32_bf16 v[184:187], a[184:187], a[200:203], v[184:187]
  ds_read_b64_tr_b16 a[172:173], v7 offset:53248
  v_accvgpr_write_b32 a77, 0
  v_mfma_f32_16x16x32_bf16 v[184:187], a[188:191], a[216:219], v[184:187]
  ds_read_b64_tr_b16 a[174:175], v7 offset:53760
  v_mfma_f32_16x16x32_bf16 v[188:191], a[184:187], a[204:207], v[188:191]
  buffer_load_dwordx4 v3, s[24:27], s77 offen offset:1024 lds
  v_accvgpr_write_b32 a78, 0
  v_mfma_f32_16x16x32_bf16 v[188:191], a[188:191], a[220:223], v[188:191]
  s_waitcnt lgkmcnt(4)
  s_waitcnt vmcnt(18)
  v_mfma_f32_16x16x32_bf16 v[64:67], a[160:163], a[224:227], v[64:67]
  ds_read_b64_tr_b16 a[176:177], v8 offset:49152
  v_accvgpr_write_b32 a79, 0
  v_mfma_f32_16x16x32_bf16 v[64:67], a[164:167], a[240:243], v[64:67]
  ds_read_b64_tr_b16 a[178:179], v8 offset:49664
  v_mfma_f32_16x16x32_bf16 v[68:71], a[160:163], a[228:231], v[68:71]
  buffer_load_dwordx4 v4, s[24:27], s77 offen offset:2048 lds
  v_accvgpr_write_b32 a80, 0
  v_mfma_f32_16x16x32_bf16 v[68:71], a[164:167], a[244:247], v[68:71]
  v_mfma_f32_16x16x32_bf16 v[72:75], a[160:163], a[232:235], v[72:75]
  ds_read_b64_tr_b16 a[180:181], v8 offset:53248
  v_accvgpr_write_b32 a81, 0
  v_mfma_f32_16x16x32_bf16 v[72:75], a[164:167], a[248:251], v[72:75]
  ds_read_b64_tr_b16 a[182:183], v8 offset:53760
  v_mfma_f32_16x16x32_bf16 v[76:79], a[160:163], a[236:239], v[76:79]
  buffer_load_dwordx4 v5, s[24:27], s77 offen offset:3072 lds
  v_accvgpr_write_b32 a82, 0
  v_mfma_f32_16x16x32_bf16 v[76:79], a[164:167], a[252:255], v[76:79]
  s_waitcnt lgkmcnt(4)
  v_mfma_f32_16x16x32_bf16 v[80:83], a[168:171], a[224:227], v[80:83]
  ds_read_b64_tr_b16 a[184:185], v9 offset:49152
  v_accvgpr_write_b32 a83, 0
  v_mfma_f32_16x16x32_bf16 v[80:83], a[172:175], a[240:243], v[80:83]
  ds_read_b64_tr_b16 a[186:187], v9 offset:49664
  v_mfma_f32_16x16x32_bf16 v[84:87], a[168:171], a[228:231], v[84:87]
  buffer_load_dwordx4 v[224:227], v1, s[8:11], s32 offen offset:2048 sc1
  v_accvgpr_write_b32 a84, 0
  v_mfma_f32_16x16x32_bf16 v[84:87], a[172:175], a[244:247], v[84:87]
  v_mfma_f32_16x16x32_bf16 v[88:91], a[168:171], a[232:235], v[88:91]
  ds_read_b64_tr_b16 a[188:189], v9 offset:53248
  v_accvgpr_write_b32 a85, 0
  v_mfma_f32_16x16x32_bf16 v[88:91], a[172:175], a[248:251], v[88:91]
  ds_read_b64_tr_b16 a[190:191], v9 offset:53760
  v_mfma_f32_16x16x32_bf16 v[92:95], a[168:171], a[236:239], v[92:95]
  buffer_load_dwordx4 v[228:231], v1, s[8:11], s33 offen offset:2048 sc1
  v_accvgpr_write_b32 a86, 0
  v_mfma_f32_16x16x32_bf16 v[92:95], a[172:175], a[252:255], v[92:95]
  s_waitcnt lgkmcnt(4)
  v_mfma_f32_16x16x32_bf16 v[96:99], a[176:179], a[224:227], v[96:99]
  ds_read_b64_tr_b16 a[160:161], v6 offset:57344
  v_accvgpr_write_b32 a87, 0
  v_mfma_f32_16x16x32_bf16 v[96:99], a[180:183], a[240:243], v[96:99]
  ds_read_b64_tr_b16 a[162:163], v6 offset:57856
  v_mfma_f32_16x16x32_bf16 v[100:103], a[176:179], a[228:231], v[100:103]
  buffer_load_dwordx4 v[232:235], v1, s[8:11], s34 offen offset:2048 sc1
  v_accvgpr_write_b32 a88, 0
  v_mfma_f32_16x16x32_bf16 v[100:103], a[180:183], a[244:247], v[100:103]
  v_accvgpr_write_b32 a89, 0
  v_mfma_f32_16x16x32_bf16 v[104:107], a[176:179], a[232:235], v[104:107]
  ds_read_b64_tr_b16 a[164:165], v6 offset:61440
  v_mfma_f32_16x16x32_bf16 v[104:107], a[180:183], a[248:251], v[104:107]
  ds_read_b64_tr_b16 a[166:167], v6 offset:61952
  v_accvgpr_write_b32 a90, 0
  v_mfma_f32_16x16x32_bf16 v[108:111], a[176:179], a[236:239], v[108:111]
  buffer_load_dwordx4 v[236:239], v1, s[8:11], s35 offen offset:2048 sc1
  v_mfma_f32_16x16x32_bf16 v[108:111], a[180:183], a[252:255], v[108:111]
  v_accvgpr_write_b32 a91, 0
  s_waitcnt lgkmcnt(4)
  v_mfma_f32_16x16x32_bf16 v[112:115], a[184:187], a[224:227], v[112:115]
  ds_read_b64_tr_b16 a[168:169], v7 offset:57344
  v_mfma_f32_16x16x32_bf16 v[112:115], a[188:191], a[240:243], v[112:115]
  ds_read_b64_tr_b16 a[170:171], v7 offset:57856
  v_accvgpr_write_b32 a92, 0
  v_mfma_f32_16x16x32_bf16 v[116:119], a[184:187], a[228:231], v[116:119]
  buffer_load_dwordx4 v[240:243], v1, s[8:11], s32 offen offset:3072 sc1
  s_add_u32 s32, s32, 4096
  v_mfma_f32_16x16x32_bf16 v[116:119], a[188:191], a[244:247], v[116:119]
  v_accvgpr_write_b32 a93, 0
  v_mfma_f32_16x16x32_bf16 v[120:123], a[184:187], a[232:235], v[120:123]
  ds_read_b64_tr_b16 a[172:173], v7 offset:61440
  v_mfma_f32_16x16x32_bf16 v[120:123], a[188:191], a[248:251], v[120:123]
  ds_read_b64_tr_b16 a[174:175], v7 offset:61952
  v_accvgpr_write_b32 a94, 0
  v_mfma_f32_16x16x32_bf16 v[124:127], a[184:187], a[236:239], v[124:127]
  buffer_load_dwordx4 v[244:247], v1, s[8:11], s33 offen offset:3072 sc1
  s_add_u32 s33, s33, 4096
  v_mfma_f32_16x16x32_bf16 v[124:127], a[188:191], a[252:255], v[124:127]
  v_accvgpr_write_b32 a95, 0
  s_waitcnt lgkmcnt(4)
  v_mfma_f32_16x16x32_bf16 v[128:131], a[160:163], a[224:227], v[128:131]
  ds_read_b64_tr_b16 a[176:177], v8 offset:57344
  v_mfma_f32_16x16x32_bf16 v[128:131], a[164:167], a[240:243], v[128:131]
  ds_read_b64_tr_b16 a[178:179], v8 offset:57856
  v_accvgpr_write_b32 a96, 0
  v_mfma_f32_16x16x32_bf16 v[132:135], a[160:163], a[228:231], v[132:135]
  buffer_load_dwordx4 v[248:251], v1, s[8:11], s34 offen offset:3072 sc1
  s_add_u32 s34, s34, 4096
  v_mfma_f32_16x16x32_bf16 v[132:135], a[164:167], a[244:247], v[132:135]
  v_accvgpr_write_b32 a97, 0
  v_mfma_f32_16x16x32_bf16 v[136:139], a[160:163], a[232:235], v[136:139]
  ds_read_b64_tr_b16 a[180:181], v8 offset:61440
  v_mfma_f32_16x16x32_bf16 v[136:139], a[164:167], a[248:251], v[136:139]
  ds_read_b64_tr_b16 a[182:183], v8 offset:61952
  v_accvgpr_write_b32 a98, 0
  v_mfma_f32_16x16x32_bf16 v[140:143], a[160:163], a[236:239], v[140:143]
  buffer_load_dwordx4 v[252:255], v1, s[8:11], s35 offen offset:3072 sc1
  s_add_u32 s35, s35, 4096
  v_mfma_f32_16x16x32_bf16 v[140:143], a[164:167], a[252:255], v[140:143]
  v_accvgpr_write_b32 a99, 0
  s_waitcnt lgkmcnt(4)
  v_mfma_f32_16x16x32_bf16 v[144:147], a[168:171], a[224:227], v[144:147]
  ds_read_b64_tr_b16 a[184:185], v9 offset:57344
  v_mfma_f32_16x16x32_bf16 v[144:147], a[172:175], a[240:243], v[144:147]
  ds_read_b64_tr_b16 a[186:187], v9 offset:57856
  v_accvgpr_write_b32 a100, 0
  v_mfma_f32_16x16x32_bf16 v[148:151], a[168:171], a[228:231], v[148:151]
  v_mfma_f32_16x16x32_bf16 v[148:151], a[172:175], a[244:247], v[148:151]
  v_accvgpr_write_b32 a101, 0
  v_mfma_f32_16x16x32_bf16 v[152:155], a[168:171], a[232:235], v[152:155]
  ds_read_b64_tr_b16 a[188:189], v9 offset:61440
  v_mfma_f32_16x16x32_bf16 v[152:155], a[172:175], a[248:251], v[152:155]
  ds_read_b64_tr_b16 a[190:191], v9 offset:61952
  v_accvgpr_write_b32 a102, 0
  v_mfma_f32_16x16x32_bf16 v[156:159], a[168:171], a[236:239], v[156:159]
  v_accvgpr_write_b32 a103, 0
  v_mfma_f32_16x16x32_bf16 v[156:159], a[172:175], a[252:255], v[156:159]
  s_waitcnt vmcnt(13)
  s_cmp_lg_u32 s3, 0
  s_cbranch_scc1 Lokf_3
  v_cmp_ne_u32 vcc, 1, v17
  s_nop 0
  s_cmp_lg_u64 vcc, 0
  s_cbranch_scc0 Lokf_3
  s_mov_b32 s86, 0x80000
Lspf_3:
  s_sub_u32 s86, s86, 1
  s_cbranch_scc1 Lokf_3
  s_sleep 1
  buffer_load_dword v17, v16, s[8:11], s90 offen sc1
  s_waitcnt vmcnt(0)
  v_cmp_ne_u32 vcc, 1, v17
  s_nop 0
  s_cmp_lg_u64 vcc, 0
  s_cbranch_scc1 Lspf_3
Lokf_3:
  s_barrier
  v_xor_b32 v6, 0x10000, v6
  v_xor_b32 v7, 0x10000, v7
  v_xor_b32 v8, 0x10000, v8
  v_xor_b32 v9, 0x10000, v9
  s_waitcnt lgkmcnt(4)
  v_mfma_f32_16x16x32_bf16 v[160:163], a[176:179], a[224:227], v[160:163]
  ds_read_b64_tr_b16 a[160:161], v6 offset:0
  s_lshl_b32 s78, s4, 20
  v_mfma_f32_16x16x32_bf16 v[160:163], a[180:183], a[240:243], v[160:163]
  ds_read_b64_tr_b16 a[162:163], v6 offset:512
  v_accvgpr_write_b32 a104, 0
  v_mfma_f32_16x16x32_bf16 v[164:167], a[176:179], a[228:231], v[164:167]
  s_add_u32 s12, s8, s78
  s_addc_u32 s13, s9, 0
  v_mfma_f32_16x16x32_bf16 v[164:167], a[180:183], a[244:247], v[164:167]
  v_accvgpr_write_b32 a105, 0
  s_sub_u32 s14, 16, s5
  v_mfma_f32_16x16x32_bf16 v[168:171], a[176:179], a[232:235], v[168:171]
  ds_read_b64_tr_b16 a[164:165], v6 offset:4096
  v_accvgpr_write_b32 a106, 0
  v_mfma_f32_16x16x32_bf16 v[168:171], a[180:183], a[248:251], v[168:171]
  ds_read_b64_tr_b16 a[166:167], v6 offset:4608
  s_lshl_b32 s14, s14, 16
  v_mfma_f32_16x16x32_bf16 v[172:175], a[176:179], a[236:239], v[172:175]
  v_accvgpr_write_b32 a107, 0
  v_mfma_f32_16x16x32_bf16 v[172:175], a[180:183], a[252:255], v[172:175]
  s_mov_b32 s15, 0x20000
  s_waitcnt lgkmcnt(4)
  v_mfma_f32_16x16x32_bf16 v[176:179], a[184:187], a[224:227], v[176:179]
  ds_read_b64_tr_b16 a[168:169], v7 offset:0
  v_accvgpr_write_b32 a108, 0
  v_mfma_f32_16x16x32_bf16 v[176:179], a[188:191], a[240:243], v[176:179]
  ds_read_b64_tr_b16 a[170:171], v7 offset:512
  s_add_u32 s78, s84, 131072
  v_mfma_f32_16x16x32_bf16 v[180:183], a[184:187], a[228:231], v[180:183]
  s_add_u32 m0, s84, 98304
  s_add_u32 s77, s79, 3145728
  buffer_load_dwordx4 v2, s[24:27], s77 offen offset:0 lds
  v_mfma_f32_16x16x32_bf16 v[180:183], a[188:191], a[244:247], v[180:183]
  s_mov_b32 s16, s100
  v_accvgpr_write_b32 a109, 0
  v_mfma_f32_16x16x32_bf16 v[184:187], a[184:187], a[232:235], v[184:187]
  ds_read_b64_tr_b16 a[172:173], v7 offset:4096
  s_mov_b32 s17, s101
  v_mfma_f32_16x16x32_bf16 v[184:187], a[188:191], a[248:251], v[184:187]
  ds_read_b64_tr_b16 a[174:175], v7 offset:4608
  v_accvgpr_write_b32 a110, 0
  v_mfma_f32_16x16x32_bf16 v[188:191], a[184:187], a[236:239], v[188:191]
  buffer_load_dwordx4 v3, s[24:27], s77 offen offset:1024 lds
  s_mov_b32 s18, 0x1c0000
  v_mfma_f32_16x16x32_bf16 v[188:191], a[188:191], a[252:255], v[188:191]
  s_waitcnt lgkmcnt(4)
  s_waitcnt vmcnt(14)
  v_mfma_f32_16x16x32_bf16 v[64:67], a[160:163], v[192:195], v[64:67]
  ds_read_b64_tr_b16 a[176:177], v8 offset:0
  v_accvgpr_write_b32 a111, 0
  v_mfma_f32_16x16x32_bf16 v[64:67], a[164:167], v[208:211], v[64:67]
  ds_read_b64_tr_b16 a[178:179], v8 offset:512
  s_mov_b32 s19, 0x20000
  v_mfma_f32_16x16x32_bf16 v[68:71], a[160:163], v[196:199], v[68:71]
  buffer_load_dwordx4 v4, s[24:27], s77 offen offset:2048 lds
  v_accvgpr_write_b32 a112, 0
  v_mfma_f32_16x16x32_bf16 v[68:71], a[164:167], v[212:215], v[68:71]
  s_lshl_b32 s85, s2, 2
  v_accvgpr_write_b32 a113, 0
  v_mfma_f32_16x16x32_bf16 v[72:75], a[160:163], v[200:203], v[72:75]
  ds_read_b64_tr_b16 a[180:181], v8 offset:4096
  v_accvgpr_write_b32 a114, 0
  v_mfma_f32_16x16x32_bf16 v[72:75], a[164:167], v[216:219], v[72:75]
  ds_read_b64_tr_b16 a[182:183], v8 offset:4608
  s_add_u32 s85, s85, s3
  v_mfma_f32_16x16x32_bf16 v[76:79], a[160:163], v[204:207], v[76:79]
  buffer_load_dwordx4 v5, s[24:27], s77 offen offset:3072 lds
  v_accvgpr_write_b32 a115, 0
  v_mfma_f32_16x16x32_bf16 v[76:79], a[164:167], v[220:223], v[76:79]
  s_and_b32 s85, s85, 511
  s_waitcnt lgkmcnt(4)
  v_mfma_f32_16x16x32_bf16 v[80:83], a[168:171], v[192:195], v[80:83]
  ds_read_b64_tr_b16 a[184:185], v9 offset:0
  v_accvgpr_write_b32 a116, 0
  v_mfma_f32_16x16x32_bf16 v[80:83], a[172:175], v[208:211], v[80:83]
  ds_read_b64_tr_b16 a[186:187], v9 offset:512
  s_lshr_b32 s80, s85, 3
  v_mfma_f32_16x16x32_bf16 v[84:87], a[168:171], v[196:199], v[84:87]
  buffer_load_dwordx4 a[192:195], v1, s[8:11], s32 offen offset:0 sc1
  v_accvgpr_write_b32 a117, 0
  v_mfma_f32_16x16x32_bf16 v[84:87], a[172:175], v[212:215], v[84:87]
  s_and_b32 s83, s85, 7
  v_accvgpr_write_b32 a118, 0
  v_mfma_f32_16x16x32_bf16 v[88:91], a[168:171], v[200:203], v[88:91]
  ds_read_b64_tr_b16 a[188:189], v9 offset:4096
  v_mfma_f32_16x16x32_bf16 v[88:91], a[172:175], v[216:219], v[88:91]
  ds_read_b64_tr_b16 a[190:191], v9 offset:4608
  v_accvgpr_write_b32 a119, 0
  v_mfma_f32_16x16x32_bf16 v[92:95], a[168:171], v[204:207], v[92:95]
  buffer_load_dwordx4 a[196:199], v1, s[8:11], s33 offen offset:0 sc1
  s_lshl_b32 s7, s83, 7
  v_mfma_f32_16x16x32_bf16 v[92:95], a[172:175], v[220:223], v[92:95]
  v_accvgpr_write_b32 a120, 0
  s_waitcnt lgkmcnt(4)
  v_mfma_f32_16x16x32_bf16 v[96:99], a[176:179], v[192:195], v[96:99]
  ds_read_b64_tr_b16 a[160:161], v6 offset:8192
  s_add_u32 s7, s7, s80
  v_mfma_f32_16x16x32_bf16 v[96:99], a[180:183], v[208:211], v[96:99]
  ds_read_b64_tr_b16 a[162:163], v6 offset:8704
  v_accvgpr_write_b32 a121, 0
  v_mfma_f32_16x16x32_bf16 v[100:103], a[176:179], v[196:199], v[100:103]
  buffer_load_dwordx4 a[200:203], v1, s[8:11], s34 offen offset:0 sc1
  s_lshl_b32 s7, s7, 12
  v_mfma_f32_16x16x32_bf16 v[100:103], a[180:183], v[212:215], v[100:103]
  v_accvgpr_write_b32 a122, 0
  v_mfma_f32_16x16x32_bf16 v[104:107], a[176:179], v[200:203], v[104:107]
  ds_read_b64_tr_b16 a[164:165], v6 offset:12288
  s_add_u32 s7, s7, 39845888
  v_mfma_f32_16x16x32_bf16 v[104:107], a[180:183], v[216:219], v[104:107]
  ds_read_b64_tr_b16 a[166:167], v6 offset:12800
  v_accvgpr_write_b32 a123, 0
  v_mfma_f32_16x16x32_bf16 v[108:111], a[176:179], v[204:207], v[108:111]
  buffer_load_dwordx4 a[204:207], v1, s[8:11], s35 offen offset:0 sc1
  v_mfma_f32_16x16x32_bf16 v[108:111], a[180:183], v[220:223], v[108:111]
  s_mul_i32 s81, s83, 56
  s_waitcnt lgkmcnt(4)
  v_mfma_f32_16x16x32_bf16 v[112:115], a[184:187], v[192:195], v[112:115]
  ds_read_b64_tr_b16 a[168:169], v7 offset:8192
  v_accvgpr_write_b32 a124, 0
  v_mfma_f32_16x16x32_bf16 v[112:115], a[188:191], v[208:211], v[112:115]
  ds_read_b64_tr_b16 a[170:171], v7 offset:8704
  s_add_u32 s81, s81, s80
  v_mfma_f32_16x16x32_bf16 v[116:119], a[184:187], v[196:199], v[116:119]
  buffer_load_dwordx4 a[208:211], v1, s[8:11], s32 offen offset:1024 sc1
  v_accvgpr_write_b32 a125, 0
  v_mfma_f32_16x16x32_bf16 v[116:119], a[188:191], v[212:215], v[116:119]
  s_lshl_b32 s81, s81, 12
  v_accvgpr_write_b32 a126, 0
  v_mfma_f32_16x16x32_bf16 v[120:123], a[184:187], v[200:203], v[120:123]
  ds_read_b64_tr_b16 a[172:173], v7 offset:12288
  v_mfma_f32_16x16x32_bf16 v[120:123], a[188:191], v[216:219], v[120:123]
  ds_read_b64_tr_b16 a[174:175], v7 offset:12800
  s_add_u32 s81, s81, 44040192
  v_mfma_f32_16x16x32_bf16 v[124:127], a[184:187], v[204:207], v[124:127]
  buffer_load_dwordx4 a[212:215], v1, s[8:11], s33 offen offset:1024 sc1
  v_accvgpr_write_b32 a127, 0
  v_mfma_f32_16x16x32_bf16 v[124:127], a[188:191], v[220:223], v[124:127]
  v_mov_b32 v12, 0x3f803f80
  s_waitcnt lgkmcnt(4)
  v_mfma_f32_16x16x32_bf16 v[128:131], a[160:163], v[192:195], v[128:131]
  ds_read_b64_tr_b16 a[176:177], v8 offset:8192
  s_lshl_b32 s80, s80, 15
  v_mfma_f32_16x16x32_bf16 v[128:131], a[164:167], v[208:211], v[128:131]
  ds_read_b64_tr_b16 a[178:179], v8 offset:8704
  v_mov_b32 v13, 0x3f803f80
  v_mfma_f32_16x16x32_bf16 v[132:135], a[160:163], v[196:199], v[132:135]
  buffer_load_dwordx4 a[216:219], v1, s[8:11], s34 offen offset:1024 sc1
  s_lshl_b32 s83, s83, 7
  v_mfma_f32_16x16x32_bf16 v[132:135], a[164:167], v[212:215], v[132:135]
  s_lshl_b32 s90, s4, 5
  s_add_u32 s90, s90, 39064576
  v_mfma_f32_16x16x32_bf16 v[136:139], a[160:163], v[200:203], v[136:139]
  ds_read_b64_tr_b16 a[180:181], v8 offset:12288
  s_lshl_b32 s76, s5, 2
  v_mfma_f32_16x16x32_bf16 v[136:139], a[164:167], v[216:219], v[136:139]
  ds_read_b64_tr_b16 a[182:183], v8 offset:12800
  s_add_u32 s90, s90, s76
  v_mfma_f32_16x16x32_bf16 v[140:143], a[160:163], v[204:207], v[140:143]
  buffer_load_dwordx4 a[220:223], v1, s[8:11], s35 offen offset:1024 sc1
  v_mfma_f32_16x16x32_bf16 v[140:143], a[164:167], v[220:223], v[140:143]
  s_waitcnt lgkmcnt(4)
  v_mfma_f32_16x16x32_bf16 v[144:147], a[168:171], v[192:195], v[144:147]
  ds_read_b64_tr_b16 a[184:185], v9 offset:8192
  v_mfma_f32_16x16x32_bf16 v[144:147], a[172:175], v[208:211], v[144:147]
  ds_read_b64_tr_b16 a[186:187], v9 offset:8704
  v_mfma_f32_16x16x32_bf16 v[148:151], a[168:171], v[196:199], v[148:151]
  s_cmp_eq_u32 s3, 0
  s_cselect_b32 s90, s90, 0x7ff00000
  v_mfma_f32_16x16x32_bf16 v[148:151], a[172:175], v[212:215], v[148:151]
  v_mov_b32 v14, 0x3f803f80
  s_add_u32 s80, s80, s83
  v_mfma_f32_16x16x32_bf16 v[152:155], a[168:171], v[200:203], v[152:155]
  ds_read_b64_tr_b16 a[188:189], v9 offset:12288
  v_mov_b32 v15, 0x3f803f80
  v_mfma_f32_16x16x32_bf16 v[152:155], a[172:175], v[216:219], v[152:155]
  ds_read_b64_tr_b16 a[190:191], v9 offset:12800
  s_and_b32 s83, s85, 15
  v_mfma_f32_16x16x32_bf16 v[156:159], a[168:171], v[204:207], v[156:159]
  s_mul_i32 s91, s83, 114688
  s_mul_i32 s83, s83, 7168
  v_mfma_f32_16x16x32_bf16 v[156:159], a[172:175], v[220:223], v[156:159]
  s_add_u32 s83, s83, 46137344
  s_waitcnt vmcnt(20)
  s_barrier
  s_cmp_lt_u32 s85, 448
  s_cselect_b32 s83, s83, 0x7ff00000
  s_cselect_b32 s81, s81, 0x7ff00000
  s_cselect_b32 s42, s42, 0
  s_waitcnt lgkmcnt(4)
  v_mfma_f32_16x16x32_bf16 v[160:163], a[176:179], v[192:195], v[160:163]
  ds_read_b64_tr_b16 a[160:161], v6 offset:16384
  v_mfma_f32_16x16x32_bf16 v[160:163], a[180:183], v[208:211], v[160:163]
  ds_read_b64_tr_b16 a[162:163], v6 offset:16896
  v_mfma_f32_16x16x32_bf16 v[164:167], a[176:179], v[196:199], v[164:167]
  v_min_u32 v18, 1, v0
  v_lshlrev_b32 v18, 27, v18
  v_mov_b32 v19, 1
  buffer_store_dword v19, v18, s[8:11], s90 offen sc1
  v_mfma_f32_16x16x32_bf16 v[164:167], a[180:183], v[212:215], v[164:167]
  s_cmp_ge_u32 s2, 128
  s_cselect_b32 s30, s30, 0
  v_mfma_f32_16x16x32_bf16 v[168:171], a[176:179], v[200:203], v[168:171]
  ds_read_b64_tr_b16 a[164:165], v6 offset:20480
  s_lshr_b32 s85, s85, 4
  v_mfma_f32_16x16x32_bf16 v[168:171], a[180:183], v[216:219], v[168:171]
  ds_read_b64_tr_b16 a[166:167], v6 offset:20992
  v_mfma_f32_16x16x32_bf16 v[172:175], a[176:179], v[204:207], v[172:175]
  s_lshl_b32 s90, s4, 5
  s_lshl_b32 s20, s85, 7
  v_mfma_f32_16x16x32_bf16 v[172:175], a[180:183], v[220:223], v[172:175]
  s_waitcnt lgkmcnt(4)
  v_mfma_f32_16x16x32_bf16 v[176:179], a[184:187], v[192:195], v[176:179]
  ds_read_b64_tr_b16 a[168:169], v7 offset:16384
  s_add_u32 s90, s90, 39064576
  v_mfma_f32_16x16x32_bf16 v[176:179], a[188:191], v[208:211], v[176:179]
  ds_read_b64_tr_b16 a[170:171], v7 offset:16896
  s_add_u32 s91, s91, s20
  v_mfma_f32_16x16x32_bf16 v[180:183], a[184:187], v[196:199], v[180:183]
  s_add_u32 m0, s84, 114688
  s_add_u32 s77, s79, 3670016
  buffer_load_dwordx4 v2, s[24:27], s77 offen offset:0 lds
  v_mfma_f32_16x16x32_bf16 v[180:183], a[188:191], v[212:215], v[180:183]
  s_cmp_eq_u32 s3, 0
  s_cselect_b32 s90, s90, 0x7ff00000
  v_mfma_f32_16x16x32_bf16 v[184:187], a[184:187], v[200:203], v[184:187]
  ds_read_b64_tr_b16 a[172:173], v7 offset:20480
  s_lshl_b32 s85, s85, 2
  v_mfma_f32_16x16x32_bf16 v[184:187], a[188:191], v[216:219], v[184:187]
  ds_read_b64_tr_b16 a[174:175], v7 offset:20992
  s_mul_i32 s87, s85, 9363
  v_mfma_f32_16x16x32_bf16 v[188:191], a[184:187], v[204:207], v[188:191]
  buffer_load_dwordx4 v3, s[24:27], s77 offen offset:1024 lds
  v_mfma_f32_16x16x32_bf16 v[188:191], a[188:191], v[220:223], v[188:191]
  s_waitcnt lgkmcnt(4)
  s_waitcnt vmcnt(15)
  v_mfma_f32_16x16x32_bf16 v[64:67], a[160:163], v[224:227], v[64:67]
  ds_read_b64_tr_b16 a[176:177], v8 offset:16384
  s_lshr_b32 s87, s87, 16
  v_mfma_f32_16x16x32_bf16 v[64:67], a[164:167], v[240:243], v[64:67]
  ds_read_b64_tr_b16 a[178:179], v8 offset:16896
  s_mul_i32 s87, s87, 107520
  v_mfma_f32_16x16x32_bf16 v[68:71], a[160:163], v[228:231], v[68:71]
  buffer_load_dwordx4 v4, s[24:27], s77 offen offset:2048 lds
  v_mfma_f32_16x16x32_bf16 v[68:71], a[164:167], v[244:247], v[68:71]
  s_lshl_b32 s20, s85, 10
  v_mfma_f32_16x16x32_bf16 v[72:75], a[160:163], v[232:235], v[72:75]
  ds_read_b64_tr_b16 a[180:181], v8 offset:20480
  v_mfma_f32_16x16x32_bf16 v[72:75], a[164:167], v[248:251], v[72:75]
  ds_read_b64_tr_b16 a[182:183], v8 offset:20992
  v_mfma_f32_16x16x32_bf16 v[76:79], a[160:163], v[236:239], v[76:79]
  buffer_load_dwordx4 v5, s[24:27], s77 offen offset:3072 lds
  s_add_u32 s20, s20, s87
  v_mfma_f32_16x16x32_bf16 v[76:79], a[164:167], v[252:255], v[76:79]
  s_waitcnt lgkmcnt(4)
  v_mfma_f32_16x16x32_bf16 v[80:83], a[168:171], v[224:227], v[80:83]
  ds_read_b64_tr_b16 a[184:185], v9 offset:16384
  s_add_u32 s20, s20, s83
  v_mfma_f32_16x16x32_bf16 v[80:83], a[172:175], v[240:243], v[80:83]
  ds_read_b64_tr_b16 a[186:187], v9 offset:16896
  v_mfma_f32_16x16x32_bf16 v[84:87], a[168:171], v[228:231], v[84:87]
  buffer_load_dwordx4 a[224:227], v1, s[8:11], s32 offen offset:2048 sc1
  s_add_u32 s85, s85, 1
  v_mfma_f32_16x16x32_bf16 v[84:87], a[172:175], v[244:247], v[84:87]
  v_mov_b32 v192, 0
  v_mfma_f32_16x16x32_bf16 v[88:91], a[168:171], v[232:235], v[88:91]
  ds_read_b64_tr_b16 a[188:189], v9 offset:20480
  s_mul_i32 s87, s85, 9363
  v_mfma_f32_16x16x32_bf16 v[88:91], a[172:175], v[248:251], v[88:91]
  ds_read_b64_tr_b16 a[190:191], v9 offset:20992
  v_mov_b32 v193, 0
  v_mfma_f32_16x16x32_bf16 v[92:95], a[168:171], v[236:239], v[92:95]
  buffer_load_dwordx4 a[228:231], v1, s[8:11], s33 offen offset:2048 sc1
  v_mov_b32 v194, 0
  v_mfma_f32_16x16x32_bf16 v[92:95], a[172:175], v[252:255], v[92:95]
  s_lshr_b32 s87, s87, 16
  s_waitcnt lgkmcnt(4)
  v_mfma_f32_16x16x32_bf16 v[96:99], a[176:179], v[224:227], v[96:99]
  ds_read_b64_tr_b16 a[160:161], v6 offset:24576
  v_mov_b32 v195, 0
  v_mfma_f32_16x16x32_bf16 v[96:99], a[180:183], v[240:243], v[96:99]
  ds_read_b64_tr_b16 a[162:163], v6 offset:25088
  s_mul_i32 s87, s87, 107520
  v_mfma_f32_16x16x32_bf16 v[100:103], a[176:179], v[228:231], v[100:103]
  buffer_load_dwordx4 a[232:235], v1, s[8:11], s34 offen offset:2048 sc1
  v_mov_b32 v196, 0
  v_mfma_f32_16x16x32_bf16 v[100:103], a[180:183], v[244:247], v[100:103]
  s_lshl_b32 s21, s85, 10
  v_mfma_f32_16x16x32_bf16 v[104:107], a[176:179], v[232:235], v[104:107]
  ds_read_b64_tr_b16 a[164:165], v6 offset:28672
  v_mov_b32 v197, 0
  v_mfma_f32_16x16x32_bf16 v[104:107], a[180:183], v[248:251], v[104:107]
  ds_read_b64_tr_b16 a[166:167], v6 offset:29184
  s_add_u32 s21, s21, s87
  v_mfma_f32_16x16x32_bf16 v[108:111], a[176:179], v[236:239], v[108:111]
  buffer_load_dwordx4 a[236:239], v1, s[8:11], s35 offen offset:2048 sc1
  v_mov_b32 v198, 0
  v_mfma_f32_16x16x32_bf16 v[108:111], a[180:183], v[252:255], v[108:111]
  s_waitcnt lgkmcnt(4)
  v_mfma_f32_16x16x32_bf16 v[112:115], a[184:187], v[224:227], v[112:115]
  ds_read_b64_tr_b16 a[168:169], v7 offset:24576
  s_add_u32 s21, s21, s83
  v_mfma_f32_16x16x32_bf16 v[112:115], a[188:191], v[240:243], v[112:115]
  ds_read_b64_tr_b16 a[170:171], v7 offset:25088
  v_mov_b32 v199, 0
  v_mfma_f32_16x16x32_bf16 v[116:119], a[184:187], v[228:231], v[116:119]
  buffer_load_dwordx4 a[240:243], v1, s[8:11], s32 offen offset:3072 sc1
  s_add_u32 s32, s32, 4096
  v_mfma_f32_16x16x32_bf16 v[116:119], a[188:191], v[244:247], v[116:119]
  s_add_u32 s85, s85, 1
  v_mov_b32 v200, 0
  v_mfma_f32_16x16x32_bf16 v[120:123], a[184:187], v[232:235], v[120:123]
  ds_read_b64_tr_b16 a[172:173], v7 offset:28672
  s_mul_i32 s87, s85, 9363
  v_mfma_f32_16x16x32_bf16 v[120:123], a[188:191], v[248:251], v[120:123]
  ds_read_b64_tr_b16 a[174:175], v7 offset:29184
  v_mov_b32 v201, 0
  v_mfma_f32_16x16x32_bf16 v[124:127], a[184:187], v[236:239], v[124:127]
  buffer_load_dwordx4 a[244:247], v1, s[8:11], s33 offen offset:3072 sc1
  s_add_u32 s33, s33, 4096
  v_mfma_f32_16x16x32_bf16 v[124:127], a[188:191], v[252:255], v[124:127]
  s_lshr_b32 s87, s87, 16
  s_waitcnt lgkmcnt(4)
  v_mfma_f32_16x16x32_bf16 v[128:131], a[160:163], v[224:227], v[128:131]
  ds_read_b64_tr_b16 a[176:177], v8 offset:24576
  v_mov_b32 v202, 0
  v_mfma_f32_16x16x32_bf16 v[128:131], a[164:167], v[240:243], v[128:131]
  ds_read_b64_tr_b16 a[178:179], v8 offset:25088
  s_mul_i32 s87, s87, 107520
  v_mfma_f32_16x16x32_bf16 v[132:135], a[160:163], v[228:231], v[132:135]
  buffer_load_dwordx4 a[248:251], v1, s[8:11], s34 offen offset:3072 sc1
  s_add_u32 s34, s34, 4096
  v_mfma_f32_16x16x32_bf16 v[132:135], a[164:167], v[244:247], v[132:135]
  v_mov_b32 v203, 0
  s_lshl_b32 s22, s85, 10
  v_mfma_f32_16x16x32_bf16 v[136:139], a[160:163], v[232:235], v[136:139]
  ds_read_b64_tr_b16 a[180:181], v8 offset:28672
  v_mov_b32 v204, 0
  v_mfma_f32_16x16x32_bf16 v[136:139], a[164:167], v[248:251], v[136:139]
  ds_read_b64_tr_b16 a[182:183], v8 offset:29184
  s_add_u32 s22, s22, s87
  v_mfma_f32_16x16x32_bf16 v[140:143], a[160:163], v[236:239], v[140:143]
  buffer_load_dwordx4 a[252:255], v1, s[8:11], s35 offen offset:3072 sc1
  s_add_u32 s35, s35, 4096
  v_mfma_f32_16x16x32_bf16 v[140:143], a[164:167], v[252:255], v[140:143]
  v_mov_b32 v205, 0
  s_waitcnt lgkmcnt(4)
  v_mfma_f32_16x16x32_bf16 v[144:147], a[168:171], v[224:227], v[144:147]
  ds_read_b64_tr_b16 a[184:185], v9 offset:24576
  s_add_u32 s22, s22, s83
  v_mfma_f32_16x16x32_bf16 v[144:147], a[172:175], v[240:243], v[144:147]
  ds_read_b64_tr_b16 a[186:187], v9 offset:25088
  v_mov_b32 v206, 0
  v_mfma_f32_16x16x32_bf16 v[148:151], a[168:171], v[228:231], v[148:151]
  s_add_u32 s77, s84, 0
  s_mov_b32 m0, s77
  s_nop 0
  buffer_load_dwordx4 v1, s[12:15], s77 offen offset:0 sc1 lds
  v_mfma_f32_16x16x32_bf16 v[148:151], a[172:175], v[244:247], v[148:151]
  v_mov_b32 v207, 0
  s_add_u32 s85, s85, 1
  v_mfma_f32_16x16x32_bf16 v[152:155], a[168:171], v[232:235], v[152:155]
  ds_read_b64_tr_b16 a[188:189], v9 offset:28672
  v_mov_b32 v208, 0
  v_mfma_f32_16x16x32_bf16 v[152:155], a[172:175], v[248:251], v[152:155]
  ds_read_b64_tr_b16 a[190:191], v9 offset:29184
  s_mul_i32 s87, s85, 9363
  v_mfma_f32_16x16x32_bf16 v[156:159], a[168:171], v[236:239], v[156:159]
  buffer_load_dwordx4 v1, s[12:15], s77 offen offset:1024 sc1 lds
  s_lshr_b32 s87, s87, 16
  v_mfma_f32_16x16x32_bf16 v[156:159], a[172:175], v[252:255], v[156:159]
  v_mov_b32 v209, 0
  s_waitcnt vmcnt(23)
  s_barrier
  s_waitcnt lgkmcnt(4)
  v_mfma_f32_16x16x32_bf16 v[160:163], a[176:179], v[224:227], v[160:163]
  ds_read_b64_tr_b16 a[160:161], v6 offset:32768
  s_mul_i32 s87, s87, 107520
  v_mfma_f32_16x16x32_bf16 v[160:163], a[180:183], v[240:243], v[160:163]
  ds_read_b64_tr_b16 a[162:163], v6 offset:33280
  v_mov_b32 v210, 0
  v_mfma_f32_16x16x32_bf16 v[164:167], a[176:179], v[228:231], v[164:167]
  buffer_load_dwordx4 v1, s[12:15], s77 offen offset:2048 sc1 lds
  v_mov_b32 v211, 0
  v_mfma_f32_16x16x32_bf16 v[164:167], a[180:183], v[244:247], v[164:167]
  s_lshl_b32 s23, s85, 10
  v_mfma_f32_16x16x32_bf16 v[168:171], a[176:179], v[232:235], v[168:171]
  ds_read_b64_tr_b16 a[164:165], v6 offset:36864
  v_mov_b32 v212, 0
  v_mfma_f32_16x16x32_bf16 v[168:171], a[180:183], v[248:251], v[168:171]
  ds_read_b64_tr_b16 a[166:167], v6 offset:37376
  s_add_u32 s23, s23, s87
  v_mfma_f32_16x16x32_bf16 v[172:175], a[176:179], v[236:239], v[172:175]
  buffer_load_dwordx4 v1, s[12:15], s77 offen offset:3072 sc1 lds
  v_mov_b32 v213, 0
  v_mfma_f32_16x16x32_bf16 v[172:175], a[180:183], v[252:255], v[172:175]
  s_add_u32 s23, s23, s83
  s_waitcnt lgkmcnt(4)
  v_mfma_f32_16x16x32_bf16 v[176:179], a[184:187], v[224:227], v[176:179]
  ds_read_b64_tr_b16 a[168:169], v7 offset:32768
  v_mov_b32 v214, 0
  v_mfma_f32_16x16x32_bf16 v[176:179], a[188:191], v[240:243], v[176:179]
  ds_read_b64_tr_b16 a[170:171], v7 offset:33280
  s_add_u32 s85, s85, 1
  v_mfma_f32_16x16x32_bf16 v[180:183], a[184:187], v[228:231], v[180:183]
  s_add_u32 s77, s84, 32768
  s_mov_b32 m0, s77
  s_nop 0
  buffer_load_dwordx4 v1, s[12:15], s77 offen offset:0 sc1 lds
  v_mfma_f32_16x16x32_bf16 v[180:183], a[188:191], v[244:247], v[180:183]
  v_mov_b32 v215, 0
  v_mfma_f32_16x16x32_bf16 v[184:187], a[184:187], v[232:235], v[184:187]
  ds_read_b64_tr_b16 a[172:173], v7 offset:36864
  v_mov_b32 v216, 0
  v_mfma_f32_16x16x32_bf16 v[184:187], a[188:191], v[248:251], v[184:187]
  ds_read_b64_tr_b16 a[174:175], v7 offset:37376
  v_mfma_f32_16x16x32_bf16 v[188:191], a[184:187], v[236:239], v[188:191]
  buffer_load_dwordx4 v1, s[12:15], s77 offen offset:1024 sc1 lds
  v_mfma_f32_16x16x32_bf16 v[188:191], a[188:191], v[252:255], v[188:191]
  s_waitcnt lgkmcnt(4)
  s_waitcnt vmcnt(19)
  v_mfma_f32_16x16x32_bf16 v[64:67], a[160:163], a[192:195], v[64:67]
  ds_read_b64_tr_b16 a[176:177], v8 offset:32768
  v_mov_b32 v217, 0
  v_mfma_f32_16x16x32_bf16 v[64:67], a[164:167], a[208:211], v[64:67]
  ds_read_b64_tr_b16 a[178:179], v8 offset:33280
  v_mov_b32 v218, 0
  v_mfma_f32_16x16x32_bf16 v[68:71], a[160:163], a[196:199], v[68:71]
  buffer_load_dwordx4 v1, s[12:15], s77 offen offset:2048 sc1 lds
  v_mfma_f32_16x16x32_bf16 v[68:71], a[164:167], a[212:215], v[68:71]
  v_mov_b32 v219, 0
  v_mfma_f32_16x16x32_bf16 v[72:75], a[160:163], a[200:203], v[72:75]
  ds_read_b64_tr_b16 a[180:181], v8 offset:36864
  v_lshrrev_b32 v244, 3, v0
  v_mfma_f32_16x16x32_bf16 v[72:75], a[164:167], a[216:219], v[72:75]
  ds_read_b64_tr_b16 a[182:183], v8 offset:37376
  v_and_b32 v245, 7, v0
  v_mfma_f32_16x16x32_bf16 v[76:79], a[160:163], a[204:207], v[76:79]
  buffer_load_dwordx4 v1, s[12:15], s77 offen offset:3072 sc1 lds
  v_mov_b32 v220, 0
  v_mfma_f32_16x16x32_bf16 v[76:79], a[164:167], a[220:223], v[76:79]
  v_and_b32 v246, 6, v244
  s_waitcnt lgkmcnt(4)
  v_mfma_f32_16x16x32_bf16 v[80:83], a[168:171], a[192:195], v[80:83]
  ds_read_b64_tr_b16 a[184:185], v9 offset:32768
  v_mov_b32 v221, 0
  v_mfma_f32_16x16x32_bf16 v[80:83], a[172:175], a[208:211], v[80:83]
  ds_read_b64_tr_b16 a[186:187], v9 offset:33280
  v_xor_b32 v246, v246, v245
  v_mfma_f32_16x16x32_bf16 v[84:87], a[168:171], a[196:199], v[84:87]
  v_mov_b32 v222, 0
  v_lshlrev_b32 v246, 4, v246
  v_mfma_f32_16x16x32_bf16 v[84:87], a[172:175], a[212:215], v[84:87]
  v_lshl_add_u32 v236, v244, 10, v246
  v_mov_b32 v223, 0
  v_mfma_f32_16x16x32_bf16 v[88:91], a[168:171], a[200:203], v[88:91]
  ds_read_b64_tr_b16 a[188:189], v9 offset:36864
  v_mfma_f32_16x16x32_bf16 v[88:91], a[172:175], a[216:219], v[88:91]
  ds_read_b64_tr_b16 a[190:191], v9 offset:37376
  v_add_u32 v237, 7168, v236
  v_mfma_f32_16x16x32_bf16 v[92:95], a[168:171], a[204:207], v[92:95]
  v_mov_b32 v255, 0xff800000
  v_mfma_f32_16x16x32_bf16 v[92:95], a[172:175], a[220:223], v[92:95]
  v_add_u32 v238, 14336, v236
  s_waitcnt lgkmcnt(4)
  v_mfma_f32_16x16x32_bf16 v[96:99], a[176:179], a[192:195], v[96:99]
  ds_read_b64_tr_b16 a[160:161], v6 offset:40960
  v_add_u32 v239, 21504, v236
  v_mfma_f32_16x16x32_bf16 v[96:99], a[180:183], a[208:211], v[96:99]
  ds_read_b64_tr_b16 a[162:163], v6 offset:41472
  s_lshl_b32 s87, s4, 12
  v_mfma_f32_16x16x32_bf16 v[100:103], a[176:179], a[196:199], v[100:103]
  v_mul_u32_u24 v240, 3584, v244
  s_add_u32 s87, s87, 48234496
  v_mfma_f32_16x16x32_bf16 v[100:103], a[180:183], a[212:215], v[100:103]
  v_add_u32 v240, v240, v246
  s_lshl_b32 s36, s89, 18
  v_mfma_f32_16x16x32_bf16 v[104:107], a[176:179], a[200:203], v[104:107]
  ds_read_b64_tr_b16 a[164:165], v6 offset:45056
  s_add_u32 s36, s36, s87
  v_mfma_f32_16x16x32_bf16 v[104:107], a[180:183], a[216:219], v[104:107]
  ds_read_b64_tr_b16 a[166:167], v6 offset:45568
  v_add_u32 v241, 27648, v240
  v_mfma_f32_16x16x32_bf16 v[108:111], a[176:179], a[204:207], v[108:111]
  v_add_u32 v242, 55296, v240
  s_add_u32 s37, s36, 131072
  v_mfma_f32_16x16x32_bf16 v[108:111], a[180:183], a[220:223], v[108:111]
  s_lshl_b32 s38, s88, 18
  s_waitcnt lgkmcnt(4)
  v_mfma_f32_16x16x32_bf16 v[112:115], a[184:187], a[192:195], v[112:115]
  ds_read_b64_tr_b16 a[168:169], v7 offset:40960
  v_add_u32 v243, 82944, v240
  v_mfma_f32_16x16x32_bf16 v[112:115], a[188:191], a[208:211], v[112:115]
  ds_read_b64_tr_b16 a[170:171], v7 offset:41472
  s_add_u32 s38, s38, s87
  v_mfma_f32_16x16x32_bf16 v[116:119], a[184:187], a[196:199], v[116:119]
  s_add_u32 s39, s38, 131072
  v_lshrrev_b32 v245, 4, v0
  v_mfma_f32_16x16x32_bf16 v[116:119], a[188:191], a[212:215], v[116:119]
  v_bfe_u32 v246, v0, 2, 2
  v_lshrrev_b32 v36, 4, v0
  v_mfma_f32_16x16x32_bf16 v[120:123], a[184:187], a[200:203], v[120:123]
  ds_read_b64_tr_b16 a[172:173], v7 offset:45056
  v_lshlrev_b32 v36, 2, v36
  v_mfma_f32_16x16x32_bf16 v[120:123], a[188:191], a[216:219], v[120:123]
  ds_read_b64_tr_b16 a[174:175], v7 offset:45568
  v_lshl_add_u32 v245, v245, 2, v246
  v_mfma_f32_16x16x32_bf16 v[124:127], a[184:187], a[204:207], v[124:127]
  v_and_b32 v37, 15, v0
  v_bfe_u32 v246, v245, 1, 2
  v_mfma_f32_16x16x32_bf16 v[124:127], a[188:191], a[220:223], v[124:127]
  v_sub_u32 v37, v37, v36
  s_waitcnt lgkmcnt(4)
  v_mfma_f32_16x16x32_bf16 v[128:131], a[160:163], a[192:195], v[128:131]
  ds_read_b64_tr_b16 a[176:177], v8 offset:40960
  v_lshlrev_b32 v245, 7, v245
  v_mfma_f32_16x16x32_bf16 v[128:131], a[164:167], a[208:211], v[128:131]
  ds_read_b64_tr_b16 a[178:179], v8 offset:41472
  v_cmp_le_i32 s[24:25], 0, v37
  v_mfma_f32_16x16x32_bf16 v[132:135], a[160:163], a[196:199], v[132:135]
  v_lshl_add_u32 v245, v246, 5, v245
  v_cmp_le_i32 s[26:27], 1, v37
  v_mfma_f32_16x16x32_bf16 v[132:135], a[164:167], a[212:215], v[132:135]
  v_cmp_le_i32 s[32:33], 2, v37
  v_and_b32 v246, 3, v0
  v_mfma_f32_16x16x32_bf16 v[136:139], a[160:163], a[200:203], v[136:139]
  ds_read_b64_tr_b16 a[180:181], v8 offset:45056
  v_cmp_le_i32 s[34:35], 3, v37
  v_mfma_f32_16x16x32_bf16 v[136:139], a[164:167], a[216:219], v[136:139]
  ds_read_b64_tr_b16 a[182:183], v8 offset:45568
  v_lshl_add_u32 v245, v246, 3, v245
  v_mfma_f32_16x16x32_bf16 v[140:143], a[160:163], a[204:207], v[140:143]
  v_mov_b32 v2, v1
  s_lshl_b32 s85, s3, 13
  v_mfma_f32_16x16x32_bf16 v[140:143], a[164:167], a[220:223], v[140:143]
  v_mov_b32 v3, v1
  s_waitcnt lgkmcnt(4)
  v_mfma_f32_16x16x32_bf16 v[144:147], a[168:171], a[192:195], v[144:147]
  ds_read_b64_tr_b16 a[184:185], v9 offset:40960
  v_mov_b32 v18, 0
  v_mfma_f32_16x16x32_bf16 v[144:147], a[172:175], a[208:211], v[144:147]
  ds_read_b64_tr_b16 a[186:187], v9 offset:41472
  s_add_u32 s85, s85, 131072
  v_mfma_f32_16x16x32_bf16 v[148:151], a[168:171], a[196:199], v[148:151]
  v_mov_b32 v19, 0
  v_add_u32 v244, s85, v245
  v_mfma_f32_16x16x32_bf16 v[148:151], a[172:175], a[212:215], v[148:151]
  v_mov_b32 v20, 0
  v_xor_b32 v245, 32, v244
  v_mfma_f32_16x16x32_bf16 v[152:155], a[168:171], a[200:203], v[152:155]
  ds_read_b64_tr_b16 a[188:189], v9 offset:45056
  v_mov_b32 v21, 0
  v_mfma_f32_16x16x32_bf16 v[152:155], a[172:175], a[216:219], v[152:155]
  ds_read_b64_tr_b16 a[190:191], v9 offset:45568
  v_xor_b32 v246, 64, v244
  v_mfma_f32_16x16x32_bf16 v[156:159], a[168:171], a[204:207], v[156:159]
  v_mov_b32 v22, 0
  v_mov_b32 v23, 0
  v_mfma_f32_16x16x32_bf16 v[156:159], a[172:175], a[220:223], v[156:159]
  v_xor_b32 v247, 0x60, v244
  s_waitcnt vmcnt(16)
  s_barrier
  v_mov_b32 v24, 0
  s_waitcnt lgkmcnt(4)
  v_mfma_f32_16x16x32_bf16 v[160:163], a[176:179], a[192:195], v[160:163]
  ds_read_b64_tr_b16 a[160:161], v6 offset:49152
  v_mov_b32 v25, 0
  v_mfma_f32_16x16x32_bf16 v[160:163], a[180:183], a[208:211], v[160:163]
  ds_read_b64_tr_b16 a[162:163], v6 offset:49664
  v_mov_b32 v26, 0
  v_mfma_f32_16x16x32_bf16 v[164:167], a[176:179], a[196:199], v[164:167]
  buffer_load_dword v17, v16, s[8:11], s90 offen sc1
  v_mov_b32 v27, 0
  v_mfma_f32_16x16x32_bf16 v[164:167], a[180:183], a[212:215], v[164:167]
  v_mfma_f32_16x16x32_bf16 v[168:171], a[176:179], a[200:203], v[168:171]
  ds_read_b64_tr_b16 a[164:165], v6 offset:53248
  v_mov_b32 v28, 0
  v_mfma_f32_16x16x32_bf16 v[168:171], a[180:183], a[216:219], v[168:171]
  ds_read_b64_tr_b16 a[166:167], v6 offset:53760
  v_mov_b32 v29, 0
  v_mfma_f32_16x16x32_bf16 v[172:175], a[176:179], a[204:207], v[172:175]
  v_mov_b32 v30, 0
  v_mfma_f32_16x16x32_bf16 v[172:175], a[180:183], a[220:223], v[172:175]
  v_mov_b32 v31, 0
  s_waitcnt lgkmcnt(4)
  v_mfma_f32_16x16x32_bf16 v[176:179], a[184:187], a[192:195], v[176:179]
  ds_read_b64_tr_b16 a[168:169], v7 offset:49152
  v_mfma_f32_16x16x32_bf16 v[176:179], a[188:191], a[208:211], v[176:179]
  ds_read_b64_tr_b16 a[170:171], v7 offset:49664
  v_mfma_f32_16x16x32_bf16 v[180:183], a[184:187], a[196:199], v[180:183]
  s_add_u32 m0, s85, 0
  s_add_u32 s76, s80, 0
  buffer_load_dwordx4 v236, s[28:31], s76 offen offset:0 nt lds
  v_mfma_f32_16x16x32_bf16 v[180:183], a[188:191], a[212:215], v[180:183]
  v_mfma_f32_16x16x32_bf16 v[184:187], a[184:187], a[200:203], v[184:187]
  ds_read_b64_tr_b16 a[172:173], v7 offset:53248
  v_mfma_f32_16x16x32_bf16 v[184:187], a[188:191], a[216:219], v[184:187]
  ds_read_b64_tr_b16 a[174:175], v7 offset:53760
  v_mfma_f32_16x16x32_bf16 v[188:191], a[184:187], a[204:207], v[188:191]
  buffer_load_dwordx4 v237, s[28:31], s76 offen offset:1024 nt lds
  v_mfma_f32_16x16x32_bf16 v[188:191], a[188:191], a[220:223], v[188:191]
  s_waitcnt lgkmcnt(4)
  s_waitcnt vmcnt(11)
  v_mfma_f32_16x16x32_bf16 v[64:67], a[160:163], a[224:227], v[64:67]
  ds_read_b64_tr_b16 a[176:177], v8 offset:49152
  v_mfma_f32_16x16x32_bf16 v[64:67], a[164:167], a[240:243], v[64:67]
  ds_read_b64_tr_b16 a[178:179], v8 offset:49664
  v_mfma_f32_16x16x32_bf16 v[68:71], a[160:163], a[228:231], v[68:71]
  buffer_load_dwordx4 v238, s[28:31], s76 offen offset:2048 nt lds
  v_mfma_f32_16x16x32_bf16 v[68:71], a[164:167], a[244:247], v[68:71]
  v_mfma_f32_16x16x32_bf16 v[72:75], a[160:163], a[232:235], v[72:75]
  ds_read_b64_tr_b16 a[180:181], v8 offset:53248
  v_mfma_f32_16x16x32_bf16 v[72:75], a[164:167], a[248:251], v[72:75]
  ds_read_b64_tr_b16 a[182:183], v8 offset:53760
  v_mfma_f32_16x16x32_bf16 v[76:79], a[160:163], a[236:239], v[76:79]
  buffer_load_dwordx4 v239, s[28:31], s76 offen offset:3072 nt lds
  v_mfma_f32_16x16x32_bf16 v[76:79], a[164:167], a[252:255], v[76:79]
  s_waitcnt lgkmcnt(4)
  v_mfma_f32_16x16x32_bf16 v[80:83], a[168:171], a[224:227], v[80:83]
  ds_read_b64_tr_b16 a[184:185], v9 offset:49152
  v_mfma_f32_16x16x32_bf16 v[80:83], a[172:175], a[240:243], v[80:83]
  ds_read_b64_tr_b16 a[186:187], v9 offset:49664
  v_mfma_f32_16x16x32_bf16 v[84:87], a[168:171], a[228:231], v[84:87]
  s_add_u32 m0, s85, 4096
  s_add_u32 s76, s80, 2097152
  buffer_load_dwordx4 v236, s[28:31], s76 offen offset:0 nt lds
  v_mfma_f32_16x16x32_bf16 v[84:87], a[172:175], a[244:247], v[84:87]
  v_mfma_f32_16x16x32_bf16 v[88:91], a[168:171], a[232:235], v[88:91]
  ds_read_b64_tr_b16 a[188:189], v9 offset:53248
  v_mfma_f32_16x16x32_bf16 v[88:91], a[172:175], a[248:251], v[88:91]
  ds_read_b64_tr_b16 a[190:191], v9 offset:53760
  v_mfma_f32_16x16x32_bf16 v[92:95], a[168:171], a[236:239], v[92:95]
  buffer_load_dwordx4 v237, s[28:31], s76 offen offset:1024 nt lds
  v_mfma_f32_16x16x32_bf16 v[92:95], a[172:175], a[252:255], v[92:95]
  s_waitcnt lgkmcnt(4)
  v_mfma_f32_16x16x32_bf16 v[96:99], a[176:179], a[224:227], v[96:99]
  ds_read_b64_tr_b16 a[160:161], v6 offset:57344
  v_mfma_f32_16x16x32_bf16 v[96:99], a[180:183], a[240:243], v[96:99]
  ds_read_b64_tr_b16 a[162:163], v6 offset:57856
  v_cvt_pk_bf16_f32 v64, v64, v65
  v_mfma_f32_16x16x32_bf16 v[100:103], a[176:179], a[228:231], v[100:103]
  buffer_load_dwordx4 v238, s[28:31], s76 offen offset:2048 nt lds
  v_cvt_pk_bf16_f32 v65, v66, v67
  v_mfma_f32_16x16x32_bf16 v[100:103], a[180:183], a[244:247], v[100:103]
  v_cvt_pk_bf16_f32 v66, v80, v81
  v_cvt_pk_bf16_f32 v67, v82, v83
  v_mfma_f32_16x16x32_bf16 v[104:107], a[176:179], a[232:235], v[104:107]
  ds_read_b64_tr_b16 a[164:165], v6 offset:61440
  v_cvt_pk_bf16_f32 v68, v68, v69
  v_mfma_f32_16x16x32_bf16 v[104:107], a[180:183], a[248:251], v[104:107]
  ds_read_b64_tr_b16 a[166:167], v6 offset:61952
  v_cvt_pk_bf16_f32 v69, v70, v71
  v_mfma_f32_16x16x32_bf16 v[108:111], a[176:179], a[236:239], v[108:111]
  buffer_load_dwordx4 v239, s[28:31], s76 offen offset:3072 nt lds
  v_cvt_pk_bf16_f32 v70, v84, v85
  v_mfma_f32_16x16x32_bf16 v[108:111], a[180:183], a[252:255], v[108:111]
  v_cvt_pk_bf16_f32 v71, v86, v87
  s_waitcnt lgkmcnt(4)
  v_mfma_f32_16x16x32_bf16 v[112:115], a[184:187], a[224:227], v[112:115]
  ds_read_b64_tr_b16 a[168:169], v7 offset:57344
  v_cvt_pk_bf16_f32 v72, v72, v73
  v_mfma_f32_16x16x32_bf16 v[112:115], a[188:191], a[240:243], v[112:115]
  ds_read_b64_tr_b16 a[170:171], v7 offset:57856
  v_cvt_pk_bf16_f32 v73, v74, v75
  v_mfma_f32_16x16x32_bf16 v[116:119], a[184:187], a[228:231], v[116:119]
  v_cvt_pk_bf16_f32 v74, v88, v89
  v_cvt_pk_bf16_f32 v75, v90, v91
  v_mfma_f32_16x16x32_bf16 v[116:119], a[188:191], a[244:247], v[116:119]
  v_cvt_pk_bf16_f32 v76, v76, v77
  v_mfma_f32_16x16x32_bf16 v[120:123], a[184:187], a[232:235], v[120:123]
  ds_read_b64_tr_b16 a[172:173], v7 offset:61440
  v_cvt_pk_bf16_f32 v77, v78, v79
  v_mfma_f32_16x16x32_bf16 v[120:123], a[188:191], a[248:251], v[120:123]
  ds_read_b64_tr_b16 a[174:175], v7 offset:61952
  v_cvt_pk_bf16_f32 v78, v92, v93
  v_mfma_f32_16x16x32_bf16 v[124:127], a[184:187], a[236:239], v[124:127]
  v_cvt_pk_bf16_f32 v79, v94, v95
  v_mfma_f32_16x16x32_bf16 v[124:127], a[188:191], a[252:255], v[124:127]
  s_waitcnt vmcnt(8)
  s_cmp_lg_u32 s3, 0
  s_cbranch_scc1 Lokf_4
  v_cmp_ne_u32 vcc, 1, v17
  s_nop 0
  s_cmp_lg_u64 vcc, 0
  s_cbranch_scc0 Lokf_4
  s_mov_b32 s86, 0x80000
Lspf_4:
  s_sub_u32 s86, s86, 1
  s_cbranch_scc1 Lokf_4
  s_sleep 1
  buffer_load_dword v17, v16, s[8:11], s90 offen sc1
  s_waitcnt vmcnt(0)
  v_cmp_ne_u32 vcc, 1, v17
  s_nop 0
  s_cmp_lg_u64 vcc, 0
  s_cbranch_scc1 Lspf_4
Lokf_4:
  s_barrier
  s_waitcnt lgkmcnt(4)
  v_mfma_f32_16x16x32_bf16 v[128:131], a[160:163], a[224:227], v[128:131]
  ds_read_b64_tr_b16 a[176:177], v8 offset:57344
  v_mfma_f32_16x16x32_bf16 v[128:131], a[164:167], a[240:243], v[128:131]
  ds_read_b64_tr_b16 a[178:179], v8 offset:57856
  v_cvt_pk_bf16_f32 v96, v96, v97
  v_mfma_f32_16x16x32_bf16 v[132:135], a[160:163], a[228:231], v[132:135]
  s_add_u32 s77, s84, 16384
  s_mov_b32 m0, s77
  s_nop 0
  buffer_load_dwordx4 v1, s[12:15], s77 offen offset:0 sc1 lds
  v_mfma_f32_16x16x32_bf16 v[132:135], a[164:167], a[244:247], v[132:135]
  ds_read_b128 a[128:131], v2 offset:0
  v_cvt_pk_bf16_f32 v97, v98, v99
  v_mfma_f32_16x16x32_bf16 v[136:139], a[160:163], a[232:235], v[136:139]
  ds_read_b64_tr_b16 a[180:181], v8 offset:61440
  v_cvt_pk_bf16_f32 v98, v112, v113
  v_mfma_f32_16x16x32_bf16 v[136:139], a[164:167], a[248:251], v[136:139]
  ds_read_b64_tr_b16 a[182:183], v8 offset:61952
  v_cvt_pk_bf16_f32 v99, v114, v115
  v_mfma_f32_16x16x32_bf16 v[140:143], a[160:163], a[236:239], v[140:143]
  buffer_load_dwordx4 v1, s[12:15], s77 offen offset:1024 sc1 lds
  v_cvt_pk_bf16_f32 v100, v100, v101
  v_mfma_f32_16x16x32_bf16 v[140:143], a[164:167], a[252:255], v[140:143]
  ds_read_b128 a[132:135], v2 offset:1024
  s_waitcnt lgkmcnt(6)
  v_mfma_f32_16x16x32_bf16 v[144:147], a[168:171], a[224:227], v[144:147]
  ds_read_b64_tr_b16 a[184:185], v9 offset:57344
  v_cvt_pk_bf16_f32 v101, v102, v103
  v_mfma_f32_16x16x32_bf16 v[144:147], a[172:175], a[240:243], v[144:147]
  ds_read_b64_tr_b16 a[186:187], v9 offset:57856
  v_cvt_pk_bf16_f32 v102, v116, v117
  v_mfma_f32_16x16x32_bf16 v[148:151], a[168:171], a[228:231], v[148:151]
  buffer_load_dwordx4 v1, s[12:15], s77 offen offset:2048 sc1 lds
  v_cvt_pk_bf16_f32 v103, v118, v119
  v_mfma_f32_16x16x32_bf16 v[148:151], a[172:175], a[244:247], v[148:151]
  ds_read_b128 a[136:139], v2 offset:2048
  v_cvt_pk_bf16_f32 v104, v104, v105
  v_mfma_f32_16x16x32_bf16 v[152:155], a[168:171], a[232:235], v[152:155]
  ds_read_b64_tr_b16 a[188:189], v9 offset:61440
  v_cvt_pk_bf16_f32 v105, v106, v107
  v_mfma_f32_16x16x32_bf16 v[152:155], a[172:175], a[248:251], v[152:155]
  ds_read_b64_tr_b16 a[190:191], v9 offset:61952
  v_cvt_pk_bf16_f32 v106, v120, v121
  v_mfma_f32_16x16x32_bf16 v[156:159], a[168:171], a[236:239], v[156:159]
  buffer_load_dwordx4 v1, s[12:15], s77 offen offset:3072 sc1 lds
  v_cvt_pk_bf16_f32 v107, v122, v123
  v_mfma_f32_16x16x32_bf16 v[156:159], a[172:175], a[252:255], v[156:159]
  ds_read_b128 a[140:143], v2 offset:3072
  s_waitcnt lgkmcnt(7)
  v_mfma_f32_16x16x32_bf16 v[160:163], a[176:179], a[224:227], v[160:163]
  v_cvt_pk_bf16_f32 v108, v108, v109
  v_cvt_pk_bf16_f32 v109, v110, v111
  v_mfma_f32_16x16x32_bf16 v[160:163], a[180:183], a[240:243], v[160:163]
  v_cvt_pk_bf16_f32 v110, v124, v125
  v_cvt_pk_bf16_f32 v111, v126, v127
  v_mfma_f32_16x16x32_bf16 v[164:167], a[176:179], a[228:231], v[164:167]
  s_add_u32 s77, s84, 65536
  s_mov_b32 m0, s77
  s_nop 0
  buffer_load_dwordx4 v1, s[12:15], s77 offen offset:0 sc1 lds
  v_mfma_f32_16x16x32_bf16 v[164:167], a[180:183], a[244:247], v[164:167]
  ds_read_b128 a[144:147], v2 offset:4096
  v_cvt_pk_bf16_f32 v128, v128, v129
  v_mfma_f32_16x16x32_bf16 v[168:171], a[176:179], a[232:235], v[168:171]
  v_cvt_pk_bf16_f32 v129, v130, v131
  v_cvt_pk_bf16_f32 v130, v144, v145
  v_mfma_f32_16x16x32_bf16 v[168:171], a[180:183], a[248:251], v[168:171]
  v_cvt_pk_bf16_f32 v131, v146, v147
  v_cvt_pk_bf16_f32 v132, v132, v133
  v_mfma_f32_16x16x32_bf16 v[172:175], a[176:179], a[236:239], v[172:175]
  buffer_load_dwordx4 v1, s[12:15], s77 offen offset:1024 sc1 lds
  v_cvt_pk_bf16_f32 v133, v134, v135
  v_mfma_f32_16x16x32_bf16 v[172:175], a[180:183], a[252:255], v[172:175]
  ds_read_b128 a[148:151], v2 offset:5120
  s_waitcnt lgkmcnt(3)
  v_mfma_f32_16x16x32_bf16 v[176:179], a[184:187], a[224:227], v[176:179]
  v_cvt_pk_bf16_f32 v134, v148, v149
  v_cvt_pk_bf16_f32 v135, v150, v151
  v_mfma_f32_16x16x32_bf16 v[176:179], a[188:191], a[240:243], v[176:179]
  v_cvt_pk_bf16_f32 v136, v136, v137
  v_cvt_pk_bf16_f32 v137, v138, v139
  v_mfma_f32_16x16x32_bf16 v[180:183], a[184:187], a[228:231], v[180:183]
  buffer_load_dwordx4 v1, s[12:15], s77 offen offset:2048 sc1 lds
  v_cvt_pk_bf16_f32 v138, v152, v153
  v_mfma_f32_16x16x32_bf16 v[180:183], a[188:191], a[244:247], v[180:183]
  ds_read_b128 a[152:155], v2 offset:6144
  v_cvt_pk_bf16_f32 v139, v154, v155
  v_mfma_f32_16x16x32_bf16 v[184:187], a[184:187], a[232:235], v[184:187]
  v_cvt_pk_bf16_f32 v140, v140, v141
  v_cvt_pk_bf16_f32 v141, v142, v143
  v_mfma_f32_16x16x32_bf16 v[184:187], a[188:191], a[248:251], v[184:187]
  v_cvt_pk_bf16_f32 v142, v156, v157
  v_cvt_pk_bf16_f32 v143, v158, v159
  v_mfma_f32_16x16x32_bf16 v[188:191], a[184:187], a[236:239], v[188:191]
  buffer_load_dwordx4 v1, s[12:15], s77 offen offset:3072 sc1 lds
  v_mfma_f32_16x16x32_bf16 v[188:191], a[188:191], a[252:255], v[188:191]
  ds_read_b128 a[156:159], v2 offset:7168
Latt_f:
  ds_read_b128 a[160:163], v2 offset:8192
  ds_read_b128 a[164:167], v2 offset:9216
  ds_read_b128 a[168:171], v2 offset:10240
  ds_read_b128 a[172:175], v2 offset:11264
  ds_read_b128 a[176:179], v2 offset:12288
  ds_read_b128 a[180:183], v2 offset:13312
  ds_read_b128 a[184:187], v2 offset:14336
  ds_read_b128 a[188:191], v2 offset:15360
  v_mov_b32 v16, 0
  v_mov_b32 v17, 0
  v_cvt_pk_bf16_f32 v160, v160, v161
  v_cvt_pk_bf16_f32 v161, v162, v163
  v_cvt_pk_bf16_f32 v162, v176, v177
  v_cvt_pk_bf16_f32 v163, v178, v179
  v_cvt_pk_bf16_f32 v164, v164, v165
  v_cvt_pk_bf16_f32 v165, v166, v167
  v_cvt_pk_bf16_f32 v166, v180, v181
  v_cvt_pk_bf16_f32 v167, v182, v183
  v_cvt_pk_bf16_f32 v168, v168, v169
  v_cvt_pk_bf16_f32 v169, v170, v171
  v_cvt_pk_bf16_f32 v170, v184, v185
  v_cvt_pk_bf16_f32 v171, v186, v187
  v_cvt_pk_bf16_f32 v172, v172, v173
  v_cvt_pk_bf16_f32 v173, v174, v175
  v_cvt_pk_bf16_f32 v174, v188, v189
  v_cvt_pk_bf16_f32 v175, v190, v191
  s_cmp_lg_u32 s88, 0
  s_cbranch_scc1 Lp0_f
  v_cndmask_b32 v208, v255, v208, s[24:25]
  v_cndmask_b32 v220, v255, v220, s[24:25]
  v_mov_b32 v212, v255
  v_cndmask_b32 v209, v255, v209, s[26:27]
  v_cndmask_b32 v221, v255, v221, s[26:27]
  v_mov_b32 v213, v255
  v_cndmask_b32 v210, v255, v210, s[32:33]
  v_cndmask_b32 v222, v255, v222, s[32:33]
  v_mov_b32 v214, v255
  v_cndmask_b32 v211, v255, v211, s[34:35]
  v_cndmask_b32 v223, v255, v223, s[34:35]
  v_mov_b32 v215, v255
Lp0_f:
  s_nop 1
  s_waitcnt lgkmcnt(8)
  v_mfma_f32_16x16x32_bf16 v[80:83], a[128:131], v[64:67], v[192:195]
  v_mfma_f32_16x16x32_bf16 v[80:83], a[132:135], v[96:99], v[80:83]
  s_add_u32 s77, s84, 49152
  s_mov_b32 m0, s77
  s_nop 0
  buffer_load_dwordx4 v1, s[12:15], s77 offen offset:0 sc1 lds
  v_mfma_f32_16x16x32_bf16 v[80:83], a[136:139], v[128:131], v[80:83]
  v_mfma_f32_16x16x32_bf16 v[80:83], a[140:143], v[160:163], v[80:83]
  v_mfma_f32_16x16x32_bf16 v[84:87], a[128:131], v[68:71], v[200:203]
  v_mfma_f32_16x16x32_bf16 v[84:87], a[132:135], v[100:103], v[84:87]
  buffer_load_dwordx4 v1, s[12:15], s77 offen offset:1024 sc1 lds
  v_mfma_f32_16x16x32_bf16 v[84:87], a[136:139], v[132:135], v[84:87]
  v_mfma_f32_16x16x32_bf16 v[84:87], a[140:143], v[164:167], v[84:87]
  v_mfma_f32_16x16x32_bf16 v[112:115], a[144:147], v[64:67], v[196:199]
  v_mfma_f32_16x16x32_bf16 v[112:115], a[148:151], v[96:99], v[112:115]
  buffer_load_dwordx4 v1, s[12:15], s77 offen offset:2048 sc1 lds
  v_mfma_f32_16x16x32_bf16 v[112:115], a[152:155], v[128:131], v[112:115]
  v_mfma_f32_16x16x32_bf16 v[112:115], a[156:159], v[160:163], v[112:115]
  v_mfma_f32_16x16x32_bf16 v[116:119], a[144:147], v[68:71], v[204:207]
  v_mfma_f32_16x16x32_bf16 v[116:119], a[148:151], v[100:103], v[116:119]
  buffer_load_dwordx4 v1, s[12:15], s77 offen offset:3072 sc1 lds
  v_mfma_f32_16x16x32_bf16 v[116:119], a[152:155], v[132:135], v[116:119]
  v_mfma_f32_16x16x32_bf16 v[116:119], a[156:159], v[164:167], v[116:119]
  v_mfma_f32_16x16x32_bf16 v[88:91], a[128:131], v[72:75], v[208:211]
  v_mfma_f32_16x16x32_bf16 v[88:91], a[132:135], v[104:107], v[88:91]
  s_add_u32 s77, s84, 98304
  s_mov_b32 m0, s77
  s_nop 0
  buffer_load_dwordx4 v1, s[12:15], s77 offen offset:0 sc1 lds
  v_mfma_f32_16x16x32_bf16 v[88:91], a[136:139], v[136:139], v[88:91]
  v_max3_f32 v224, v80, v81, v82
  v_max3_f32 v225, v84, v85, v86
  v_max3_f32 v224, v224, v83, v112
  v_mfma_f32_16x16x32_bf16 v[88:91], a[140:143], v[168:171], v[88:91]
  v_max3_f32 v225, v225, v87, v116
  v_max3_f32 v224, v224, v113, v114
  v_max3_f32 v225, v225, v117, v118
  v_mfma_f32_16x16x32_bf16 v[92:95], a[128:131], v[76:79], v[216:219]
  v_max_f32 v224, v224, v115
  v_max_f32 v225, v225, v119
  v_mfma_f32_16x16x32_bf16 v[92:95], a[132:135], v[108:111], v[92:95]
  buffer_load_dwordx4 v1, s[12:15], s77 offen offset:1024 sc1 lds
  v_mov_b32 v228, v224
  v_mov_b32 v229, v225
  s_nop 0
  v_permlane16_swap_b32 v224, v228
  v_mfma_f32_16x16x32_bf16 v[92:95], a[136:139], v[140:143], v[92:95]
  v_permlane16_swap_b32 v225, v229
  v_max_f32 v224, v224, v228
  v_mfma_f32_16x16x32_bf16 v[92:95], a[140:143], v[172:175], v[92:95]
  v_max_f32 v225, v225, v229
  v_mov_b32 v228, v224
  v_mov_b32 v229, v225
  v_mfma_f32_16x16x32_bf16 v[120:123], a[144:147], v[72:75], v[212:215]
  v_permlane32_swap_b32 v224, v228
  v_permlane32_swap_b32 v225, v229
  v_mfma_f32_16x16x32_bf16 v[120:123], a[148:151], v[104:107], v[120:123]
  buffer_load_dwordx4 v1, s[12:15], s77 offen offset:2048 sc1 lds
  v_max_f32 v224, v224, v228
  v_max_f32 v225, v225, v229
  v_sub_f32 v192, v192, v224
  v_mfma_f32_16x16x32_bf16 v[120:123], a[152:155], v[136:139], v[120:123]
  v_sub_f32 v193, v193, v224
  v_sub_f32 v194, v194, v224
  v_sub_f32 v195, v195, v224
  v_mfma_f32_16x16x32_bf16 v[120:123], a[156:159], v[168:171], v[120:123]
  v_sub_f32 v200, v200, v225
  v_sub_f32 v201, v201, v225
  v_mfma_f32_16x16x32_bf16 v[124:127], a[144:147], v[76:79], v[220:223]
  v_sub_f32 v202, v202, v225
  v_sub_f32 v203, v203, v225
  v_sub_f32 v196, v196, v224
  v_mfma_f32_16x16x32_bf16 v[124:127], a[148:151], v[108:111], v[124:127]
  buffer_load_dwordx4 v1, s[12:15], s77 offen offset:3072 sc1 lds
  v_sub_f32 v197, v197, v224
  v_sub_f32 v198, v198, v224
  v_mfma_f32_16x16x32_bf16 v[124:127], a[152:155], v[140:143], v[124:127]
  v_sub_f32 v199, v199, v224
  v_sub_f32 v204, v204, v225
  v_sub_f32 v205, v205, v225
  v_mfma_f32_16x16x32_bf16 v[124:127], a[156:159], v[172:175], v[124:127]
  v_sub_f32 v206, v206, v225
  v_sub_f32 v207, v207, v225
  s_waitcnt lgkmcnt(0)
  v_mfma_f32_16x16x32_bf16 v[144:147], a[160:163], v[64:67], v[192:195]
  v_mfma_f32_16x16x32_bf16 v[144:147], a[164:167], v[96:99], v[144:147]
  s_add_u32 s77, s84, 81920
  s_mov_b32 m0, s77
  s_nop 0
  buffer_load_dwordx4 v1, s[12:15], s77 offen offset:0 sc1 lds
  v_mfma_f32_16x16x32_bf16 v[144:147], a[168:171], v[128:131], v[144:147]
  v_max3_f32 v226, v88, v89, v90
  v_max3_f32 v227, v92, v93, v94
  v_max3_f32 v226, v226, v91, v120
  v_mfma_f32_16x16x32_bf16 v[144:147], a[172:175], v[160:163], v[144:147]
  v_max3_f32 v227, v227, v95, v124
  v_max3_f32 v226, v226, v121, v122
  v_max3_f32 v227, v227, v125, v126
  v_mfma_f32_16x16x32_bf16 v[148:151], a[160:163], v[68:71], v[200:203]
  v_max_f32 v226, v226, v123
  v_max_f32 v227, v227, v127
  v_mfma_f32_16x16x32_bf16 v[148:151], a[164:167], v[100:103], v[148:151]
  buffer_load_dwordx4 v1, s[12:15], s77 offen offset:1024 sc1 lds
  v_mov_b32 v230, v226
  v_mov_b32 v231, v227
  s_nop 0
  v_permlane16_swap_b32 v226, v230
  v_mfma_f32_16x16x32_bf16 v[148:151], a[168:171], v[132:135], v[148:151]
  v_permlane16_swap_b32 v227, v231
  v_max_f32 v226, v226, v230
  v_mfma_f32_16x16x32_bf16 v[148:151], a[172:175], v[164:167], v[148:151]
  v_max_f32 v227, v227, v231
  v_mov_b32 v230, v226
  v_mov_b32 v231, v227
  v_mfma_f32_16x16x32_bf16 v[176:179], a[176:179], v[64:67], v[196:199]
  v_permlane32_swap_b32 v226, v230
  v_permlane32_swap_b32 v227, v231
  v_mfma_f32_16x16x32_bf16 v[176:179], a[180:183], v[96:99], v[176:179]
  buffer_load_dwordx4 v1, s[12:15], s77 offen offset:2048 sc1 lds
  v_max_f32 v226, v226, v230
  v_max_f32 v227, v227, v231
  v_sub_f32 v208, v208, v226
  v_mfma_f32_16x16x32_bf16 v[176:179], a[184:187], v[128:131], v[176:179]
  v_sub_f32 v209, v209, v226
  v_sub_f32 v210, v210, v226
  v_sub_f32 v211, v211, v226
  v_mfma_f32_16x16x32_bf16 v[176:179], a[188:191], v[160:163], v[176:179]
  v_sub_f32 v216, v216, v227
  v_sub_f32 v217, v217, v227
  v_mfma_f32_16x16x32_bf16 v[180:183], a[176:179], v[68:71], v[204:207]
  v_sub_f32 v218, v218, v227
  v_sub_f32 v219, v219, v227
  v_sub_f32 v212, v212, v226
  v_mfma_f32_16x16x32_bf16 v[180:183], a[180:183], v[100:103], v[180:183]
  buffer_load_dwordx4 v1, s[12:15], s77 offen offset:3072 sc1 lds
  v_sub_f32 v213, v213, v226
  v_sub_f32 v214, v214, v226
  v_mfma_f32_16x16x32_bf16 v[180:183], a[184:187], v[132:135], v[180:183]
  v_sub_f32 v215, v215, v226
  v_sub_f32 v220, v220, v227
  v_sub_f32 v221, v221, v227
  v_mfma_f32_16x16x32_bf16 v[180:183], a[188:191], v[164:167], v[180:183]
  v_sub_f32 v222, v222, v227
  v_sub_f32 v223, v223, v227
  s_cmp_lg_u32 s88, 1
  s_cbranch_scc1 Lp1_f
  v_cndmask_b32 v208, v255, v208, s[24:25]
  v_cndmask_b32 v220, v255, v220, s[24:25]
  v_mov_b32 v212, v255
  v_cndmask_b32 v209, v255, v209, s[26:27]
  v_cndmask_b32 v221, v255, v221, s[26:27]
  v_mov_b32 v213, v255
  v_cndmask_b32 v210, v255, v210, s[32:33]
  v_cndmask_b32 v222, v255, v222, s[32:33]
  v_mov_b32 v214, v255
  v_cndmask_b32 v211, v255, v211, s[34:35]
  v_cndmask_b32 v223, v255, v223, s[34:35]
  v_mov_b32 v215, v255
Lp1_f:
  s_nop 1
  v_mfma_f32_16x16x32_bf16 v[152:155], a[160:163], v[72:75], v[208:211]
  v_sub_f32 v80, v80, v224
  v_sub_f32 v81, v81, v224
  v_sub_f32 v82, v82, v224
  v_mfma_f32_16x16x32_bf16 v[152:155], a[164:167], v[104:107], v[152:155]
  s_waitcnt vmcnt(16)
  s_barrier
  v_add_u32 v2, 32768, v1
  v_sub_f32 v83, v83, v224
  v_sub_f32 v112, v112, v224
  v_mfma_f32_16x16x32_bf16 v[152:155], a[168:171], v[136:139], v[152:155]
  ds_read_b128 a[128:131], v2 offset:0
  v_sub_f32 v113, v113, v224
  v_sub_f32 v114, v114, v224
  v_mfma_f32_16x16x32_bf16 v[152:155], a[172:175], v[168:171], v[152:155]
  ds_read_b128 a[132:135], v2 offset:1024
  v_sub_f32 v115, v115, v224
  v_sub_f32 v84, v84, v225
  v_mfma_f32_16x16x32_bf16 v[156:159], a[160:163], v[76:79], v[216:219]
  ds_read_b128 a[136:139], v2 offset:2048
  v_sub_f32 v85, v85, v225
  v_sub_f32 v86, v86, v225
  v_sub_f32 v87, v87, v225
  v_mfma_f32_16x16x32_bf16 v[156:159], a[164:167], v[108:111], v[156:159]
  ds_read_b128 a[140:143], v2 offset:3072
  v_sub_f32 v116, v116, v225
  v_sub_f32 v117, v117, v225
  v_mfma_f32_16x16x32_bf16 v[156:159], a[168:171], v[140:143], v[156:159]
  ds_read_b128 a[144:147], v2 offset:4096
  v_sub_f32 v118, v118, v225
  v_sub_f32 v119, v119, v225
  v_mfma_f32_16x16x32_bf16 v[156:159], a[172:175], v[172:175], v[156:159]
  ds_read_b128 a[148:151], v2 offset:5120
  v_sub_f32 v88, v88, v226
  v_sub_f32 v89, v89, v226
  v_mfma_f32_16x16x32_bf16 v[184:187], a[176:179], v[72:75], v[212:215]
  ds_read_b128 a[152:155], v2 offset:6144
  v_sub_f32 v90, v90, v226
  v_sub_f32 v91, v91, v226
  v_sub_f32 v120, v120, v226
  v_mfma_f32_16x16x32_bf16 v[184:187], a[180:183], v[104:107], v[184:187]
  ds_read_b128 a[156:159], v2 offset:7168
  v_sub_f32 v121, v121, v226
  v_sub_f32 v122, v122, v226
  v_mfma_f32_16x16x32_bf16 v[184:187], a[184:187], v[136:139], v[184:187]
  v_sub_f32 v123, v123, v226
  v_sub_f32 v92, v92, v227
  v_mfma_f32_16x16x32_bf16 v[184:187], a[188:191], v[168:171], v[184:187]
  v_sub_f32 v93, v93, v227
  v_sub_f32 v94, v94, v227
  v_mfma_f32_16x16x32_bf16 v[188:191], a[176:179], v[76:79], v[220:223]
  v_sub_f32 v95, v95, v227
  v_sub_f32 v124, v124, v227
  v_sub_f32 v125, v125, v227
  v_mfma_f32_16x16x32_bf16 v[188:191], a[180:183], v[108:111], v[188:191]
  v_sub_f32 v126, v126, v227
  v_sub_f32 v127, v127, v227
  v_mfma_f32_16x16x32_bf16 v[188:191], a[184:187], v[140:143], v[188:191]
  v_exp_f32 v80, v80
  v_exp_f32 v81, v81
  v_mfma_f32_16x16x32_bf16 v[188:191], a[188:191], v[172:175], v[188:191]
  v_exp_f32 v82, v82
  v_exp_f32 v83, v83
  v_cvt_pk_bf16_f32 v32, v80, v81
  v_exp_f32 v112, v112
  v_exp_f32 v113, v113
  v_cvt_pk_bf16_f32 v33, v82, v83
  v_exp_f32 v114, v114
  v_exp_f32 v115, v115
  v_cvt_pk_bf16_f32 v34, v112, v113
  v_exp_f32 v84, v84
  v_exp_f32 v85, v85
  v_cvt_pk_bf16_f32 v35, v114, v115
  v_exp_f32 v86, v86
  v_exp_f32 v87, v87
  v_cvt_pk_bf16_f32 v36, v84, v85
  v_exp_f32 v116, v116
  v_exp_f32 v117, v117
  v_cvt_pk_bf16_f32 v37, v86, v87
  v_exp_f32 v118, v118
  v_exp_f32 v119, v119
  v_cvt_pk_bf16_f32 v38, v116, v117
  v_exp_f32 v88, v88
  v_exp_f32 v89, v89
  v_cvt_pk_bf16_f32 v39, v118, v119
  v_exp_f32 v90, v90
  v_exp_f32 v91, v91
  v_cvt_pk_bf16_f32 v40, v88, v89
  v_exp_f32 v120, v120
  v_exp_f32 v121, v121
  v_cvt_pk_bf16_f32 v41, v90, v91
  v_exp_f32 v122, v122
  v_exp_f32 v123, v123
  v_cvt_pk_bf16_f32 v42, v120, v121
  v_exp_f32 v92, v92
  v_exp_f32 v93, v93
  v_cvt_pk_bf16_f32 v43, v122, v123
  v_exp_f32 v94, v94
  v_exp_f32 v95, v95
  v_cvt_pk_bf16_f32 v44, v92, v93
  v_exp_f32 v124, v124
  v_exp_f32 v125, v125
  v_cvt_pk_bf16_f32 v45, v94, v95
  v_exp_f32 v126, v126
  v_exp_f32 v127, v127
  v_cvt_pk_bf16_f32 v46, v124, v125
  v_cvt_pk_bf16_f32 v47, v126, v127
  s_waitcnt lgkmcnt(4)
  s_and_b32 s87, s3, 1
  s_sub_u32 s86, s88, 1
  s_ashr_i32 s86, s86, 1
  s_sub_u32 s86, s86, s87
  s_max_i32 s86, s86, 0
  s_mov_b32 s1, 0
  s_cmp_lt_u32 s2, 128
  s_cbranch_scc1 Ldd_f_go
  s_mov_b32 s1, 2
  s_sub_u32 s0, s86, 7
  s_mov_b32 s86, 2
  v_mfma_f32_16x16x32_bf16 v[80:83], a[128:131], v[64:67], v[192:195]
  ds_read_b128 a[160:163], v3 offset:16384
  s_and_b32 m0, s78, 0x1ffff
  v_mfma_f32_16x16x32_bf16 v[80:83], a[132:135], v[96:99], v[80:83]
  v_exp_f32 v144, v144
  v_mfma_f32_16x16x32_bf16 v[80:83], a[136:139], v[128:131], v[80:83]
  ds_read_b128 a[164:167], v3 offset:17408
  ds_read_b64_tr_b16 a[192:193], v244 offset:0
  v_mfma_f32_16x16x32_bf16 v[80:83], a[140:143], v[160:163], v[80:83]
  v_exp_f32 v145, v145
  v_mfma_f32_16x16x32_bf16 v[84:87], a[128:131], v[68:71], v[200:203]
  buffer_load_dwordx4 v1, s[12:15], s78 offen offset:0 sc1 lds
  v_cvt_pk_bf16_f32 v48, v144, v145
  v_mfma_f32_16x16x32_bf16 v[84:87], a[132:135], v[100:103], v[84:87]
  v_exp_f32 v146, v146
  v_mfma_f32_16x16x32_bf16 v[84:87], a[136:139], v[132:135], v[84:87]
  ds_read_b128 a[168:171], v3 offset:18432
  ds_read_b64_tr_b16 a[194:195], v244 offset:2048
  v_mfma_f32_16x16x32_bf16 v[84:87], a[140:143], v[164:167], v[84:87]
  v_exp_f32 v147, v147
  v_mfma_f32_16x16x32_bf16 v[88:91], a[128:131], v[72:75], v[208:211]
  ds_read_b128 a[172:175], v3 offset:19456
  v_cvt_pk_bf16_f32 v49, v146, v147
  v_mfma_f32_16x16x32_bf16 v[88:91], a[132:135], v[104:107], v[88:91]
  v_exp_f32 v176, v176
  v_mfma_f32_16x16x32_bf16 v[88:91], a[136:139], v[136:139], v[88:91]
  ds_read_b128 a[176:179], v3 offset:20480
  ds_read_b64_tr_b16 a[196:197], v245 offset:0
  v_mfma_f32_16x16x32_bf16 v[88:91], a[140:143], v[168:171], v[88:91]
  v_exp_f32 v177, v177
  v_mfma_f32_16x16x32_bf16 v[92:95], a[128:131], v[76:79], v[216:219]
  ds_read_b128 a[180:183], v3 offset:21504
  v_cvt_pk_bf16_f32 v50, v176, v177
  v_mfma_f32_16x16x32_bf16 v[92:95], a[132:135], v[108:111], v[92:95]
  v_exp_f32 v178, v178
  v_mfma_f32_16x16x32_bf16 v[92:95], a[136:139], v[140:143], v[92:95]
  ds_read_b64_tr_b16 a[198:199], v245 offset:2048
  s_waitcnt lgkmcnt(10)
  v_mfma_f32_16x16x32_bf16 v[92:95], a[140:143], v[172:175], v[92:95]
  v_exp_f32 v179, v179
  v_mfma_f32_16x16x32_bf16 v[112:115], a[144:147], v[64:67], v[196:199]
  ds_read_b128 a[184:187], v3 offset:22528
  v_cvt_pk_bf16_f32 v51, v178, v179
  v_mfma_f32_16x16x32_bf16 v[112:115], a[148:151], v[96:99], v[112:115]
  v_exp_f32 v148, v148
  v_mfma_f32_16x16x32_bf16 v[112:115], a[152:155], v[128:131], v[112:115]
  ds_read_b128 a[188:191], v3 offset:23552
  ds_read_b64_tr_b16 a[200:201], v246 offset:0
  v_mfma_f32_16x16x32_bf16 v[112:115], a[156:159], v[160:163], v[112:115]
  v_exp_f32 v149, v149
  v_mfma_f32_16x16x32_bf16 v[116:119], a[144:147], v[68:71], v[204:207]
  ds_read_b64_tr_b16 a[202:203], v246 offset:2048
  v_cvt_pk_bf16_f32 v52, v148, v149
  v_mfma_f32_16x16x32_bf16 v[116:119], a[148:151], v[100:103], v[116:119]
  v_exp_f32 v150, v150
  v_mfma_f32_16x16x32_bf16 v[116:119], a[152:155], v[132:135], v[116:119]
  buffer_load_dwordx4 v1, s[12:15], s78 offen offset:1024 sc1 lds
  v_mfma_f32_16x16x32_bf16 v[116:119], a[156:159], v[164:167], v[116:119]
  v_mfma_f32_16x16x32_bf16 v[120:123], a[144:147], v[72:75], v[212:215]
  v_exp_f32 v151, v151
  v_mfma_f32_16x16x32_bf16 v[120:123], a[148:151], v[104:107], v[120:123]
  ds_read_b64_tr_b16 a[204:205], v247 offset:0
  v_cvt_pk_bf16_f32 v53, v150, v151
  v_mfma_f32_16x16x32_bf16 v[120:123], a[152:155], v[136:139], v[120:123]
  v_exp_f32 v180, v180
  v_mfma_f32_16x16x32_bf16 v[120:123], a[156:159], v[168:171], v[120:123]
  v_mfma_f32_16x16x32_bf16 v[124:127], a[144:147], v[76:79], v[220:223]
  v_exp_f32 v181, v181
  v_mfma_f32_16x16x32_bf16 v[124:127], a[148:151], v[108:111], v[124:127]
  v_cvt_pk_bf16_f32 v54, v180, v181
  s_waitcnt lgkmcnt(9)
  v_mfma_f32_16x16x32_bf16 v[124:127], a[152:155], v[140:143], v[124:127]
  v_exp_f32 v182, v182
  v_mfma_f32_16x16x32_bf16 v[124:127], a[156:159], v[172:175], v[124:127]
  ds_read_b64_tr_b16 a[206:207], v247 offset:2048
  v_mfma_f32_16x16x32_bf16 a[0:3], a[160:163], v[32:35], a[0:3]
  v_exp_f32 v183, v183
  v_mfma_f32_16x16x32_bf16 a[4:7], a[160:163], v[36:39], a[4:7]
  ds_read_b128 a[128:131], v2 offset:8192
  v_cvt_pk_bf16_f32 v55, v182, v183
  v_mfma_f32_16x16x32_bf16 a[8:11], a[160:163], v[40:43], a[8:11]
  v_exp_f32 v152, v152
  v_mfma_f32_16x16x32_bf16 a[12:15], a[160:163], v[44:47], a[12:15]
  ds_read_b128 a[132:135], v2 offset:9216
  ds_read_b64_tr_b16 a[208:209], v244 offset:4096
  v_mfma_f32_16x16x32_bf16 a[16:19], a[164:167], v[32:35], a[16:19]
  v_exp_f32 v153, v153
  v_mfma_f32_16x16x32_bf16 a[20:23], a[164:167], v[36:39], a[20:23]
  ds_read_b128 a[136:139], v2 offset:10240
  v_cvt_pk_bf16_f32 v56, v152, v153
  v_mfma_f32_16x16x32_bf16 a[24:27], a[164:167], v[40:43], a[24:27]
  v_exp_f32 v154, v154
  v_mfma_f32_16x16x32_bf16 a[28:31], a[164:167], v[44:47], a[28:31]
  ds_read_b64_tr_b16 a[210:211], v244 offset:6144
  ds_read_b64_tr_b16 a[212:213], v245 offset:4096
  v_mfma_f32_16x16x32_bf16 a[32:35], a[168:171], v[32:35], a[32:35]
  v_exp_f32 v155, v155
  v_mfma_f32_16x16x32_bf16 a[36:39], a[168:171], v[36:39], a[36:39]
  ds_read_b128 a[140:143], v2 offset:11264
  v_cvt_pk_bf16_f32 v57, v154, v155
  v_mfma_f32_16x16x32_bf16 a[40:43], a[168:171], v[40:43], a[40:43]
  v_exp_f32 v184, v184
  v_mfma_f32_16x16x32_bf16 a[44:47], a[168:171], v[44:47], a[44:47]
  ds_read_b128 a[144:147], v2 offset:12288
  ds_read_b64_tr_b16 a[214:215], v245 offset:6144
  v_mfma_f32_16x16x32_bf16 a[48:51], a[172:175], v[32:35], a[48:51]
  v_exp_f32 v185, v185
  v_mfma_f32_16x16x32_bf16 a[52:55], a[172:175], v[36:39], a[52:55]
  v_cvt_pk_bf16_f32 v58, v184, v185
  s_waitcnt lgkmcnt(13)
  v_mfma_f32_16x16x32_bf16 a[56:59], a[172:175], v[40:43], a[56:59]
  ds_read_b128 a[148:151], v2 offset:13312
  buffer_load_dwordx4 v1, s[12:15], s78 offen offset:2048 sc1 lds
  v_mfma_f32_16x16x32_bf16 a[60:63], a[172:175], v[44:47], a[60:63]
  v_exp_f32 v186, v186
  v_mfma_f32_16x16x32_bf16 a[64:67], a[176:179], v[32:35], a[64:67]
  ds_read_b128 a[152:155], v2 offset:14336
  ds_read_b64_tr_b16 a[216:217], v246 offset:4096
  v_mfma_f32_16x16x32_bf16 a[68:71], a[176:179], v[36:39], a[68:71]
  v_exp_f32 v187, v187
  v_mfma_f32_16x16x32_bf16 a[72:75], a[176:179], v[40:43], a[72:75]
  ds_read_b64_tr_b16 a[218:219], v246 offset:6144
  v_cvt_pk_bf16_f32 v59, v186, v187
  v_mfma_f32_16x16x32_bf16 a[76:79], a[176:179], v[44:47], a[76:79]
  v_exp_f32 v156, v156
  v_mfma_f32_16x16x32_bf16 a[80:83], a[180:183], v[32:35], a[80:83]
  ds_read_b128 a[156:159], v2 offset:15360
  buffer_load_dwordx4 v1, s[12:15], s78 offen offset:3072 sc1 lds
  v_mfma_f32_16x16x32_bf16 a[84:87], a[180:183], v[36:39], a[84:87]
  v_exp_f32 v157, v157
  v_mfma_f32_16x16x32_bf16 a[88:91], a[180:183], v[40:43], a[88:91]
  ds_read_b64_tr_b16 a[220:221], v247 offset:4096
  v_cvt_pk_bf16_f32 v60, v156, v157
  v_mfma_f32_16x16x32_bf16 a[92:95], a[180:183], v[44:47], a[92:95]
  v_exp_f32 v158, v158
  v_mfma_f32_16x16x32_bf16 a[96:99], a[184:187], v[32:35], a[96:99]
  s_sub_u32 s78, s78, 16384
  v_mfma_f32_16x16x32_bf16 a[100:103], a[184:187], v[36:39], a[100:103]
  v_exp_f32 v159, v159
  v_mfma_f32_16x16x32_bf16 a[104:107], a[184:187], v[40:43], a[104:107]
  ds_read_b64_tr_b16 a[222:223], v247 offset:6144
  v_cvt_pk_bf16_f32 v61, v158, v159
  v_mfma_f32_16x16x32_bf16 a[108:111], a[184:187], v[44:47], a[108:111]
  v_exp_f32 v188, v188
  v_mfma_f32_16x16x32_bf16 a[112:115], a[188:191], v[32:35], a[112:115]
  v_mfma_f32_16x16x32_bf16 a[116:119], a[188:191], v[36:39], a[116:119]
  v_exp_f32 v189, v189
  v_mfma_f32_16x16x32_bf16 a[120:123], a[188:191], v[40:43], a[120:123]
  v_cvt_pk_bf16_f32 v62, v188, v189
  v_mfma_f32_16x16x32_bf16 a[124:127], a[188:191], v[44:47], a[124:127]
  v_exp_f32 v190, v190
  v_mfma_f32_16x16x32_bf16 v[16:19], v[12:15], v[32:35], v[16:19]
  v_mfma_f32_16x16x32_bf16 v[20:23], v[12:15], v[36:39], v[20:23]
  v_exp_f32 v191, v191
  v_mfma_f32_16x16x32_bf16 v[24:27], v[12:15], v[40:43], v[24:27]
  v_cvt_pk_bf16_f32 v63, v190, v191
  v_mfma_f32_16x16x32_bf16 v[28:31], v[12:15], v[44:47], v[28:31]
  s_waitcnt lgkmcnt(9)
  v_mfma_f32_16x16x32_bf16 v[144:147], a[128:131], v[64:67], v[192:195]
  ds_read_b128 a[160:163], v3 offset:24576
  s_and_b32 m0, s78, 0x1ffff
  v_mfma_f32_16x16x32_bf16 v[144:147], a[132:135], v[96:99], v[144:147]
  s_waitcnt lgkmcnt(1)
  buffer_store_dwordx4 a[192:195], v1, s[8:11], s7 offen offset:0 sc1
  v_exp_f32 v80, v80
  v_mfma_f32_16x16x32_bf16 v[144:147], a[136:139], v[128:131], v[144:147]
  ds_read_b128 a[164:167], v3 offset:25600
  buffer_load_dwordx4 v1, s[12:15], s78 offen offset:0 sc1 lds
  v_mfma_f32_16x16x32_bf16 v[144:147], a[140:143], v[160:163], v[144:147]
  v_exp_f32 v81, v81
  v_mfma_f32_16x16x32_bf16 v[148:151], a[128:131], v[68:71], v[200:203]
  v_cvt_pk_bf16_f32 v32, v80, v81
  v_mfma_f32_16x16x32_bf16 v[148:151], a[132:135], v[100:103], v[148:151]
  v_exp_f32 v82, v82
  v_mfma_f32_16x16x32_bf16 v[148:151], a[136:139], v[132:135], v[148:151]
  ds_read_b128 a[168:171], v3 offset:26624
  v_mfma_f32_16x16x32_bf16 v[148:151], a[140:143], v[164:167], v[148:151]
  v_exp_f32 v83, v83
  v_mfma_f32_16x16x32_bf16 v[152:155], a[128:131], v[72:75], v[208:211]
  ds_read_b128 a[172:175], v3 offset:27648
  v_cvt_pk_bf16_f32 v33, v82, v83
  v_mfma_f32_16x16x32_bf16 v[152:155], a[132:135], v[104:107], v[152:155]
  v_exp_f32 v112, v112
  v_mfma_f32_16x16x32_bf16 v[152:155], a[136:139], v[136:139], v[152:155]
  ds_read_b128 a[176:179], v3 offset:28672
  buffer_store_dwordx4 a[196:199], v1, s[8:11], s7 offen offset:1024 sc1
  v_mfma_f32_16x16x32_bf16 v[152:155], a[140:143], v[168:171], v[152:155]
  v_exp_f32 v113, v113
  v_mfma_f32_16x16x32_bf16 v[156:159], a[128:131], v[76:79], v[216:219]
  ds_read_b128 a[180:183], v3 offset:29696
  v_cvt_pk_bf16_f32 v34, v112, v113
  v_mfma_f32_16x16x32_bf16 v[156:159], a[132:135], v[108:111], v[156:159]
  v_exp_f32 v114, v114
  v_mfma_f32_16x16x32_bf16 v[156:159], a[136:139], v[140:143], v[156:159]
  buffer_load_dwordx4 v1, s[12:15], s78 offen offset:1024 sc1 lds
  v_mfma_f32_16x16x32_bf16 v[156:159], a[140:143], v[172:175], v[156:159]
  v_exp_f32 v115, v115
  v_mfma_f32_16x16x32_bf16 v[176:179], a[144:147], v[64:67], v[196:199]
  ds_read_b128 a[184:187], v3 offset:30720
  v_cvt_pk_bf16_f32 v35, v114, v115
  v_mfma_f32_16x16x32_bf16 v[176:179], a[148:151], v[96:99], v[176:179]
  v_exp_f32 v84, v84
  v_mfma_f32_16x16x32_bf16 v[176:179], a[152:155], v[128:131], v[176:179]
  ds_read_b128 a[188:191], v3 offset:31744
  buffer_store_dwordx4 a[200:203], v1, s[8:11], s7 offen offset:2048 sc1
  v_mfma_f32_16x16x32_bf16 v[176:179], a[156:159], v[160:163], v[176:179]
  v_exp_f32 v85, v85
  v_mfma_f32_16x16x32_bf16 v[180:183], a[144:147], v[68:71], v[204:207]
  buffer_load_dwordx4 v1, s[12:15], s78 offen offset:2048 sc1 lds
  v_cvt_pk_bf16_f32 v36, v84, v85
  v_mfma_f32_16x16x32_bf16 v[180:183], a[148:151], v[100:103], v[180:183]
  v_exp_f32 v86, v86
  v_mfma_f32_16x16x32_bf16 v[180:183], a[152:155], v[132:135], v[180:183]
  v_mfma_f32_16x16x32_bf16 v[180:183], a[156:159], v[164:167], v[180:183]
  v_mfma_f32_16x16x32_bf16 v[184:187], a[144:147], v[72:75], v[212:215]
  v_exp_f32 v87, v87
  v_mfma_f32_16x16x32_bf16 v[184:187], a[148:151], v[104:107], v[184:187]
  buffer_store_dwordx4 a[204:207], v1, s[8:11], s7 offen offset:3072 sc1
  s_add_u32 s7, s7, 262144
  v_cvt_pk_bf16_f32 v37, v86, v87
  v_mfma_f32_16x16x32_bf16 v[184:187], a[152:155], v[136:139], v[184:187]
  v_exp_f32 v116, v116
  v_mfma_f32_16x16x32_bf16 v[184:187], a[156:159], v[168:171], v[184:187]
  v_mfma_f32_16x16x32_bf16 v[188:191], a[144:147], v[76:79], v[220:223]
  v_exp_f32 v117, v117
  v_mfma_f32_16x16x32_bf16 v[188:191], a[148:151], v[108:111], v[188:191]
  v_cvt_pk_bf16_f32 v38, v116, v117
  s_waitcnt lgkmcnt(4)
  v_mfma_f32_16x16x32_bf16 v[188:191], a[152:155], v[140:143], v[188:191]
  v_exp_f32 v118, v118
  v_mfma_f32_16x16x32_bf16 v[188:191], a[156:159], v[172:175], v[188:191]
  buffer_load_dwordx4 v1, s[12:15], s78 offen offset:3072 sc1 lds
  s_add_u32 s78, s78, 49152
  v_mfma_f32_16x16x32_bf16 a[0:3], a[160:163], v[48:51], a[0:3]
  v_exp_f32 v119, v119
  v_mfma_f32_16x16x32_bf16 a[4:7], a[160:163], v[52:55], a[4:7]
  buffer_store_dwordx4 a[208:211], v1, s[8:11], s7 offen offset:0 sc1
  v_cvt_pk_bf16_f32 v39, v118, v119
  v_mfma_f32_16x16x32_bf16 a[8:11], a[160:163], v[56:59], a[8:11]
  v_exp_f32 v88, v88
  v_mfma_f32_16x16x32_bf16 a[12:15], a[160:163], v[60:63], a[12:15]
  v_mov_b32 v3, v2
  v_add_u32 v2, 0x8000, v2
  v_mfma_f32_16x16x32_bf16 a[16:19], a[164:167], v[48:51], a[16:19]
  v_exp_f32 v89, v89
  v_mfma_f32_16x16x32_bf16 a[20:23], a[164:167], v[52:55], a[20:23]
  v_cvt_pk_bf16_f32 v40, v88, v89
  v_and_b32 v2, 0x1ffff, v2
  v_mfma_f32_16x16x32_bf16 a[24:27], a[164:167], v[56:59], a[24:27]
  v_exp_f32 v90, v90
  v_mfma_f32_16x16x32_bf16 a[28:31], a[164:167], v[60:63], a[28:31]
  s_waitcnt vmcnt(16) lgkmcnt(0)
  s_barrier
  v_mfma_f32_16x16x32_bf16 a[32:35], a[168:171], v[48:51], a[32:35]
  v_exp_f32 v91, v91
  v_mfma_f32_16x16x32_bf16 a[36:39], a[168:171], v[52:55], a[36:39]
  ds_read_b128 a[128:131], v2 offset:0
  v_cvt_pk_bf16_f32 v41, v90, v91
  v_mfma_f32_16x16x32_bf16 a[40:43], a[168:171], v[56:59], a[40:43]
  v_exp_f32 v120, v120
  v_mfma_f32_16x16x32_bf16 a[44:47], a[168:171], v[60:63], a[44:47]
  ds_read_b128 a[132:135], v2 offset:1024
  buffer_store_dwordx4 a[212:215], v1, s[8:11], s7 offen offset:1024 sc1
  v_mfma_f32_16x16x32_bf16 a[48:51], a[172:175], v[48:51], a[48:51]
  v_exp_f32 v121, v121
  v_mfma_f32_16x16x32_bf16 a[52:55], a[172:175], v[52:55], a[52:55]
  ds_read_b128 a[136:139], v2 offset:2048
  v_cvt_pk_bf16_f32 v42, v120, v121
  v_mfma_f32_16x16x32_bf16 a[56:59], a[172:175], v[56:59], a[56:59]
  ds_read_b128 a[140:143], v2 offset:3072
  v_mfma_f32_16x16x32_bf16 a[60:63], a[172:175], v[60:63], a[60:63]
  v_exp_f32 v122, v122
  v_mfma_f32_16x16x32_bf16 a[64:67], a[176:179], v[48:51], a[64:67]
  ds_read_b128 a[144:147], v2 offset:4096
  v_mfma_f32_16x16x32_bf16 a[68:71], a[176:179], v[52:55], a[68:71]
  buffer_store_dwordx4 a[216:219], v1, s[8:11], s7 offen offset:2048 sc1
  v_exp_f32 v123, v123
  v_mfma_f32_16x16x32_bf16 a[72:75], a[176:179], v[56:59], a[72:75]
  ds_read_b128 a[148:151], v2 offset:5120
  v_cvt_pk_bf16_f32 v43, v122, v123
  v_mfma_f32_16x16x32_bf16 a[76:79], a[176:179], v[60:63], a[76:79]
  v_exp_f32 v92, v92
  v_mfma_f32_16x16x32_bf16 a[80:83], a[180:183], v[48:51], a[80:83]
  ds_read_b128 a[152:155], v2 offset:6144
  v_mfma_f32_16x16x32_bf16 a[84:87], a[180:183], v[52:55], a[84:87]
  v_exp_f32 v93, v93
  v_mfma_f32_16x16x32_bf16 a[88:91], a[180:183], v[56:59], a[88:91]
  ds_read_b128 a[156:159], v2 offset:7168
  v_cvt_pk_bf16_f32 v44, v92, v93
  v_mfma_f32_16x16x32_bf16 a[92:95], a[180:183], v[60:63], a[92:95]
  v_exp_f32 v94, v94
  v_mfma_f32_16x16x32_bf16 a[96:99], a[184:187], v[48:51], a[96:99]
  v_mfma_f32_16x16x32_bf16 a[100:103], a[184:187], v[52:55], a[100:103]
  v_exp_f32 v95, v95
  v_mfma_f32_16x16x32_bf16 a[104:107], a[184:187], v[56:59], a[104:107]
  buffer_store_dwordx4 a[220:223], v1, s[8:11], s7 offen offset:3072 sc1
  v_cvt_pk_bf16_f32 v45, v94, v95
  v_mfma_f32_16x16x32_bf16 a[108:111], a[184:187], v[60:63], a[108:111]
  v_exp_f32 v124, v124
  v_mfma_f32_16x16x32_bf16 a[112:115], a[188:191], v[48:51], a[112:115]
  v_mfma_f32_16x16x32_bf16 a[116:119], a[188:191], v[52:55], a[116:119]
  v_exp_f32 v125, v125
  v_mfma_f32_16x16x32_bf16 a[120:123], a[188:191], v[56:59], a[120:123]
  v_cvt_pk_bf16_f32 v46, v124, v125
  v_mfma_f32_16x16x32_bf16 a[124:127], a[188:191], v[60:63], a[124:127]
  v_exp_f32 v126, v126
  v_mfma_f32_16x16x32_bf16 v[16:19], v[12:15], v[48:51], v[16:19]
  v_mfma_f32_16x16x32_bf16 v[20:23], v[12:15], v[52:55], v[20:23]
  v_exp_f32 v127, v127
  v_mfma_f32_16x16x32_bf16 v[24:27], v[12:15], v[56:59], v[24:27]
  v_cvt_pk_bf16_f32 v47, v126, v127
  v_mfma_f32_16x16x32_bf16 v[28:31], v[12:15], v[60:63], v[28:31]
  s_waitcnt lgkmcnt(4)
  v_mfma_f32_16x16x32_bf16 v[80:83], a[128:131], v[64:67], v[192:195]
  ds_read_b128 a[160:163], v3 offset:16384
  s_and_b32 m0, s78, 0x1ffff
  v_mfma_f32_16x16x32_bf16 v[80:83], a[132:135], v[96:99], v[80:83]
  v_exp_f32 v144, v144
  v_mfma_f32_16x16x32_bf16 v[80:83], a[136:139], v[128:131], v[80:83]
  ds_read_b128 a[164:167], v3 offset:17408
  buffer_load_dwordx4 v1, s[12:15], s78 offen offset:0 sc1 lds
  v_mfma_f32_16x16x32_bf16 v[80:83], a[140:143], v[160:163], v[80:83]
  v_exp_f32 v145, v145
  v_mfma_f32_16x16x32_bf16 v[84:87], a[128:131], v[68:71], v[200:203]
  v_cvt_pk_bf16_f32 v48, v144, v145
  v_mfma_f32_16x16x32_bf16 v[84:87], a[132:135], v[100:103], v[84:87]
  v_exp_f32 v146, v146
  v_mfma_f32_16x16x32_bf16 v[84:87], a[136:139], v[132:135], v[84:87]
  ds_read_b128 a[168:171], v3 offset:18432
  v_mfma_f32_16x16x32_bf16 v[84:87], a[140:143], v[164:167], v[84:87]
  v_exp_f32 v147, v147
  v_mfma_f32_16x16x32_bf16 v[88:91], a[128:131], v[72:75], v[208:211]
  ds_read_b128 a[172:175], v3 offset:19456
  v_cvt_pk_bf16_f32 v49, v146, v147
  v_mfma_f32_16x16x32_bf16 v[88:91], a[132:135], v[104:107], v[88:91]
  v_exp_f32 v176, v176
  v_mfma_f32_16x16x32_bf16 v[88:91], a[136:139], v[136:139], v[88:91]
  ds_read_b128 a[176:179], v3 offset:20480
  buffer_load_dwordx4 v1, s[12:15], s78 offen offset:1024 sc1 lds
  v_mfma_f32_16x16x32_bf16 v[88:91], a[140:143], v[168:171], v[88:91]
  v_exp_f32 v177, v177
  v_mfma_f32_16x16x32_bf16 v[92:95], a[128:131], v[76:79], v[216:219]
  ds_read_b128 a[180:183], v3 offset:21504
  v_cvt_pk_bf16_f32 v50, v176, v177
  v_mfma_f32_16x16x32_bf16 v[92:95], a[132:135], v[108:111], v[92:95]
  v_exp_f32 v178, v178
  v_mfma_f32_16x16x32_bf16 v[92:95], a[136:139], v[140:143], v[92:95]
  buffer_load_dwordx4 v1, s[12:15], s78 offen offset:2048 sc1 lds
  s_waitcnt lgkmcnt(6)
  v_mfma_f32_16x16x32_bf16 v[92:95], a[140:143], v[172:175], v[92:95]
  v_exp_f32 v179, v179
  v_mfma_f32_16x16x32_bf16 v[112:115], a[144:147], v[64:67], v[196:199]
  ds_read_b128 a[184:187], v3 offset:22528
  v_cvt_pk_bf16_f32 v51, v178, v179
  v_mfma_f32_16x16x32_bf16 v[112:115], a[148:151], v[96:99], v[112:115]
  v_exp_f32 v148, v148
  v_mfma_f32_16x16x32_bf16 v[112:115], a[152:155], v[128:131], v[112:115]
  ds_read_b128 a[188:191], v3 offset:23552
  buffer_load_dwordx4 v1, s[12:15], s78 offen offset:3072 sc1 lds
  v_mfma_f32_16x16x32_bf16 v[112:115], a[156:159], v[160:163], v[112:115]
  v_exp_f32 v149, v149
  v_mfma_f32_16x16x32_bf16 v[116:119], a[144:147], v[68:71], v[204:207]
  v_cvt_pk_bf16_f32 v52, v148, v149
  s_sub_u32 s78, s78, 16384
  v_mfma_f32_16x16x32_bf16 v[116:119], a[148:151], v[100:103], v[116:119]
  v_exp_f32 v150, v150
  v_mfma_f32_16x16x32_bf16 v[116:119], a[152:155], v[132:135], v[116:119]
  s_add_u32 m0, s85, 0
  s_add_u32 s76, s80, 0
  buffer_load_dwordx4 v236, s[16:19], s76 offen offset:0 nt lds
  v_mfma_f32_16x16x32_bf16 v[116:119], a[156:159], v[164:167], v[116:119]
  v_mfma_f32_16x16x32_bf16 v[120:123], a[144:147], v[72:75], v[212:215]
  v_exp_f32 v151, v151
  v_mfma_f32_16x16x32_bf16 v[120:123], a[148:151], v[104:107], v[120:123]
  v_cvt_pk_bf16_f32 v53, v150, v151
  v_mfma_f32_16x16x32_bf16 v[120:123], a[152:155], v[136:139], v[120:123]
  v_exp_f32 v180, v180
  v_mfma_f32_16x16x32_bf16 v[120:123], a[156:159], v[168:171], v[120:123]
  buffer_load_dwordx4 v237, s[16:19], s76 offen offset:1024 nt lds
  v_mfma_f32_16x16x32_bf16 v[124:127], a[144:147], v[76:79], v[220:223]
  v_exp_f32 v181, v181
  v_mfma_f32_16x16x32_bf16 v[124:127], a[148:151], v[108:111], v[124:127]
  v_cvt_pk_bf16_f32 v54, v180, v181
  s_waitcnt lgkmcnt(4)
  v_mfma_f32_16x16x32_bf16 v[124:127], a[152:155], v[140:143], v[124:127]
  v_exp_f32 v182, v182
  v_mfma_f32_16x16x32_bf16 v[124:127], a[156:159], v[172:175], v[124:127]
  v_mfma_f32_16x16x32_bf16 a[0:3], a[160:163], v[32:35], a[0:3]
  buffer_load_dwordx4 v238, s[16:19], s76 offen offset:2048 nt lds
  v_exp_f32 v183, v183
  v_mfma_f32_16x16x32_bf16 a[4:7], a[160:163], v[36:39], a[4:7]
  ds_read_b128 a[128:131], v2 offset:8192
  v_cvt_pk_bf16_f32 v55, v182, v183
  v_mfma_f32_16x16x32_bf16 a[8:11], a[160:163], v[40:43], a[8:11]
  v_exp_f32 v152, v152
  v_mfma_f32_16x16x32_bf16 a[12:15], a[160:163], v[44:47], a[12:15]
  ds_read_b128 a[132:135], v2 offset:9216
  v_mfma_f32_16x16x32_bf16 a[16:19], a[164:167], v[32:35], a[16:19]
  v_exp_f32 v153, v153
  v_mfma_f32_16x16x32_bf16 a[20:23], a[164:167], v[36:39], a[20:23]
  ds_read_b128 a[136:139], v2 offset:10240
  v_cvt_pk_bf16_f32 v56, v152, v153
  v_mfma_f32_16x16x32_bf16 a[24:27], a[164:167], v[40:43], a[24:27]
  v_exp_f32 v154, v154
  v_mfma_f32_16x16x32_bf16 a[28:31], a[164:167], v[44:47], a[28:31]
  buffer_load_dwordx4 v239, s[16:19], s76 offen offset:3072 nt lds
  v_mfma_f32_16x16x32_bf16 a[32:35], a[168:171], v[32:35], a[32:35]
  v_exp_f32 v155, v155
  v_mfma_f32_16x16x32_bf16 a[36:39], a[168:171], v[36:39], a[36:39]
  ds_read_b128 a[140:143], v2 offset:11264
  v_cvt_pk_bf16_f32 v57, v154, v155
  v_mfma_f32_16x16x32_bf16 a[40:43], a[168:171], v[40:43], a[40:43]
  v_exp_f32 v184, v184
  v_mfma_f32_16x16x32_bf16 a[44:47], a[168:171], v[44:47], a[44:47]
  ds_read_b128 a[144:147], v2 offset:12288
  s_add_u32 m0, s85, 4096
  s_add_u32 s76, s91, 0
  buffer_load_dwordx4 v240, s[40:43], s76 offen offset:0 nt lds
  v_mfma_f32_16x16x32_bf16 a[48:51], a[172:175], v[32:35], a[48:51]
  v_exp_f32 v185, v185
  v_mfma_f32_16x16x32_bf16 a[52:55], a[172:175], v[36:39], a[52:55]
  v_cvt_pk_bf16_f32 v58, v184, v185
  s_waitcnt lgkmcnt(5)
  v_mfma_f32_16x16x32_bf16 a[56:59], a[172:175], v[40:43], a[56:59]
  ds_read_b128 a[148:151], v2 offset:13312
  v_mfma_f32_16x16x32_bf16 a[60:63], a[172:175], v[44:47], a[60:63]
  v_exp_f32 v186, v186
  v_mfma_f32_16x16x32_bf16 a[64:67], a[176:179], v[32:35], a[64:67]
  ds_read_b128 a[152:155], v2 offset:14336
  v_mfma_f32_16x16x32_bf16 a[68:71], a[176:179], v[36:39], a[68:71]
  v_exp_f32 v187, v187
  v_mfma_f32_16x16x32_bf16 a[72:75], a[176:179], v[40:43], a[72:75]
  buffer_load_dwordx4 v241, s[40:43], s76 offen offset:1024 nt lds
  v_cvt_pk_bf16_f32 v59, v186, v187
  v_mfma_f32_16x16x32_bf16 a[76:79], a[176:179], v[44:47], a[76:79]
  v_exp_f32 v156, v156
  v_mfma_f32_16x16x32_bf16 a[80:83], a[180:183], v[32:35], a[80:83]
  ds_read_b128 a[156:159], v2 offset:15360
  v_mfma_f32_16x16x32_bf16 a[84:87], a[180:183], v[36:39], a[84:87]
  v_exp_f32 v157, v157
  v_mfma_f32_16x16x32_bf16 a[88:91], a[180:183], v[40:43], a[88:91]
  buffer_load_dwordx4 v242, s[40:43], s76 offen offset:2048 nt lds
  v_cvt_pk_bf16_f32 v60, v156, v157
  v_mfma_f32_16x16x32_bf16 a[92:95], a[180:183], v[44:47], a[92:95]
  v_exp_f32 v158, v158
  v_mfma_f32_16x16x32_bf16 a[96:99], a[184:187], v[32:35], a[96:99]
  v_mfma_f32_16x16x32_bf16 a[100:103], a[184:187], v[36:39], a[100:103]
  v_exp_f32 v159, v159
  v_mfma_f32_16x16x32_bf16 a[104:107], a[184:187], v[40:43], a[104:107]
  v_cvt_pk_bf16_f32 v61, v158, v159
  v_mfma_f32_16x16x32_bf16 a[108:111], a[184:187], v[44:47], a[108:111]
  v_exp_f32 v188, v188
  v_mfma_f32_16x16x32_bf16 a[112:115], a[188:191], v[32:35], a[112:115]
  buffer_load_dwordx4 v243, s[40:43], s76 offen offset:3072 nt lds
  v_mfma_f32_16x16x32_bf16 a[116:119], a[188:191], v[36:39], a[116:119]
  v_exp_f32 v189, v189
  v_mfma_f32_16x16x32_bf16 a[120:123], a[188:191], v[40:43], a[120:123]
  v_cvt_pk_bf16_f32 v62, v188, v189
  v_mfma_f32_16x16x32_bf16 a[124:127], a[188:191], v[44:47], a[124:127]
  v_exp_f32 v190, v190
  v_mfma_f32_16x16x32_bf16 v[16:19], v[12:15], v[32:35], v[16:19]
  v_mfma_f32_16x16x32_bf16 v[20:23], v[12:15], v[36:39], v[20:23]
  v_exp_f32 v191, v191
  v_mfma_f32_16x16x32_bf16 v[24:27], v[12:15], v[40:43], v[24:27]
  v_cvt_pk_bf16_f32 v63, v190, v191
  v_mfma_f32_16x16x32_bf16 v[28:31], v[12:15], v[44:47], v[28:31]
  s_waitcnt lgkmcnt(4)
  v_mfma_f32_16x16x32_bf16 v[144:147], a[128:131], v[64:67], v[192:195]
  ds_read_b128 a[160:163], v3 offset:24576
  s_and_b32 m0, s78, 0x1ffff
  v_mfma_f32_16x16x32_bf16 v[144:147], a[132:135], v[96:99], v[144:147]
  v_exp_f32 v80, v80
  v_mfma_f32_16x16x32_bf16 v[144:147], a[136:139], v[128:131], v[144:147]
  ds_read_b128 a[164:167], v3 offset:25600
  buffer_load_dwordx4 v1, s[12:15], s78 offen offset:0 sc1 lds
  v_mfma_f32_16x16x32_bf16 v[144:147], a[140:143], v[160:163], v[144:147]
  v_exp_f32 v81, v81
  v_mfma_f32_16x16x32_bf16 v[148:151], a[128:131], v[68:71], v[200:203]
  v_cvt_pk_bf16_f32 v32, v80, v81
  v_mfma_f32_16x16x32_bf16 v[148:151], a[132:135], v[100:103], v[148:151]
  v_exp_f32 v82, v82
  v_mfma_f32_16x16x32_bf16 v[148:151], a[136:139], v[132:135], v[148:151]
  ds_read_b128 a[168:171], v3 offset:26624
  v_mfma_f32_16x16x32_bf16 v[148:151], a[140:143], v[164:167], v[148:151]
  v_exp_f32 v83, v83
  v_mfma_f32_16x16x32_bf16 v[152:155], a[128:131], v[72:75], v[208:211]
  ds_read_b128 a[172:175], v3 offset:27648
  v_cvt_pk_bf16_f32 v33, v82, v83
  v_mfma_f32_16x16x32_bf16 v[152:155], a[132:135], v[104:107], v[152:155]
  v_exp_f32 v112, v112
  v_mfma_f32_16x16x32_bf16 v[152:155], a[136:139], v[136:139], v[152:155]
  ds_read_b128 a[176:179], v3 offset:28672
  v_mfma_f32_16x16x32_bf16 v[152:155], a[140:143], v[168:171], v[152:155]
  v_exp_f32 v113, v113
  v_mfma_f32_16x16x32_bf16 v[156:159], a[128:131], v[76:79], v[216:219]
  ds_read_b128 a[180:183], v3 offset:29696
  v_cvt_pk_bf16_f32 v34, v112, v113
  v_mfma_f32_16x16x32_bf16 v[156:159], a[132:135], v[108:111], v[156:159]
  v_exp_f32 v114, v114
  v_mfma_f32_16x16x32_bf16 v[156:159], a[136:139], v[140:143], v[156:159]
  buffer_load_dwordx4 v1, s[12:15], s78 offen offset:1024 sc1 lds
  s_waitcnt lgkmcnt(6)
  v_mfma_f32_16x16x32_bf16 v[156:159], a[140:143], v[172:175], v[156:159]
  v_exp_f32 v115, v115
  v_mfma_f32_16x16x32_bf16 v[176:179], a[144:147], v[64:67], v[196:199]
  ds_read_b128 a[184:187], v3 offset:30720
  v_cvt_pk_bf16_f32 v35, v114, v115
  v_mfma_f32_16x16x32_bf16 v[176:179], a[148:151], v[96:99], v[176:179]
  v_exp_f32 v84, v84
  v_mfma_f32_16x16x32_bf16 v[176:179], a[152:155], v[128:131], v[176:179]
  ds_read_b128 a[188:191], v3 offset:31744
  v_mfma_f32_16x16x32_bf16 v[176:179], a[156:159], v[160:163], v[176:179]
  v_exp_f32 v85, v85
  v_mfma_f32_16x16x32_bf16 v[180:183], a[144:147], v[68:71], v[204:207]
  buffer_load_dwordx4 v1, s[12:15], s78 offen offset:2048 sc1 lds
  v_cvt_pk_bf16_f32 v36, v84, v85
  v_mfma_f32_16x16x32_bf16 v[180:183], a[148:151], v[100:103], v[180:183]
  v_exp_f32 v86, v86
  v_mfma_f32_16x16x32_bf16 v[180:183], a[152:155], v[132:135], v[180:183]
  v_mfma_f32_16x16x32_bf16 v[180:183], a[156:159], v[164:167], v[180:183]
  v_mfma_f32_16x16x32_bf16 v[184:187], a[144:147], v[72:75], v[212:215]
  v_exp_f32 v87, v87
  v_mfma_f32_16x16x32_bf16 v[184:187], a[148:151], v[104:107], v[184:187]
  v_cvt_pk_bf16_f32 v37, v86, v87
  v_mfma_f32_16x16x32_bf16 v[184:187], a[152:155], v[136:139], v[184:187]
  v_exp_f32 v116, v116
  v_mfma_f32_16x16x32_bf16 v[184:187], a[156:159], v[168:171], v[184:187]
  v_mfma_f32_16x16x32_bf16 v[188:191], a[144:147], v[76:79], v[220:223]
  v_exp_f32 v117, v117
  v_mfma_f32_16x16x32_bf16 v[188:191], a[148:151], v[108:111], v[188:191]
  v_cvt_pk_bf16_f32 v38, v116, v117
  s_waitcnt lgkmcnt(4)
  v_mfma_f32_16x16x32_bf16 v[188:191], a[152:155], v[140:143], v[188:191]
  v_exp_f32 v118, v118
  v_mfma_f32_16x16x32_bf16 v[188:191], a[156:159], v[172:175], v[188:191]
  buffer_load_dwordx4 v1, s[12:15], s78 offen offset:3072 sc1 lds
  s_add_u32 s78, s78, 49152
  v_mfma_f32_16x16x32_bf16 a[0:3], a[160:163], v[48:51], a[0:3]
  v_exp_f32 v119, v119
  v_mfma_f32_16x16x32_bf16 a[4:7], a[160:163], v[52:55], a[4:7]
  v_cvt_pk_bf16_f32 v39, v118, v119
  v_mfma_f32_16x16x32_bf16 a[8:11], a[160:163], v[56:59], a[8:11]
  v_exp_f32 v88, v88
  v_mfma_f32_16x16x32_bf16 a[12:15], a[160:163], v[60:63], a[12:15]
  v_mov_b32 v3, v2
  v_add_u32 v2, 0x8000, v2
  v_mfma_f32_16x16x32_bf16 a[16:19], a[164:167], v[48:51], a[16:19]
  v_exp_f32 v89, v89
  v_mfma_f32_16x16x32_bf16 a[20:23], a[164:167], v[52:55], a[20:23]
  v_cvt_pk_bf16_f32 v40, v88, v89
  v_and_b32 v2, 0x1ffff, v2
  v_mfma_f32_16x16x32_bf16 a[24:27], a[164:167], v[56:59], a[24:27]
  v_exp_f32 v90, v90
  v_mfma_f32_16x16x32_bf16 a[28:31], a[164:167], v[60:63], a[28:31]
  s_waitcnt vmcnt(16) lgkmcnt(0)
  s_barrier
  v_mfma_f32_16x16x32_bf16 a[32:35], a[168:171], v[48:51], a[32:35]
  v_exp_f32 v91, v91
  v_mfma_f32_16x16x32_bf16 a[36:39], a[168:171], v[52:55], a[36:39]
  ds_read_b128 a[128:131], v2 offset:0
  v_cvt_pk_bf16_f32 v41, v90, v91
  v_mfma_f32_16x16x32_bf16 a[40:43], a[168:171], v[56:59], a[40:43]
  v_exp_f32 v120, v120
  v_mfma_f32_16x16x32_bf16 a[44:47], a[168:171], v[60:63], a[44:47]
  ds_read_b128 a[132:135], v2 offset:1024
  v_mfma_f32_16x16x32_bf16 a[48:51], a[172:175], v[48:51], a[48:51]
  v_exp_f32 v121, v121
  v_mfma_f32_16x16x32_bf16 a[52:55], a[172:175], v[52:55], a[52:55]
  ds_read_b128 a[136:139], v2 offset:2048
  v_cvt_pk_bf16_f32 v42, v120, v121
  v_mfma_f32_16x16x32_bf16 a[56:59], a[172:175], v[56:59], a[56:59]
  ds_read_b128 a[140:143], v2 offset:3072
  v_mfma_f32_16x16x32_bf16 a[60:63], a[172:175], v[60:63], a[60:63]
  v_exp_f32 v122, v122
  v_mfma_f32_16x16x32_bf16 a[64:67], a[176:179], v[48:51], a[64:67]
  ds_read_b128 a[144:147], v2 offset:4096
  v_mfma_f32_16x16x32_bf16 a[68:71], a[176:179], v[52:55], a[68:71]
  v_exp_f32 v123, v123
  v_mfma_f32_16x16x32_bf16 a[72:75], a[176:179], v[56:59], a[72:75]
  ds_read_b128 a[148:151], v2 offset:5120
  v_cvt_pk_bf16_f32 v43, v122, v123
  v_mfma_f32_16x16x32_bf16 a[76:79], a[176:179], v[60:63], a[76:79]
  v_exp_f32 v92, v92
  v_mfma_f32_16x16x32_bf16 a[80:83], a[180:183], v[48:51], a[80:83]
  ds_read_b128 a[152:155], v2 offset:6144
  v_mfma_f32_16x16x32_bf16 a[84:87], a[180:183], v[52:55], a[84:87]
  v_exp_f32 v93, v93
  v_mfma_f32_16x16x32_bf16 a[88:91], a[180:183], v[56:59], a[88:91]
  ds_read_b128 a[156:159], v2 offset:7168
  v_cvt_pk_bf16_f32 v44, v92, v93
  v_mfma_f32_16x16x32_bf16 a[92:95], a[180:183], v[60:63], a[92:95]
  v_exp_f32 v94, v94
  v_mfma_f32_16x16x32_bf16 a[96:99], a[184:187], v[48:51], a[96:99]
  v_mfma_f32_16x16x32_bf16 a[100:103], a[184:187], v[52:55], a[100:103]
  v_exp_f32 v95, v95
  v_mfma_f32_16x16x32_bf16 a[104:107], a[184:187], v[56:59], a[104:107]
  v_cvt_pk_bf16_f32 v45, v94, v95
  v_mfma_f32_16x16x32_bf16 a[108:111], a[184:187], v[60:63], a[108:111]
  v_exp_f32 v124, v124
  v_mfma_f32_16x16x32_bf16 a[112:115], a[188:191], v[48:51], a[112:115]
  v_mfma_f32_16x16x32_bf16 a[116:119], a[188:191], v[52:55], a[116:119]
  v_exp_f32 v125, v125
  v_mfma_f32_16x16x32_bf16 a[120:123], a[188:191], v[56:59], a[120:123]
  v_cvt_pk_bf16_f32 v46, v124, v125
  v_mfma_f32_16x16x32_bf16 a[124:127], a[188:191], v[60:63], a[124:127]
  v_exp_f32 v126, v126
  v_mfma_f32_16x16x32_bf16 v[16:19], v[12:15], v[48:51], v[16:19]
  v_mfma_f32_16x16x32_bf16 v[20:23], v[12:15], v[52:55], v[20:23]
  v_exp_f32 v127, v127
  v_mfma_f32_16x16x32_bf16 v[24:27], v[12:15], v[56:59], v[24:27]
  v_cvt_pk_bf16_f32 v47, v126, v127
  v_mfma_f32_16x16x32_bf16 v[28:31], v[12:15], v[60:63], v[28:31]
  s_waitcnt lgkmcnt(4)
Ldd_f_go:
  s_sub_u32 s86, s86, 1
  s_cbranch_scc1 Ldd_f_done
  .p2align 6
Ldd_f:
  v_mfma_f32_16x16x32_bf16 v[80:83], a[128:131], v[64:67], v[192:195]
  ds_read_b128 a[160:163], v3 offset:16384
  s_and_b32 m0, s78, 0x1ffff
  v_mfma_f32_16x16x32_bf16 v[80:83], a[132:135], v[96:99], v[80:83]
  v_exp_f32 v144, v144
  v_mfma_f32_16x16x32_bf16 v[80:83], a[136:139], v[128:131], v[80:83]
  ds_read_b128 a[164:167], v3 offset:17408
  buffer_load_dwordx4 v1, s[12:15], s78 offen offset:0 sc1 lds
  v_mfma_f32_16x16x32_bf16 v[80:83], a[140:143], v[160:163], v[80:83]
  v_exp_f32 v145, v145
  v_mfma_f32_16x16x32_bf16 v[84:87], a[128:131], v[68:71], v[200:203]
  v_cvt_pk_bf16_f32 v48, v144, v145
  v_mfma_f32_16x16x32_bf16 v[84:87], a[132:135], v[100:103], v[84:87]
  v_exp_f32 v146, v146
  v_mfma_f32_16x16x32_bf16 v[84:87], a[136:139], v[132:135], v[84:87]
  ds_read_b128 a[168:171], v3 offset:18432
  v_mfma_f32_16x16x32_bf16 v[84:87], a[140:143], v[164:167], v[84:87]
  v_exp_f32 v147, v147
  v_mfma_f32_16x16x32_bf16 v[88:91], a[128:131], v[72:75], v[208:211]
  ds_read_b128 a[172:175], v3 offset:19456
  v_cvt_pk_bf16_f32 v49, v146, v147
  v_mfma_f32_16x16x32_bf16 v[88:91], a[132:135], v[104:107], v[88:91]
  v_exp_f32 v176, v176
  v_mfma_f32_16x16x32_bf16 v[88:91], a[136:139], v[136:139], v[88:91]
  ds_read_b128 a[176:179], v3 offset:20480
  v_mfma_f32_16x16x32_bf16 v[88:91], a[140:143], v[168:171], v[88:91]
  v_exp_f32 v177, v177
  v_mfma_f32_16x16x32_bf16 v[92:95], a[128:131], v[76:79], v[216:219]
  ds_read_b128 a[180:183], v3 offset:21504
  v_cvt_pk_bf16_f32 v50, v176, v177
  v_mfma_f32_16x16x32_bf16 v[92:95], a[132:135], v[108:111], v[92:95]
  v_exp_f32 v178, v178
  v_mfma_f32_16x16x32_bf16 v[92:95], a[136:139], v[140:143], v[92:95]
  s_waitcnt lgkmcnt(6)
  v_mfma_f32_16x16x32_bf16 v[92:95], a[140:143], v[172:175], v[92:95]
  v_exp_f32 v179, v179
  v_mfma_f32_16x16x32_bf16 v[112:115], a[144:147], v[64:67], v[196:199]
  ds_read_b128 a[184:187], v3 offset:22528
  v_cvt_pk_bf16_f32 v51, v178, v179
  v_mfma_f32_16x16x32_bf16 v[112:115], a[148:151], v[96:99], v[112:115]
  v_exp_f32 v148, v148
  v_mfma_f32_16x16x32_bf16 v[112:115], a[152:155], v[128:131], v[112:115]
  ds_read_b128 a[188:191], v3 offset:23552
  buffer_load_dwordx4 v1, s[12:15], s78 offen offset:1024 sc1 lds
  v_mfma_f32_16x16x32_bf16 v[112:115], a[156:159], v[160:163], v[112:115]
  v_exp_f32 v149, v149
  v_mfma_f32_16x16x32_bf16 v[116:119], a[144:147], v[68:71], v[204:207]
  v_cvt_pk_bf16_f32 v52, v148, v149
  v_mfma_f32_16x16x32_bf16 v[116:119], a[148:151], v[100:103], v[116:119]
  v_exp_f32 v150, v150
  v_mfma_f32_16x16x32_bf16 v[116:119], a[152:155], v[132:135], v[116:119]
  v_mfma_f32_16x16x32_bf16 v[116:119], a[156:159], v[164:167], v[116:119]
  v_mfma_f32_16x16x32_bf16 v[120:123], a[144:147], v[72:75], v[212:215]
  v_exp_f32 v151, v151
  v_mfma_f32_16x16x32_bf16 v[120:123], a[148:151], v[104:107], v[120:123]
  v_cvt_pk_bf16_f32 v53, v150, v151
  v_mfma_f32_16x16x32_bf16 v[120:123], a[152:155], v[136:139], v[120:123]
  v_exp_f32 v180, v180
  v_mfma_f32_16x16x32_bf16 v[120:123], a[156:159], v[168:171], v[120:123]
  v_mfma_f32_16x16x32_bf16 v[124:127], a[144:147], v[76:79], v[220:223]
  v_exp_f32 v181, v181
  v_mfma_f32_16x16x32_bf16 v[124:127], a[148:151], v[108:111], v[124:127]
  v_cvt_pk_bf16_f32 v54, v180, v181
  s_waitcnt lgkmcnt(4)
  v_mfma_f32_16x16x32_bf16 v[124:127], a[152:155], v[140:143], v[124:127]
  v_exp_f32 v182, v182
  v_mfma_f32_16x16x32_bf16 v[124:127], a[156:159], v[172:175], v[124:127]
  v_mfma_f32_16x16x32_bf16 a[0:3], a[160:163], v[32:35], a[0:3]
  v_exp_f32 v183, v183
  v_mfma_f32_16x16x32_bf16 a[4:7], a[160:163], v[36:39], a[4:7]
  ds_read_b128 a[128:131], v2 offset:8192
  v_cvt_pk_bf16_f32 v55, v182, v183
  v_mfma_f32_16x16x32_bf16 a[8:11], a[160:163], v[40:43], a[8:11]
  v_exp_f32 v152, v152
  v_mfma_f32_16x16x32_bf16 a[12:15], a[160:163], v[44:47], a[12:15]
  ds_read_b128 a[132:135], v2 offset:9216
  buffer_load_dwordx4 v1, s[12:15], s78 offen offset:2048 sc1 lds
  v_mfma_f32_16x16x32_bf16 a[16:19], a[164:167], v[32:35], a[16:19]
  v_exp_f32 v153, v153
  v_mfma_f32_16x16x32_bf16 a[20:23], a[164:167], v[36:39], a[20:23]
  ds_read_b128 a[136:139], v2 offset:10240
  v_cvt_pk_bf16_f32 v56, v152, v153
  v_mfma_f32_16x16x32_bf16 a[24:27], a[164:167], v[40:43], a[24:27]
  v_exp_f32 v154, v154
  v_mfma_f32_16x16x32_bf16 a[28:31], a[164:167], v[44:47], a[28:31]
  v_mfma_f32_16x16x32_bf16 a[32:35], a[168:171], v[32:35], a[32:35]
  v_exp_f32 v155, v155
  v_mfma_f32_16x16x32_bf16 a[36:39], a[168:171], v[36:39], a[36:39]
  ds_read_b128 a[140:143], v2 offset:11264
  v_cvt_pk_bf16_f32 v57, v154, v155
  v_mfma_f32_16x16x32_bf16 a[40:43], a[168:171], v[40:43], a[40:43]
  v_exp_f32 v184, v184
  v_mfma_f32_16x16x32_bf16 a[44:47], a[168:171], v[44:47], a[44:47]
  ds_read_b128 a[144:147], v2 offset:12288
  v_mfma_f32_16x16x32_bf16 a[48:51], a[172:175], v[32:35], a[48:51]
  v_exp_f32 v185, v185
  v_mfma_f32_16x16x32_bf16 a[52:55], a[172:175], v[36:39], a[52:55]
  v_cvt_pk_bf16_f32 v58, v184, v185
  s_waitcnt lgkmcnt(5)
  v_mfma_f32_16x16x32_bf16 a[56:59], a[172:175], v[40:43], a[56:59]
  ds_read_b128 a[148:151], v2 offset:13312
  v_mfma_f32_16x16x32_bf16 a[60:63], a[172:175], v[44:47], a[60:63]
  v_exp_f32 v186, v186
  v_mfma_f32_16x16x32_bf16 a[64:67], a[176:179], v[32:35], a[64:67]
  ds_read_b128 a[152:155], v2 offset:14336
  v_mfma_f32_16x16x32_bf16 a[68:71], a[176:179], v[36:39], a[68:71]
  v_exp_f32 v187, v187
  v_mfma_f32_16x16x32_bf16 a[72:75], a[176:179], v[40:43], a[72:75]
  buffer_load_dwordx4 v1, s[12:15], s78 offen offset:3072 sc1 lds
  v_cvt_pk_bf16_f32 v59, v186, v187
  v_mfma_f32_16x16x32_bf16 a[76:79], a[176:179], v[44:47], a[76:79]
  v_exp_f32 v156, v156
  v_mfma_f32_16x16x32_bf16 a[80:83], a[180:183], v[32:35], a[80:83]
  ds_read_b128 a[156:159], v2 offset:15360
  s_sub_u32 s78, s78, 16384
  v_mfma_f32_16x16x32_bf16 a[84:87], a[180:183], v[36:39], a[84:87]
  v_exp_f32 v157, v157
  v_mfma_f32_16x16x32_bf16 a[88:91], a[180:183], v[40:43], a[88:91]
  v_cvt_pk_bf16_f32 v60, v156, v157
  v_mfma_f32_16x16x32_bf16 a[92:95], a[180:183], v[44:47], a[92:95]
  v_exp_f32 v158, v158
  v_mfma_f32_16x16x32_bf16 a[96:99], a[184:187], v[32:35], a[96:99]
  v_mfma_f32_16x16x32_bf16 a[100:103], a[184:187], v[36:39], a[100:103]
  v_exp_f32 v159, v159
  v_mfma_f32_16x16x32_bf16 a[104:107], a[184:187], v[40:43], a[104:107]
  v_cvt_pk_bf16_f32 v61, v158, v159
  v_mfma_f32_16x16x32_bf16 a[108:111], a[184:187], v[44:47], a[108:111]
  v_exp_f32 v188, v188
  v_mfma_f32_16x16x32_bf16 a[112:115], a[188:191], v[32:35], a[112:115]
  v_mfma_f32_16x16x32_bf16 a[116:119], a[188:191], v[36:39], a[116:119]
  v_exp_f32 v189, v189
  v_mfma_f32_16x16x32_bf16 a[120:123], a[188:191], v[40:43], a[120:123]
  v_cvt_pk_bf16_f32 v62, v188, v189
  v_mfma_f32_16x16x32_bf16 a[124:127], a[188:191], v[44:47], a[124:127]
  v_exp_f32 v190, v190
  v_mfma_f32_16x16x32_bf16 v[16:19], v[12:15], v[32:35], v[16:19]
  v_mfma_f32_16x16x32_bf16 v[20:23], v[12:15], v[36:39], v[20:23]
  v_exp_f32 v191, v191
  v_mfma_f32_16x16x32_bf16 v[24:27], v[12:15], v[40:43], v[24:27]
  v_cvt_pk_bf16_f32 v63, v190, v191
  v_mfma_f32_16x16x32_bf16 v[28:31], v[12:15], v[44:47], v[28:31]
  s_waitcnt lgkmcnt(4)
  v_mfma_f32_16x16x32_bf16 v[144:147], a[128:131], v[64:67], v[192:195]
  ds_read_b128 a[160:163], v3 offset:24576
  s_and_b32 m0, s78, 0x1ffff
  v_mfma_f32_16x16x32_bf16 v[144:147], a[132:135], v[96:99], v[144:147]
  v_exp_f32 v80, v80
  v_mfma_f32_16x16x32_bf16 v[144:147], a[136:139], v[128:131], v[144:147]
  ds_read_b128 a[164:167], v3 offset:25600
  buffer_load_dwordx4 v1, s[12:15], s78 offen offset:0 sc1 lds
  v_mfma_f32_16x16x32_bf16 v[144:147], a[140:143], v[160:163], v[144:147]
  v_exp_f32 v81, v81
  v_mfma_f32_16x16x32_bf16 v[148:151], a[128:131], v[68:71], v[200:203]
  v_cvt_pk_bf16_f32 v32, v80, v81
  v_mfma_f32_16x16x32_bf16 v[148:151], a[132:135], v[100:103], v[148:151]
  v_exp_f32 v82, v82
  v_mfma_f32_16x16x32_bf16 v[148:151], a[136:139], v[132:135], v[148:151]
  ds_read_b128 a[168:171], v3 offset:26624
  v_mfma_f32_16x16x32_bf16 v[148:151], a[140:143], v[164:167], v[148:151]
  v_exp_f32 v83, v83
  v_mfma_f32_16x16x32_bf16 v[152:155], a[128:131], v[72:75], v[208:211]
  ds_read_b128 a[172:175], v3 offset:27648
  v_cvt_pk_bf16_f32 v33, v82, v83
  v_mfma_f32_16x16x32_bf16 v[152:155], a[132:135], v[104:107], v[152:155]
  v_exp_f32 v112, v112
  v_mfma_f32_16x16x32_bf16 v[152:155], a[136:139], v[136:139], v[152:155]
  ds_read_b128 a[176:179], v3 offset:28672
  v_mfma_f32_16x16x32_bf16 v[152:155], a[140:143], v[168:171], v[152:155]
  v_exp_f32 v113, v113
  v_mfma_f32_16x16x32_bf16 v[156:159], a[128:131], v[76:79], v[216:219]
  ds_read_b128 a[180:183], v3 offset:29696
  v_cvt_pk_bf16_f32 v34, v112, v113
  v_mfma_f32_16x16x32_bf16 v[156:159], a[132:135], v[108:111], v[156:159]
  v_exp_f32 v114, v114
  v_mfma_f32_16x16x32_bf16 v[156:159], a[136:139], v[140:143], v[156:159]
  buffer_load_dwordx4 v1, s[12:15], s78 offen offset:1024 sc1 lds
  s_waitcnt lgkmcnt(6)
  v_mfma_f32_16x16x32_bf16 v[156:159], a[140:143], v[172:175], v[156:159]
  v_exp_f32 v115, v115
  v_mfma_f32_16x16x32_bf16 v[176:179], a[144:147], v[64:67], v[196:199]
  ds_read_b128 a[184:187], v3 offset:30720
  v_cvt_pk_bf16_f32 v35, v114, v115
  v_mfma_f32_16x16x32_bf16 v[176:179], a[148:151], v[96:99], v[176:179]
  v_exp_f32 v84, v84
  v_mfma_f32_16x16x32_bf16 v[176:179], a[152:155], v[128:131], v[176:179]
  ds_read_b128 a[188:191], v3 offset:31744
  v_mfma_f32_16x16x32_bf16 v[176:179], a[156:159], v[160:163], v[176:179]
  v_exp_f32 v85, v85
  v_mfma_f32_16x16x32_bf16 v[180:183], a[144:147], v[68:71], v[204:207]
  buffer_load_dwordx4 v1, s[12:15], s78 offen offset:2048 sc1 lds
  v_cvt_pk_bf16_f32 v36, v84, v85
  v_mfma_f32_16x16x32_bf16 v[180:183], a[148:151], v[100:103], v[180:183]
  v_exp_f32 v86, v86
  v_mfma_f32_16x16x32_bf16 v[180:183], a[152:155], v[132:135], v[180:183]
  v_mfma_f32_16x16x32_bf16 v[180:183], a[156:159], v[164:167], v[180:183]
  v_mfma_f32_16x16x32_bf16 v[184:187], a[144:147], v[72:75], v[212:215]
  v_exp_f32 v87, v87
  v_mfma_f32_16x16x32_bf16 v[184:187], a[148:151], v[104:107], v[184:187]
  v_cvt_pk_bf16_f32 v37, v86, v87
  v_mfma_f32_16x16x32_bf16 v[184:187], a[152:155], v[136:139], v[184:187]
  v_exp_f32 v116, v116
  v_mfma_f32_16x16x32_bf16 v[184:187], a[156:159], v[168:171], v[184:187]
  v_mfma_f32_16x16x32_bf16 v[188:191], a[144:147], v[76:79], v[220:223]
  v_exp_f32 v117, v117
  v_mfma_f32_16x16x32_bf16 v[188:191], a[148:151], v[108:111], v[188:191]
  v_cvt_pk_bf16_f32 v38, v116, v117
  s_waitcnt lgkmcnt(4)
  v_mfma_f32_16x16x32_bf16 v[188:191], a[152:155], v[140:143], v[188:191]
  v_exp_f32 v118, v118
  v_mfma_f32_16x16x32_bf16 v[188:191], a[156:159], v[172:175], v[188:191]
  buffer_load_dwordx4 v1, s[12:15], s78 offen offset:3072 sc1 lds
  s_add_u32 s78, s78, 49152
  v_mfma_f32_16x16x32_bf16 a[0:3], a[160:163], v[48:51], a[0:3]
  v_exp_f32 v119, v119
  v_mfma_f32_16x16x32_bf16 a[4:7], a[160:163], v[52:55], a[4:7]
  v_cvt_pk_bf16_f32 v39, v118, v119
  v_mfma_f32_16x16x32_bf16 a[8:11], a[160:163], v[56:59], a[8:11]
  v_exp_f32 v88, v88
  v_mfma_f32_16x16x32_bf16 a[12:15], a[160:163], v[60:63], a[12:15]
  v_mov_b32 v3, v2
  v_add_u32 v2, 0x8000, v2
  v_mfma_f32_16x16x32_bf16 a[16:19], a[164:167], v[48:51], a[16:19]
  v_exp_f32 v89, v89
  v_mfma_f32_16x16x32_bf16 a[20:23], a[164:167], v[52:55], a[20:23]
  v_cvt_pk_bf16_f32 v40, v88, v89
  v_and_b32 v2, 0x1ffff, v2
  v_mfma_f32_16x16x32_bf16 a[24:27], a[164:167], v[56:59], a[24:27]
  v_exp_f32 v90, v90
  v_mfma_f32_16x16x32_bf16 a[28:31], a[164:167], v[60:63], a[28:31]
  s_waitcnt vmcnt(16) lgkmcnt(0)
  s_barrier
  v_mfma_f32_16x16x32_bf16 a[32:35], a[168:171], v[48:51], a[32:35]
  v_exp_f32 v91, v91
  v_mfma_f32_16x16x32_bf16 a[36:39], a[168:171], v[52:55], a[36:39]
  ds_read_b128 a[128:131], v2 offset:0
  v_cvt_pk_bf16_f32 v41, v90, v91
  v_mfma_f32_16x16x32_bf16 a[40:43], a[168:171], v[56:59], a[40:43]
  v_exp_f32 v120, v120
  v_mfma_f32_16x16x32_bf16 a[44:47], a[168:171], v[60:63], a[44:47]
  ds_read_b128 a[132:135], v2 offset:1024
  v_mfma_f32_16x16x32_bf16 a[48:51], a[172:175], v[48:51], a[48:51]
  v_exp_f32 v121, v121
  v_mfma_f32_16x16x32_bf16 a[52:55], a[172:175], v[52:55], a[52:55]
  ds_read_b128 a[136:139], v2 offset:2048
  v_cvt_pk_bf16_f32 v42, v120, v121
  v_mfma_f32_16x16x32_bf16 a[56:59], a[172:175], v[56:59], a[56:59]
  ds_read_b128 a[140:143], v2 offset:3072
  v_mfma_f32_16x16x32_bf16 a[60:63], a[172:175], v[60:63], a[60:63]
  v_exp_f32 v122, v122
  v_mfma_f32_16x16x32_bf16 a[64:67], a[176:179], v[48:51], a[64:67]
  ds_read_b128 a[144:147], v2 offset:4096
  v_mfma_f32_16x16x32_bf16 a[68:71], a[176:179], v[52:55], a[68:71]
  v_exp_f32 v123, v123
  v_mfma_f32_16x16x32_bf16 a[72:75], a[176:179], v[56:59], a[72:75]
  ds_read_b128 a[148:151], v2 offset:5120
  v_cvt_pk_bf16_f32 v43, v122, v123
  v_mfma_f32_16x16x32_bf16 a[76:79], a[176:179], v[60:63], a[76:79]
  v_exp_f32 v92, v92
  v_mfma_f32_16x16x32_bf16 a[80:83], a[180:183], v[48:51], a[80:83]
  ds_read_b128 a[152:155], v2 offset:6144
  v_mfma_f32_16x16x32_bf16 a[84:87], a[180:183], v[52:55], a[84:87]
  v_exp_f32 v93, v93
  v_mfma_f32_16x16x32_bf16 a[88:91], a[180:183], v[56:59], a[88:91]
  ds_read_b128 a[156:159], v2 offset:7168
  v_cvt_pk_bf16_f32 v44, v92, v93
  v_mfma_f32_16x16x32_bf16 a[92:95], a[180:183], v[60:63], a[92:95]
  v_exp_f32 v94, v94
  v_mfma_f32_16x16x32_bf16 a[96:99], a[184:187], v[48:51], a[96:99]
  v_mfma_f32_16x16x32_bf16 a[100:103], a[184:187], v[52:55], a[100:103]
  v_exp_f32 v95, v95
  v_mfma_f32_16x16x32_bf16 a[104:107], a[184:187], v[56:59], a[104:107]
  v_cvt_pk_bf16_f32 v45, v94, v95
  v_mfma_f32_16x16x32_bf16 a[108:111], a[184:187], v[60:63], a[108:111]
  v_exp_f32 v124, v124
  v_mfma_f32_16x16x32_bf16 a[112:115], a[188:191], v[48:51], a[112:115]
  v_mfma_f32_16x16x32_bf16 a[116:119], a[188:191], v[52:55], a[116:119]
  v_exp_f32 v125, v125
  v_mfma_f32_16x16x32_bf16 a[120:123], a[188:191], v[56:59], a[120:123]
  v_cvt_pk_bf16_f32 v46, v124, v125
  v_mfma_f32_16x16x32_bf16 a[124:127], a[188:191], v[60:63], a[124:127]
  v_exp_f32 v126, v126
  v_mfma_f32_16x16x32_bf16 v[16:19], v[12:15], v[48:51], v[16:19]
  v_mfma_f32_16x16x32_bf16 v[20:23], v[12:15], v[52:55], v[20:23]
  v_exp_f32 v127, v127
  v_mfma_f32_16x16x32_bf16 v[24:27], v[12:15], v[56:59], v[24:27]
  v_cvt_pk_bf16_f32 v47, v126, v127
  s_sub_u32 s86, s86, 1
  v_mfma_f32_16x16x32_bf16 v[28:31], v[12:15], v[60:63], v[28:31]
  s_waitcnt lgkmcnt(4)
  s_cbranch_scc0 Ldd_f
  s_sub_u32 s1, s1, 1
  s_cbranch_scc1 Ldd_f_done
  s_cmp_eq_u32 s1, 0
  s_cbranch_scc1 Ldd_f_pub
  v_mfma_f32_16x16x32_bf16 v[80:83], a[128:131], v[64:67], v[192:195]
  ds_read_b128 a[160:163], v3 offset:16384
  s_and_b32 m0, s78, 0x1ffff
  v_mfma_f32_16x16x32_bf16 v[80:83], a[132:135], v[96:99], v[80:83]
  v_exp_f32 v144, v144
  v_mfma_f32_16x16x32_bf16 v[80:83], a[136:139], v[128:131], v[80:83]
  ds_read_b128 a[164:167], v3 offset:17408
  ds_read_b64_tr_b16 a[192:193], v244 offset:0
  v_mfma_f32_16x16x32_bf16 v[80:83], a[140:143], v[160:163], v[80:83]
  v_exp_f32 v145, v145
  v_mfma_f32_16x16x32_bf16 v[84:87], a[128:131], v[68:71], v[200:203]
  buffer_load_dwordx4 v1, s[12:15], s78 offen offset:0 sc1 lds
  v_cvt_pk_bf16_f32 v48, v144, v145
  v_mfma_f32_16x16x32_bf16 v[84:87], a[132:135], v[100:103], v[84:87]
  v_exp_f32 v146, v146
  v_mfma_f32_16x16x32_bf16 v[84:87], a[136:139], v[132:135], v[84:87]
  ds_read_b128 a[168:171], v3 offset:18432
  ds_read_b64_tr_b16 a[194:195], v244 offset:2048
  v_mfma_f32_16x16x32_bf16 v[84:87], a[140:143], v[164:167], v[84:87]
  v_exp_f32 v147, v147
  v_mfma_f32_16x16x32_bf16 v[88:91], a[128:131], v[72:75], v[208:211]
  ds_read_b128 a[172:175], v3 offset:19456
  v_cvt_pk_bf16_f32 v49, v146, v147
  v_mfma_f32_16x16x32_bf16 v[88:91], a[132:135], v[104:107], v[88:91]
  v_exp_f32 v176, v176
  v_mfma_f32_16x16x32_bf16 v[88:91], a[136:139], v[136:139], v[88:91]
  ds_read_b128 a[176:179], v3 offset:20480
  ds_read_b64_tr_b16 a[196:197], v245 offset:0
  v_mfma_f32_16x16x32_bf16 v[88:91], a[140:143], v[168:171], v[88:91]
  v_exp_f32 v177, v177
  v_mfma_f32_16x16x32_bf16 v[92:95], a[128:131], v[76:79], v[216:219]
  ds_read_b128 a[180:183], v3 offset:21504
  v_cvt_pk_bf16_f32 v50, v176, v177
  v_mfma_f32_16x16x32_bf16 v[92:95], a[132:135], v[108:111], v[92:95]
  v_exp_f32 v178, v178
  v_mfma_f32_16x16x32_bf16 v[92:95], a[136:139], v[140:143], v[92:95]
  ds_read_b64_tr_b16 a[198:199], v245 offset:2048
  s_waitcnt lgkmcnt(10)
  v_mfma_f32_16x16x32_bf16 v[92:95], a[140:143], v[172:175], v[92:95]
  v_exp_f32 v179, v179
  v_mfma_f32_16x16x32_bf16 v[112:115], a[144:147], v[64:67], v[196:199]
  ds_read_b128 a[184:187], v3 offset:22528
  v_cvt_pk_bf16_f32 v51, v178, v179
  v_mfma_f32_16x16x32_bf16 v[112:115], a[148:151], v[96:99], v[112:115]
  v_exp_f32 v148, v148
  v_mfma_f32_16x16x32_bf16 v[112:115], a[152:155], v[128:131], v[112:115]
  ds_read_b128 a[188:191], v3 offset:23552
  ds_read_b64_tr_b16 a[200:201], v246 offset:0
  v_mfma_f32_16x16x32_bf16 v[112:115], a[156:159], v[160:163], v[112:115]
  v_exp_f32 v149, v149
  v_mfma_f32_16x16x32_bf16 v[116:119], a[144:147], v[68:71], v[204:207]
  ds_read_b64_tr_b16 a[202:203], v246 offset:2048
  v_cvt_pk_bf16_f32 v52, v148, v149
  v_mfma_f32_16x16x32_bf16 v[116:119], a[148:151], v[100:103], v[116:119]
  v_exp_f32 v150, v150
  v_mfma_f32_16x16x32_bf16 v[116:119], a[152:155], v[132:135], v[116:119]
  buffer_load_dwordx4 v1, s[12:15], s78 offen offset:1024 sc1 lds
  v_mfma_f32_16x16x32_bf16 v[116:119], a[156:159], v[164:167], v[116:119]
  v_mfma_f32_16x16x32_bf16 v[120:123], a[144:147], v[72:75], v[212:215]
  v_exp_f32 v151, v151
  v_mfma_f32_16x16x32_bf16 v[120:123], a[148:151], v[104:107], v[120:123]
  ds_read_b64_tr_b16 a[204:205], v247 offset:0
  v_cvt_pk_bf16_f32 v53, v150, v151
  v_mfma_f32_16x16x32_bf16 v[120:123], a[152:155], v[136:139], v[120:123]
  v_exp_f32 v180, v180
  v_mfma_f32_16x16x32_bf16 v[120:123], a[156:159], v[168:171], v[120:123]
  v_mfma_f32_16x16x32_bf16 v[124:127], a[144:147], v[76:79], v[220:223]
  v_exp_f32 v181, v181
  v_mfma_f32_16x16x32_bf16 v[124:127], a[148:151], v[108:111], v[124:127]
  v_cvt_pk_bf16_f32 v54, v180, v181
  s_waitcnt lgkmcnt(9)
  v_mfma_f32_16x16x32_bf16 v[124:127], a[152:155], v[140:143], v[124:127]
  v_exp_f32 v182, v182
  v_mfma_f32_16x16x32_bf16 v[124:127], a[156:159], v[172:175], v[124:127]
  ds_read_b64_tr_b16 a[206:207], v247 offset:2048
  v_mfma_f32_16x16x32_bf16 a[0:3], a[160:163], v[32:35], a[0:3]
  v_exp_f32 v183, v183
  v_mfma_f32_16x16x32_bf16 a[4:7], a[160:163], v[36:39], a[4:7]
  ds_read_b128 a[128:131], v2 offset:8192
  v_cvt_pk_bf16_f32 v55, v182, v183
  v_mfma_f32_16x16x32_bf16 a[8:11], a[160:163], v[40:43], a[8:11]
  v_exp_f32 v152, v152
  v_mfma_f32_16x16x32_bf16 a[12:15], a[160:163], v[44:47], a[12:15]
  ds_read_b128 a[132:135], v2 offset:9216
  ds_read_b64_tr_b16 a[208:209], v244 offset:4096
  v_mfma_f32_16x16x32_bf16 a[16:19], a[164:167], v[32:35], a[16:19]
  v_exp_f32 v153, v153
  v_mfma_f32_16x16x32_bf16 a[20:23], a[164:167], v[36:39], a[20:23]
  ds_read_b128 a[136:139], v2 offset:10240
  v_cvt_pk_bf16_f32 v56, v152, v153
  v_mfma_f32_16x16x32_bf16 a[24:27], a[164:167], v[40:43], a[24:27]
  v_exp_f32 v154, v154
  v_mfma_f32_16x16x32_bf16 a[28:31], a[164:167], v[44:47], a[28:31]
  ds_read_b64_tr_b16 a[210:211], v244 offset:6144
  ds_read_b64_tr_b16 a[212:213], v245 offset:4096
  v_mfma_f32_16x16x32_bf16 a[32:35], a[168:171], v[32:35], a[32:35]
  v_exp_f32 v155, v155
  v_mfma_f32_16x16x32_bf16 a[36:39], a[168:171], v[36:39], a[36:39]
  ds_read_b128 a[140:143], v2 offset:11264
  v_cvt_pk_bf16_f32 v57, v154, v155
  v_mfma_f32_16x16x32_bf16 a[40:43], a[168:171], v[40:43], a[40:43]
  v_exp_f32 v184, v184
  v_mfma_f32_16x16x32_bf16 a[44:47], a[168:171], v[44:47], a[44:47]
  ds_read_b128 a[144:147], v2 offset:12288
  ds_read_b64_tr_b16 a[214:215], v245 offset:6144
  v_mfma_f32_16x16x32_bf16 a[48:51], a[172:175], v[32:35], a[48:51]
  v_exp_f32 v185, v185
  v_mfma_f32_16x16x32_bf16 a[52:55], a[172:175], v[36:39], a[52:55]
  v_cvt_pk_bf16_f32 v58, v184, v185
  s_waitcnt lgkmcnt(13)
  v_mfma_f32_16x16x32_bf16 a[56:59], a[172:175], v[40:43], a[56:59]
  ds_read_b128 a[148:151], v2 offset:13312
  buffer_load_dwordx4 v1, s[12:15], s78 offen offset:2048 sc1 lds
  v_mfma_f32_16x16x32_bf16 a[60:63], a[172:175], v[44:47], a[60:63]
  v_exp_f32 v186, v186
  v_mfma_f32_16x16x32_bf16 a[64:67], a[176:179], v[32:35], a[64:67]
  ds_read_b128 a[152:155], v2 offset:14336
  ds_read_b64_tr_b16 a[216:217], v246 offset:4096
  v_mfma_f32_16x16x32_bf16 a[68:71], a[176:179], v[36:39], a[68:71]
  v_exp_f32 v187, v187
  v_mfma_f32_16x16x32_bf16 a[72:75], a[176:179], v[40:43], a[72:75]
  ds_read_b64_tr_b16 a[218:219], v246 offset:6144
  v_cvt_pk_bf16_f32 v59, v186, v187
  v_mfma_f32_16x16x32_bf16 a[76:79], a[176:179], v[44:47], a[76:79]
  v_exp_f32 v156, v156
  v_mfma_f32_16x16x32_bf16 a[80:83], a[180:183], v[32:35], a[80:83]
  ds_read_b128 a[156:159], v2 offset:15360
  buffer_load_dwordx4 v1, s[12:15], s78 offen offset:3072 sc1 lds
  v_mfma_f32_16x16x32_bf16 a[84:87], a[180:183], v[36:39], a[84:87]
  v_exp_f32 v157, v157
  v_mfma_f32_16x16x32_bf16 a[88:91], a[180:183], v[40:43], a[88:91]
  ds_read_b64_tr_b16 a[220:221], v247 offset:4096
  v_cvt_pk_bf16_f32 v60, v156, v157
  v_mfma_f32_16x16x32_bf16 a[92:95], a[180:183], v[44:47], a[92:95]
  v_exp_f32 v158, v158
  v_mfma_f32_16x16x32_bf16 a[96:99], a[184:187], v[32:35], a[96:99]
  s_sub_u32 s78, s78, 16384
  v_mfma_f32_16x16x32_bf16 a[100:103], a[184:187], v[36:39], a[100:103]
  v_exp_f32 v159, v159
  v_mfma_f32_16x16x32_bf16 a[104:107], a[184:187], v[40:43], a[104:107]
  ds_read_b64_tr_b16 a[222:223], v247 offset:6144
  v_cvt_pk_bf16_f32 v61, v158, v159
  v_mfma_f32_16x16x32_bf16 a[108:111], a[184:187], v[44:47], a[108:111]
  v_exp_f32 v188, v188
  v_mfma_f32_16x16x32_bf16 a[112:115], a[188:191], v[32:35], a[112:115]
  v_mfma_f32_16x16x32_bf16 a[116:119], a[188:191], v[36:39], a[116:119]
  v_exp_f32 v189, v189
  v_mfma_f32_16x16x32_bf16 a[120:123], a[188:191], v[40:43], a[120:123]
  v_cvt_pk_bf16_f32 v62, v188, v189
  v_mfma_f32_16x16x32_bf16 a[124:127], a[188:191], v[44:47], a[124:127]
  v_exp_f32 v190, v190
  v_mfma_f32_16x16x32_bf16 v[16:19], v[12:15], v[32:35], v[16:19]
  v_mfma_f32_16x16x32_bf16 v[20:23], v[12:15], v[36:39], v[20:23]
  v_exp_f32 v191, v191
  v_mfma_f32_16x16x32_bf16 v[24:27], v[12:15], v[40:43], v[24:27]
  v_cvt_pk_bf16_f32 v63, v190, v191
  v_mfma_f32_16x16x32_bf16 v[28:31], v[12:15], v[44:47], v[28:31]
  s_waitcnt lgkmcnt(9)
  v_mfma_f32_16x16x32_bf16 v[144:147], a[128:131], v[64:67], v[192:195]
  ds_read_b128 a[160:163], v3 offset:24576
  s_and_b32 m0, s78, 0x1ffff
  v_mfma_f32_16x16x32_bf16 v[144:147], a[132:135], v[96:99], v[144:147]
  s_waitcnt lgkmcnt(1)
  buffer_store_dwordx4 a[192:195], v1, s[8:11], s81 offen offset:0 sc1
  v_exp_f32 v80, v80
  v_mfma_f32_16x16x32_bf16 v[144:147], a[136:139], v[128:131], v[144:147]
  ds_read_b128 a[164:167], v3 offset:25600
  buffer_load_dwordx4 v1, s[12:15], s78 offen offset:0 sc1 lds
  v_mfma_f32_16x16x32_bf16 v[144:147], a[140:143], v[160:163], v[144:147]
  v_exp_f32 v81, v81
  v_mfma_f32_16x16x32_bf16 v[148:151], a[128:131], v[68:71], v[200:203]
  v_cvt_pk_bf16_f32 v32, v80, v81
  v_mfma_f32_16x16x32_bf16 v[148:151], a[132:135], v[100:103], v[148:151]
  v_exp_f32 v82, v82
  v_mfma_f32_16x16x32_bf16 v[148:151], a[136:139], v[132:135], v[148:151]
  ds_read_b128 a[168:171], v3 offset:26624
  v_mfma_f32_16x16x32_bf16 v[148:151], a[140:143], v[164:167], v[148:151]
  v_exp_f32 v83, v83
  v_mfma_f32_16x16x32_bf16 v[152:155], a[128:131], v[72:75], v[208:211]
  ds_read_b128 a[172:175], v3 offset:27648
  v_cvt_pk_bf16_f32 v33, v82, v83
  v_mfma_f32_16x16x32_bf16 v[152:155], a[132:135], v[104:107], v[152:155]
  v_exp_f32 v112, v112
  v_mfma_f32_16x16x32_bf16 v[152:155], a[136:139], v[136:139], v[152:155]
  ds_read_b128 a[176:179], v3 offset:28672
  buffer_store_dwordx4 a[196:199], v1, s[8:11], s81 offen offset:1024 sc1
  v_mfma_f32_16x16x32_bf16 v[152:155], a[140:143], v[168:171], v[152:155]
  v_exp_f32 v113, v113
  v_mfma_f32_16x16x32_bf16 v[156:159], a[128:131], v[76:79], v[216:219]
  ds_read_b128 a[180:183], v3 offset:29696
  v_cvt_pk_bf16_f32 v34, v112, v113
  v_mfma_f32_16x16x32_bf16 v[156:159], a[132:135], v[108:111], v[156:159]
  v_exp_f32 v114, v114
  v_mfma_f32_16x16x32_bf16 v[156:159], a[136:139], v[140:143], v[156:159]
  buffer_load_dwordx4 v1, s[12:15], s78 offen offset:1024 sc1 lds
  v_mfma_f32_16x16x32_bf16 v[156:159], a[140:143], v[172:175], v[156:159]
  v_exp_f32 v115, v115
  v_mfma_f32_16x16x32_bf16 v[176:179], a[144:147], v[64:67], v[196:199]
  ds_read_b128 a[184:187], v3 offset:30720
  v_cvt_pk_bf16_f32 v35, v114, v115
  v_mfma_f32_16x16x32_bf16 v[176:179], a[148:151], v[96:99], v[176:179]
  v_exp_f32 v84, v84
  v_mfma_f32_16x16x32_bf16 v[176:179], a[152:155], v[128:131], v[176:179]
  ds_read_b128 a[188:191], v3 offset:31744
  buffer_store_dwordx4 a[200:203], v1, s[8:11], s81 offen offset:2048 sc1
  v_mfma_f32_16x16x32_bf16 v[176:179], a[156:159], v[160:163], v[176:179]
  v_exp_f32 v85, v85
  v_mfma_f32_16x16x32_bf16 v[180:183], a[144:147], v[68:71], v[204:207]
  buffer_load_dwordx4 v1, s[12:15], s78 offen offset:2048 sc1 lds
  v_cvt_pk_bf16_f32 v36, v84, v85
  v_mfma_f32_16x16x32_bf16 v[180:183], a[148:151], v[100:103], v[180:183]
  v_exp_f32 v86, v86
  v_mfma_f32_16x16x32_bf16 v[180:183], a[152:155], v[132:135], v[180:183]
  v_mfma_f32_16x16x32_bf16 v[180:183], a[156:159], v[164:167], v[180:183]
  v_mfma_f32_16x16x32_bf16 v[184:187], a[144:147], v[72:75], v[212:215]
  v_exp_f32 v87, v87
  v_mfma_f32_16x16x32_bf16 v[184:187], a[148:151], v[104:107], v[184:187]
  buffer_store_dwordx4 a[204:207], v1, s[8:11], s81 offen offset:3072 sc1
  v_cvt_pk_bf16_f32 v37, v86, v87
  v_mfma_f32_16x16x32_bf16 v[184:187], a[152:155], v[136:139], v[184:187]
  v_exp_f32 v116, v116
  v_mfma_f32_16x16x32_bf16 v[184:187], a[156:159], v[168:171], v[184:187]
  v_mfma_f32_16x16x32_bf16 v[188:191], a[144:147], v[76:79], v[220:223]
  v_exp_f32 v117, v117
  v_mfma_f32_16x16x32_bf16 v[188:191], a[148:151], v[108:111], v[188:191]
  v_cvt_pk_bf16_f32 v38, v116, v117
  s_waitcnt lgkmcnt(4)
  v_mfma_f32_16x16x32_bf16 v[188:191], a[152:155], v[140:143], v[188:191]
  v_exp_f32 v118, v118
  v_mfma_f32_16x16x32_bf16 v[188:191], a[156:159], v[172:175], v[188:191]
  buffer_load_dwordx4 v1, s[12:15], s78 offen offset:3072 sc1 lds
  s_add_u32 s78, s78, 49152
  v_mfma_f32_16x16x32_bf16 a[0:3], a[160:163], v[48:51], a[0:3]
  v_exp_f32 v119, v119
  v_mfma_f32_16x16x32_bf16 a[4:7], a[160:163], v[52:55], a[4:7]
  buffer_store_dwordx4 a[208:211], v1, s[8:11], s20 offen offset:0 sc1
  v_cvt_pk_bf16_f32 v39, v118, v119
  v_mfma_f32_16x16x32_bf16 a[8:11], a[160:163], v[56:59], a[8:11]
  v_exp_f32 v88, v88
  v_mfma_f32_16x16x32_bf16 a[12:15], a[160:163], v[60:63], a[12:15]
  v_mov_b32 v3, v2
  v_add_u32 v2, 0x8000, v2
  v_mfma_f32_16x16x32_bf16 a[16:19], a[164:167], v[48:51], a[16:19]
  v_exp_f32 v89, v89
  v_mfma_f32_16x16x32_bf16 a[20:23], a[164:167], v[52:55], a[20:23]
  v_cvt_pk_bf16_f32 v40, v88, v89
  v_and_b32 v2, 0x1ffff, v2
  v_mfma_f32_16x16x32_bf16 a[24:27], a[164:167], v[56:59], a[24:27]
  v_exp_f32 v90, v90
  v_mfma_f32_16x16x32_bf16 a[28:31], a[164:167], v[60:63], a[28:31]
  s_waitcnt vmcnt(16) lgkmcnt(0)
  s_barrier
  v_mfma_f32_16x16x32_bf16 a[32:35], a[168:171], v[48:51], a[32:35]
  v_exp_f32 v91, v91
  v_mfma_f32_16x16x32_bf16 a[36:39], a[168:171], v[52:55], a[36:39]
  ds_read_b128 a[128:131], v2 offset:0
  v_cvt_pk_bf16_f32 v41, v90, v91
  v_mfma_f32_16x16x32_bf16 a[40:43], a[168:171], v[56:59], a[40:43]
  v_exp_f32 v120, v120
  v_mfma_f32_16x16x32_bf16 a[44:47], a[168:171], v[60:63], a[44:47]
  ds_read_b128 a[132:135], v2 offset:1024
  buffer_store_dwordx4 a[212:215], v1, s[8:11], s21 offen offset:0 sc1
  v_mfma_f32_16x16x32_bf16 a[48:51], a[172:175], v[48:51], a[48:51]
  v_exp_f32 v121, v121
  v_mfma_f32_16x16x32_bf16 a[52:55], a[172:175], v[52:55], a[52:55]
  ds_read_b128 a[136:139], v2 offset:2048
  v_cvt_pk_bf16_f32 v42, v120, v121
  v_mfma_f32_16x16x32_bf16 a[56:59], a[172:175], v[56:59], a[56:59]
  ds_read_b128 a[140:143], v2 offset:3072
  v_mfma_f32_16x16x32_bf16 a[60:63], a[172:175], v[60:63], a[60:63]
  v_exp_f32 v122, v122
  v_mfma_f32_16x16x32_bf16 a[64:67], a[176:179], v[48:51], a[64:67]
  ds_read_b128 a[144:147], v2 offset:4096
  v_mfma_f32_16x16x32_bf16 a[68:71], a[176:179], v[52:55], a[68:71]
  buffer_store_dwordx4 a[216:219], v1, s[8:11], s22 offen offset:0 sc1
  v_exp_f32 v123, v123
  v_mfma_f32_16x16x32_bf16 a[72:75], a[176:179], v[56:59], a[72:75]
  ds_read_b128 a[148:151], v2 offset:5120
  v_cvt_pk_bf16_f32 v43, v122, v123
  v_mfma_f32_16x16x32_bf16 a[76:79], a[176:179], v[60:63], a[76:79]
  v_exp_f32 v92, v92
  v_mfma_f32_16x16x32_bf16 a[80:83], a[180:183], v[48:51], a[80:83]
  ds_read_b128 a[152:155], v2 offset:6144
  v_mfma_f32_16x16x32_bf16 a[84:87], a[180:183], v[52:55], a[84:87]
  v_exp_f32 v93, v93
  v_mfma_f32_16x16x32_bf16 a[88:91], a[180:183], v[56:59], a[88:91]
  ds_read_b128 a[156:159], v2 offset:7168
  v_cvt_pk_bf16_f32 v44, v92, v93
  v_mfma_f32_16x16x32_bf16 a[92:95], a[180:183], v[60:63], a[92:95]
  v_exp_f32 v94, v94
  v_mfma_f32_16x16x32_bf16 a[96:99], a[184:187], v[48:51], a[96:99]
  v_mfma_f32_16x16x32_bf16 a[100:103], a[184:187], v[52:55], a[100:103]
  v_exp_f32 v95, v95
  v_mfma_f32_16x16x32_bf16 a[104:107], a[184:187], v[56:59], a[104:107]
  buffer_store_dwordx4 a[220:223], v1, s[8:11], s23 offen offset:0 sc1
  v_cvt_pk_bf16_f32 v45, v94, v95
  v_mfma_f32_16x16x32_bf16 a[108:111], a[184:187], v[60:63], a[108:111]
  v_exp_f32 v124, v124
  v_mfma_f32_16x16x32_bf16 a[112:115], a[188:191], v[48:51], a[112:115]
  v_mfma_f32_16x16x32_bf16 a[116:119], a[188:191], v[52:55], a[116:119]
  v_exp_f32 v125, v125
  v_mfma_f32_16x16x32_bf16 a[120:123], a[188:191], v[56:59], a[120:123]
  v_cvt_pk_bf16_f32 v46, v124, v125
  v_mfma_f32_16x16x32_bf16 a[124:127], a[188:191], v[60:63], a[124:127]
  v_exp_f32 v126, v126
  v_mfma_f32_16x16x32_bf16 v[16:19], v[12:15], v[48:51], v[16:19]
  v_mfma_f32_16x16x32_bf16 v[20:23], v[12:15], v[52:55], v[20:23]
  v_exp_f32 v127, v127
  v_mfma_f32_16x16x32_bf16 v[24:27], v[12:15], v[56:59], v[24:27]
  v_cvt_pk_bf16_f32 v47, v126, v127
  v_mfma_f32_16x16x32_bf16 v[28:31], v[12:15], v[60:63], v[28:31]
  s_waitcnt lgkmcnt(4)
  s_mov_b32 s86, 2
  s_branch Ldd_f_go
Ldd_f_pub:
  s_lshl_b32 s90, s2, 2
  s_add_u32 s90, s90, 39065600
  s_cmp_eq_u32 s3, 0
  s_cselect_b32 s90, s90, 0x7ff00000
  v_min_u32 v232, 1, v0
  v_lshlrev_b32 v232, 27, v232
  v_mov_b32 v233, 1
  buffer_store_dword v233, v232, s[8:11], s90 offen sc1
  s_mov_b32 s86, s0
  s_branch Ldd_f_go
Ldd_f_done:
  s_bitcmp1_b32 s3, 0
  s_cbranch_scc1 Lodd1_f
  s_cmp_eq_u32 s88, 0
  s_cbranch_scc1 Lt2s_f
  v_cndmask_b32 v208, v255, v208, s[24:25]
  v_cndmask_b32 v220, v255, v220, s[24:25]
  v_mov_b32 v212, v255
  v_cndmask_b32 v209, v255, v209, s[26:27]
  v_cndmask_b32 v221, v255, v221, s[26:27]
  v_mov_b32 v213, v255
  v_cndmask_b32 v210, v255, v210, s[32:33]
  v_cndmask_b32 v222, v255, v222, s[32:33]
  v_mov_b32 v214, v255
  v_cndmask_b32 v211, v255, v211, s[34:35]
  v_cndmask_b32 v223, v255, v223, s[34:35]
  v_mov_b32 v215, v255
  s_nop 1
  v_mfma_f32_16x16x32_bf16 v[80:83], a[128:131], v[64:67], v[192:195]
  ds_read_b128 a[160:163], v3 offset:16384
  s_and_b32 m0, s78, 0x1ffff
  v_mfma_f32_16x16x32_bf16 v[80:83], a[132:135], v[96:99], v[80:83]
  v_exp_f32 v144, v144
  v_mfma_f32_16x16x32_bf16 v[80:83], a[136:139], v[128:131], v[80:83]
  ds_read_b128 a[164:167], v3 offset:17408
  buffer_load_dwordx4 v1, s[12:15], s78 offen offset:0 sc1 lds
  v_mfma_f32_16x16x32_bf16 v[80:83], a[140:143], v[160:163], v[80:83]
  v_exp_f32 v145, v145
  v_mfma_f32_16x16x32_bf16 v[84:87], a[128:131], v[68:71], v[200:203]
  v_cvt_pk_bf16_f32 v48, v144, v145
  v_mfma_f32_16x16x32_bf16 v[84:87], a[132:135], v[100:103], v[84:87]
  v_exp_f32 v146, v146
  v_mfma_f32_16x16x32_bf16 v[84:87], a[136:139], v[132:135], v[84:87]
  ds_read_b128 a[168:171], v3 offset:18432
  v_mfma_f32_16x16x32_bf16 v[84:87], a[140:143], v[164:167], v[84:87]
  v_exp_f32 v147, v147
  v_mfma_f32_16x16x32_bf16 v[88:91], a[128:131], v[72:75], v[208:211]
  ds_read_b128 a[172:175], v3 offset:19456
  v_cvt_pk_bf16_f32 v49, v146, v147
  v_mfma_f32_16x16x32_bf16 v[88:91], a[132:135], v[104:107], v[88:91]
  v_exp_f32 v176, v176
  v_mfma_f32_16x16x32_bf16 v[88:91], a[136:139], v[136:139], v[88:91]
  ds_read_b128 a[176:179], v3 offset:20480
  v_mfma_f32_16x16x32_bf16 v[88:91], a[140:143], v[168:171], v[88:91]
  v_exp_f32 v177, v177
  v_mfma_f32_16x16x32_bf16 v[92:95], a[128:131], v[76:79], v[216:219]
  ds_read_b128 a[180:183], v3 offset:21504
  v_cvt_pk_bf16_f32 v50, v176, v177
  v_mfma_f32_16x16x32_bf16 v[92:95], a[132:135], v[108:111], v[92:95]
  v_exp_f32 v178, v178
  v_mfma_f32_16x16x32_bf16 v[92:95], a[136:139], v[140:143], v[92:95]
  s_waitcnt lgkmcnt(6)
  v_mfma_f32_16x16x32_bf16 v[92:95], a[140:143], v[172:175], v[92:95]
  v_exp_f32 v179, v179
  v_mfma_f32_16x16x32_bf16 v[112:115], a[144:147], v[64:67], v[196:199]
  ds_read_b128 a[184:187], v3 offset:22528
  v_cvt_pk_bf16_f32 v51, v178, v179
  v_mfma_f32_16x16x32_bf16 v[112:115], a[148:151], v[96:99], v[112:115]
  v_exp_f32 v148, v148
  v_mfma_f32_16x16x32_bf16 v[112:115], a[152:155], v[128:131], v[112:115]
  ds_read_b128 a[188:191], v3 offset:23552
  buffer_load_dwordx4 v1, s[12:15], s78 offen offset:1024 sc1 lds
  v_mfma_f32_16x16x32_bf16 v[112:115], a[156:159], v[160:163], v[112:115]
  v_exp_f32 v149, v149
  v_mfma_f32_16x16x32_bf16 v[116:119], a[144:147], v[68:71], v[204:207]
  v_cvt_pk_bf16_f32 v52, v148, v149
  v_mfma_f32_16x16x32_bf16 v[116:119], a[148:151], v[100:103], v[116:119]
  v_exp_f32 v150, v150
  v_mfma_f32_16x16x32_bf16 v[116:119], a[152:155], v[132:135], v[116:119]
  v_mfma_f32_16x16x32_bf16 v[116:119], a[156:159], v[164:167], v[116:119]
  v_mfma_f32_16x16x32_bf16 v[120:123], a[144:147], v[72:75], v[212:215]
  v_exp_f32 v151, v151
  v_mfma_f32_16x16x32_bf16 v[120:123], a[148:151], v[104:107], v[120:123]
  v_cvt_pk_bf16_f32 v53, v150, v151
  v_mfma_f32_16x16x32_bf16 v[120:123], a[152:155], v[136:139], v[120:123]
  v_exp_f32 v180, v180
  v_mfma_f32_16x16x32_bf16 v[120:123], a[156:159], v[168:171], v[120:123]
  v_mfma_f32_16x16x32_bf16 v[124:127], a[144:147], v[76:79], v[220:223]
  v_exp_f32 v181, v181
  v_mfma_f32_16x16x32_bf16 v[124:127], a[148:151], v[108:111], v[124:127]
  v_cvt_pk_bf16_f32 v54, v180, v181
  s_waitcnt lgkmcnt(4)
  v_mfma_f32_16x16x32_bf16 v[124:127], a[152:155], v[140:143], v[124:127]
  v_exp_f32 v182, v182
  v_mfma_f32_16x16x32_bf16 v[124:127], a[156:159], v[172:175], v[124:127]
  v_mfma_f32_16x16x32_bf16 a[0:3], a[160:163], v[32:35], a[0:3]
  v_exp_f32 v183, v183
  v_mfma_f32_16x16x32_bf16 a[4:7], a[160:163], v[36:39], a[4:7]
  ds_read_b128 a[128:131], v2 offset:8192
  v_cvt_pk_bf16_f32 v55, v182, v183
  v_mfma_f32_16x16x32_bf16 a[8:11], a[160:163], v[40:43], a[8:11]
  v_exp_f32 v152, v152
  v_mfma_f32_16x16x32_bf16 a[12:15], a[160:163], v[44:47], a[12:15]
  ds_read_b128 a[132:135], v2 offset:9216
  buffer_load_dwordx4 v1, s[12:15], s78 offen offset:2048 sc1 lds
  v_mfma_f32_16x16x32_bf16 a[16:19], a[164:167], v[32:35], a[16:19]
  v_exp_f32 v153, v153
  v_mfma_f32_16x16x32_bf16 a[20:23], a[164:167], v[36:39], a[20:23]
  ds_read_b128 a[136:139], v2 offset:10240
  v_cvt_pk_bf16_f32 v56, v152, v153
  v_mfma_f32_16x16x32_bf16 a[24:27], a[164:167], v[40:43], a[24:27]
  v_exp_f32 v154, v154
  v_mfma_f32_16x16x32_bf16 a[28:31], a[164:167], v[44:47], a[28:31]
  v_mfma_f32_16x16x32_bf16 a[32:35], a[168:171], v[32:35], a[32:35]
  v_exp_f32 v155, v155
  v_mfma_f32_16x16x32_bf16 a[36:39], a[168:171], v[36:39], a[36:39]
  ds_read_b128 a[140:143], v2 offset:11264
  v_cvt_pk_bf16_f32 v57, v154, v155
  v_mfma_f32_16x16x32_bf16 a[40:43], a[168:171], v[40:43], a[40:43]
  v_exp_f32 v184, v184
  v_mfma_f32_16x16x32_bf16 a[44:47], a[168:171], v[44:47], a[44:47]
  ds_read_b128 a[144:147], v2 offset:12288
  v_mfma_f32_16x16x32_bf16 a[48:51], a[172:175], v[32:35], a[48:51]
  v_exp_f32 v185, v185
  v_mfma_f32_16x16x32_bf16 a[52:55], a[172:175], v[36:39], a[52:55]
  v_cvt_pk_bf16_f32 v58, v184, v185
  s_waitcnt lgkmcnt(5)
  v_mfma_f32_16x16x32_bf16 a[56:59], a[172:175], v[40:43], a[56:59]
  ds_read_b128 a[148:151], v2 offset:13312
  v_mfma_f32_16x16x32_bf16 a[60:63], a[172:175], v[44:47], a[60:63]
  v_exp_f32 v186, v186
  v_mfma_f32_16x16x32_bf16 a[64:67], a[176:179], v[32:35], a[64:67]
  ds_read_b128 a[152:155], v2 offset:14336
  v_mfma_f32_16x16x32_bf16 a[68:71], a[176:179], v[36:39], a[68:71]
  v_exp_f32 v187, v187
  v_mfma_f32_16x16x32_bf16 a[72:75], a[176:179], v[40:43], a[72:75]
  buffer_load_dwordx4 v1, s[12:15], s78 offen offset:3072 sc1 lds
  v_cvt_pk_bf16_f32 v59, v186, v187
  v_mfma_f32_16x16x32_bf16 a[76:79], a[176:179], v[44:47], a[76:79]
  v_exp_f32 v156, v156
  v_mfma_f32_16x16x32_bf16 a[80:83], a[180:183], v[32:35], a[80:83]
  ds_read_b128 a[156:159], v2 offset:15360
  s_sub_u32 s78, s78, 16384
  v_mfma_f32_16x16x32_bf16 a[84:87], a[180:183], v[36:39], a[84:87]
  v_exp_f32 v157, v157
  v_mfma_f32_16x16x32_bf16 a[88:91], a[180:183], v[40:43], a[88:91]
  v_cvt_pk_bf16_f32 v60, v156, v157
  v_mfma_f32_16x16x32_bf16 a[92:95], a[180:183], v[44:47], a[92:95]
  v_exp_f32 v158, v158
  v_mfma_f32_16x16x32_bf16 a[96:99], a[184:187], v[32:35], a[96:99]
  v_mfma_f32_16x16x32_bf16 a[100:103], a[184:187], v[36:39], a[100:103]
  v_exp_f32 v159, v159
  v_mfma_f32_16x16x32_bf16 a[104:107], a[184:187], v[40:43], a[104:107]
  v_cvt_pk_bf16_f32 v61, v158, v159
  v_mfma_f32_16x16x32_bf16 a[108:111], a[184:187], v[44:47], a[108:111]
  v_exp_f32 v188, v188
  v_mfma_f32_16x16x32_bf16 a[112:115], a[188:191], v[32:35], a[112:115]
  v_mfma_f32_16x16x32_bf16 a[116:119], a[188:191], v[36:39], a[116:119]
  v_exp_f32 v189, v189
  v_mfma_f32_16x16x32_bf16 a[120:123], a[188:191], v[40:43], a[120:123]
  v_cvt_pk_bf16_f32 v62, v188, v189
  v_mfma_f32_16x16x32_bf16 a[124:127], a[188:191], v[44:47], a[124:127]
  v_exp_f32 v190, v190
  v_mfma_f32_16x16x32_bf16 v[16:19], v[12:15], v[32:35], v[16:19]
  v_mfma_f32_16x16x32_bf16 v[20:23], v[12:15], v[36:39], v[20:23]
  v_exp_f32 v191, v191
  v_mfma_f32_16x16x32_bf16 v[24:27], v[12:15], v[40:43], v[24:27]
  v_cvt_pk_bf16_f32 v63, v190, v191
  v_mfma_f32_16x16x32_bf16 v[28:31], v[12:15], v[44:47], v[28:31]
  s_waitcnt lgkmcnt(4)
  v_mfma_f32_16x16x32_bf16 v[144:147], a[128:131], v[64:67], v[192:195]
  ds_read_b128 a[160:163], v3 offset:24576
  s_and_b32 m0, s78, 0x1ffff
  v_mfma_f32_16x16x32_bf16 v[144:147], a[132:135], v[96:99], v[144:147]
  v_exp_f32 v80, v80
  v_mfma_f32_16x16x32_bf16 v[144:147], a[136:139], v[128:131], v[144:147]
  buffer_load_dwordx4 v1, s[12:15], s78 offen offset:0 sc1 lds
  v_exp_f32 v81, v81
  v_mfma_f32_16x16x32_bf16 v[144:147], a[140:143], v[160:163], v[144:147]
  ds_read_b128 a[164:167], v3 offset:25600
  v_cvt_pk_bf16_f32 v32, v80, v81
  v_mfma_f32_16x16x32_bf16 v[148:151], a[128:131], v[68:71], v[200:203]
  v_exp_f32 v82, v82
  v_mfma_f32_16x16x32_bf16 v[148:151], a[132:135], v[100:103], v[148:151]
  v_exp_f32 v83, v83
  s_waitcnt lgkmcnt(2)
  v_mfma_f32_16x16x32_bf16 v[148:151], a[136:139], v[132:135], v[148:151]
  buffer_load_dwordx4 v1, s[12:15], s78 offen offset:1024 sc1 lds
  v_cvt_pk_bf16_f32 v33, v82, v83
  v_mfma_f32_16x16x32_bf16 v[148:151], a[140:143], v[164:167], v[148:151]
  v_exp_f32 v112, v112
  v_mfma_f32_16x16x32_bf16 v[176:179], a[144:147], v[64:67], v[196:199]
  v_exp_f32 v113, v113
  v_mfma_f32_16x16x32_bf16 v[176:179], a[148:151], v[96:99], v[176:179]
  ds_read_b128 a[168:171], v3 offset:26624
  v_cvt_pk_bf16_f32 v34, v112, v113
  v_mfma_f32_16x16x32_bf16 v[176:179], a[152:155], v[128:131], v[176:179]
  buffer_load_dwordx4 v1, s[12:15], s78 offen offset:2048 sc1 lds
  v_exp_f32 v114, v114
  v_mfma_f32_16x16x32_bf16 v[176:179], a[156:159], v[160:163], v[176:179]
  ds_read_b128 a[172:175], v3 offset:27648
  ds_read_b128 a[176:179], v3 offset:28672
  ds_read_b128 a[180:183], v3 offset:29696
  v_mfma_f32_16x16x32_bf16 v[180:183], a[144:147], v[68:71], v[204:207]
  ds_read_b128 a[184:187], v3 offset:30720
  v_exp_f32 v115, v115
  v_mfma_f32_16x16x32_bf16 v[180:183], a[148:151], v[100:103], v[180:183]
  ds_read_b128 a[188:191], v3 offset:31744
  v_exp_f32 v84, v84
  v_mfma_f32_16x16x32_bf16 v[180:183], a[152:155], v[132:135], v[180:183]
  buffer_load_dwordx4 v1, s[12:15], s78 offen offset:3072 sc1 lds
  v_cvt_pk_bf16_f32 v35, v114, v115
  s_waitcnt lgkmcnt(4)
  v_mfma_f32_16x16x32_bf16 v[180:183], a[156:159], v[164:167], v[180:183]
  v_exp_f32 v85, v85
  v_mfma_f32_16x16x32_bf16 a[0:3], a[160:163], v[48:51], a[0:3]
  v_exp_f32 v86, v86
  v_mfma_f32_16x16x32_bf16 a[4:7], a[160:163], v[52:55], a[4:7]
  v_cvt_pk_bf16_f32 v36, v84, v85
  s_add_u32 s78, s78, 49152
  v_mfma_f32_16x16x32_bf16 a[8:11], a[160:163], v[56:59], a[8:11]
  v_exp_f32 v87, v87
  v_mfma_f32_16x16x32_bf16 a[12:15], a[160:163], v[60:63], a[12:15]
  v_cvt_pk_bf16_f32 v37, v86, v87
  v_mfma_f32_16x16x32_bf16 a[16:19], a[164:167], v[48:51], a[16:19]
  v_exp_f32 v116, v116
  v_mfma_f32_16x16x32_bf16 a[20:23], a[164:167], v[52:55], a[20:23]
  v_exp_f32 v117, v117
  v_mfma_f32_16x16x32_bf16 a[24:27], a[164:167], v[56:59], a[24:27]
  v_cvt_pk_bf16_f32 v38, v116, v117
  v_mfma_f32_16x16x32_bf16 a[28:31], a[164:167], v[60:63], a[28:31]
  v_exp_f32 v118, v118
  v_mfma_f32_16x16x32_bf16 a[32:35], a[168:171], v[48:51], a[32:35]
  v_exp_f32 v119, v119
  v_mfma_f32_16x16x32_bf16 a[36:39], a[168:171], v[52:55], a[36:39]
  v_cvt_pk_bf16_f32 v39, v118, v119
  v_mov_b32 v3, v2
  v_add_u32 v2, 0x8000, v2
  v_mfma_f32_16x16x32_bf16 a[40:43], a[168:171], v[56:59], a[40:43]
  v_exp_f32 v88, v88
  v_and_b32 v2, 0x1ffff, v2
  v_mfma_f32_16x16x32_bf16 a[44:47], a[168:171], v[60:63], a[44:47]
  s_waitcnt vmcnt(16) lgkmcnt(0)
  s_barrier
  v_mfma_f32_16x16x32_bf16 a[48:51], a[172:175], v[48:51], a[48:51]
  v_exp_f32 v89, v89
  v_mfma_f32_16x16x32_bf16 a[52:55], a[172:175], v[52:55], a[52:55]
  v_exp_f32 v90, v90
  v_mfma_f32_16x16x32_bf16 a[56:59], a[172:175], v[56:59], a[56:59]
  ds_read_b128 a[128:131], v2 offset:0
  v_cvt_pk_bf16_f32 v40, v88, v89
  v_mfma_f32_16x16x32_bf16 a[60:63], a[172:175], v[60:63], a[60:63]
  v_exp_f32 v91, v91
  v_mfma_f32_16x16x32_bf16 a[64:67], a[176:179], v[48:51], a[64:67]
  v_exp_f32 v120, v120
  v_mfma_f32_16x16x32_bf16 a[68:71], a[176:179], v[52:55], a[68:71]
  ds_read_b128 a[132:135], v2 offset:1024
  v_cvt_pk_bf16_f32 v41, v90, v91
  v_mfma_f32_16x16x32_bf16 a[72:75], a[176:179], v[56:59], a[72:75]
  v_exp_f32 v121, v121
  v_mfma_f32_16x16x32_bf16 a[76:79], a[176:179], v[60:63], a[76:79]
  ds_read_b128 a[136:139], v2 offset:2048
  v_cvt_pk_bf16_f32 v42, v120, v121
  v_mfma_f32_16x16x32_bf16 a[80:83], a[180:183], v[48:51], a[80:83]
  v_exp_f32 v122, v122
  v_mfma_f32_16x16x32_bf16 a[84:87], a[180:183], v[52:55], a[84:87]
  v_exp_f32 v123, v123
  v_mfma_f32_16x16x32_bf16 a[88:91], a[180:183], v[56:59], a[88:91]
  ds_read_b128 a[140:143], v2 offset:3072
  v_cvt_pk_bf16_f32 v43, v122, v123
  v_mfma_f32_16x16x32_bf16 a[92:95], a[180:183], v[60:63], a[92:95]
  v_exp_f32 v92, v92
  v_mfma_f32_16x16x32_bf16 a[96:99], a[184:187], v[48:51], a[96:99]
  v_exp_f32 v93, v93
  v_mfma_f32_16x16x32_bf16 a[100:103], a[184:187], v[52:55], a[100:103]
  ds_read_b128 a[144:147], v2 offset:4096
  v_cvt_pk_bf16_f32 v44, v92, v93
  v_mfma_f32_16x16x32_bf16 a[104:107], a[184:187], v[56:59], a[104:107]
  v_exp_f32 v94, v94
  v_mfma_f32_16x16x32_bf16 a[108:111], a[184:187], v[60:63], a[108:111]
  ds_read_b128 a[148:151], v2 offset:5120
  ds_read_b128 a[152:155], v2 offset:6144
  v_mfma_f32_16x16x32_bf16 a[112:115], a[188:191], v[48:51], a[112:115]
  v_exp_f32 v95, v95
  v_mfma_f32_16x16x32_bf16 a[116:119], a[188:191], v[52:55], a[116:119]
  v_exp_f32 v124, v124
  v_mfma_f32_16x16x32_bf16 a[120:123], a[188:191], v[56:59], a[120:123]
  ds_read_b128 a[156:159], v2 offset:7168
  v_cvt_pk_bf16_f32 v45, v94, v95
  v_mfma_f32_16x16x32_bf16 a[124:127], a[188:191], v[60:63], a[124:127]
  v_exp_f32 v125, v125
  v_mfma_f32_16x16x32_bf16 v[16:19], v[12:15], v[48:51], v[16:19]
  v_exp_f32 v126, v126
  v_mfma_f32_16x16x32_bf16 v[20:23], v[12:15], v[52:55], v[20:23]
  v_cvt_pk_bf16_f32 v46, v124, v125
  v_mfma_f32_16x16x32_bf16 v[24:27], v[12:15], v[56:59], v[24:27]
  v_exp_f32 v127, v127
  v_mfma_f32_16x16x32_bf16 v[28:31], v[12:15], v[60:63], v[28:31]
  v_cvt_pk_bf16_f32 v47, v126, v127
  s_waitcnt lgkmcnt(4)
Lt2s_f:
  v_mfma_f32_16x16x32_bf16 v[80:83], a[128:131], v[64:67], v[192:195]
  ds_read_b128 a[160:163], v3 offset:16384
  s_and_b32 m0, s78, 0x1ffff
  v_mfma_f32_16x16x32_bf16 v[80:83], a[132:135], v[96:99], v[80:83]
  v_exp_f32 v144, v144
  v_mfma_f32_16x16x32_bf16 v[80:83], a[136:139], v[128:131], v[80:83]
  buffer_load_dwordx4 v1, s[12:15], s78 offen offset:0 sc1 lds
  ds_read_b128 a[164:167], v3 offset:17408
  v_mfma_f32_16x16x32_bf16 v[80:83], a[140:143], v[160:163], v[80:83]
  ds_read_b128 a[168:171], v3 offset:18432
  ds_read_b128 a[172:175], v3 offset:19456
  v_mfma_f32_16x16x32_bf16 v[84:87], a[128:131], v[68:71], v[200:203]
  v_exp_f32 v145, v145
  v_mfma_f32_16x16x32_bf16 v[84:87], a[132:135], v[100:103], v[84:87]
  ds_read_b128 a[176:179], v3 offset:20480
  v_cvt_pk_bf16_f32 v48, v144, v145
  s_waitcnt lgkmcnt(5)
  v_mfma_f32_16x16x32_bf16 v[84:87], a[136:139], v[132:135], v[84:87]
  buffer_load_dwordx4 v1, s[12:15], s78 offen offset:1024 sc1 lds
  ds_read_b128 a[180:183], v3 offset:21504
  v_mfma_f32_16x16x32_bf16 v[84:87], a[140:143], v[164:167], v[84:87]
  v_exp_f32 v146, v146
  v_mfma_f32_16x16x32_bf16 v[112:115], a[144:147], v[64:67], v[196:199]
  ds_read_b128 a[184:187], v3 offset:22528
  ds_read_b128 a[188:191], v3 offset:23552
  v_mfma_f32_16x16x32_bf16 v[112:115], a[148:151], v[96:99], v[112:115]
  s_lshr_b32 s80, s2, 5
  s_lshl_b32 s82, s80, 19
  v_mfma_f32_16x16x32_bf16 v[112:115], a[152:155], v[128:131], v[112:115]
  buffer_load_dwordx4 v1, s[12:15], s78 offen offset:2048 sc1 lds
  v_exp_f32 v147, v147
  v_mfma_f32_16x16x32_bf16 v[112:115], a[156:159], v[160:163], v[112:115]
  v_cvt_pk_bf16_f32 v49, v146, v147
  s_lshl_b32 s76, s3, 17
  v_mfma_f32_16x16x32_bf16 v[116:119], a[144:147], v[68:71], v[204:207]
  s_add_u32 s82, s82, s76
  s_add_u32 s82, s82, 39845888
  v_mfma_f32_16x16x32_bf16 v[116:119], a[148:151], v[100:103], v[116:119]
  v_exp_f32 v176, v176
  v_mfma_f32_16x16x32_bf16 v[116:119], a[152:155], v[132:135], v[116:119]
  buffer_load_dwordx4 v1, s[12:15], s78 offen offset:3072 sc1 lds
  s_sub_u32 s78, s78, 16384
  v_mfma_f32_16x16x32_bf16 v[116:119], a[156:159], v[164:167], v[116:119]
  s_waitcnt lgkmcnt(4)
  s_lshl_b32 s81, s3, 13
  v_mfma_f32_16x16x32_bf16 a[0:3], a[160:163], v[32:35], a[0:3]
  v_exp_f32 v177, v177
  v_mfma_f32_16x16x32_bf16 a[4:7], a[160:163], v[36:39], a[4:7]
  ds_read_b128 a[128:131], v2 offset:8192
  v_cvt_pk_bf16_f32 v50, v176, v177
  v_mfma_f32_16x16x32_bf16 a[8:11], a[160:163], v[40:43], a[8:11]
  ds_read_b128 a[132:135], v2 offset:9216
  s_add_u32 s81, s81, 131072
  v_mfma_f32_16x16x32_bf16 a[12:15], a[160:163], v[44:47], a[12:15]
  s_mov_b32 s16, s92
  s_mov_b32 s17, s93
  v_mfma_f32_16x16x32_bf16 a[16:19], a[164:167], v[32:35], a[16:19]
  v_exp_f32 v178, v178
  v_mfma_f32_16x16x32_bf16 a[20:23], a[164:167], v[36:39], a[20:23]
  ds_read_b128 a[136:139], v2 offset:10240
  s_mov_b32 s18, 0x200000
  v_mfma_f32_16x16x32_bf16 a[24:27], a[164:167], v[40:43], a[24:27]
  s_mov_b32 s19, 0x20000
  s_and_b32 s79, s2, 7
  v_mfma_f32_16x16x32_bf16 a[28:31], a[164:167], v[44:47], a[28:31]
  v_exp_f32 v179, v179
  v_mfma_f32_16x16x32_bf16 a[32:35], a[168:171], v[32:35], a[32:35]
  ds_read_b128 a[140:143], v2 offset:11264
  v_cvt_pk_bf16_f32 v51, v178, v179
  v_mfma_f32_16x16x32_bf16 a[36:39], a[168:171], v[36:39], a[36:39]
  s_lshl_b32 s79, s79, 2
  s_bfe_u32 s76, s2, 0x20003
  v_mfma_f32_16x16x32_bf16 a[40:43], a[168:171], v[40:43], a[40:43]
  v_exp_f32 v148, v148
  v_mfma_f32_16x16x32_bf16 a[44:47], a[168:171], v[44:47], a[44:47]
  ds_read_b128 a[144:147], v2 offset:12288
  s_add_u32 s79, s79, s76
  v_mfma_f32_16x16x32_bf16 a[48:51], a[172:175], v[32:35], a[48:51]
  s_lshl_b32 s79, s79, 2
  s_add_u32 s79, s79, s3
  v_mfma_f32_16x16x32_bf16 a[52:55], a[172:175], v[36:39], a[52:55]
  v_exp_f32 v149, v149
  v_mfma_f32_16x16x32_bf16 a[56:59], a[172:175], v[40:43], a[56:59]
  v_cvt_pk_bf16_f32 v52, v148, v149
  s_waitcnt lgkmcnt(5)
  v_mfma_f32_16x16x32_bf16 a[60:63], a[172:175], v[44:47], a[60:63]
  ds_read_b128 a[148:151], v2 offset:13312
  s_lshl_b32 s79, s79, 14
  v_mfma_f32_16x16x32_bf16 a[64:67], a[176:179], v[32:35], a[64:67]
  v_exp_f32 v150, v150
  v_mfma_f32_16x16x32_bf16 a[68:71], a[176:179], v[36:39], a[68:71]
  ds_read_b128 a[152:155], v2 offset:14336
  s_lshl_b32 s76, s80, 7
  v_mfma_f32_16x16x32_bf16 a[72:75], a[176:179], v[40:43], a[72:75]
  s_add_u32 s79, s79, s76
  s_mul_i32 s83, s5, 12288
  v_mfma_f32_16x16x32_bf16 a[76:79], a[176:179], v[44:47], a[76:79]
  ds_read_b128 a[156:159], v2 offset:15360
  s_lshl_b32 s76, s80, 8
  v_mfma_f32_16x16x32_bf16 a[80:83], a[180:183], v[32:35], a[80:83]
  v_exp_f32 v151, v151
  v_mfma_f32_16x16x32_bf16 a[84:87], a[180:183], v[36:39], a[84:87]
  v_cvt_pk_bf16_f32 v53, v150, v151
  s_add_u32 s83, s83, s76
  v_mfma_f32_16x16x32_bf16 a[88:91], a[180:183], v[40:43], a[88:91]
  s_add_u32 s83, s83, 38866944
  v_lshrrev_b32 v237, 4, v0
  v_mfma_f32_16x16x32_bf16 a[92:95], a[180:183], v[44:47], a[92:95]
  v_exp_f32 v180, v180
  v_mfma_f32_16x16x32_bf16 a[96:99], a[184:187], v[32:35], a[96:99]
  v_and_b32 v236, 15, v0
  v_lshlrev_b32 v236, 10, v236
  v_mfma_f32_16x16x32_bf16 a[100:103], a[184:187], v[36:39], a[100:103]
  v_lshl_add_u32 v236, v237, 3, v236
  v_lshlrev_b32 v237, 2, v0
  v_mfma_f32_16x16x32_bf16 a[104:107], a[184:187], v[40:43], a[104:107]
  v_exp_f32 v181, v181
  v_mfma_f32_16x16x32_bf16 a[108:111], a[184:187], v[44:47], a[108:111]
  v_cvt_pk_bf16_f32 v54, v180, v181
  v_mfma_f32_16x16x32_bf16 a[112:115], a[188:191], v[32:35], a[112:115]
  v_mfma_f32_16x16x32_bf16 a[116:119], a[188:191], v[36:39], a[116:119]
  v_exp_f32 v182, v182
  v_mfma_f32_16x16x32_bf16 a[120:123], a[188:191], v[40:43], a[120:123]
  v_mfma_f32_16x16x32_bf16 a[124:127], a[188:191], v[44:47], a[124:127]
  v_mfma_f32_16x16x32_bf16 v[16:19], v[12:15], v[32:35], v[16:19]
  v_exp_f32 v183, v183
  v_mfma_f32_16x16x32_bf16 v[20:23], v[12:15], v[36:39], v[20:23]
  v_cvt_pk_bf16_f32 v55, v182, v183
  v_mfma_f32_16x16x32_bf16 v[24:27], v[12:15], v[40:43], v[24:27]
  v_mfma_f32_16x16x32_bf16 v[28:31], v[12:15], v[44:47], v[28:31]
  s_waitcnt lgkmcnt(4)
  v_mfma_f32_16x16x32_bf16 v[144:147], a[128:131], v[64:67], v[192:195]
  ds_read_b128 a[160:163], v3 offset:24576
  s_and_b32 m0, s78, 0x1ffff
  v_mfma_f32_16x16x32_bf16 v[144:147], a[132:135], v[96:99], v[144:147]
  v_exp_f32 v80, v80
  v_mfma_f32_16x16x32_bf16 v[144:147], a[136:139], v[128:131], v[144:147]
  buffer_load_dwordx4 v1, s[12:15], s78 offen offset:0 sc1 lds
  ds_read_b128 a[164:167], v3 offset:25600
  v_mfma_f32_16x16x32_bf16 v[144:147], a[140:143], v[160:163], v[144:147]
  v_exp_f32 v81, v81
  v_mfma_f32_16x16x32_bf16 v[148:151], a[128:131], v[68:71], v[200:203]
  ds_read_b128 a[168:171], v3 offset:26624
  v_cvt_pk_bf16_f32 v32, v80, v81
  v_mfma_f32_16x16x32_bf16 v[148:151], a[132:135], v[100:103], v[148:151]
  v_exp_f32 v82, v82
  s_waitcnt lgkmcnt(3)
  v_mfma_f32_16x16x32_bf16 v[148:151], a[136:139], v[132:135], v[148:151]
  buffer_load_dwordx4 v1, s[12:15], s78 offen offset:1024 sc1 lds
  ds_read_b128 a[172:175], v3 offset:27648
  v_mfma_f32_16x16x32_bf16 v[148:151], a[140:143], v[164:167], v[148:151]
  v_exp_f32 v83, v83
  v_mfma_f32_16x16x32_bf16 v[176:179], a[144:147], v[64:67], v[196:199]
  ds_read_b128 a[176:179], v3 offset:28672
  v_cvt_pk_bf16_f32 v33, v82, v83
  v_mfma_f32_16x16x32_bf16 v[176:179], a[148:151], v[96:99], v[176:179]
  v_exp_f32 v112, v112
  v_mfma_f32_16x16x32_bf16 v[176:179], a[152:155], v[128:131], v[176:179]
  buffer_load_dwordx4 v1, s[12:15], s78 offen offset:2048 sc1 lds
  ds_read_b128 a[180:183], v3 offset:29696
  v_mfma_f32_16x16x32_bf16 v[176:179], a[156:159], v[160:163], v[176:179]
  v_exp_f32 v113, v113
  v_mfma_f32_16x16x32_bf16 v[180:183], a[144:147], v[68:71], v[204:207]
  ds_read_b128 a[184:187], v3 offset:30720
  ds_read_b128 a[188:191], v3 offset:31744
  v_cvt_pk_bf16_f32 v34, v112, v113
  v_mfma_f32_16x16x32_bf16 v[180:183], a[148:151], v[100:103], v[180:183]
  v_exp_f32 v114, v114
  s_waitcnt lgkmcnt(4)
  v_mfma_f32_16x16x32_bf16 v[180:183], a[152:155], v[132:135], v[180:183]
  buffer_load_dwordx4 v1, s[12:15], s78 offen offset:3072 sc1 lds
  s_add_u32 s78, s78, 49152
  v_mfma_f32_16x16x32_bf16 v[180:183], a[156:159], v[164:167], v[180:183]
  v_exp_f32 v115, v115
  v_mfma_f32_16x16x32_bf16 a[0:3], a[160:163], v[48:51], a[0:3]
  v_cvt_pk_bf16_f32 v35, v114, v115
  v_mov_b32 v3, v2
  v_add_u32 v2, 0x8000, v2
  v_mfma_f32_16x16x32_bf16 a[4:7], a[160:163], v[52:55], a[4:7]
  v_exp_f32 v84, v84
  v_and_b32 v2, 0x1ffff, v2
  v_mfma_f32_16x16x32_bf16 a[16:19], a[164:167], v[48:51], a[16:19]
  s_waitcnt vmcnt(16) lgkmcnt(0)
  s_barrier
  v_mfma_f32_16x16x32_bf16 a[20:23], a[164:167], v[52:55], a[20:23]
  v_exp_f32 v85, v85
  v_mfma_f32_16x16x32_bf16 a[32:35], a[168:171], v[48:51], a[32:35]
  ds_read_b128 a[128:131], v2 offset:0
  v_cvt_pk_bf16_f32 v36, v84, v85
  v_mfma_f32_16x16x32_bf16 a[36:39], a[168:171], v[52:55], a[36:39]
  v_exp_f32 v86, v86
  v_mfma_f32_16x16x32_bf16 a[48:51], a[172:175], v[48:51], a[48:51]
  ds_read_b128 a[132:135], v2 offset:1024
  ds_read_b128 a[136:139], v2 offset:2048
  v_mfma_f32_16x16x32_bf16 a[52:55], a[172:175], v[52:55], a[52:55]
  v_exp_f32 v87, v87
  v_mfma_f32_16x16x32_bf16 a[64:67], a[176:179], v[48:51], a[64:67]
  ds_read_b128 a[140:143], v2 offset:3072
  v_cvt_pk_bf16_f32 v37, v86, v87
  v_mfma_f32_16x16x32_bf16 a[68:71], a[176:179], v[52:55], a[68:71]
  v_exp_f32 v116, v116
  v_mfma_f32_16x16x32_bf16 a[80:83], a[180:183], v[48:51], a[80:83]
  ds_read_b128 a[144:147], v2 offset:4096
  ds_read_b128 a[148:151], v2 offset:5120
  v_mfma_f32_16x16x32_bf16 a[84:87], a[180:183], v[52:55], a[84:87]
  v_exp_f32 v117, v117
  v_mfma_f32_16x16x32_bf16 a[96:99], a[184:187], v[48:51], a[96:99]
  ds_read_b128 a[152:155], v2 offset:6144
  v_cvt_pk_bf16_f32 v38, v116, v117
  v_mfma_f32_16x16x32_bf16 a[100:103], a[184:187], v[52:55], a[100:103]
  v_exp_f32 v118, v118
  v_mfma_f32_16x16x32_bf16 a[112:115], a[188:191], v[48:51], a[112:115]
  ds_read_b128 a[156:159], v2 offset:7168
  v_mfma_f32_16x16x32_bf16 a[116:119], a[188:191], v[52:55], a[116:119]
  v_exp_f32 v119, v119
  v_mfma_f32_16x16x32_bf16 v[16:19], v[12:15], v[48:51], v[16:19]
  v_cvt_pk_bf16_f32 v39, v118, v119
  v_mfma_f32_16x16x32_bf16 v[20:23], v[12:15], v[52:55], v[20:23]
  s_waitcnt lgkmcnt(4)
  s_branch Lss_entry_f
Lodd1_f:
  s_cmp_eq_u32 s88, 1
  s_cbranch_scc1 Lt12_f
  v_mfma_f32_16x16x32_bf16 v[80:83], a[128:131], v[64:67], v[192:195]
  ds_read_b128 a[160:163], v3 offset:16384
  s_and_b32 m0, s78, 0x1ffff
  v_mfma_f32_16x16x32_bf16 v[80:83], a[132:135], v[96:99], v[80:83]
  v_exp_f32 v144, v144
  v_mfma_f32_16x16x32_bf16 v[80:83], a[136:139], v[128:131], v[80:83]
  ds_read_b128 a[164:167], v3 offset:17408
  buffer_load_dwordx4 v1, s[12:15], s78 offen offset:0 sc1 lds
  v_mfma_f32_16x16x32_bf16 v[80:83], a[140:143], v[160:163], v[80:83]
  v_exp_f32 v145, v145
  v_mfma_f32_16x16x32_bf16 v[84:87], a[128:131], v[68:71], v[200:203]
  v_cvt_pk_bf16_f32 v48, v144, v145
  v_mfma_f32_16x16x32_bf16 v[84:87], a[132:135], v[100:103], v[84:87]
  v_exp_f32 v146, v146
  v_mfma_f32_16x16x32_bf16 v[84:87], a[136:139], v[132:135], v[84:87]
  ds_read_b128 a[168:171], v3 offset:18432
  v_mfma_f32_16x16x32_bf16 v[84:87], a[140:143], v[164:167], v[84:87]
  v_exp_f32 v147, v147
  v_mfma_f32_16x16x32_bf16 v[88:91], a[128:131], v[72:75], v[208:211]
  ds_read_b128 a[172:175], v3 offset:19456
  v_cvt_pk_bf16_f32 v49, v146, v147
  v_mfma_f32_16x16x32_bf16 v[88:91], a[132:135], v[104:107], v[88:91]
  v_exp_f32 v176, v176
  v_mfma_f32_16x16x32_bf16 v[88:91], a[136:139], v[136:139], v[88:91]
  ds_read_b128 a[176:179], v3 offset:20480
  v_mfma_f32_16x16x32_bf16 v[88:91], a[140:143], v[168:171], v[88:91]
  v_exp_f32 v177, v177
  v_mfma_f32_16x16x32_bf16 v[92:95], a[128:131], v[76:79], v[216:219]
  ds_read_b128 a[180:183], v3 offset:21504
  v_cvt_pk_bf16_f32 v50, v176, v177
  v_mfma_f32_16x16x32_bf16 v[92:95], a[132:135], v[108:111], v[92:95]
  v_exp_f32 v178, v178
  v_mfma_f32_16x16x32_bf16 v[92:95], a[136:139], v[140:143], v[92:95]
  s_waitcnt lgkmcnt(6)
  v_mfma_f32_16x16x32_bf16 v[92:95], a[140:143], v[172:175], v[92:95]
  v_exp_f32 v179, v179
  v_mfma_f32_16x16x32_bf16 v[112:115], a[144:147], v[64:67], v[196:199]
  ds_read_b128 a[184:187], v3 offset:22528
  v_cvt_pk_bf16_f32 v51, v178, v179
  v_mfma_f32_16x16x32_bf16 v[112:115], a[148:151], v[96:99], v[112:115]
  v_exp_f32 v148, v148
  v_mfma_f32_16x16x32_bf16 v[112:115], a[152:155], v[128:131], v[112:115]
  ds_read_b128 a[188:191], v3 offset:23552
  buffer_load_dwordx4 v1, s[12:15], s78 offen offset:1024 sc1 lds
  v_mfma_f32_16x16x32_bf16 v[112:115], a[156:159], v[160:163], v[112:115]
  v_exp_f32 v149, v149
  v_mfma_f32_16x16x32_bf16 v[116:119], a[144:147], v[68:71], v[204:207]
  v_cvt_pk_bf16_f32 v52, v148, v149
  v_mfma_f32_16x16x32_bf16 v[116:119], a[148:151], v[100:103], v[116:119]
  v_exp_f32 v150, v150
  v_mfma_f32_16x16x32_bf16 v[116:119], a[152:155], v[132:135], v[116:119]
  v_mfma_f32_16x16x32_bf16 v[116:119], a[156:159], v[164:167], v[116:119]
  v_mfma_f32_16x16x32_bf16 v[120:123], a[144:147], v[72:75], v[212:215]
  v_exp_f32 v151, v151
  v_mfma_f32_16x16x32_bf16 v[120:123], a[148:151], v[104:107], v[120:123]
  v_cvt_pk_bf16_f32 v53, v150, v151
  v_mfma_f32_16x16x32_bf16 v[120:123], a[152:155], v[136:139], v[120:123]
  v_exp_f32 v180, v180
  v_mfma_f32_16x16x32_bf16 v[120:123], a[156:159], v[168:171], v[120:123]
  v_mfma_f32_16x16x32_bf16 v[124:127], a[144:147], v[76:79], v[220:223]
  v_exp_f32 v181, v181
  v_mfma_f32_16x16x32_bf16 v[124:127], a[148:151], v[108:111], v[124:127]
  v_cvt_pk_bf16_f32 v54, v180, v181
  s_waitcnt lgkmcnt(4)
  v_mfma_f32_16x16x32_bf16 v[124:127], a[152:155], v[140:143], v[124:127]
  v_exp_f32 v182, v182
  v_mfma_f32_16x16x32_bf16 v[124:127], a[156:159], v[172:175], v[124:127]
  v_mfma_f32_16x16x32_bf16 a[0:3], a[160:163], v[32:35], a[0:3]
  v_exp_f32 v183, v183
  v_mfma_f32_16x16x32_bf16 a[4:7], a[160:163], v[36:39], a[4:7]
  ds_read_b128 a[128:131], v2 offset:8192
  v_cvt_pk_bf16_f32 v55, v182, v183
  v_mfma_f32_16x16x32_bf16 a[8:11], a[160:163], v[40:43], a[8:11]
  v_exp_f32 v152, v152
  v_mfma_f32_16x16x32_bf16 a[12:15], a[160:163], v[44:47], a[12:15]
  ds_read_b128 a[132:135], v2 offset:9216
  buffer_load_dwordx4 v1, s[12:15], s78 offen offset:2048 sc1 lds
  v_mfma_f32_16x16x32_bf16 a[16:19], a[164:167], v[32:35], a[16:19]
  v_exp_f32 v153, v153
  v_mfma_f32_16x16x32_bf16 a[20:23], a[164:167], v[36:39], a[20:23]
  ds_read_b128 a[136:139], v2 offset:10240
  v_cvt_pk_bf16_f32 v56, v152, v153
  v_mfma_f32_16x16x32_bf16 a[24:27], a[164:167], v[40:43], a[24:27]
  v_exp_f32 v154, v154
  v_mfma_f32_16x16x32_bf16 a[28:31], a[164:167], v[44:47], a[28:31]
  v_mfma_f32_16x16x32_bf16 a[32:35], a[168:171], v[32:35], a[32:35]
  v_exp_f32 v155, v155
  v_mfma_f32_16x16x32_bf16 a[36:39], a[168:171], v[36:39], a[36:39]
  ds_read_b128 a[140:143], v2 offset:11264
  v_cvt_pk_bf16_f32 v57, v154, v155
  v_mfma_f32_16x16x32_bf16 a[40:43], a[168:171], v[40:43], a[40:43]
  v_exp_f32 v184, v184
  v_mfma_f32_16x16x32_bf16 a[44:47], a[168:171], v[44:47], a[44:47]
  ds_read_b128 a[144:147], v2 offset:12288
  v_mfma_f32_16x16x32_bf16 a[48:51], a[172:175], v[32:35], a[48:51]
  v_exp_f32 v185, v185
  v_mfma_f32_16x16x32_bf16 a[52:55], a[172:175], v[36:39], a[52:55]
  v_cvt_pk_bf16_f32 v58, v184, v185
  s_waitcnt lgkmcnt(5)
  v_mfma_f32_16x16x32_bf16 a[56:59], a[172:175], v[40:43], a[56:59]
  ds_read_b128 a[148:151], v2 offset:13312
  v_mfma_f32_16x16x32_bf16 a[60:63], a[172:175], v[44:47], a[60:63]
  v_exp_f32 v186, v186
  v_mfma_f32_16x16x32_bf16 a[64:67], a[176:179], v[32:35], a[64:67]
  ds_read_b128 a[152:155], v2 offset:14336
  v_mfma_f32_16x16x32_bf16 a[68:71], a[176:179], v[36:39], a[68:71]
  v_exp_f32 v187, v187
  v_mfma_f32_16x16x32_bf16 a[72:75], a[176:179], v[40:43], a[72:75]
  buffer_load_dwordx4 v1, s[12:15], s78 offen offset:3072 sc1 lds
  v_cvt_pk_bf16_f32 v59, v186, v187
  v_mfma_f32_16x16x32_bf16 a[76:79], a[176:179], v[44:47], a[76:79]
  v_exp_f32 v156, v156
  v_mfma_f32_16x16x32_bf16 a[80:83], a[180:183], v[32:35], a[80:83]
  ds_read_b128 a[156:159], v2 offset:15360
  s_sub_u32 s78, s78, 16384
  v_mfma_f32_16x16x32_bf16 a[84:87], a[180:183], v[36:39], a[84:87]
  v_exp_f32 v157, v157
  v_mfma_f32_16x16x32_bf16 a[88:91], a[180:183], v[40:43], a[88:91]
  v_cvt_pk_bf16_f32 v60, v156, v157
  v_mfma_f32_16x16x32_bf16 a[92:95], a[180:183], v[44:47], a[92:95]
  v_exp_f32 v158, v158
  v_mfma_f32_16x16x32_bf16 a[96:99], a[184:187], v[32:35], a[96:99]
  v_mfma_f32_16x16x32_bf16 a[100:103], a[184:187], v[36:39], a[100:103]
  v_exp_f32 v159, v159
  v_mfma_f32_16x16x32_bf16 a[104:107], a[184:187], v[40:43], a[104:107]
  v_cvt_pk_bf16_f32 v61, v158, v159
  v_mfma_f32_16x16x32_bf16 a[108:111], a[184:187], v[44:47], a[108:111]
  v_exp_f32 v188, v188
  v_mfma_f32_16x16x32_bf16 a[112:115], a[188:191], v[32:35], a[112:115]
  v_mfma_f32_16x16x32_bf16 a[116:119], a[188:191], v[36:39], a[116:119]
  v_exp_f32 v189, v189
  v_mfma_f32_16x16x32_bf16 a[120:123], a[188:191], v[40:43], a[120:123]
  v_cvt_pk_bf16_f32 v62, v188, v189
  v_mfma_f32_16x16x32_bf16 a[124:127], a[188:191], v[44:47], a[124:127]
  v_exp_f32 v190, v190
  v_mfma_f32_16x16x32_bf16 v[16:19], v[12:15], v[32:35], v[16:19]
  v_mfma_f32_16x16x32_bf16 v[20:23], v[12:15], v[36:39], v[20:23]
  v_exp_f32 v191, v191
  v_mfma_f32_16x16x32_bf16 v[24:27], v[12:15], v[40:43], v[24:27]
  v_cvt_pk_bf16_f32 v63, v190, v191
  v_mfma_f32_16x16x32_bf16 v[28:31], v[12:15], v[44:47], v[28:31]
  s_waitcnt lgkmcnt(4)
  v_cndmask_b32 v208, v255, v208, s[24:25]
  v_cndmask_b32 v220, v255, v220, s[24:25]
  v_mov_b32 v212, v255
  v_cndmask_b32 v209, v255, v209, s[26:27]
  v_cndmask_b32 v221, v255, v221, s[26:27]
  v_mov_b32 v213, v255
  v_cndmask_b32 v210, v255, v210, s[32:33]
  v_cndmask_b32 v222, v255, v222, s[32:33]
  v_mov_b32 v214, v255
  v_cndmask_b32 v211, v255, v211, s[34:35]
  v_cndmask_b32 v223, v255, v223, s[34:35]
  v_mov_b32 v215, v255
  s_nop 0
  v_mfma_f32_16x16x32_bf16 v[144:147], a[128:131], v[64:67], v[192:195]
  ds_read_b128 a[160:163], v3 offset:24576
  s_and_b32 m0, s78, 0x1ffff
  v_mfma_f32_16x16x32_bf16 v[144:147], a[132:135], v[96:99], v[144:147]
  v_exp_f32 v80, v80
  v_mfma_f32_16x16x32_bf16 v[144:147], a[136:139], v[128:131], v[144:147]
  ds_read_b128 a[164:167], v3 offset:25600
  buffer_load_dwordx4 v1, s[12:15], s78 offen offset:0 sc1 lds
  v_mfma_f32_16x16x32_bf16 v[144:147], a[140:143], v[160:163], v[144:147]
  v_exp_f32 v81, v81
  v_mfma_f32_16x16x32_bf16 v[148:151], a[128:131], v[68:71], v[200:203]
  v_cvt_pk_bf16_f32 v32, v80, v81
  v_mfma_f32_16x16x32_bf16 v[148:151], a[132:135], v[100:103], v[148:151]
  v_exp_f32 v82, v82
  v_mfma_f32_16x16x32_bf16 v[148:151], a[136:139], v[132:135], v[148:151]
  ds_read_b128 a[168:171], v3 offset:26624
  v_mfma_f32_16x16x32_bf16 v[148:151], a[140:143], v[164:167], v[148:151]
  v_exp_f32 v83, v83
  v_mfma_f32_16x16x32_bf16 v[152:155], a[128:131], v[72:75], v[208:211]
  ds_read_b128 a[172:175], v3 offset:27648
  v_cvt_pk_bf16_f32 v33, v82, v83
  v_mfma_f32_16x16x32_bf16 v[152:155], a[132:135], v[104:107], v[152:155]
  v_exp_f32 v112, v112
  v_mfma_f32_16x16x32_bf16 v[152:155], a[136:139], v[136:139], v[152:155]
  ds_read_b128 a[176:179], v3 offset:28672
  v_mfma_f32_16x16x32_bf16 v[152:155], a[140:143], v[168:171], v[152:155]
  v_exp_f32 v113, v113
  v_mfma_f32_16x16x32_bf16 v[156:159], a[128:131], v[76:79], v[216:219]
  ds_read_b128 a[180:183], v3 offset:29696
  v_cvt_pk_bf16_f32 v34, v112, v113
  v_mfma_f32_16x16x32_bf16 v[156:159], a[132:135], v[108:111], v[156:159]
  v_exp_f32 v114, v114
  v_mfma_f32_16x16x32_bf16 v[156:159], a[136:139], v[140:143], v[156:159]
  buffer_load_dwordx4 v1, s[12:15], s78 offen offset:1024 sc1 lds
  s_waitcnt lgkmcnt(6)
  v_mfma_f32_16x16x32_bf16 v[156:159], a[140:143], v[172:175], v[156:159]
  v_exp_f32 v115, v115
  v_mfma_f32_16x16x32_bf16 v[176:179], a[144:147], v[64:67], v[196:199]
  ds_read_b128 a[184:187], v3 offset:30720
  v_cvt_pk_bf16_f32 v35, v114, v115
  v_mfma_f32_16x16x32_bf16 v[176:179], a[148:151], v[96:99], v[176:179]
  v_exp_f32 v84, v84
  v_mfma_f32_16x16x32_bf16 v[176:179], a[152:155], v[128:131], v[176:179]
  ds_read_b128 a[188:191], v3 offset:31744
  v_mfma_f32_16x16x32_bf16 v[176:179], a[156:159], v[160:163], v[176:179]
  v_exp_f32 v85, v85
  v_mfma_f32_16x16x32_bf16 v[180:183], a[144:147], v[68:71], v[204:207]
  buffer_load_dwordx4 v1, s[12:15], s78 offen offset:2048 sc1 lds
  v_cvt_pk_bf16_f32 v36, v84, v85
  v_mfma_f32_16x16x32_bf16 v[180:183], a[148:151], v[100:103], v[180:183]
  v_exp_f32 v86, v86
  v_mfma_f32_16x16x32_bf16 v[180:183], a[152:155], v[132:135], v[180:183]
  v_mfma_f32_16x16x32_bf16 v[180:183], a[156:159], v[164:167], v[180:183]
  v_mfma_f32_16x16x32_bf16 v[184:187], a[144:147], v[72:75], v[212:215]
  v_exp_f32 v87, v87
  v_mfma_f32_16x16x32_bf16 v[184:187], a[148:151], v[104:107], v[184:187]
  v_cvt_pk_bf16_f32 v37, v86, v87
  v_mfma_f32_16x16x32_bf16 v[184:187], a[152:155], v[136:139], v[184:187]
  v_exp_f32 v116, v116
  v_mfma_f32_16x16x32_bf16 v[184:187], a[156:159], v[168:171], v[184:187]
  v_mfma_f32_16x16x32_bf16 v[188:191], a[144:147], v[76:79], v[220:223]
  v_exp_f32 v117, v117
  v_mfma_f32_16x16x32_bf16 v[188:191], a[148:151], v[108:111], v[188:191]
  v_cvt_pk_bf16_f32 v38, v116, v117
  s_waitcnt lgkmcnt(4)
  v_mfma_f32_16x16x32_bf16 v[188:191], a[152:155], v[140:143], v[188:191]
  v_exp_f32 v118, v118
  v_mfma_f32_16x16x32_bf16 v[188:191], a[156:159], v[172:175], v[188:191]
  buffer_load_dwordx4 v1, s[12:15], s78 offen offset:3072 sc1 lds
  s_add_u32 s78, s78, 49152
  v_mfma_f32_16x16x32_bf16 a[0:3], a[160:163], v[48:51], a[0:3]
  v_exp_f32 v119, v119
  v_mfma_f32_16x16x32_bf16 a[4:7], a[160:163], v[52:55], a[4:7]
  v_cvt_pk_bf16_f32 v39, v118, v119
  v_mfma_f32_16x16x32_bf16 a[8:11], a[160:163], v[56:59], a[8:11]
  v_exp_f32 v88, v88
  v_mfma_f32_16x16x32_bf16 a[12:15], a[160:163], v[60:63], a[12:15]
  v_mov_b32 v3, v2
  v_add_u32 v2, 0x8000, v2
  v_mfma_f32_16x16x32_bf16 a[16:19], a[164:167], v[48:51], a[16:19]
  v_exp_f32 v89, v89
  v_mfma_f32_16x16x32_bf16 a[20:23], a[164:167], v[52:55], a[20:23]
  v_cvt_pk_bf16_f32 v40, v88, v89
  v_and_b32 v2, 0x1ffff, v2
  v_mfma_f32_16x16x32_bf16 a[24:27], a[164:167], v[56:59], a[24:27]
  v_exp_f32 v90, v90
  v_mfma_f32_16x16x32_bf16 a[28:31], a[164:167], v[60:63], a[28:31]
  s_waitcnt vmcnt(16) lgkmcnt(0)
  s_barrier
  v_mfma_f32_16x16x32_bf16 a[32:35], a[168:171], v[48:51], a[32:35]
  v_exp_f32 v91, v91
  v_mfma_f32_16x16x32_bf16 a[36:39], a[168:171], v[52:55], a[36:39]
  ds_read_b128 a[128:131], v2 offset:0
  v_cvt_pk_bf16_f32 v41, v90, v91
  v_mfma_f32_16x16x32_bf16 a[40:43], a[168:171], v[56:59], a[40:43]
  v_exp_f32 v120, v120
  v_mfma_f32_16x16x32_bf16 a[44:47], a[168:171], v[60:63], a[44:47]
  ds_read_b128 a[132:135], v2 offset:1024
  v_mfma_f32_16x16x32_bf16 a[48:51], a[172:175], v[48:51], a[48:51]
  v_exp_f32 v121, v121
  v_mfma_f32_16x16x32_bf16 a[52:55], a[172:175], v[52:55], a[52:55]
  ds_read_b128 a[136:139], v2 offset:2048
  v_cvt_pk_bf16_f32 v42, v120, v121
  v_mfma_f32_16x16x32_bf16 a[56:59], a[172:175], v[56:59], a[56:59]
  ds_read_b128 a[140:143], v2 offset:3072
  v_mfma_f32_16x16x32_bf16 a[60:63], a[172:175], v[60:63], a[60:63]
  v_exp_f32 v122, v122
  v_mfma_f32_16x16x32_bf16 a[64:67], a[176:179], v[48:51], a[64:67]
  ds_read_b128 a[144:147], v2 offset:4096
  v_mfma_f32_16x16x32_bf16 a[68:71], a[176:179], v[52:55], a[68:71]
  v_exp_f32 v123, v123
  v_mfma_f32_16x16x32_bf16 a[72:75], a[176:179], v[56:59], a[72:75]
  ds_read_b128 a[148:151], v2 offset:5120
  v_cvt_pk_bf16_f32 v43, v122, v123
  v_mfma_f32_16x16x32_bf16 a[76:79], a[176:179], v[60:63], a[76:79]
  v_exp_f32 v92, v92
  v_mfma_f32_16x16x32_bf16 a[80:83], a[180:183], v[48:51], a[80:83]
  ds_read_b128 a[152:155], v2 offset:6144
  v_mfma_f32_16x16x32_bf16 a[84:87], a[180:183], v[52:55], a[84:87]
  v_exp_f32 v93, v93
  v_mfma_f32_16x16x32_bf16 a[88:91], a[180:183], v[56:59], a[88:91]
  ds_read_b128 a[156:159], v2 offset:7168
  v_cvt_pk_bf16_f32 v44, v92, v93
  v_mfma_f32_16x16x32_bf16 a[92:95], a[180:183], v[60:63], a[92:95]
  v_exp_f32 v94, v94
  v_mfma_f32_16x16x32_bf16 a[96:99], a[184:187], v[48:51], a[96:99]
  v_mfma_f32_16x16x32_bf16 a[100:103], a[184:187], v[52:55], a[100:103]
  v_exp_f32 v95, v95
  v_mfma_f32_16x16x32_bf16 a[104:107], a[184:187], v[56:59], a[104:107]
  v_cvt_pk_bf16_f32 v45, v94, v95
  v_mfma_f32_16x16x32_bf16 a[108:111], a[184:187], v[60:63], a[108:111]
  v_exp_f32 v124, v124
  v_mfma_f32_16x16x32_bf16 a[112:115], a[188:191], v[48:51], a[112:115]
  v_mfma_f32_16x16x32_bf16 a[116:119], a[188:191], v[52:55], a[116:119]
  v_exp_f32 v125, v125
  v_mfma_f32_16x16x32_bf16 a[120:123], a[188:191], v[56:59], a[120:123]
  v_cvt_pk_bf16_f32 v46, v124, v125
  v_mfma_f32_16x16x32_bf16 a[124:127], a[188:191], v[60:63], a[124:127]
  v_exp_f32 v126, v126
  v_mfma_f32_16x16x32_bf16 v[16:19], v[12:15], v[48:51], v[16:19]
  v_mfma_f32_16x16x32_bf16 v[20:23], v[12:15], v[52:55], v[20:23]
  v_exp_f32 v127, v127
  v_mfma_f32_16x16x32_bf16 v[24:27], v[12:15], v[56:59], v[24:27]
  v_cvt_pk_bf16_f32 v47, v126, v127
  v_mfma_f32_16x16x32_bf16 v[28:31], v[12:15], v[60:63], v[28:31]
  s_waitcnt lgkmcnt(4)
Lt12_f:
  v_mfma_f32_16x16x32_bf16 v[80:83], a[128:131], v[64:67], v[192:195]
  ds_read_b128 a[160:163], v3 offset:16384
  s_and_b32 m0, s78, 0x1ffff
  v_mfma_f32_16x16x32_bf16 v[80:83], a[132:135], v[96:99], v[80:83]
  v_exp_f32 v144, v144
  v_mfma_f32_16x16x32_bf16 v[80:83], a[136:139], v[128:131], v[80:83]
  buffer_load_dwordx4 v1, s[12:15], s78 offen offset:0 sc1 lds
  v_exp_f32 v145, v145
  v_mfma_f32_16x16x32_bf16 v[80:83], a[140:143], v[160:163], v[80:83]
  ds_read_b128 a[164:167], v3 offset:17408
  v_cvt_pk_bf16_f32 v48, v144, v145
  v_mfma_f32_16x16x32_bf16 v[84:87], a[128:131], v[68:71], v[200:203]
  v_exp_f32 v146, v146
  v_mfma_f32_16x16x32_bf16 v[84:87], a[132:135], v[100:103], v[84:87]
  v_exp_f32 v147, v147
  s_waitcnt lgkmcnt(2)
  v_mfma_f32_16x16x32_bf16 v[84:87], a[136:139], v[132:135], v[84:87]
  buffer_load_dwordx4 v1, s[12:15], s78 offen offset:1024 sc1 lds
  v_cvt_pk_bf16_f32 v49, v146, v147
  v_mfma_f32_16x16x32_bf16 v[84:87], a[140:143], v[164:167], v[84:87]
  v_exp_f32 v176, v176
  v_mfma_f32_16x16x32_bf16 v[112:115], a[144:147], v[64:67], v[196:199]
  v_exp_f32 v177, v177
  v_mfma_f32_16x16x32_bf16 v[112:115], a[148:151], v[96:99], v[112:115]
  ds_read_b128 a[168:171], v3 offset:18432
  v_cvt_pk_bf16_f32 v50, v176, v177
  v_mfma_f32_16x16x32_bf16 v[112:115], a[152:155], v[128:131], v[112:115]
  buffer_load_dwordx4 v1, s[12:15], s78 offen offset:2048 sc1 lds
  v_exp_f32 v178, v178
  v_mfma_f32_16x16x32_bf16 v[112:115], a[156:159], v[160:163], v[112:115]
  ds_read_b128 a[172:175], v3 offset:19456
  ds_read_b128 a[176:179], v3 offset:20480
  ds_read_b128 a[180:183], v3 offset:21504
  v_mfma_f32_16x16x32_bf16 v[116:119], a[144:147], v[68:71], v[204:207]
  ds_read_b128 a[184:187], v3 offset:22528
  v_exp_f32 v179, v179
  v_mfma_f32_16x16x32_bf16 v[116:119], a[148:151], v[100:103], v[116:119]
  ds_read_b128 a[188:191], v3 offset:23552
  v_exp_f32 v148, v148
  v_mfma_f32_16x16x32_bf16 v[116:119], a[152:155], v[132:135], v[116:119]
  buffer_load_dwordx4 v1, s[12:15], s78 offen offset:3072 sc1 lds
  v_cvt_pk_bf16_f32 v51, v178, v179
  s_waitcnt lgkmcnt(4)
  v_mfma_f32_16x16x32_bf16 v[116:119], a[156:159], v[164:167], v[116:119]
  v_exp_f32 v149, v149
  v_mfma_f32_16x16x32_bf16 a[0:3], a[160:163], v[32:35], a[0:3]
  v_exp_f32 v150, v150
  v_mfma_f32_16x16x32_bf16 a[4:7], a[160:163], v[36:39], a[4:7]
  v_cvt_pk_bf16_f32 v52, v148, v149
  s_sub_u32 s78, s78, 16384
  v_mfma_f32_16x16x32_bf16 a[8:11], a[160:163], v[40:43], a[8:11]
  v_exp_f32 v151, v151
  v_mfma_f32_16x16x32_bf16 a[12:15], a[160:163], v[44:47], a[12:15]
  ds_read_b128 a[128:131], v2 offset:8192
  v_cvt_pk_bf16_f32 v53, v150, v151
  v_mfma_f32_16x16x32_bf16 a[16:19], a[164:167], v[32:35], a[16:19]
  v_exp_f32 v180, v180
  v_mfma_f32_16x16x32_bf16 a[20:23], a[164:167], v[36:39], a[20:23]
  v_exp_f32 v181, v181
  v_mfma_f32_16x16x32_bf16 a[24:27], a[164:167], v[40:43], a[24:27]
  ds_read_b128 a[132:135], v2 offset:9216
  v_cvt_pk_bf16_f32 v54, v180, v181
  v_mfma_f32_16x16x32_bf16 a[28:31], a[164:167], v[44:47], a[28:31]
  v_exp_f32 v182, v182
  v_mfma_f32_16x16x32_bf16 a[32:35], a[168:171], v[32:35], a[32:35]
  v_exp_f32 v183, v183
  v_mfma_f32_16x16x32_bf16 a[36:39], a[168:171], v[36:39], a[36:39]
  ds_read_b128 a[136:139], v2 offset:10240
  v_cvt_pk_bf16_f32 v55, v182, v183
  v_mfma_f32_16x16x32_bf16 a[40:43], a[168:171], v[40:43], a[40:43]
  v_exp_f32 v152, v152
  v_mfma_f32_16x16x32_bf16 a[44:47], a[168:171], v[44:47], a[44:47]
  ds_read_b128 a[140:143], v2 offset:11264
  ds_read_b128 a[144:147], v2 offset:12288
  v_mfma_f32_16x16x32_bf16 a[48:51], a[172:175], v[32:35], a[48:51]
  v_exp_f32 v153, v153
  v_mfma_f32_16x16x32_bf16 a[52:55], a[172:175], v[36:39], a[52:55]
  v_exp_f32 v154, v154
  v_mfma_f32_16x16x32_bf16 a[56:59], a[172:175], v[40:43], a[56:59]
  v_cvt_pk_bf16_f32 v56, v152, v153
  s_waitcnt lgkmcnt(5)
  v_mfma_f32_16x16x32_bf16 a[60:63], a[172:175], v[44:47], a[60:63]
  v_exp_f32 v155, v155
  v_mfma_f32_16x16x32_bf16 a[64:67], a[176:179], v[32:35], a[64:67]
  v_exp_f32 v184, v184
  v_mfma_f32_16x16x32_bf16 a[68:71], a[176:179], v[36:39], a[68:71]
  ds_read_b128 a[148:151], v2 offset:13312
  v_cvt_pk_bf16_f32 v57, v154, v155
  v_mfma_f32_16x16x32_bf16 a[72:75], a[176:179], v[40:43], a[72:75]
  v_exp_f32 v185, v185
  v_mfma_f32_16x16x32_bf16 a[76:79], a[176:179], v[44:47], a[76:79]
  ds_read_b128 a[152:155], v2 offset:14336
  v_cvt_pk_bf16_f32 v58, v184, v185
  v_mfma_f32_16x16x32_bf16 a[80:83], a[180:183], v[32:35], a[80:83]
  v_exp_f32 v186, v186
  v_mfma_f32_16x16x32_bf16 a[84:87], a[180:183], v[36:39], a[84:87]
  v_exp_f32 v187, v187
  v_mfma_f32_16x16x32_bf16 a[88:91], a[180:183], v[40:43], a[88:91]
  ds_read_b128 a[156:159], v2 offset:15360
  v_cvt_pk_bf16_f32 v59, v186, v187
  v_mfma_f32_16x16x32_bf16 a[92:95], a[180:183], v[44:47], a[92:95]
  v_exp_f32 v156, v156
  v_mfma_f32_16x16x32_bf16 a[96:99], a[184:187], v[32:35], a[96:99]
  v_exp_f32 v157, v157
  v_mfma_f32_16x16x32_bf16 a[100:103], a[184:187], v[36:39], a[100:103]
  v_cvt_pk_bf16_f32 v60, v156, v157
  v_mfma_f32_16x16x32_bf16 a[104:107], a[184:187], v[40:43], a[104:107]
  v_exp_f32 v158, v158
  v_mfma_f32_16x16x32_bf16 a[108:111], a[184:187], v[44:47], a[108:111]
  v_mfma_f32_16x16x32_bf16 a[112:115], a[188:191], v[32:35], a[112:115]
  v_exp_f32 v159, v159
  v_mfma_f32_16x16x32_bf16 a[116:119], a[188:191], v[36:39], a[116:119]
  v_exp_f32 v188, v188
  v_mfma_f32_16x16x32_bf16 a[120:123], a[188:191], v[40:43], a[120:123]
  v_cvt_pk_bf16_f32 v61, v158, v159
  v_mfma_f32_16x16x32_bf16 a[124:127], a[188:191], v[44:47], a[124:127]
  v_exp_f32 v189, v189
  v_mfma_f32_16x16x32_bf16 v[16:19], v[12:15], v[32:35], v[16:19]
  v_exp_f32 v190, v190
  v_mfma_f32_16x16x32_bf16 v[20:23], v[12:15], v[36:39], v[20:23]
  v_cvt_pk_bf16_f32 v62, v188, v189
  v_mfma_f32_16x16x32_bf16 v[24:27], v[12:15], v[40:43], v[24:27]
  v_exp_f32 v191, v191
  v_mfma_f32_16x16x32_bf16 v[28:31], v[12:15], v[44:47], v[28:31]
  v_cvt_pk_bf16_f32 v63, v190, v191
  s_waitcnt lgkmcnt(4)
  v_mfma_f32_16x16x32_bf16 v[144:147], a[128:131], v[64:67], v[192:195]
  ds_read_b128 a[160:163], v3 offset:24576
  s_and_b32 m0, s78, 0x1ffff
  v_mfma_f32_16x16x32_bf16 v[144:147], a[132:135], v[96:99], v[144:147]
  v_exp_f32 v80, v80
  v_mfma_f32_16x16x32_bf16 v[144:147], a[136:139], v[128:131], v[144:147]
  buffer_load_dwordx4 v1, s[12:15], s78 offen offset:0 sc1 lds
  ds_read_b128 a[164:167], v3 offset:25600
  v_mfma_f32_16x16x32_bf16 v[144:147], a[140:143], v[160:163], v[144:147]
  ds_read_b128 a[168:171], v3 offset:26624
  ds_read_b128 a[172:175], v3 offset:27648
  v_mfma_f32_16x16x32_bf16 v[148:151], a[128:131], v[68:71], v[200:203]
  v_exp_f32 v81, v81
  v_mfma_f32_16x16x32_bf16 v[148:151], a[132:135], v[100:103], v[148:151]
  ds_read_b128 a[176:179], v3 offset:28672
  v_cvt_pk_bf16_f32 v32, v80, v81
  s_waitcnt lgkmcnt(5)
  v_mfma_f32_16x16x32_bf16 v[148:151], a[136:139], v[132:135], v[148:151]
  buffer_load_dwordx4 v1, s[12:15], s78 offen offset:1024 sc1 lds
  ds_read_b128 a[180:183], v3 offset:29696
  v_mfma_f32_16x16x32_bf16 v[148:151], a[140:143], v[164:167], v[148:151]
  v_exp_f32 v82, v82
  v_mfma_f32_16x16x32_bf16 v[176:179], a[144:147], v[64:67], v[196:199]
  ds_read_b128 a[184:187], v3 offset:30720
  ds_read_b128 a[188:191], v3 offset:31744
  v_mfma_f32_16x16x32_bf16 v[176:179], a[148:151], v[96:99], v[176:179]
  s_lshr_b32 s80, s2, 5
  s_lshl_b32 s82, s80, 19
  v_mfma_f32_16x16x32_bf16 v[176:179], a[152:155], v[128:131], v[176:179]
  buffer_load_dwordx4 v1, s[12:15], s78 offen offset:2048 sc1 lds
  v_exp_f32 v83, v83
  v_mfma_f32_16x16x32_bf16 v[176:179], a[156:159], v[160:163], v[176:179]
  v_cvt_pk_bf16_f32 v33, v82, v83
  s_lshl_b32 s76, s3, 17
  v_mfma_f32_16x16x32_bf16 v[180:183], a[144:147], v[68:71], v[204:207]
  s_add_u32 s82, s82, s76
  s_add_u32 s82, s82, 39845888
  v_mfma_f32_16x16x32_bf16 v[180:183], a[148:151], v[100:103], v[180:183]
  v_exp_f32 v112, v112
  v_mfma_f32_16x16x32_bf16 v[180:183], a[152:155], v[132:135], v[180:183]
  buffer_load_dwordx4 v1, s[12:15], s78 offen offset:3072 sc1 lds
  s_add_u32 s78, s78, 49152
  v_mfma_f32_16x16x32_bf16 v[180:183], a[156:159], v[164:167], v[180:183]
  s_waitcnt lgkmcnt(4)
  s_lshl_b32 s81, s3, 13
  v_mfma_f32_16x16x32_bf16 a[0:3], a[160:163], v[48:51], a[0:3]
  v_exp_f32 v113, v113
  v_mfma_f32_16x16x32_bf16 a[4:7], a[160:163], v[52:55], a[4:7]
  v_cvt_pk_bf16_f32 v34, v112, v113
  v_mov_b32 v3, v2
  v_mfma_f32_16x16x32_bf16 a[8:11], a[160:163], v[56:59], a[8:11]
  v_add_u32 v2, 0x8000, v2
  v_and_b32 v2, 0x1ffff, v2
  v_mfma_f32_16x16x32_bf16 a[12:15], a[160:163], v[60:63], a[12:15]
  s_add_u32 s81, s81, 131072
  s_mov_b32 s16, s92
  v_mfma_f32_16x16x32_bf16 a[16:19], a[164:167], v[48:51], a[16:19]
  v_exp_f32 v114, v114
  v_mfma_f32_16x16x32_bf16 a[20:23], a[164:167], v[52:55], a[20:23]
  s_waitcnt vmcnt(16) lgkmcnt(0)
  s_barrier
  v_mfma_f32_16x16x32_bf16 a[24:27], a[164:167], v[56:59], a[24:27]
  ds_read_b128 a[128:131], v2 offset:0
  s_mov_b32 s17, s93
  v_mfma_f32_16x16x32_bf16 a[28:31], a[164:167], v[60:63], a[28:31]
  v_exp_f32 v115, v115
  v_mfma_f32_16x16x32_bf16 a[32:35], a[168:171], v[48:51], a[32:35]
  ds_read_b128 a[132:135], v2 offset:1024
  v_cvt_pk_bf16_f32 v35, v114, v115
  v_mfma_f32_16x16x32_bf16 a[36:39], a[168:171], v[52:55], a[36:39]
  s_mov_b32 s18, 0x200000
  s_mov_b32 s19, 0x20000
  v_mfma_f32_16x16x32_bf16 a[40:43], a[168:171], v[56:59], a[40:43]
  v_exp_f32 v84, v84
  v_mfma_f32_16x16x32_bf16 a[44:47], a[168:171], v[60:63], a[44:47]
  ds_read_b128 a[136:139], v2 offset:2048
  s_and_b32 s79, s2, 7
  v_mfma_f32_16x16x32_bf16 a[48:51], a[172:175], v[48:51], a[48:51]
  ds_read_b128 a[140:143], v2 offset:3072
  s_lshl_b32 s79, s79, 2
  v_mfma_f32_16x16x32_bf16 a[52:55], a[172:175], v[52:55], a[52:55]
  v_exp_f32 v85, v85
  v_mfma_f32_16x16x32_bf16 a[56:59], a[172:175], v[56:59], a[56:59]
  v_cvt_pk_bf16_f32 v36, v84, v85
  s_bfe_u32 s76, s2, 0x20003
  v_mfma_f32_16x16x32_bf16 a[60:63], a[172:175], v[60:63], a[60:63]
  ds_read_b128 a[144:147], v2 offset:4096
  s_add_u32 s79, s79, s76
  v_mfma_f32_16x16x32_bf16 a[64:67], a[176:179], v[48:51], a[64:67]
  v_exp_f32 v86, v86
  v_mfma_f32_16x16x32_bf16 a[68:71], a[176:179], v[52:55], a[68:71]
  ds_read_b128 a[148:151], v2 offset:5120
  s_lshl_b32 s79, s79, 2
  v_mfma_f32_16x16x32_bf16 a[72:75], a[176:179], v[56:59], a[72:75]
  s_add_u32 s79, s79, s3
  s_lshl_b32 s79, s79, 14
  v_mfma_f32_16x16x32_bf16 a[76:79], a[176:179], v[60:63], a[76:79]
  ds_read_b128 a[152:155], v2 offset:6144
  s_lshl_b32 s76, s80, 7
  v_mfma_f32_16x16x32_bf16 a[80:83], a[180:183], v[48:51], a[80:83]
  v_exp_f32 v87, v87
  v_mfma_f32_16x16x32_bf16 a[84:87], a[180:183], v[52:55], a[84:87]
  ds_read_b128 a[156:159], v2 offset:7168
  v_cvt_pk_bf16_f32 v37, v86, v87
  v_mfma_f32_16x16x32_bf16 a[88:91], a[180:183], v[56:59], a[88:91]
  s_add_u32 s79, s79, s76
  s_mul_i32 s83, s5, 12288
  v_mfma_f32_16x16x32_bf16 a[92:95], a[180:183], v[60:63], a[92:95]
  v_exp_f32 v116, v116
  v_mfma_f32_16x16x32_bf16 a[96:99], a[184:187], v[48:51], a[96:99]
  s_lshl_b32 s76, s80, 8
  s_add_u32 s83, s83, s76
  v_mfma_f32_16x16x32_bf16 a[100:103], a[184:187], v[52:55], a[100:103]
  s_add_u32 s83, s83, 38866944
  v_lshrrev_b32 v237, 4, v0
  v_mfma_f32_16x16x32_bf16 a[104:107], a[184:187], v[56:59], a[104:107]
  v_exp_f32 v117, v117
  v_mfma_f32_16x16x32_bf16 a[108:111], a[184:187], v[60:63], a[108:111]
  v_cvt_pk_bf16_f32 v38, v116, v117
  v_and_b32 v236, 15, v0
  v_mfma_f32_16x16x32_bf16 a[112:115], a[188:191], v[48:51], a[112:115]
  v_lshlrev_b32 v236, 10, v236
  v_lshl_add_u32 v236, v237, 3, v236
  v_mfma_f32_16x16x32_bf16 a[116:119], a[188:191], v[52:55], a[116:119]
  v_exp_f32 v118, v118
  v_mfma_f32_16x16x32_bf16 a[120:123], a[188:191], v[56:59], a[120:123]
  v_lshlrev_b32 v237, 2, v0
  v_mfma_f32_16x16x32_bf16 a[124:127], a[188:191], v[60:63], a[124:127]
  v_mfma_f32_16x16x32_bf16 v[16:19], v[12:15], v[48:51], v[16:19]
  v_exp_f32 v119, v119
  v_mfma_f32_16x16x32_bf16 v[20:23], v[12:15], v[52:55], v[20:23]
  v_cvt_pk_bf16_f32 v39, v118, v119
  v_mfma_f32_16x16x32_bf16 v[24:27], v[12:15], v[56:59], v[24:27]
  v_mfma_f32_16x16x32_bf16 v[28:31], v[12:15], v[60:63], v[28:31]
  s_waitcnt lgkmcnt(4)
Lss_entry_f:
  v_lshlrev_b32 v234, 3, v0
  s_mov_b32 s90, 39066112
  buffer_load_dwordx2 v[232:233], v234, s[8:11], s90 offen sc1
  s_nop 7
  v_rcp_f32 v220, v24
  v_rcp_f32 v221, v28
  v_accvgpr_read_b32 v208, a8
  v_accvgpr_read_b32 v209, a9
  v_accvgpr_read_b32 v210, a10
  v_accvgpr_read_b32 v211, a11
  v_accvgpr_read_b32 v212, a24
  v_accvgpr_read_b32 v213, a25
  v_accvgpr_read_b32 v214, a26
  v_accvgpr_read_b32 v215, a27
  v_pk_mul_f32 v[208:209], v[208:209], v[220:221] op_sel:[0,0] op_sel_hi:[1,0]
  v_pk_mul_f32 v[210:211], v[210:211], v[220:221] op_sel:[0,0] op_sel_hi:[1,0]
  v_pk_mul_f32 v[212:213], v[212:213], v[220:221] op_sel:[0,0] op_sel_hi:[1,0]
  v_pk_mul_f32 v[214:215], v[214:215], v[220:221] op_sel:[0,0] op_sel_hi:[1,0]
  v_cvt_pk_bf16_f32 v40, v208, v209
  v_cvt_pk_bf16_f32 v41, v210, v211
  v_cvt_pk_bf16_f32 v42, v212, v213
  v_cvt_pk_bf16_f32 v43, v214, v215
  buffer_store_dwordx4 v[40:43], v1, s[8:11], s38 offen offset:0 sc1
  v_accvgpr_read_b32 v208, a40
  v_accvgpr_read_b32 v209, a41
  v_accvgpr_read_b32 v210, a42
  v_accvgpr_read_b32 v211, a43
  v_accvgpr_read_b32 v212, a56
  v_accvgpr_read_b32 v213, a57
  v_accvgpr_read_b32 v214, a58
  v_accvgpr_read_b32 v215, a59
  v_pk_mul_f32 v[208:209], v[208:209], v[220:221] op_sel:[0,0] op_sel_hi:[1,0]
  v_pk_mul_f32 v[210:211], v[210:211], v[220:221] op_sel:[0,0] op_sel_hi:[1,0]
  v_pk_mul_f32 v[212:213], v[212:213], v[220:221] op_sel:[0,0] op_sel_hi:[1,0]
  v_pk_mul_f32 v[214:215], v[214:215], v[220:221] op_sel:[0,0] op_sel_hi:[1,0]
  v_cvt_pk_bf16_f32 v44, v208, v209
  v_cvt_pk_bf16_f32 v45, v210, v211
  v_cvt_pk_bf16_f32 v46, v212, v213
  v_cvt_pk_bf16_f32 v47, v214, v215
  buffer_store_dwordx4 v[44:47], v1, s[8:11], s38 offen offset:1024 sc1
  v_accvgpr_read_b32 v208, a72
  v_accvgpr_read_b32 v209, a73
  v_accvgpr_read_b32 v210, a74
  v_accvgpr_read_b32 v211, a75
  v_accvgpr_read_b32 v212, a88
  v_accvgpr_read_b32 v213, a89
  v_accvgpr_read_b32 v214, a90
  v_accvgpr_read_b32 v215, a91
  v_pk_mul_f32 v[208:209], v[208:209], v[220:221] op_sel:[0,0] op_sel_hi:[1,0]
  v_pk_mul_f32 v[210:211], v[210:211], v[220:221] op_sel:[0,0] op_sel_hi:[1,0]
  v_pk_mul_f32 v[212:213], v[212:213], v[220:221] op_sel:[0,0] op_sel_hi:[1,0]
  v_pk_mul_f32 v[214:215], v[214:215], v[220:221] op_sel:[0,0] op_sel_hi:[1,0]
  v_cvt_pk_bf16_f32 v40, v208, v209
  v_cvt_pk_bf16_f32 v41, v210, v211
  v_cvt_pk_bf16_f32 v42, v212, v213
  v_cvt_pk_bf16_f32 v43, v214, v215
  buffer_store_dwordx4 v[40:43], v1, s[8:11], s38 offen offset:2048 sc1
  v_accvgpr_read_b32 v208, a104
  v_accvgpr_read_b32 v209, a105
  v_accvgpr_read_b32 v210, a106
  v_accvgpr_read_b32 v211, a107
  v_accvgpr_read_b32 v212, a120
  v_accvgpr_read_b32 v213, a121
  v_accvgpr_read_b32 v214, a122
  v_accvgpr_read_b32 v215, a123
  v_pk_mul_f32 v[208:209], v[208:209], v[220:221] op_sel:[0,0] op_sel_hi:[1,0]
  v_pk_mul_f32 v[210:211], v[210:211], v[220:221] op_sel:[0,0] op_sel_hi:[1,0]
  v_pk_mul_f32 v[212:213], v[212:213], v[220:221] op_sel:[0,0] op_sel_hi:[1,0]
  v_pk_mul_f32 v[214:215], v[214:215], v[220:221] op_sel:[0,0] op_sel_hi:[1,0]
  v_cvt_pk_bf16_f32 v44, v208, v209
  v_cvt_pk_bf16_f32 v45, v210, v211
  v_cvt_pk_bf16_f32 v46, v212, v213
  v_cvt_pk_bf16_f32 v47, v214, v215
  buffer_store_dwordx4 v[44:47], v1, s[8:11], s38 offen offset:3072 sc1
  v_accvgpr_read_b32 v208, a12
  v_accvgpr_read_b32 v209, a13
  v_accvgpr_read_b32 v210, a14
  v_accvgpr_read_b32 v211, a15
  v_accvgpr_read_b32 v212, a28
  v_accvgpr_read_b32 v213, a29
  v_accvgpr_read_b32 v214, a30
  v_accvgpr_read_b32 v215, a31
  v_pk_mul_f32 v[208:209], v[208:209], v[220:221] op_sel:[0,1] op_sel_hi:[1,1]
  v_pk_mul_f32 v[210:211], v[210:211], v[220:221] op_sel:[0,1] op_sel_hi:[1,1]
  v_pk_mul_f32 v[212:213], v[212:213], v[220:221] op_sel:[0,1] op_sel_hi:[1,1]
  v_pk_mul_f32 v[214:215], v[214:215], v[220:221] op_sel:[0,1] op_sel_hi:[1,1]
  v_cvt_pk_bf16_f32 v40, v208, v209
  v_cvt_pk_bf16_f32 v41, v210, v211
  v_cvt_pk_bf16_f32 v42, v212, v213
  v_cvt_pk_bf16_f32 v43, v214, v215
  buffer_store_dwordx4 v[40:43], v1, s[8:11], s39 offen offset:0 sc1
  v_accvgpr_read_b32 v208, a44
  v_accvgpr_read_b32 v209, a45
  v_accvgpr_read_b32 v210, a46
  v_accvgpr_read_b32 v211, a47
  v_accvgpr_read_b32 v212, a60
  v_accvgpr_read_b32 v213, a61
  v_accvgpr_read_b32 v214, a62
  v_accvgpr_read_b32 v215, a63
  v_pk_mul_f32 v[208:209], v[208:209], v[220:221] op_sel:[0,1] op_sel_hi:[1,1]
  v_pk_mul_f32 v[210:211], v[210:211], v[220:221] op_sel:[0,1] op_sel_hi:[1,1]
  v_pk_mul_f32 v[212:213], v[212:213], v[220:221] op_sel:[0,1] op_sel_hi:[1,1]
  v_pk_mul_f32 v[214:215], v[214:215], v[220:221] op_sel:[0,1] op_sel_hi:[1,1]
  v_cvt_pk_bf16_f32 v44, v208, v209
  v_cvt_pk_bf16_f32 v45, v210, v211
  v_cvt_pk_bf16_f32 v46, v212, v213
  v_cvt_pk_bf16_f32 v47, v214, v215
  buffer_store_dwordx4 v[44:47], v1, s[8:11], s39 offen offset:1024 sc1
  v_accvgpr_read_b32 v208, a76
  v_accvgpr_read_b32 v209, a77
  v_accvgpr_read_b32 v210, a78
  v_accvgpr_read_b32 v211, a79
  v_accvgpr_read_b32 v212, a92
  v_accvgpr_read_b32 v213, a93
  v_accvgpr_read_b32 v214, a94
  v_accvgpr_read_b32 v215, a95
  v_pk_mul_f32 v[208:209], v[208:209], v[220:221] op_sel:[0,1] op_sel_hi:[1,1]
  v_pk_mul_f32 v[210:211], v[210:211], v[220:221] op_sel:[0,1] op_sel_hi:[1,1]
  v_pk_mul_f32 v[212:213], v[212:213], v[220:221] op_sel:[0,1] op_sel_hi:[1,1]
  v_pk_mul_f32 v[214:215], v[214:215], v[220:221] op_sel:[0,1] op_sel_hi:[1,1]
  v_cvt_pk_bf16_f32 v40, v208, v209
  v_cvt_pk_bf16_f32 v41, v210, v211
  v_cvt_pk_bf16_f32 v42, v212, v213
  v_cvt_pk_bf16_f32 v43, v214, v215
  buffer_store_dwordx4 v[40:43], v1, s[8:11], s39 offen offset:2048 sc1
  v_accvgpr_read_b32 v208, a108
  v_accvgpr_read_b32 v209, a109
  v_accvgpr_read_b32 v210, a110
  v_accvgpr_read_b32 v211, a111
  v_accvgpr_read_b32 v212, a124
  v_accvgpr_read_b32 v213, a125
  v_accvgpr_read_b32 v214, a126
  v_accvgpr_read_b32 v215, a127
  v_pk_mul_f32 v[208:209], v[208:209], v[220:221] op_sel:[0,1] op_sel_hi:[1,1]
  v_pk_mul_f32 v[210:211], v[210:211], v[220:221] op_sel:[0,1] op_sel_hi:[1,1]
  v_pk_mul_f32 v[212:213], v[212:213], v[220:221] op_sel:[0,1] op_sel_hi:[1,1]
  v_pk_mul_f32 v[214:215], v[214:215], v[220:221] op_sel:[0,1] op_sel_hi:[1,1]
  v_cvt_pk_bf16_f32 v44, v208, v209
  v_cvt_pk_bf16_f32 v45, v210, v211
  v_cvt_pk_bf16_f32 v46, v212, v213
  v_cvt_pk_bf16_f32 v47, v214, v215
  buffer_store_dwordx4 v[44:47], v1, s[8:11], s39 offen offset:3072 sc1
  s_sub_u32 s86, s89, s88
  s_lshr_b32 s86, s86, 1
  s_sub_u32 s86, s86, 2
  s_cmp_ge_u32 s86, 4
  s_cselect_b32 s1, 1, 0
  s_mov_b32 s0, s1
  s_mul_i32 s76, s1, 3
  s_sub_u32 s86, s86, s76
Lss_f_go:
  s_sub_u32 s86, s86, 1
  s_cbranch_scc1 Lss_f_done
  .p2align 6
Lss_f:
  v_mfma_f32_16x16x32_bf16 v[80:83], a[128:131], v[64:67], v[192:195]
  ds_read_b128 a[160:163], v3 offset:16384
  s_and_b32 m0, s78, 0x1ffff
  v_mfma_f32_16x16x32_bf16 v[80:83], a[132:135], v[96:99], v[80:83]
  v_exp_f32 v144, v144
  v_mfma_f32_16x16x32_bf16 v[80:83], a[136:139], v[128:131], v[80:83]
  buffer_load_dwordx4 v1, s[12:15], s78 offen offset:0 sc1 lds
  ds_read_b128 a[164:167], v3 offset:17408
  v_mfma_f32_16x16x32_bf16 v[80:83], a[140:143], v[160:163], v[80:83]
  v_exp_f32 v145, v145
  v_mfma_f32_16x16x32_bf16 v[84:87], a[128:131], v[68:71], v[200:203]
  ds_read_b128 a[168:171], v3 offset:18432
  v_cvt_pk_bf16_f32 v48, v144, v145
  v_mfma_f32_16x16x32_bf16 v[84:87], a[132:135], v[100:103], v[84:87]
  v_exp_f32 v146, v146
  s_waitcnt lgkmcnt(3)
  v_mfma_f32_16x16x32_bf16 v[84:87], a[136:139], v[132:135], v[84:87]
  buffer_load_dwordx4 v1, s[12:15], s78 offen offset:1024 sc1 lds
  ds_read_b128 a[172:175], v3 offset:19456
  v_mfma_f32_16x16x32_bf16 v[84:87], a[140:143], v[164:167], v[84:87]
  v_exp_f32 v147, v147
  v_mfma_f32_16x16x32_bf16 v[112:115], a[144:147], v[64:67], v[196:199]
  ds_read_b128 a[176:179], v3 offset:20480
  v_cvt_pk_bf16_f32 v49, v146, v147
  v_mfma_f32_16x16x32_bf16 v[112:115], a[148:151], v[96:99], v[112:115]
  v_exp_f32 v176, v176
  v_mfma_f32_16x16x32_bf16 v[112:115], a[152:155], v[128:131], v[112:115]
  buffer_load_dwordx4 v1, s[12:15], s78 offen offset:2048 sc1 lds
  ds_read_b128 a[180:183], v3 offset:21504
  v_mfma_f32_16x16x32_bf16 v[112:115], a[156:159], v[160:163], v[112:115]
  v_exp_f32 v177, v177
  v_mfma_f32_16x16x32_bf16 v[116:119], a[144:147], v[68:71], v[204:207]
  ds_read_b128 a[184:187], v3 offset:22528
  ds_read_b128 a[188:191], v3 offset:23552
  v_cvt_pk_bf16_f32 v50, v176, v177
  v_mfma_f32_16x16x32_bf16 v[116:119], a[148:151], v[100:103], v[116:119]
  v_exp_f32 v178, v178
  s_waitcnt lgkmcnt(4)
  v_mfma_f32_16x16x32_bf16 v[116:119], a[152:155], v[132:135], v[116:119]
  buffer_load_dwordx4 v1, s[12:15], s78 offen offset:3072 sc1 lds
  s_sub_u32 s78, s78, 16384
  v_mfma_f32_16x16x32_bf16 v[116:119], a[156:159], v[164:167], v[116:119]
  v_exp_f32 v179, v179
  v_mfma_f32_16x16x32_bf16 a[0:3], a[160:163], v[32:35], a[0:3]
  ds_read_b128 a[128:131], v2 offset:8192
  v_cvt_pk_bf16_f32 v51, v178, v179
  v_mfma_f32_16x16x32_bf16 a[4:7], a[160:163], v[36:39], a[4:7]
  v_exp_f32 v148, v148
  v_mfma_f32_16x16x32_bf16 a[16:19], a[164:167], v[32:35], a[16:19]
  ds_read_b128 a[132:135], v2 offset:9216
  ds_read_b128 a[136:139], v2 offset:10240
  v_mfma_f32_16x16x32_bf16 a[20:23], a[164:167], v[36:39], a[20:23]
  v_exp_f32 v149, v149
  v_mfma_f32_16x16x32_bf16 a[32:35], a[168:171], v[32:35], a[32:35]
  ds_read_b128 a[140:143], v2 offset:11264
  v_cvt_pk_bf16_f32 v52, v148, v149
  v_mfma_f32_16x16x32_bf16 a[36:39], a[168:171], v[36:39], a[36:39]
  v_exp_f32 v150, v150
  v_mfma_f32_16x16x32_bf16 a[48:51], a[172:175], v[32:35], a[48:51]
  ds_read_b128 a[144:147], v2 offset:12288
  s_waitcnt lgkmcnt(5)
  v_mfma_f32_16x16x32_bf16 a[52:55], a[172:175], v[36:39], a[52:55]
  v_exp_f32 v151, v151
  v_mfma_f32_16x16x32_bf16 a[64:67], a[176:179], v[32:35], a[64:67]
  ds_read_b128 a[148:151], v2 offset:13312
  v_cvt_pk_bf16_f32 v53, v150, v151
  v_mfma_f32_16x16x32_bf16 a[68:71], a[176:179], v[36:39], a[68:71]
  v_exp_f32 v180, v180
  v_mfma_f32_16x16x32_bf16 a[80:83], a[180:183], v[32:35], a[80:83]
  ds_read_b128 a[152:155], v2 offset:14336
  ds_read_b128 a[156:159], v2 offset:15360
  v_mfma_f32_16x16x32_bf16 a[84:87], a[180:183], v[36:39], a[84:87]
  v_exp_f32 v181, v181
  v_mfma_f32_16x16x32_bf16 a[96:99], a[184:187], v[32:35], a[96:99]
  v_cvt_pk_bf16_f32 v54, v180, v181
  v_mfma_f32_16x16x32_bf16 a[100:103], a[184:187], v[36:39], a[100:103]
  v_exp_f32 v182, v182
  v_mfma_f32_16x16x32_bf16 a[112:115], a[188:191], v[32:35], a[112:115]
  v_mfma_f32_16x16x32_bf16 a[116:119], a[188:191], v[36:39], a[116:119]
  v_exp_f32 v183, v183
  v_mfma_f32_16x16x32_bf16 v[16:19], v[12:15], v[32:35], v[16:19]
  v_cvt_pk_bf16_f32 v55, v182, v183
  v_mfma_f32_16x16x32_bf16 v[20:23], v[12:15], v[36:39], v[20:23]
  s_waitcnt lgkmcnt(4)
  v_mfma_f32_16x16x32_bf16 v[144:147], a[128:131], v[64:67], v[192:195]
  ds_read_b128 a[160:163], v3 offset:24576
  s_and_b32 m0, s78, 0x1ffff
  v_mfma_f32_16x16x32_bf16 v[144:147], a[132:135], v[96:99], v[144:147]
  v_exp_f32 v80, v80
  v_mfma_f32_16x16x32_bf16 v[144:147], a[136:139], v[128:131], v[144:147]
  buffer_load_dwordx4 v1, s[12:15], s78 offen offset:0 sc1 lds
  ds_read_b128 a[164:167], v3 offset:25600
  v_mfma_f32_16x16x32_bf16 v[144:147], a[140:143], v[160:163], v[144:147]
  v_exp_f32 v81, v81
  v_mfma_f32_16x16x32_bf16 v[148:151], a[128:131], v[68:71], v[200:203]
  ds_read_b128 a[168:171], v3 offset:26624
  v_cvt_pk_bf16_f32 v32, v80, v81
  v_mfma_f32_16x16x32_bf16 v[148:151], a[132:135], v[100:103], v[148:151]
  v_exp_f32 v82, v82
  s_waitcnt lgkmcnt(3)
  v_mfma_f32_16x16x32_bf16 v[148:151], a[136:139], v[132:135], v[148:151]
  buffer_load_dwordx4 v1, s[12:15], s78 offen offset:1024 sc1 lds
  ds_read_b128 a[172:175], v3 offset:27648
  v_mfma_f32_16x16x32_bf16 v[148:151], a[140:143], v[164:167], v[148:151]
  v_exp_f32 v83, v83
  v_mfma_f32_16x16x32_bf16 v[176:179], a[144:147], v[64:67], v[196:199]
  ds_read_b128 a[176:179], v3 offset:28672
  v_cvt_pk_bf16_f32 v33, v82, v83
  v_mfma_f32_16x16x32_bf16 v[176:179], a[148:151], v[96:99], v[176:179]
  v_exp_f32 v112, v112
  v_mfma_f32_16x16x32_bf16 v[176:179], a[152:155], v[128:131], v[176:179]
  buffer_load_dwordx4 v1, s[12:15], s78 offen offset:2048 sc1 lds
  ds_read_b128 a[180:183], v3 offset:29696
  v_mfma_f32_16x16x32_bf16 v[176:179], a[156:159], v[160:163], v[176:179]
  v_exp_f32 v113, v113
  v_mfma_f32_16x16x32_bf16 v[180:183], a[144:147], v[68:71], v[204:207]
  ds_read_b128 a[184:187], v3 offset:30720
  ds_read_b128 a[188:191], v3 offset:31744
  v_cvt_pk_bf16_f32 v34, v112, v113
  v_mfma_f32_16x16x32_bf16 v[180:183], a[148:151], v[100:103], v[180:183]
  v_exp_f32 v114, v114
  s_waitcnt lgkmcnt(4)
  v_mfma_f32_16x16x32_bf16 v[180:183], a[152:155], v[132:135], v[180:183]
  buffer_load_dwordx4 v1, s[12:15], s78 offen offset:3072 sc1 lds
  s_add_u32 s78, s78, 49152
  v_mfma_f32_16x16x32_bf16 v[180:183], a[156:159], v[164:167], v[180:183]
  v_exp_f32 v115, v115
  v_mfma_f32_16x16x32_bf16 a[0:3], a[160:163], v[48:51], a[0:3]
  v_cvt_pk_bf16_f32 v35, v114, v115
  v_mov_b32 v3, v2
  v_add_u32 v2, 0x8000, v2
  v_mfma_f32_16x16x32_bf16 a[4:7], a[160:163], v[52:55], a[4:7]
  v_exp_f32 v84, v84
  v_and_b32 v2, 0x1ffff, v2
  v_mfma_f32_16x16x32_bf16 a[16:19], a[164:167], v[48:51], a[16:19]
  s_waitcnt vmcnt(16) lgkmcnt(0)
  s_barrier
  v_mfma_f32_16x16x32_bf16 a[20:23], a[164:167], v[52:55], a[20:23]
  v_exp_f32 v85, v85
  v_mfma_f32_16x16x32_bf16 a[32:35], a[168:171], v[48:51], a[32:35]
  ds_read_b128 a[128:131], v2 offset:0
  v_cvt_pk_bf16_f32 v36, v84, v85
  v_mfma_f32_16x16x32_bf16 a[36:39], a[168:171], v[52:55], a[36:39]
  v_exp_f32 v86, v86
  v_mfma_f32_16x16x32_bf16 a[48:51], a[172:175], v[48:51], a[48:51]
  ds_read_b128 a[132:135], v2 offset:1024
  ds_read_b128 a[136:139], v2 offset:2048
  v_mfma_f32_16x16x32_bf16 a[52:55], a[172:175], v[52:55], a[52:55]
  v_exp_f32 v87, v87
  v_mfma_f32_16x16x32_bf16 a[64:67], a[176:179], v[48:51], a[64:67]
  ds_read_b128 a[140:143], v2 offset:3072
  v_cvt_pk_bf16_f32 v37, v86, v87
  v_mfma_f32_16x16x32_bf16 a[68:71], a[176:179], v[52:55], a[68:71]
  v_exp_f32 v116, v116
  v_mfma_f32_16x16x32_bf16 a[80:83], a[180:183], v[48:51], a[80:83]
  ds_read_b128 a[144:147], v2 offset:4096
  ds_read_b128 a[148:151], v2 offset:5120
  v_mfma_f32_16x16x32_bf16 a[84:87], a[180:183], v[52:55], a[84:87]
  v_exp_f32 v117, v117
  v_mfma_f32_16x16x32_bf16 a[96:99], a[184:187], v[48:51], a[96:99]
  ds_read_b128 a[152:155], v2 offset:6144
  v_cvt_pk_bf16_f32 v38, v116, v117
  v_mfma_f32_16x16x32_bf16 a[100:103], a[184:187], v[52:55], a[100:103]
  v_exp_f32 v118, v118
  v_mfma_f32_16x16x32_bf16 a[112:115], a[188:191], v[48:51], a[112:115]
  ds_read_b128 a[156:159], v2 offset:7168
  v_mfma_f32_16x16x32_bf16 a[116:119], a[188:191], v[52:55], a[116:119]
  v_exp_f32 v119, v119
  v_mfma_f32_16x16x32_bf16 v[16:19], v[12:15], v[48:51], v[16:19]
  v_cvt_pk_bf16_f32 v39, v118, v119
  s_sub_u32 s86, s86, 1
  v_mfma_f32_16x16x32_bf16 v[20:23], v[12:15], v[52:55], v[20:23]
  s_waitcnt lgkmcnt(4)
  s_cbranch_scc0 Lss_f
  s_sub_u32 s1, s1, 1
  s_cbranch_scc1 Lss_f_done
  buffer_load_dwordx2 v[232:233], v234, s[8:11], s90 offen sc1
  s_mov_b32 s86, 1
  s_branch Lss_f_go
Lss_f_done:
  s_nop 0
  s_waitcnt vmcnt(8)
  v_and_b32 v232, v232, v233
  v_cmp_ne_u32 vcc, 1, v232
  s_nop 0
  s_cmp_lg_u64 vcc, 0
  s_cbranch_scc0 Lokf_5
  s_mov_b32 s86, 0x80000
Lspf_5:
  s_sub_u32 s86, s86, 1
  s_cbranch_scc1 Lokf_5
  s_sleep 1
  buffer_load_dwordx2 v[232:233], v234, s[8:11], s90 offen sc1
  s_waitcnt vmcnt(0)
  v_and_b32 v232, v232, v233
  v_cmp_ne_u32 vcc, 1, v232
  s_nop 0
  s_cmp_lg_u64 vcc, 0
  s_cbranch_scc1 Lspf_5
Lokf_5:
  s_getpc_b64 s[40:41]
Lct1_f:
  s_add_u32 s40, s40, Lfin_f-Lct1_f
  s_addc_u32 s41, s41, 0
  s_mov_b32 s42, Lend_f-Lfin_f
  s_mov_b32 s43, 0x20000
  s_cmp_eq_u32 s3, 0
  s_cselect_b32 s42, s42, 0
  s_lshr_b32 s76, s2, 3
  s_mul_i32 s76, s76, 1024
  v_min_u32 v238, 7, v0
  v_lshlrev_b32 v238, 7, v238
  buffer_load_dword v239, v238, s[40:43], s76 offen
  s_cmp_eq_u32 s0, 0
  s_cbranch_scc1 Lxt_f
  v_mfma_f32_16x16x32_bf16 v[80:83], a[128:131], v[64:67], v[192:195]
  ds_read_b128 a[160:163], v3 offset:16384
  s_and_b32 m0, s78, 0x1ffff
  v_mfma_f32_16x16x32_bf16 v[80:83], a[132:135], v[96:99], v[80:83]
  buffer_load_dwordx2 v[208:209], v236, s[16:19], s79 offen offset:0
  v_exp_f32 v144, v144
  v_mfma_f32_16x16x32_bf16 v[80:83], a[136:139], v[128:131], v[80:83]
  buffer_load_dwordx4 v1, s[12:15], s78 offen offset:0 sc1 lds
  ds_read_b128 a[164:167], v3 offset:17408
  v_mfma_f32_16x16x32_bf16 v[80:83], a[140:143], v[160:163], v[80:83]
  v_exp_f32 v145, v145
  v_mfma_f32_16x16x32_bf16 v[84:87], a[128:131], v[68:71], v[200:203]
  ds_read_b128 a[168:171], v3 offset:18432
  v_cvt_pk_bf16_f32 v48, v144, v145
  v_mfma_f32_16x16x32_bf16 v[84:87], a[132:135], v[100:103], v[84:87]
  v_exp_f32 v146, v146
  s_waitcnt lgkmcnt(3)
  v_mfma_f32_16x16x32_bf16 v[84:87], a[136:139], v[132:135], v[84:87]
  buffer_load_dwordx4 v1, s[12:15], s78 offen offset:1024 sc1 lds
  ds_read_b128 a[172:175], v3 offset:19456
  v_mfma_f32_16x16x32_bf16 v[84:87], a[140:143], v[164:167], v[84:87]
  v_exp_f32 v147, v147
  v_mfma_f32_16x16x32_bf16 v[112:115], a[144:147], v[64:67], v[196:199]
  ds_read_b128 a[176:179], v3 offset:20480
  buffer_load_dwordx2 v[210:211], v236, s[16:19], s79 offen offset:32
  v_cvt_pk_bf16_f32 v49, v146, v147
  v_mfma_f32_16x16x32_bf16 v[112:115], a[148:151], v[96:99], v[112:115]
  v_exp_f32 v176, v176
  v_mfma_f32_16x16x32_bf16 v[112:115], a[152:155], v[128:131], v[112:115]
  buffer_load_dwordx4 v1, s[12:15], s78 offen offset:2048 sc1 lds
  ds_read_b128 a[180:183], v3 offset:21504
  v_mfma_f32_16x16x32_bf16 v[112:115], a[156:159], v[160:163], v[112:115]
  v_exp_f32 v177, v177
  v_mfma_f32_16x16x32_bf16 v[116:119], a[144:147], v[68:71], v[204:207]
  ds_read_b128 a[184:187], v3 offset:22528
  ds_read_b128 a[188:191], v3 offset:23552
  v_cvt_pk_bf16_f32 v50, v176, v177
  v_mfma_f32_16x16x32_bf16 v[116:119], a[148:151], v[100:103], v[116:119]
  v_exp_f32 v178, v178
  s_waitcnt lgkmcnt(4)
  v_mfma_f32_16x16x32_bf16 v[116:119], a[152:155], v[132:135], v[116:119]
  buffer_load_dwordx4 v1, s[12:15], s78 offen offset:3072 sc1 lds
  s_sub_u32 s78, s78, 16384
  v_mfma_f32_16x16x32_bf16 v[116:119], a[156:159], v[164:167], v[116:119]
  v_exp_f32 v179, v179
  v_mfma_f32_16x16x32_bf16 a[0:3], a[160:163], v[32:35], a[0:3]
  ds_read_b128 a[128:131], v2 offset:8192
  buffer_load_dwordx2 v[212:213], v236, s[16:19], s79 offen offset:64
  v_cvt_pk_bf16_f32 v51, v178, v179
  v_mfma_f32_16x16x32_bf16 a[4:7], a[160:163], v[36:39], a[4:7]
  v_exp_f32 v148, v148
  v_mfma_f32_16x16x32_bf16 a[16:19], a[164:167], v[32:35], a[16:19]
  ds_read_b128 a[132:135], v2 offset:9216
  ds_read_b128 a[136:139], v2 offset:10240
  v_mfma_f32_16x16x32_bf16 a[20:23], a[164:167], v[36:39], a[20:23]
  v_exp_f32 v149, v149
  v_mfma_f32_16x16x32_bf16 a[32:35], a[168:171], v[32:35], a[32:35]
  ds_read_b128 a[140:143], v2 offset:11264
  v_cvt_pk_bf16_f32 v52, v148, v149
  v_mfma_f32_16x16x32_bf16 a[36:39], a[168:171], v[36:39], a[36:39]
  v_exp_f32 v150, v150
  v_mfma_f32_16x16x32_bf16 a[48:51], a[172:175], v[32:35], a[48:51]
  ds_read_b128 a[144:147], v2 offset:12288
  s_waitcnt lgkmcnt(5)
  v_mfma_f32_16x16x32_bf16 a[52:55], a[172:175], v[36:39], a[52:55]
  v_exp_f32 v151, v151
  v_mfma_f32_16x16x32_bf16 a[64:67], a[176:179], v[32:35], a[64:67]
  ds_read_b128 a[148:151], v2 offset:13312
  buffer_load_dwordx2 v[214:215], v236, s[16:19], s79 offen offset:96
  v_cvt_pk_bf16_f32 v53, v150, v151
  v_mfma_f32_16x16x32_bf16 a[68:71], a[176:179], v[36:39], a[68:71]
  v_exp_f32 v180, v180
  v_mfma_f32_16x16x32_bf16 a[80:83], a[180:183], v[32:35], a[80:83]
  ds_read_b128 a[152:155], v2 offset:14336
  ds_read_b128 a[156:159], v2 offset:15360
  v_mfma_f32_16x16x32_bf16 a[84:87], a[180:183], v[36:39], a[84:87]
  v_exp_f32 v181, v181
  v_mfma_f32_16x16x32_bf16 a[96:99], a[184:187], v[32:35], a[96:99]
  v_cvt_pk_bf16_f32 v54, v180, v181
  v_mfma_f32_16x16x32_bf16 a[100:103], a[184:187], v[36:39], a[100:103]
  v_exp_f32 v182, v182
  v_mfma_f32_16x16x32_bf16 a[112:115], a[188:191], v[32:35], a[112:115]
  v_mfma_f32_16x16x32_bf16 a[116:119], a[188:191], v[36:39], a[116:119]
  v_exp_f32 v183, v183
  v_mfma_f32_16x16x32_bf16 v[16:19], v[12:15], v[32:35], v[16:19]
  v_cvt_pk_bf16_f32 v55, v182, v183
  v_mfma_f32_16x16x32_bf16 v[20:23], v[12:15], v[36:39], v[20:23]
  s_waitcnt lgkmcnt(4)
  v_mfma_f32_16x16x32_bf16 v[144:147], a[128:131], v[64:67], v[192:195]
  ds_read_b128 a[160:163], v3 offset:24576
  s_and_b32 m0, s78, 0x1ffff
  v_mfma_f32_16x16x32_bf16 v[144:147], a[132:135], v[96:99], v[144:147]
  buffer_load_dword v216, v237, s[8:11], s83 offen offset:0 sc1
  v_exp_f32 v80, v80
  v_mfma_f32_16x16x32_bf16 v[144:147], a[136:139], v[128:131], v[144:147]
  buffer_load_dwordx4 v1, s[12:15], s78 offen offset:0 sc1 lds
  ds_read_b128 a[164:167], v3 offset:25600
  v_mfma_f32_16x16x32_bf16 v[144:147], a[140:143], v[160:163], v[144:147]
  v_exp_f32 v81, v81
  v_mfma_f32_16x16x32_bf16 v[148:151], a[128:131], v[68:71], v[200:203]
  ds_read_b128 a[168:171], v3 offset:26624
  v_cvt_pk_bf16_f32 v32, v80, v81
  v_mfma_f32_16x16x32_bf16 v[148:151], a[132:135], v[100:103], v[148:151]
  v_exp_f32 v82, v82
  s_waitcnt lgkmcnt(3)
  v_mfma_f32_16x16x32_bf16 v[148:151], a[136:139], v[132:135], v[148:151]
  buffer_load_dwordx4 v1, s[12:15], s78 offen offset:1024 sc1 lds
  ds_read_b128 a[172:175], v3 offset:27648
  buffer_load_dword v217, v237, s[8:11], s83 offen offset:2048 sc1
  s_add_u32 s83, s83, 4096
  v_mfma_f32_16x16x32_bf16 v[148:151], a[140:143], v[164:167], v[148:151]
  v_exp_f32 v83, v83
  v_mfma_f32_16x16x32_bf16 v[176:179], a[144:147], v[64:67], v[196:199]
  ds_read_b128 a[176:179], v3 offset:28672
  v_cvt_pk_bf16_f32 v33, v82, v83
  v_mfma_f32_16x16x32_bf16 v[176:179], a[148:151], v[96:99], v[176:179]
  buffer_load_dword v218, v237, s[8:11], s83 offen offset:0 sc1
  v_exp_f32 v112, v112
  v_mfma_f32_16x16x32_bf16 v[176:179], a[152:155], v[128:131], v[176:179]
  buffer_load_dwordx4 v1, s[12:15], s78 offen offset:2048 sc1 lds
  ds_read_b128 a[180:183], v3 offset:29696
  v_mfma_f32_16x16x32_bf16 v[176:179], a[156:159], v[160:163], v[176:179]
  v_exp_f32 v113, v113
  v_mfma_f32_16x16x32_bf16 v[180:183], a[144:147], v[68:71], v[204:207]
  ds_read_b128 a[184:187], v3 offset:30720
  ds_read_b128 a[188:191], v3 offset:31744
  v_cvt_pk_bf16_f32 v34, v112, v113
  v_mfma_f32_16x16x32_bf16 v[180:183], a[148:151], v[100:103], v[180:183]
  v_exp_f32 v114, v114
  s_waitcnt lgkmcnt(4)
  v_mfma_f32_16x16x32_bf16 v[180:183], a[152:155], v[132:135], v[180:183]
  buffer_load_dwordx4 v1, s[12:15], s78 offen offset:3072 sc1 lds
  s_add_u32 s77, s82, 32768
  buffer_load_dwordx4 a[8:11], v1, s[8:11], s77 offen offset:0 sc1
  s_add_u32 s78, s78, 49152
  v_mfma_f32_16x16x32_bf16 v[180:183], a[156:159], v[164:167], v[180:183]
  v_exp_f32 v115, v115
  v_mfma_f32_16x16x32_bf16 a[0:3], a[160:163], v[48:51], a[0:3]
  v_cvt_pk_bf16_f32 v35, v114, v115
  v_mov_b32 v3, v2
  v_add_u32 v2, 0x8000, v2
  v_mfma_f32_16x16x32_bf16 a[4:7], a[160:163], v[52:55], a[4:7]
  v_exp_f32 v84, v84
  v_and_b32 v2, 0x1ffff, v2
  v_mfma_f32_16x16x32_bf16 a[16:19], a[164:167], v[48:51], a[16:19]
  buffer_load_dwordx4 a[12:15], v1, s[8:11], s77 offen offset:1024 sc1
  s_waitcnt vmcnt(16) lgkmcnt(0)
  s_barrier
  v_mfma_f32_16x16x32_bf16 a[20:23], a[164:167], v[52:55], a[20:23]
  v_exp_f32 v85, v85
  v_mfma_f32_16x16x32_bf16 a[32:35], a[168:171], v[48:51], a[32:35]
  ds_read_b128 a[128:131], v2 offset:0
  v_cvt_pk_bf16_f32 v36, v84, v85
  v_mfma_f32_16x16x32_bf16 a[36:39], a[168:171], v[52:55], a[36:39]
  v_exp_f32 v86, v86
  v_mfma_f32_16x16x32_bf16 a[48:51], a[172:175], v[48:51], a[48:51]
  ds_read_b128 a[132:135], v2 offset:1024
  ds_read_b128 a[136:139], v2 offset:2048
  v_mfma_f32_16x16x32_bf16 a[52:55], a[172:175], v[52:55], a[52:55]
  buffer_load_dwordx4 a[24:27], v1, s[8:11], s77 offen offset:2048 sc1
  v_exp_f32 v87, v87
  v_mfma_f32_16x16x32_bf16 a[64:67], a[176:179], v[48:51], a[64:67]
  ds_read_b128 a[140:143], v2 offset:3072
  v_cvt_pk_bf16_f32 v37, v86, v87
  v_mfma_f32_16x16x32_bf16 a[68:71], a[176:179], v[52:55], a[68:71]
  v_exp_f32 v116, v116
  v_mfma_f32_16x16x32_bf16 a[80:83], a[180:183], v[48:51], a[80:83]
  ds_read_b128 a[144:147], v2 offset:4096
  ds_read_b128 a[148:151], v2 offset:5120
  v_mfma_f32_16x16x32_bf16 a[84:87], a[180:183], v[52:55], a[84:87]
  buffer_load_dwordx4 a[28:31], v1, s[8:11], s77 offen offset:3072 sc1
  v_exp_f32 v117, v117
  v_mfma_f32_16x16x32_bf16 a[96:99], a[184:187], v[48:51], a[96:99]
  ds_read_b128 a[152:155], v2 offset:6144
  v_cvt_pk_bf16_f32 v38, v116, v117
  v_mfma_f32_16x16x32_bf16 a[100:103], a[184:187], v[52:55], a[100:103]
  v_exp_f32 v118, v118
  v_mfma_f32_16x16x32_bf16 a[112:115], a[188:191], v[48:51], a[112:115]
  ds_read_b128 a[156:159], v2 offset:7168
  v_mfma_f32_16x16x32_bf16 a[116:119], a[188:191], v[52:55], a[116:119]
  v_exp_f32 v119, v119
  v_mfma_f32_16x16x32_bf16 v[16:19], v[12:15], v[48:51], v[16:19]
  v_cvt_pk_bf16_f32 v39, v118, v119
  v_mfma_f32_16x16x32_bf16 v[20:23], v[12:15], v[52:55], v[20:23]
  s_waitcnt lgkmcnt(4)
  v_mfma_f32_16x16x32_bf16 v[80:83], a[128:131], v[64:67], v[192:195]
  ds_read_b128 a[160:163], v3 offset:16384
  s_and_b32 m0, s78, 0x1ffff
  v_mfma_f32_16x16x32_bf16 v[80:83], a[132:135], v[96:99], v[80:83]
  s_add_u32 s77, s82, 36864
  buffer_load_dwordx4 a[40:43], v1, s[8:11], s77 offen offset:0 sc1
  v_exp_f32 v144, v144
  v_mfma_f32_16x16x32_bf16 v[80:83], a[136:139], v[128:131], v[80:83]
  buffer_load_dwordx4 v1, s[12:15], s78 offen offset:0 sc1 lds
  ds_read_b128 a[164:167], v3 offset:17408
  v_mfma_f32_16x16x32_bf16 v[80:83], a[140:143], v[160:163], v[80:83]
  v_exp_f32 v145, v145
  v_mfma_f32_16x16x32_bf16 v[84:87], a[128:131], v[68:71], v[200:203]
  ds_read_b128 a[168:171], v3 offset:18432
  v_cvt_pk_bf16_f32 v48, v144, v145
  v_mfma_f32_16x16x32_bf16 v[84:87], a[132:135], v[100:103], v[84:87]
  v_exp_f32 v146, v146
  s_waitcnt lgkmcnt(3)
  v_mfma_f32_16x16x32_bf16 v[84:87], a[136:139], v[132:135], v[84:87]
  buffer_load_dwordx4 v1, s[12:15], s78 offen offset:1024 sc1 lds
  ds_read_b128 a[172:175], v3 offset:19456
  buffer_load_dwordx4 a[44:47], v1, s[8:11], s77 offen offset:1024 sc1
  v_mfma_f32_16x16x32_bf16 v[84:87], a[140:143], v[164:167], v[84:87]
  v_exp_f32 v147, v147
  v_mfma_f32_16x16x32_bf16 v[112:115], a[144:147], v[64:67], v[196:199]
  ds_read_b128 a[176:179], v3 offset:20480
  v_cvt_pk_bf16_f32 v49, v146, v147
  v_mfma_f32_16x16x32_bf16 v[112:115], a[148:151], v[96:99], v[112:115]
  v_exp_f32 v176, v176
  v_mfma_f32_16x16x32_bf16 v[112:115], a[152:155], v[128:131], v[112:115]
  buffer_load_dwordx4 v1, s[12:15], s78 offen offset:2048 sc1 lds
  ds_read_b128 a[180:183], v3 offset:21504
  v_mfma_f32_16x16x32_bf16 v[112:115], a[156:159], v[160:163], v[112:115]
  buffer_load_dwordx4 a[56:59], v1, s[8:11], s77 offen offset:2048 sc1
  v_exp_f32 v177, v177
  v_mfma_f32_16x16x32_bf16 v[116:119], a[144:147], v[68:71], v[204:207]
  ds_read_b128 a[184:187], v3 offset:22528
  ds_read_b128 a[188:191], v3 offset:23552
  v_cvt_pk_bf16_f32 v50, v176, v177
  v_mfma_f32_16x16x32_bf16 v[116:119], a[148:151], v[100:103], v[116:119]
  v_exp_f32 v178, v178
  s_waitcnt lgkmcnt(4)
  v_mfma_f32_16x16x32_bf16 v[116:119], a[152:155], v[132:135], v[116:119]
  buffer_load_dwordx4 v1, s[12:15], s78 offen offset:3072 sc1 lds
  s_sub_u32 s78, s78, 16384
  v_mfma_f32_16x16x32_bf16 v[116:119], a[156:159], v[164:167], v[116:119]
  v_exp_f32 v179, v179
  v_mfma_f32_16x16x32_bf16 a[0:3], a[160:163], v[32:35], a[0:3]
  ds_read_b128 a[128:131], v2 offset:8192
  buffer_load_dwordx4 a[60:63], v1, s[8:11], s77 offen offset:3072 sc1
  v_cvt_pk_bf16_f32 v51, v178, v179
  v_mfma_f32_16x16x32_bf16 a[4:7], a[160:163], v[36:39], a[4:7]
  v_exp_f32 v148, v148
  v_mfma_f32_16x16x32_bf16 a[16:19], a[164:167], v[32:35], a[16:19]
  ds_read_b128 a[132:135], v2 offset:9216
  ds_read_b128 a[136:139], v2 offset:10240
  v_mfma_f32_16x16x32_bf16 a[20:23], a[164:167], v[36:39], a[20:23]
  v_exp_f32 v149, v149
  v_mfma_f32_16x16x32_bf16 a[32:35], a[168:171], v[32:35], a[32:35]
  ds_read_b128 a[140:143], v2 offset:11264
  v_cvt_pk_bf16_f32 v52, v148, v149
  v_mfma_f32_16x16x32_bf16 a[36:39], a[168:171], v[36:39], a[36:39]
  s_add_u32 s77, s82, 40960
  buffer_load_dwordx4 a[72:75], v1, s[8:11], s77 offen offset:0 sc1
  v_exp_f32 v150, v150
  v_mfma_f32_16x16x32_bf16 a[48:51], a[172:175], v[32:35], a[48:51]
  ds_read_b128 a[144:147], v2 offset:12288
  s_waitcnt lgkmcnt(5)
  v_mfma_f32_16x16x32_bf16 a[52:55], a[172:175], v[36:39], a[52:55]
  v_exp_f32 v151, v151
  v_mfma_f32_16x16x32_bf16 a[64:67], a[176:179], v[32:35], a[64:67]
  ds_read_b128 a[148:151], v2 offset:13312
  v_cvt_pk_bf16_f32 v53, v150, v151
  v_mfma_f32_16x16x32_bf16 a[68:71], a[176:179], v[36:39], a[68:71]
  v_exp_f32 v180, v180
  v_mfma_f32_16x16x32_bf16 a[80:83], a[180:183], v[32:35], a[80:83]
  ds_read_b128 a[152:155], v2 offset:14336
  ds_read_b128 a[156:159], v2 offset:15360
  v_mfma_f32_16x16x32_bf16 a[84:87], a[180:183], v[36:39], a[84:87]
  v_exp_f32 v181, v181
  v_mfma_f32_16x16x32_bf16 a[96:99], a[184:187], v[32:35], a[96:99]
  buffer_load_dwordx4 a[76:79], v1, s[8:11], s77 offen offset:1024 sc1
  v_cvt_pk_bf16_f32 v54, v180, v181
  v_mfma_f32_16x16x32_bf16 a[100:103], a[184:187], v[36:39], a[100:103]
  v_exp_f32 v182, v182
  v_mfma_f32_16x16x32_bf16 a[112:115], a[188:191], v[32:35], a[112:115]
  v_mfma_f32_16x16x32_bf16 a[116:119], a[188:191], v[36:39], a[116:119]
  v_exp_f32 v183, v183
  v_mfma_f32_16x16x32_bf16 v[16:19], v[12:15], v[32:35], v[16:19]
  v_cvt_pk_bf16_f32 v55, v182, v183
  v_mfma_f32_16x16x32_bf16 v[20:23], v[12:15], v[36:39], v[20:23]
  s_waitcnt lgkmcnt(4)
  v_mfma_f32_16x16x32_bf16 v[144:147], a[128:131], v[64:67], v[192:195]
  ds_read_b128 a[160:163], v3 offset:24576
  s_and_b32 m0, s78, 0x1ffff
  v_mfma_f32_16x16x32_bf16 v[144:147], a[132:135], v[96:99], v[144:147]
  buffer_load_dwordx4 a[88:91], v1, s[8:11], s77 offen offset:2048 sc1
  v_exp_f32 v80, v80
  v_mfma_f32_16x16x32_bf16 v[144:147], a[136:139], v[128:131], v[144:147]
  buffer_load_dwordx4 v1, s[12:15], s78 offen offset:0 sc1 lds
  ds_read_b128 a[164:167], v3 offset:25600
  v_mfma_f32_16x16x32_bf16 v[144:147], a[140:143], v[160:163], v[144:147]
  v_exp_f32 v81, v81
  v_mfma_f32_16x16x32_bf16 v[148:151], a[128:131], v[68:71], v[200:203]
  ds_read_b128 a[168:171], v3 offset:26624
  v_cvt_pk_bf16_f32 v32, v80, v81
  v_mfma_f32_16x16x32_bf16 v[148:151], a[132:135], v[100:103], v[148:151]
  v_exp_f32 v82, v82
  s_waitcnt lgkmcnt(3)
  v_mfma_f32_16x16x32_bf16 v[148:151], a[136:139], v[132:135], v[148:151]
  buffer_load_dwordx4 v1, s[12:15], s78 offen offset:1024 sc1 lds
  ds_read_b128 a[172:175], v3 offset:27648
  buffer_load_dwordx4 a[92:95], v1, s[8:11], s77 offen offset:3072 sc1
  v_mfma_f32_16x16x32_bf16 v[148:151], a[140:143], v[164:167], v[148:151]
  v_exp_f32 v83, v83
  v_mfma_f32_16x16x32_bf16 v[176:179], a[144:147], v[64:67], v[196:199]
  ds_read_b128 a[176:179], v3 offset:28672
  v_cvt_pk_bf16_f32 v33, v82, v83
  v_mfma_f32_16x16x32_bf16 v[176:179], a[148:151], v[96:99], v[176:179]
  v_exp_f32 v112, v112
  v_mfma_f32_16x16x32_bf16 v[176:179], a[152:155], v[128:131], v[176:179]
  buffer_load_dwordx4 v1, s[12:15], s78 offen offset:2048 sc1 lds
  ds_read_b128 a[180:183], v3 offset:29696
  v_mfma_f32_16x16x32_bf16 v[176:179], a[156:159], v[160:163], v[176:179]
  s_add_u32 s77, s82, 45056
  buffer_load_dwordx4 a[104:107], v1, s[8:11], s77 offen offset:0 sc1
  v_exp_f32 v113, v113
  v_mfma_f32_16x16x32_bf16 v[180:183], a[144:147], v[68:71], v[204:207]
  ds_read_b128 a[184:187], v3 offset:30720
  ds_read_b128 a[188:191], v3 offset:31744
  v_cvt_pk_bf16_f32 v34, v112, v113
  v_mfma_f32_16x16x32_bf16 v[180:183], a[148:151], v[100:103], v[180:183]
  v_exp_f32 v114, v114
  s_waitcnt lgkmcnt(4)
  v_mfma_f32_16x16x32_bf16 v[180:183], a[152:155], v[132:135], v[180:183]
  buffer_load_dwordx4 v1, s[12:15], s78 offen offset:3072 sc1 lds
  s_add_u32 s78, s78, 49152
  v_mfma_f32_16x16x32_bf16 v[180:183], a[156:159], v[164:167], v[180:183]
  v_exp_f32 v115, v115
  v_mfma_f32_16x16x32_bf16 a[0:3], a[160:163], v[48:51], a[0:3]
  v_cvt_pk_bf16_f32 v35, v114, v115
  v_mov_b32 v3, v2
  v_add_u32 v2, 0x8000, v2
  v_mfma_f32_16x16x32_bf16 a[4:7], a[160:163], v[52:55], a[4:7]
  v_exp_f32 v84, v84
  v_and_b32 v2, 0x1ffff, v2
  v_mfma_f32_16x16x32_bf16 a[16:19], a[164:167], v[48:51], a[16:19]
  buffer_load_dwordx4 a[108:111], v1, s[8:11], s77 offen offset:1024 sc1
  s_waitcnt vmcnt(16) lgkmcnt(0)
  s_barrier
  v_mfma_f32_16x16x32_bf16 a[20:23], a[164:167], v[52:55], a[20:23]
  v_exp_f32 v85, v85
  v_mfma_f32_16x16x32_bf16 a[32:35], a[168:171], v[48:51], a[32:35]
  ds_read_b128 a[128:131], v2 offset:0
  v_cvt_pk_bf16_f32 v36, v84, v85
  v_mfma_f32_16x16x32_bf16 a[36:39], a[168:171], v[52:55], a[36:39]
  buffer_load_dwordx4 a[120:123], v1, s[8:11], s77 offen offset:2048 sc1
  v_exp_f32 v86, v86
  v_mfma_f32_16x16x32_bf16 a[48:51], a[172:175], v[48:51], a[48:51]
  ds_read_b128 a[132:135], v2 offset:1024
  ds_read_b128 a[136:139], v2 offset:2048
  v_mfma_f32_16x16x32_bf16 a[52:55], a[172:175], v[52:55], a[52:55]
  v_exp_f32 v87, v87
  v_mfma_f32_16x16x32_bf16 a[64:67], a[176:179], v[48:51], a[64:67]
  ds_read_b128 a[140:143], v2 offset:3072
  v_cvt_pk_bf16_f32 v37, v86, v87
  v_mfma_f32_16x16x32_bf16 a[68:71], a[176:179], v[52:55], a[68:71]
  v_exp_f32 v116, v116
  v_mfma_f32_16x16x32_bf16 a[80:83], a[180:183], v[48:51], a[80:83]
  ds_read_b128 a[144:147], v2 offset:4096
  ds_read_b128 a[148:151], v2 offset:5120
  buffer_load_dwordx4 a[124:127], v1, s[8:11], s77 offen offset:3072 sc1
  v_mfma_f32_16x16x32_bf16 a[84:87], a[180:183], v[52:55], a[84:87]
  v_exp_f32 v117, v117
  v_mfma_f32_16x16x32_bf16 a[96:99], a[184:187], v[48:51], a[96:99]
  ds_read_b128 a[152:155], v2 offset:6144
  v_cvt_pk_bf16_f32 v38, v116, v117
  v_mfma_f32_16x16x32_bf16 a[100:103], a[184:187], v[52:55], a[100:103]
  v_exp_f32 v118, v118
  v_mfma_f32_16x16x32_bf16 a[112:115], a[188:191], v[48:51], a[112:115]
  ds_read_b128 a[156:159], v2 offset:7168
  v_mfma_f32_16x16x32_bf16 a[116:119], a[188:191], v[52:55], a[116:119]
  v_exp_f32 v119, v119
  v_mfma_f32_16x16x32_bf16 v[16:19], v[12:15], v[48:51], v[16:19]
  v_cvt_pk_bf16_f32 v39, v118, v119
  v_mfma_f32_16x16x32_bf16 v[20:23], v[12:15], v[52:55], v[20:23]
  s_waitcnt lgkmcnt(4)
  s_branch Lxs_f
Lxt_f:
  buffer_load_dwordx2 v[208:209], v236, s[16:19], s79 offen offset:0
  buffer_load_dwordx2 v[210:211], v236, s[16:19], s79 offen offset:32
  buffer_load_dwordx2 v[212:213], v236, s[16:19], s79 offen offset:64
  buffer_load_dwordx2 v[214:215], v236, s[16:19], s79 offen offset:96
  buffer_load_dword v216, v237, s[8:11], s83 offen offset:0 sc1
  buffer_load_dword v217, v237, s[8:11], s83 offen offset:2048 sc1
  s_add_u32 s83, s83, 4096
  buffer_load_dword v218, v237, s[8:11], s83 offen offset:0 sc1
Lxs_f:
  s_bitcmp1_b32 s3, 0
  s_cbranch_scc1 Lodd2_f
  v_cndmask_b32 v192, v255, v192, s[24:25]
  v_cndmask_b32 v204, v255, v204, s[24:25]
  v_mov_b32 v196, v255
  v_cndmask_b32 v193, v255, v193, s[26:27]
  v_cndmask_b32 v205, v255, v205, s[26:27]
  v_mov_b32 v197, v255
  v_cndmask_b32 v194, v255, v194, s[32:33]
  v_cndmask_b32 v206, v255, v206, s[32:33]
  v_mov_b32 v198, v255
  v_cndmask_b32 v195, v255, v195, s[34:35]
  v_cndmask_b32 v207, v255, v207, s[34:35]
  v_mov_b32 v199, v255
  s_nop 1
  v_mfma_f32_16x16x32_bf16 v[80:83], a[128:131], v[64:67], v[192:195]
  ds_read_b128 a[160:163], v3 offset:16384
  s_and_b32 m0, s78, 0x1ffff
  v_mfma_f32_16x16x32_bf16 v[80:83], a[132:135], v[96:99], v[80:83]
  s_add_u32 s77, s82, 0
  buffer_load_dwordx4 a[192:195], v1, s[8:11], s77 offen offset:0 sc1
  v_exp_f32 v144, v144
  v_mfma_f32_16x16x32_bf16 v[80:83], a[136:139], v[128:131], v[80:83]
  buffer_load_dwordx4 v1, s[12:15], s78 offen offset:0 sc1 lds
  ds_read_b128 a[164:167], v3 offset:17408
  v_mfma_f32_16x16x32_bf16 v[80:83], a[140:143], v[160:163], v[80:83]
  v_exp_f32 v145, v145
  v_mfma_f32_16x16x32_bf16 v[84:87], a[128:131], v[68:71], v[200:203]
  ds_read_b128 a[168:171], v3 offset:18432
  buffer_load_dwordx4 a[196:199], v1, s[8:11], s77 offen offset:1024 sc1
  v_cvt_pk_bf16_f32 v48, v144, v145
  v_mfma_f32_16x16x32_bf16 v[84:87], a[132:135], v[100:103], v[84:87]
  v_exp_f32 v146, v146
  s_waitcnt lgkmcnt(3)
  v_mfma_f32_16x16x32_bf16 v[84:87], a[136:139], v[132:135], v[84:87]
  buffer_load_dwordx4 v1, s[12:15], s78 offen offset:1024 sc1 lds
  ds_read_b128 a[172:175], v3 offset:19456
  v_mfma_f32_16x16x32_bf16 v[84:87], a[140:143], v[164:167], v[84:87]
  buffer_load_dwordx4 a[200:203], v1, s[8:11], s77 offen offset:2048 sc1
  v_exp_f32 v147, v147
  v_mfma_f32_16x16x32_bf16 v[112:115], a[144:147], v[64:67], v[196:199]
  ds_read_b128 a[176:179], v3 offset:20480
  v_cvt_pk_bf16_f32 v49, v146, v147
  v_mfma_f32_16x16x32_bf16 v[112:115], a[148:151], v[96:99], v[112:115]
  v_exp_f32 v176, v176
  v_mfma_f32_16x16x32_bf16 v[112:115], a[152:155], v[128:131], v[112:115]
  buffer_load_dwordx4 v1, s[12:15], s78 offen offset:2048 sc1 lds
  ds_read_b128 a[180:183], v3 offset:21504
  buffer_load_dwordx4 a[204:207], v1, s[8:11], s77 offen offset:3072 sc1
  v_mfma_f32_16x16x32_bf16 v[112:115], a[156:159], v[160:163], v[112:115]
  v_exp_f32 v177, v177
  v_mfma_f32_16x16x32_bf16 v[116:119], a[144:147], v[68:71], v[204:207]
  ds_read_b128 a[184:187], v3 offset:22528
  ds_read_b128 a[188:191], v3 offset:23552
  v_cvt_pk_bf16_f32 v50, v176, v177
  v_mfma_f32_16x16x32_bf16 v[116:119], a[148:151], v[100:103], v[116:119]
  v_exp_f32 v178, v178
  s_waitcnt lgkmcnt(4)
  v_mfma_f32_16x16x32_bf16 v[116:119], a[152:155], v[132:135], v[116:119]
  buffer_load_dwordx4 v1, s[12:15], s78 offen offset:3072 sc1 lds
  s_add_u32 s77, s82, 4096
  buffer_load_dwordx4 a[208:211], v1, s[8:11], s77 offen offset:0 sc1
  s_sub_u32 s78, s78, 16384
  v_mfma_f32_16x16x32_bf16 v[116:119], a[156:159], v[164:167], v[116:119]
  v_exp_f32 v179, v179
  v_mfma_f32_16x16x32_bf16 a[0:3], a[160:163], v[32:35], a[0:3]
  ds_read_b128 a[128:131], v2 offset:8192
  buffer_load_dwordx4 a[212:215], v1, s[8:11], s77 offen offset:1024 sc1
  v_cvt_pk_bf16_f32 v51, v178, v179
  v_mfma_f32_16x16x32_bf16 a[4:7], a[160:163], v[36:39], a[4:7]
  v_exp_f32 v148, v148
  v_mfma_f32_16x16x32_bf16 a[16:19], a[164:167], v[32:35], a[16:19]
  ds_read_b128 a[132:135], v2 offset:9216
  ds_read_b128 a[136:139], v2 offset:10240
  v_mfma_f32_16x16x32_bf16 a[20:23], a[164:167], v[36:39], a[20:23]
  buffer_load_dwordx4 a[216:219], v1, s[8:11], s77 offen offset:2048 sc1
  v_exp_f32 v149, v149
  v_mfma_f32_16x16x32_bf16 a[32:35], a[168:171], v[32:35], a[32:35]
  ds_read_b128 a[140:143], v2 offset:11264
  v_cvt_pk_bf16_f32 v52, v148, v149
  v_mfma_f32_16x16x32_bf16 a[36:39], a[168:171], v[36:39], a[36:39]
  v_exp_f32 v150, v150
  v_mfma_f32_16x16x32_bf16 a[48:51], a[172:175], v[32:35], a[48:51]
  ds_read_b128 a[144:147], v2 offset:12288
  buffer_load_dwordx4 a[220:223], v1, s[8:11], s77 offen offset:3072 sc1
  s_waitcnt lgkmcnt(5)
  v_mfma_f32_16x16x32_bf16 a[52:55], a[172:175], v[36:39], a[52:55]
  v_exp_f32 v151, v151
  v_mfma_f32_16x16x32_bf16 a[64:67], a[176:179], v[32:35], a[64:67]
  ds_read_b128 a[148:151], v2 offset:13312
  v_cvt_pk_bf16_f32 v53, v150, v151
  v_mfma_f32_16x16x32_bf16 a[68:71], a[176:179], v[36:39], a[68:71]
  s_add_u32 s77, s82, 8192
  buffer_load_dwordx4 a[224:227], v1, s[8:11], s77 offen offset:0 sc1
  v_exp_f32 v180, v180
  v_mfma_f32_16x16x32_bf16 a[80:83], a[180:183], v[32:35], a[80:83]
  ds_read_b128 a[152:155], v2 offset:14336
  ds_read_b128 a[156:159], v2 offset:15360
  v_mfma_f32_16x16x32_bf16 a[84:87], a[180:183], v[36:39], a[84:87]
  v_exp_f32 v181, v181
  v_mfma_f32_16x16x32_bf16 a[96:99], a[184:187], v[32:35], a[96:99]
  buffer_load_dwordx4 a[228:231], v1, s[8:11], s77 offen offset:1024 sc1
  v_cvt_pk_bf16_f32 v54, v180, v181
  v_mfma_f32_16x16x32_bf16 a[100:103], a[184:187], v[36:39], a[100:103]
  v_exp_f32 v182, v182
  v_mfma_f32_16x16x32_bf16 a[112:115], a[188:191], v[32:35], a[112:115]
  v_mfma_f32_16x16x32_bf16 a[116:119], a[188:191], v[36:39], a[116:119]
  v_exp_f32 v183, v183
  v_mfma_f32_16x16x32_bf16 v[16:19], v[12:15], v[32:35], v[16:19]
  v_cvt_pk_bf16_f32 v55, v182, v183
  v_mfma_f32_16x16x32_bf16 v[20:23], v[12:15], v[36:39], v[20:23]
  s_waitcnt lgkmcnt(4)
  ds_read_b128 a[160:163], v3 offset:24576
  ds_read_b128 a[164:167], v3 offset:25600
  ds_read_b128 a[168:171], v3 offset:26624
  ds_read_b128 a[172:175], v3 offset:27648
  ds_read_b128 a[176:179], v3 offset:28672
  ds_read_b128 a[180:183], v3 offset:29696
  ds_read_b128 a[184:187], v3 offset:30720
  ds_read_b128 a[188:191], v3 offset:31744
  s_waitcnt lgkmcnt(4)
  v_mov_b32 v3, v2
  v_add_u32 v2, 0x8000, v2
  v_and_b32 v2, 0x1ffff, v2
  s_and_b32 m0, s78, 0x1ffff
  s_nop 0
  buffer_load_dwordx4 v1, s[12:15], s78 offen offset:0 sc1 lds
  buffer_load_dwordx4 v1, s[12:15], s78 offen offset:1024 sc1 lds
  buffer_load_dwordx4 v1, s[12:15], s78 offen offset:2048 sc1 lds
  buffer_load_dwordx4 v1, s[12:15], s78 offen offset:3072 sc1 lds
  s_add_u32 s78, s78, 49152
  v_mfma_f32_16x16x32_bf16 a[0:3], a[160:163], v[48:51], a[0:3]
  v_mfma_f32_16x16x32_bf16 a[4:7], a[160:163], v[52:55], a[4:7]
  buffer_load_dwordx4 a[232:235], v1, s[8:11], s77 offen offset:2048 sc1
  v_exp_f32 v80, v80
  v_mfma_f32_16x16x32_bf16 a[16:19], a[164:167], v[48:51], a[16:19]
  v_exp_f32 v81, v81
  v_mfma_f32_16x16x32_bf16 a[20:23], a[164:167], v[52:55], a[20:23]
  buffer_load_dwordx4 a[236:239], v1, s[8:11], s77 offen offset:3072 sc1
  v_exp_f32 v82, v82
  v_mfma_f32_16x16x32_bf16 a[32:35], a[168:171], v[48:51], a[32:35]
  v_exp_f32 v83, v83
  v_mfma_f32_16x16x32_bf16 a[36:39], a[168:171], v[52:55], a[36:39]
  v_exp_f32 v112, v112
  v_mfma_f32_16x16x32_bf16 a[48:51], a[172:175], v[48:51], a[48:51]
  s_add_u32 s77, s82, 12288
  buffer_load_dwordx4 a[240:243], v1, s[8:11], s77 offen offset:0 sc1
  v_exp_f32 v113, v113
  v_mfma_f32_16x16x32_bf16 a[52:55], a[172:175], v[52:55], a[52:55]
  v_exp_f32 v114, v114
  v_cvt_pk_bf16_f32 v34, v112, v113
  s_waitcnt vmcnt(16) lgkmcnt(0)
  s_barrier
  v_mfma_f32_16x16x32_bf16 a[64:67], a[176:179], v[48:51], a[64:67]
  ds_read_b128 a[128:131], v2 offset:0
  buffer_load_dwordx4 a[244:247], v1, s[8:11], s77 offen offset:1024 sc1
  v_exp_f32 v115, v115
  v_mfma_f32_16x16x32_bf16 a[68:71], a[176:179], v[52:55], a[68:71]
  v_exp_f32 v84, v84
  v_cvt_pk_bf16_f32 v35, v114, v115
  v_mfma_f32_16x16x32_bf16 a[80:83], a[180:183], v[48:51], a[80:83]
  ds_read_b128 a[132:135], v2 offset:1024
  v_exp_f32 v85, v85
  v_mfma_f32_16x16x32_bf16 a[84:87], a[180:183], v[52:55], a[84:87]
  buffer_load_dwordx4 a[248:251], v1, s[8:11], s77 offen offset:2048 sc1
  v_exp_f32 v86, v86
  v_cvt_pk_bf16_f32 v36, v84, v85
  v_mfma_f32_16x16x32_bf16 a[96:99], a[184:187], v[48:51], a[96:99]
  ds_read_b128 a[136:139], v2 offset:2048
  v_exp_f32 v87, v87
  v_mfma_f32_16x16x32_bf16 a[100:103], a[184:187], v[52:55], a[100:103]
  buffer_load_dwordx4 a[252:255], v1, s[8:11], s77 offen offset:3072 sc1
  v_exp_f32 v116, v116
  v_cvt_pk_bf16_f32 v37, v86, v87
  v_mfma_f32_16x16x32_bf16 a[112:115], a[188:191], v[48:51], a[112:115]
  ds_read_b128 a[140:143], v2 offset:3072
  v_exp_f32 v117, v117
  v_mfma_f32_16x16x32_bf16 a[116:119], a[188:191], v[52:55], a[116:119]
  v_exp_f32 v118, v118
  v_cvt_pk_bf16_f32 v38, v116, v117
  v_mfma_f32_16x16x32_bf16 v[16:19], v[12:15], v[48:51], v[16:19]
  ds_read_b128 a[144:147], v2 offset:4096
  ds_read_b128 a[148:151], v2 offset:5120
  ds_read_b128 a[152:155], v2 offset:6144
  ds_read_b128 a[156:159], v2 offset:7168
  v_exp_f32 v119, v119
  v_mfma_f32_16x16x32_bf16 v[20:23], v[12:15], v[52:55], v[20:23]
  v_cvt_pk_bf16_f32 v32, v80, v81
  v_cvt_pk_bf16_f32 v33, v82, v83
  v_cvt_pk_bf16_f32 v39, v118, v119
  s_waitcnt lgkmcnt(4)
  ds_read_b128 a[160:163], v3 offset:16384
  ds_read_b128 a[164:167], v3 offset:17408
  ds_read_b128 a[168:171], v3 offset:18432
  ds_read_b128 a[172:175], v3 offset:19456
  ds_read_b128 a[176:179], v3 offset:20480
  ds_read_b128 a[180:183], v3 offset:21504
  ds_read_b128 a[184:187], v3 offset:22528
  ds_read_b128 a[188:191], v3 offset:23552
  s_waitcnt lgkmcnt(4)
  v_mfma_f32_16x16x32_bf16 a[0:3], a[160:163], v[32:35], a[0:3]
  s_add_u32 m0, s81, 0
  s_add_u32 s77, s82, 65536
  buffer_load_dwordx4 v1, s[8:11], s77 offen offset:0 sc1 lds
  v_mfma_f32_16x16x32_bf16 a[4:7], a[160:163], v[36:39], a[4:7]
  v_mfma_f32_16x16x32_bf16 a[16:19], a[164:167], v[32:35], a[16:19]
  buffer_load_dwordx4 v1, s[8:11], s77 offen offset:1024 sc1 lds
  v_mfma_f32_16x16x32_bf16 a[20:23], a[164:167], v[36:39], a[20:23]
  v_mfma_f32_16x16x32_bf16 a[32:35], a[168:171], v[32:35], a[32:35]
  buffer_load_dwordx4 v1, s[8:11], s77 offen offset:2048 sc1 lds
  v_mfma_f32_16x16x32_bf16 a[36:39], a[168:171], v[36:39], a[36:39]
  s_waitcnt lgkmcnt(0)
  v_mfma_f32_16x16x32_bf16 a[48:51], a[172:175], v[32:35], a[48:51]
  buffer_load_dwordx4 v1, s[8:11], s77 offen offset:3072 sc1 lds
  v_mfma_f32_16x16x32_bf16 a[52:55], a[172:175], v[36:39], a[52:55]
  v_mfma_f32_16x16x32_bf16 a[64:67], a[176:179], v[32:35], a[64:67]
  s_add_u32 m0, s81, 4096
  s_add_u32 s77, s82, 69632
  buffer_load_dwordx4 v1, s[8:11], s77 offen offset:0 sc1 lds
  v_mfma_f32_16x16x32_bf16 a[68:71], a[176:179], v[36:39], a[68:71]
  v_mfma_f32_16x16x32_bf16 a[80:83], a[180:183], v[32:35], a[80:83]
  buffer_load_dwordx4 v1, s[8:11], s77 offen offset:1024 sc1 lds
  v_mfma_f32_16x16x32_bf16 a[84:87], a[180:183], v[36:39], a[84:87]
  v_mfma_f32_16x16x32_bf16 a[96:99], a[184:187], v[32:35], a[96:99]
  buffer_load_dwordx4 v1, s[8:11], s77 offen offset:2048 sc1 lds
  v_mfma_f32_16x16x32_bf16 a[100:103], a[184:187], v[36:39], a[100:103]
  v_mfma_f32_16x16x32_bf16 a[112:115], a[188:191], v[32:35], a[112:115]
  buffer_load_dwordx4 v1, s[8:11], s77 offen offset:3072 sc1 lds
  v_mfma_f32_16x16x32_bf16 a[116:119], a[188:191], v[36:39], a[116:119]
  v_mfma_f32_16x16x32_bf16 v[16:19], v[12:15], v[32:35], v[16:19]
  v_mfma_f32_16x16x32_bf16 v[20:23], v[12:15], v[36:39], v[20:23]
  s_branch Lfin_f
Lodd2_f:
  v_mfma_f32_16x16x32_bf16 v[80:83], a[128:131], v[64:67], v[192:195]
  ds_read_b128 a[160:163], v3 offset:16384
  s_and_b32 m0, s78, 0x1ffff
  v_mfma_f32_16x16x32_bf16 v[80:83], a[132:135], v[96:99], v[80:83]
  s_add_u32 s77, s82, 0
  buffer_load_dwordx4 a[192:195], v1, s[8:11], s77 offen offset:0 sc1
  v_exp_f32 v144, v144
  v_mfma_f32_16x16x32_bf16 v[80:83], a[136:139], v[128:131], v[80:83]
  buffer_load_dwordx4 v1, s[12:15], s78 offen offset:0 sc1 lds
  ds_read_b128 a[164:167], v3 offset:17408
  v_mfma_f32_16x16x32_bf16 v[80:83], a[140:143], v[160:163], v[80:83]
  v_exp_f32 v145, v145
  v_mfma_f32_16x16x32_bf16 v[84:87], a[128:131], v[68:71], v[200:203]
  ds_read_b128 a[168:171], v3 offset:18432
  buffer_load_dwordx4 a[196:199], v1, s[8:11], s77 offen offset:1024 sc1
  v_cvt_pk_bf16_f32 v48, v144, v145
  v_mfma_f32_16x16x32_bf16 v[84:87], a[132:135], v[100:103], v[84:87]
  v_exp_f32 v146, v146
  s_waitcnt lgkmcnt(3)
  v_mfma_f32_16x16x32_bf16 v[84:87], a[136:139], v[132:135], v[84:87]
  buffer_load_dwordx4 v1, s[12:15], s78 offen offset:1024 sc1 lds
  ds_read_b128 a[172:175], v3 offset:19456
  v_mfma_f32_16x16x32_bf16 v[84:87], a[140:143], v[164:167], v[84:87]
  v_exp_f32 v147, v147
  v_mfma_f32_16x16x32_bf16 v[112:115], a[144:147], v[64:67], v[196:199]
  ds_read_b128 a[176:179], v3 offset:20480
  buffer_load_dwordx4 a[200:203], v1, s[8:11], s77 offen offset:2048 sc1
  v_cvt_pk_bf16_f32 v49, v146, v147
  v_mfma_f32_16x16x32_bf16 v[112:115], a[148:151], v[96:99], v[112:115]
  v_exp_f32 v176, v176
  v_mfma_f32_16x16x32_bf16 v[112:115], a[152:155], v[128:131], v[112:115]
  buffer_load_dwordx4 v1, s[12:15], s78 offen offset:2048 sc1 lds
  ds_read_b128 a[180:183], v3 offset:21504
  v_mfma_f32_16x16x32_bf16 v[112:115], a[156:159], v[160:163], v[112:115]
  v_exp_f32 v177, v177
  v_mfma_f32_16x16x32_bf16 v[116:119], a[144:147], v[68:71], v[204:207]
  ds_read_b128 a[184:187], v3 offset:22528
  ds_read_b128 a[188:191], v3 offset:23552
  v_cvt_pk_bf16_f32 v50, v176, v177
  v_mfma_f32_16x16x32_bf16 v[116:119], a[148:151], v[100:103], v[116:119]
  v_exp_f32 v178, v178
  s_waitcnt lgkmcnt(4)
  v_mfma_f32_16x16x32_bf16 v[116:119], a[152:155], v[132:135], v[116:119]
  buffer_load_dwordx4 v1, s[12:15], s78 offen offset:3072 sc1 lds
  buffer_load_dwordx4 a[204:207], v1, s[8:11], s77 offen offset:3072 sc1
  s_sub_u32 s78, s78, 16384
  v_mfma_f32_16x16x32_bf16 v[116:119], a[156:159], v[164:167], v[116:119]
  v_exp_f32 v179, v179
  v_mfma_f32_16x16x32_bf16 a[0:3], a[160:163], v[32:35], a[0:3]
  ds_read_b128 a[128:131], v2 offset:8192
  s_add_u32 s77, s82, 4096
  buffer_load_dwordx4 a[208:211], v1, s[8:11], s77 offen offset:0 sc1
  v_cvt_pk_bf16_f32 v51, v178, v179
  v_mfma_f32_16x16x32_bf16 a[4:7], a[160:163], v[36:39], a[4:7]
  v_exp_f32 v148, v148
  v_mfma_f32_16x16x32_bf16 a[16:19], a[164:167], v[32:35], a[16:19]
  ds_read_b128 a[132:135], v2 offset:9216
  ds_read_b128 a[136:139], v2 offset:10240
  v_mfma_f32_16x16x32_bf16 a[20:23], a[164:167], v[36:39], a[20:23]
  v_exp_f32 v149, v149
  v_mfma_f32_16x16x32_bf16 a[32:35], a[168:171], v[32:35], a[32:35]
  ds_read_b128 a[140:143], v2 offset:11264
  buffer_load_dwordx4 a[212:215], v1, s[8:11], s77 offen offset:1024 sc1
  v_cvt_pk_bf16_f32 v52, v148, v149
  v_mfma_f32_16x16x32_bf16 a[36:39], a[168:171], v[36:39], a[36:39]
  v_exp_f32 v150, v150
  v_mfma_f32_16x16x32_bf16 a[48:51], a[172:175], v[32:35], a[48:51]
  ds_read_b128 a[144:147], v2 offset:12288
  s_waitcnt lgkmcnt(5)
  v_mfma_f32_16x16x32_bf16 a[52:55], a[172:175], v[36:39], a[52:55]
  v_exp_f32 v151, v151
  v_mfma_f32_16x16x32_bf16 a[64:67], a[176:179], v[32:35], a[64:67]
  ds_read_b128 a[148:151], v2 offset:13312
  buffer_load_dwordx4 a[216:219], v1, s[8:11], s77 offen offset:2048 sc1
  v_cvt_pk_bf16_f32 v53, v150, v151
  v_mfma_f32_16x16x32_bf16 a[68:71], a[176:179], v[36:39], a[68:71]
  v_exp_f32 v180, v180
  v_mfma_f32_16x16x32_bf16 a[80:83], a[180:183], v[32:35], a[80:83]
  ds_read_b128 a[152:155], v2 offset:14336
  ds_read_b128 a[156:159], v2 offset:15360
  v_mfma_f32_16x16x32_bf16 a[84:87], a[180:183], v[36:39], a[84:87]
  v_exp_f32 v181, v181
  v_mfma_f32_16x16x32_bf16 a[96:99], a[184:187], v[32:35], a[96:99]
  buffer_load_dwordx4 a[220:223], v1, s[8:11], s77 offen offset:3072 sc1
  v_cvt_pk_bf16_f32 v54, v180, v181
  v_mfma_f32_16x16x32_bf16 a[100:103], a[184:187], v[36:39], a[100:103]
  v_exp_f32 v182, v182
  v_mfma_f32_16x16x32_bf16 a[112:115], a[188:191], v[32:35], a[112:115]
  v_mfma_f32_16x16x32_bf16 a[116:119], a[188:191], v[36:39], a[116:119]
  v_exp_f32 v183, v183
  v_mfma_f32_16x16x32_bf16 v[16:19], v[12:15], v[32:35], v[16:19]
  v_cvt_pk_bf16_f32 v55, v182, v183
  v_mfma_f32_16x16x32_bf16 v[20:23], v[12:15], v[36:39], v[20:23]
  s_waitcnt lgkmcnt(4)
  v_cndmask_b32 v192, v255, v192, s[24:25]
  v_cndmask_b32 v204, v255, v204, s[24:25]
  v_mov_b32 v196, v255
  v_cndmask_b32 v193, v255, v193, s[26:27]
  v_cndmask_b32 v205, v255, v205, s[26:27]
  v_mov_b32 v197, v255
  v_cndmask_b32 v194, v255, v194, s[32:33]
  v_cndmask_b32 v206, v255, v206, s[32:33]
  v_mov_b32 v198, v255
  v_cndmask_b32 v195, v255, v195, s[34:35]
  v_cndmask_b32 v207, v255, v207, s[34:35]
  v_mov_b32 v199, v255
  s_nop 0
  v_mfma_f32_16x16x32_bf16 v[144:147], a[128:131], v[64:67], v[192:195]
  ds_read_b128 a[160:163], v3 offset:24576
  s_and_b32 m0, s78, 0x1ffff
  v_mfma_f32_16x16x32_bf16 v[144:147], a[132:135], v[96:99], v[144:147]
  s_add_u32 s77, s82, 8192
  buffer_load_dwordx4 a[224:227], v1, s[8:11], s77 offen offset:0 sc1
  v_exp_f32 v80, v80
  v_mfma_f32_16x16x32_bf16 v[144:147], a[136:139], v[128:131], v[144:147]
  buffer_load_dwordx4 v1, s[12:15], s78 offen offset:0 sc1 lds
  ds_read_b128 a[164:167], v3 offset:25600
  v_mfma_f32_16x16x32_bf16 v[144:147], a[140:143], v[160:163], v[144:147]
  v_exp_f32 v81, v81
  v_mfma_f32_16x16x32_bf16 v[148:151], a[128:131], v[68:71], v[200:203]
  ds_read_b128 a[168:171], v3 offset:26624
  buffer_load_dwordx4 a[228:231], v1, s[8:11], s77 offen offset:1024 sc1
  v_cvt_pk_bf16_f32 v32, v80, v81
  v_mfma_f32_16x16x32_bf16 v[148:151], a[132:135], v[100:103], v[148:151]
  v_exp_f32 v82, v82
  s_waitcnt lgkmcnt(3)
  v_mfma_f32_16x16x32_bf16 v[148:151], a[136:139], v[132:135], v[148:151]
  buffer_load_dwordx4 v1, s[12:15], s78 offen offset:1024 sc1 lds
  ds_read_b128 a[172:175], v3 offset:27648
  v_mfma_f32_16x16x32_bf16 v[148:151], a[140:143], v[164:167], v[148:151]
  v_exp_f32 v83, v83
  v_mfma_f32_16x16x32_bf16 v[176:179], a[144:147], v[64:67], v[196:199]
  ds_read_b128 a[176:179], v3 offset:28672
  buffer_load_dwordx4 a[232:235], v1, s[8:11], s77 offen offset:2048 sc1
  v_cvt_pk_bf16_f32 v33, v82, v83
  v_mfma_f32_16x16x32_bf16 v[176:179], a[148:151], v[96:99], v[176:179]
  v_exp_f32 v112, v112
  v_mfma_f32_16x16x32_bf16 v[176:179], a[152:155], v[128:131], v[176:179]
  buffer_load_dwordx4 v1, s[12:15], s78 offen offset:2048 sc1 lds
  ds_read_b128 a[180:183], v3 offset:29696
  v_mfma_f32_16x16x32_bf16 v[176:179], a[156:159], v[160:163], v[176:179]
  v_exp_f32 v113, v113
  v_mfma_f32_16x16x32_bf16 v[180:183], a[144:147], v[68:71], v[204:207]
  ds_read_b128 a[184:187], v3 offset:30720
  ds_read_b128 a[188:191], v3 offset:31744
  v_cvt_pk_bf16_f32 v34, v112, v113
  v_mfma_f32_16x16x32_bf16 v[180:183], a[148:151], v[100:103], v[180:183]
  v_exp_f32 v114, v114
  s_waitcnt lgkmcnt(4)
  v_mfma_f32_16x16x32_bf16 v[180:183], a[152:155], v[132:135], v[180:183]
  buffer_load_dwordx4 v1, s[12:15], s78 offen offset:3072 sc1 lds
  buffer_load_dwordx4 a[236:239], v1, s[8:11], s77 offen offset:3072 sc1
  s_add_u32 s78, s78, 49152
  v_mfma_f32_16x16x32_bf16 v[180:183], a[156:159], v[164:167], v[180:183]
  v_exp_f32 v115, v115
  v_mfma_f32_16x16x32_bf16 a[0:3], a[160:163], v[48:51], a[0:3]
  v_cvt_pk_bf16_f32 v35, v114, v115
  v_mov_b32 v3, v2
  v_add_u32 v2, 0x8000, v2
  v_mfma_f32_16x16x32_bf16 a[4:7], a[160:163], v[52:55], a[4:7]
  v_exp_f32 v84, v84
  v_and_b32 v2, 0x1ffff, v2
  v_mfma_f32_16x16x32_bf16 a[16:19], a[164:167], v[48:51], a[16:19]
  s_add_u32 s77, s82, 12288
  buffer_load_dwordx4 a[240:243], v1, s[8:11], s77 offen offset:0 sc1
  s_waitcnt vmcnt(16) lgkmcnt(0)
  s_barrier
  v_mfma_f32_16x16x32_bf16 a[20:23], a[164:167], v[52:55], a[20:23]
  v_exp_f32 v85, v85
  v_mfma_f32_16x16x32_bf16 a[32:35], a[168:171], v[48:51], a[32:35]
  ds_read_b128 a[128:131], v2 offset:0
  buffer_load_dwordx4 a[244:247], v1, s[8:11], s77 offen offset:1024 sc1
  v_cvt_pk_bf16_f32 v36, v84, v85
  v_mfma_f32_16x16x32_bf16 a[36:39], a[168:171], v[52:55], a[36:39]
  v_exp_f32 v86, v86
  v_mfma_f32_16x16x32_bf16 a[48:51], a[172:175], v[48:51], a[48:51]
  ds_read_b128 a[132:135], v2 offset:1024
  ds_read_b128 a[136:139], v2 offset:2048
  v_mfma_f32_16x16x32_bf16 a[52:55], a[172:175], v[52:55], a[52:55]
  v_exp_f32 v87, v87
  v_mfma_f32_16x16x32_bf16 a[64:67], a[176:179], v[48:51], a[64:67]
  ds_read_b128 a[140:143], v2 offset:3072
  buffer_load_dwordx4 a[248:251], v1, s[8:11], s77 offen offset:2048 sc1
  v_cvt_pk_bf16_f32 v37, v86, v87
  v_mfma_f32_16x16x32_bf16 a[68:71], a[176:179], v[52:55], a[68:71]
  v_exp_f32 v116, v116
  v_mfma_f32_16x16x32_bf16 a[80:83], a[180:183], v[48:51], a[80:83]
  ds_read_b128 a[144:147], v2 offset:4096
  ds_read_b128 a[148:151], v2 offset:5120
  v_mfma_f32_16x16x32_bf16 a[84:87], a[180:183], v[52:55], a[84:87]
  v_exp_f32 v117, v117
  v_mfma_f32_16x16x32_bf16 a[96:99], a[184:187], v[48:51], a[96:99]
  ds_read_b128 a[152:155], v2 offset:6144
  v_cvt_pk_bf16_f32 v38, v116, v117
  v_mfma_f32_16x16x32_bf16 a[100:103], a[184:187], v[52:55], a[100:103]
  v_exp_f32 v118, v118
  v_mfma_f32_16x16x32_bf16 a[112:115], a[188:191], v[48:51], a[112:115]
  ds_read_b128 a[156:159], v2 offset:7168
  buffer_load_dwordx4 a[252:255], v1, s[8:11], s77 offen offset:3072 sc1
  v_mfma_f32_16x16x32_bf16 a[116:119], a[188:191], v[52:55], a[116:119]
  v_exp_f32 v119, v119
  v_mfma_f32_16x16x32_bf16 v[16:19], v[12:15], v[48:51], v[16:19]
  v_cvt_pk_bf16_f32 v39, v118, v119
  v_mfma_f32_16x16x32_bf16 v[20:23], v[12:15], v[52:55], v[20:23]
  s_waitcnt lgkmcnt(4)
  ds_read_b128 a[160:163], v3 offset:16384
  ds_read_b128 a[164:167], v3 offset:17408
  ds_read_b128 a[168:171], v3 offset:18432
  ds_read_b128 a[172:175], v3 offset:19456
  ds_read_b128 a[176:179], v3 offset:20480
  ds_read_b128 a[180:183], v3 offset:21504
  ds_read_b128 a[184:187], v3 offset:22528
  ds_read_b128 a[188:191], v3 offset:23552
  s_waitcnt lgkmcnt(4)
  v_mfma_f32_16x16x32_bf16 a[0:3], a[160:163], v[32:35], a[0:3]
  s_add_u32 m0, s81, 0
  s_add_u32 s77, s82, 65536
  buffer_load_dwordx4 v1, s[8:11], s77 offen offset:0 sc1 lds
  v_mfma_f32_16x16x32_bf16 a[4:7], a[160:163], v[36:39], a[4:7]
  v_exp_f32 v144, v144
  v_mfma_f32_16x16x32_bf16 a[16:19], a[164:167], v[32:35], a[16:19]
  v_exp_f32 v145, v145
  v_mfma_f32_16x16x32_bf16 a[20:23], a[164:167], v[36:39], a[20:23]
  v_exp_f32 v146, v146
  v_mfma_f32_16x16x32_bf16 a[32:35], a[168:171], v[32:35], a[32:35]
  buffer_load_dwordx4 v1, s[8:11], s77 offen offset:1024 sc1 lds
  v_exp_f32 v147, v147
  v_mfma_f32_16x16x32_bf16 a[36:39], a[168:171], v[36:39], a[36:39]
  v_exp_f32 v176, v176
  s_waitcnt lgkmcnt(0)
  v_mfma_f32_16x16x32_bf16 a[48:51], a[172:175], v[32:35], a[48:51]
  v_exp_f32 v177, v177
  v_mfma_f32_16x16x32_bf16 a[52:55], a[172:175], v[36:39], a[52:55]
  v_exp_f32 v178, v178
  v_cvt_pk_bf16_f32 v50, v176, v177
  v_mfma_f32_16x16x32_bf16 a[64:67], a[176:179], v[32:35], a[64:67]
  buffer_load_dwordx4 v1, s[8:11], s77 offen offset:2048 sc1 lds
  v_exp_f32 v179, v179
  v_mfma_f32_16x16x32_bf16 a[68:71], a[176:179], v[36:39], a[68:71]
  v_exp_f32 v148, v148
  v_cvt_pk_bf16_f32 v51, v178, v179
  v_mfma_f32_16x16x32_bf16 a[80:83], a[180:183], v[32:35], a[80:83]
  v_exp_f32 v149, v149
  v_mfma_f32_16x16x32_bf16 a[84:87], a[180:183], v[36:39], a[84:87]
  v_exp_f32 v150, v150
  v_cvt_pk_bf16_f32 v52, v148, v149
  v_mfma_f32_16x16x32_bf16 a[96:99], a[184:187], v[32:35], a[96:99]
  buffer_load_dwordx4 v1, s[8:11], s77 offen offset:3072 sc1 lds
  v_exp_f32 v151, v151
  v_mfma_f32_16x16x32_bf16 a[100:103], a[184:187], v[36:39], a[100:103]
  v_exp_f32 v180, v180
  v_cvt_pk_bf16_f32 v53, v150, v151
  v_mfma_f32_16x16x32_bf16 a[112:115], a[188:191], v[32:35], a[112:115]
  v_exp_f32 v181, v181
  v_mfma_f32_16x16x32_bf16 a[116:119], a[188:191], v[36:39], a[116:119]
  v_exp_f32 v182, v182
  v_cvt_pk_bf16_f32 v54, v180, v181
  v_mfma_f32_16x16x32_bf16 v[16:19], v[12:15], v[32:35], v[16:19]
  v_exp_f32 v183, v183
  v_mfma_f32_16x16x32_bf16 v[20:23], v[12:15], v[36:39], v[20:23]
  v_cvt_pk_bf16_f32 v48, v144, v145
  v_cvt_pk_bf16_f32 v49, v146, v147
  v_cvt_pk_bf16_f32 v55, v182, v183
  ds_read_b128 a[160:163], v3 offset:24576
  ds_read_b128 a[164:167], v3 offset:25600
  ds_read_b128 a[168:171], v3 offset:26624
  ds_read_b128 a[172:175], v3 offset:27648
  ds_read_b128 a[176:179], v3 offset:28672
  ds_read_b128 a[180:183], v3 offset:29696
  ds_read_b128 a[184:187], v3 offset:30720
  ds_read_b128 a[188:191], v3 offset:31744
  s_waitcnt lgkmcnt(4)
  v_mfma_f32_16x16x32_bf16 a[0:3], a[160:163], v[48:51], a[0:3]
  s_add_u32 m0, s81, 4096
  s_add_u32 s77, s82, 69632
  buffer_load_dwordx4 v1, s[8:11], s77 offen offset:0 sc1 lds
  v_mfma_f32_16x16x32_bf16 a[4:7], a[160:163], v[52:55], a[4:7]
  v_mfma_f32_16x16x32_bf16 a[16:19], a[164:167], v[48:51], a[16:19]
  v_mfma_f32_16x16x32_bf16 a[20:23], a[164:167], v[52:55], a[20:23]
  v_mfma_f32_16x16x32_bf16 a[32:35], a[168:171], v[48:51], a[32:35]
  buffer_load_dwordx4 v1, s[8:11], s77 offen offset:1024 sc1 lds
  v_mfma_f32_16x16x32_bf16 a[36:39], a[168:171], v[52:55], a[36:39]
  s_waitcnt lgkmcnt(0)
  v_mfma_f32_16x16x32_bf16 a[48:51], a[172:175], v[48:51], a[48:51]
  v_mfma_f32_16x16x32_bf16 a[52:55], a[172:175], v[52:55], a[52:55]
  v_mfma_f32_16x16x32_bf16 a[64:67], a[176:179], v[48:51], a[64:67]
  buffer_load_dwordx4 v1, s[8:11], s77 offen offset:2048 sc1 lds
  v_mfma_f32_16x16x32_bf16 a[68:71], a[176:179], v[52:55], a[68:71]
  v_mfma_f32_16x16x32_bf16 a[80:83], a[180:183], v[48:51], a[80:83]
  v_mfma_f32_16x16x32_bf16 a[84:87], a[180:183], v[52:55], a[84:87]
  v_mfma_f32_16x16x32_bf16 a[96:99], a[184:187], v[48:51], a[96:99]
  buffer_load_dwordx4 v1, s[8:11], s77 offen offset:3072 sc1 lds
  v_mfma_f32_16x16x32_bf16 a[100:103], a[184:187], v[52:55], a[100:103]
  v_mfma_f32_16x16x32_bf16 a[112:115], a[188:191], v[48:51], a[112:115]
  v_mfma_f32_16x16x32_bf16 a[116:119], a[188:191], v[52:55], a[116:119]
  v_mfma_f32_16x16x32_bf16 v[16:19], v[12:15], v[48:51], v[16:19]
  v_mfma_f32_16x16x32_bf16 v[20:23], v[12:15], v[52:55], v[20:23]
Lfin_f:
  s_cmp_ge_u32 s3, 2
  s_cbranch_scc1 Lepi_f
  s_waitcnt vmcnt(24)
  s_barrier
Lepi_f:
  s_waitcnt vmcnt(24)
  s_mov_b32 s76, 0x6c800000
  s_mov_b64 s[20:21], 0
  s_nop 5
  v_cmp_ngt_f32 vcc, s76, v16
  s_nop 0
  s_or_b64 s[20:21], s[20:21], vcc
  v_cmp_ngt_f32 vcc, s76, v20
  s_nop 0
  s_or_b64 s[20:21], s[20:21], vcc
  v_cmp_ngt_f32 vcc, s76, v24
  s_nop 0
  s_or_b64 s[20:21], s[20:21], vcc
  v_cmp_ngt_f32 vcc, s76, v28
  s_nop 0
  s_or_b64 s[20:21], s[20:21], vcc
  s_cmp_lg_u64 s[20:21], 0
  s_cselect_b32 s90, 1, 0
  v_mov_b32 v224, s90
  s_and_b32 s90, s14, 0x1ffff
  s_lshl_b32 s76, s3, 12
  s_add_u32 s76, s76, s90
  v_mov_b32 v225, s76
  ds_write_b32 v225, v224
  v_rcp_f32 v248, v16
  v_rcp_f32 v249, v20
  v_accvgpr_read_b32 v224, a0
  v_accvgpr_read_b32 v225, a1
  v_accvgpr_read_b32 v226, a2
  v_accvgpr_read_b32 v227, a3
  s_add_u32 s77, s82, 16384
  buffer_load_dwordx4 a[128:131], v1, s[8:11], s77 offen offset:0 sc1
  v_accvgpr_read_b32 v228, a16
  v_accvgpr_read_b32 v229, a17
  v_accvgpr_read_b32 v230, a18
  v_accvgpr_read_b32 v231, a19
  v_pk_mul_f32 v[224:225], v[224:225], v[248:249] op_sel:[0,0] op_sel_hi:[1,0]
  v_pk_mul_f32 v[226:227], v[226:227], v[248:249] op_sel:[0,0] op_sel_hi:[1,0]
  v_pk_mul_f32 v[228:229], v[228:229], v[248:249] op_sel:[0,0] op_sel_hi:[1,0]
  v_pk_mul_f32 v[230:231], v[230:231], v[248:249] op_sel:[0,0] op_sel_hi:[1,0]
  v_cvt_pk_bf16_f32 v232, v224, v225
  v_cvt_pk_bf16_f32 v233, v226, v227
  v_cvt_pk_bf16_f32 v234, v228, v229
  v_cvt_pk_bf16_f32 v235, v230, v231
  buffer_store_dwordx4 v[232:235], v1, s[8:11], s36 offen offset:0 sc1
  v_accvgpr_read_b32 v224, a32
  v_accvgpr_read_b32 v225, a33
  v_accvgpr_read_b32 v226, a34
  v_accvgpr_read_b32 v227, a35
  buffer_load_dwordx4 a[132:135], v1, s[8:11], s77 offen offset:1024 sc1
  v_accvgpr_read_b32 v228, a48
  v_accvgpr_read_b32 v229, a49
  v_accvgpr_read_b32 v230, a50
  v_accvgpr_read_b32 v231, a51
  v_pk_mul_f32 v[224:225], v[224:225], v[248:249] op_sel:[0,0] op_sel_hi:[1,0]
  v_pk_mul_f32 v[226:227], v[226:227], v[248:249] op_sel:[0,0] op_sel_hi:[1,0]
  v_pk_mul_f32 v[228:229], v[228:229], v[248:249] op_sel:[0,0] op_sel_hi:[1,0]
  v_pk_mul_f32 v[230:231], v[230:231], v[248:249] op_sel:[0,0] op_sel_hi:[1,0]
  v_cvt_pk_bf16_f32 v236, v224, v225
  v_cvt_pk_bf16_f32 v237, v226, v227
  v_cvt_pk_bf16_f32 v238, v228, v229
  v_cvt_pk_bf16_f32 v239, v230, v231
  buffer_store_dwordx4 v[236:239], v1, s[8:11], s36 offen offset:1024 sc1
  v_accvgpr_read_b32 v224, a64
  v_accvgpr_read_b32 v225, a65
  v_accvgpr_read_b32 v226, a66
  v_accvgpr_read_b32 v227, a67
  buffer_load_dwordx4 a[136:139], v1, s[8:11], s77 offen offset:2048 sc1
  v_accvgpr_read_b32 v228, a80
  v_accvgpr_read_b32 v229, a81
  v_accvgpr_read_b32 v230, a82
  v_accvgpr_read_b32 v231, a83
  v_pk_mul_f32 v[224:225], v[224:225], v[248:249] op_sel:[0,0] op_sel_hi:[1,0]
  v_pk_mul_f32 v[226:227], v[226:227], v[248:249] op_sel:[0,0] op_sel_hi:[1,0]
  v_pk_mul_f32 v[228:229], v[228:229], v[248:249] op_sel:[0,0] op_sel_hi:[1,0]
  v_pk_mul_f32 v[230:231], v[230:231], v[248:249] op_sel:[0,0] op_sel_hi:[1,0]
  v_cvt_pk_bf16_f32 v232, v224, v225
  v_cvt_pk_bf16_f32 v233, v226, v227
  v_cvt_pk_bf16_f32 v234, v228, v229
  v_cvt_pk_bf16_f32 v235, v230, v231
  buffer_store_dwordx4 v[232:235], v1, s[8:11], s36 offen offset:2048 sc1
  v_accvgpr_read_b32 v224, a96
  v_accvgpr_read_b32 v225, a97
  v_accvgpr_read_b32 v226, a98
  v_accvgpr_read_b32 v227, a99
  buffer_load_dwordx4 a[140:143], v1, s[8:11], s77 offen offset:3072 sc1
  v_accvgpr_read_b32 v228, a112
  v_accvgpr_read_b32 v229, a113
  v_accvgpr_read_b32 v230, a114
  v_accvgpr_read_b32 v231, a115
  v_pk_mul_f32 v[224:225], v[224:225], v[248:249] op_sel:[0,0] op_sel_hi:[1,0]
  v_pk_mul_f32 v[226:227], v[226:227], v[248:249] op_sel:[0,0] op_sel_hi:[1,0]
  v_pk_mul_f32 v[228:229], v[228:229], v[248:249] op_sel:[0,0] op_sel_hi:[1,0]
  v_pk_mul_f32 v[230:231], v[230:231], v[248:249] op_sel:[0,0] op_sel_hi:[1,0]
  v_cvt_pk_bf16_f32 v236, v224, v225
  v_cvt_pk_bf16_f32 v237, v226, v227
  v_cvt_pk_bf16_f32 v238, v228, v229
  v_cvt_pk_bf16_f32 v239, v230, v231
  buffer_store_dwordx4 v[236:239], v1, s[8:11], s36 offen offset:3072 sc1
  v_accvgpr_read_b32 v224, a4
  v_accvgpr_read_b32 v225, a5
  v_accvgpr_read_b32 v226, a6
  v_accvgpr_read_b32 v227, a7
  s_add_u32 s77, s82, 20480
  buffer_load_dwordx4 a[144:147], v1, s[8:11], s77 offen offset:0 sc1
  v_accvgpr_read_b32 v228, a20
  v_accvgpr_read_b32 v229, a21
  v_accvgpr_read_b32 v230, a22
  v_accvgpr_read_b32 v231, a23
  v_pk_mul_f32 v[224:225], v[224:225], v[248:249] op_sel:[0,1] op_sel_hi:[1,1]
  v_pk_mul_f32 v[226:227], v[226:227], v[248:249] op_sel:[0,1] op_sel_hi:[1,1]
  v_pk_mul_f32 v[228:229], v[228:229], v[248:249] op_sel:[0,1] op_sel_hi:[1,1]
  v_pk_mul_f32 v[230:231], v[230:231], v[248:249] op_sel:[0,1] op_sel_hi:[1,1]
  v_cvt_pk_bf16_f32 v232, v224, v225
  v_cvt_pk_bf16_f32 v233, v226, v227
  v_cvt_pk_bf16_f32 v234, v228, v229
  v_cvt_pk_bf16_f32 v235, v230, v231
  buffer_store_dwordx4 v[232:235], v1, s[8:11], s37 offen offset:0 sc1
  v_accvgpr_read_b32 v224, a36
  v_accvgpr_read_b32 v225, a37
  v_accvgpr_read_b32 v226, a38
  v_accvgpr_read_b32 v227, a39
  buffer_load_dwordx4 a[148:151], v1, s[8:11], s77 offen offset:1024 sc1
  v_accvgpr_read_b32 v228, a52
  v_accvgpr_read_b32 v229, a53
  v_accvgpr_read_b32 v230, a54
  v_accvgpr_read_b32 v231, a55
  v_pk_mul_f32 v[224:225], v[224:225], v[248:249] op_sel:[0,1] op_sel_hi:[1,1]
  v_pk_mul_f32 v[226:227], v[226:227], v[248:249] op_sel:[0,1] op_sel_hi:[1,1]
  v_pk_mul_f32 v[228:229], v[228:229], v[248:249] op_sel:[0,1] op_sel_hi:[1,1]
  v_pk_mul_f32 v[230:231], v[230:231], v[248:249] op_sel:[0,1] op_sel_hi:[1,1]
  v_cvt_pk_bf16_f32 v236, v224, v225
  v_cvt_pk_bf16_f32 v237, v226, v227
  v_cvt_pk_bf16_f32 v238, v228, v229
  v_cvt_pk_bf16_f32 v239, v230, v231
  buffer_store_dwordx4 v[236:239], v1, s[8:11], s37 offen offset:1024 sc1
  v_accvgpr_read_b32 v224, a68
  v_accvgpr_read_b32 v225, a69
  v_accvgpr_read_b32 v226, a70
  v_accvgpr_read_b32 v227, a71
  buffer_load_dwordx4 a[152:155], v1, s[8:11], s77 offen offset:2048 sc1
  v_accvgpr_read_b32 v228, a84
  v_accvgpr_read_b32 v229, a85
  v_accvgpr_read_b32 v230, a86
  v_accvgpr_read_b32 v231, a87
  v_pk_mul_f32 v[224:225], v[224:225], v[248:249] op_sel:[0,1] op_sel_hi:[1,1]
  v_pk_mul_f32 v[226:227], v[226:227], v[248:249] op_sel:[0,1] op_sel_hi:[1,1]
  v_pk_mul_f32 v[228:229], v[228:229], v[248:249] op_sel:[0,1] op_sel_hi:[1,1]
  v_pk_mul_f32 v[230:231], v[230:231], v[248:249] op_sel:[0,1] op_sel_hi:[1,1]
  v_cvt_pk_bf16_f32 v232, v224, v225
  v_cvt_pk_bf16_f32 v233, v226, v227
  v_cvt_pk_bf16_f32 v234, v228, v229
  v_cvt_pk_bf16_f32 v235, v230, v231
  buffer_store_dwordx4 v[232:235], v1, s[8:11], s37 offen offset:2048 sc1
  v_accvgpr_read_b32 v224, a100
  v_accvgpr_read_b32 v225, a101
  v_accvgpr_read_b32 v226, a102
  v_accvgpr_read_b32 v227, a103
  buffer_load_dwordx4 a[156:159], v1, s[8:11], s77 offen offset:3072 sc1
  v_accvgpr_read_b32 v228, a116
  v_accvgpr_read_b32 v229, a117
  v_accvgpr_read_b32 v230, a118
  v_accvgpr_read_b32 v231, a119
  v_pk_mul_f32 v[224:225], v[224:225], v[248:249] op_sel:[0,1] op_sel_hi:[1,1]
  v_pk_mul_f32 v[226:227], v[226:227], v[248:249] op_sel:[0,1] op_sel_hi:[1,1]
  v_pk_mul_f32 v[228:229], v[228:229], v[248:249] op_sel:[0,1] op_sel_hi:[1,1]
  v_pk_mul_f32 v[230:231], v[230:231], v[248:249] op_sel:[0,1] op_sel_hi:[1,1]
  v_cvt_pk_bf16_f32 v236, v224, v225
  v_cvt_pk_bf16_f32 v237, v226, v227
  v_cvt_pk_bf16_f32 v238, v228, v229
  v_cvt_pk_bf16_f32 v239, v230, v231
  buffer_store_dwordx4 v[236:239], v1, s[8:11], s37 offen offset:3072 sc1
  s_add_u32 s77, s82, 24576
  buffer_load_dwordx4 a[160:163], v1, s[8:11], s77 offen offset:0 sc1
  buffer_load_dwordx4 a[164:167], v1, s[8:11], s77 offen offset:1024 sc1
  buffer_load_dwordx4 a[168:171], v1, s[8:11], s77 offen offset:2048 sc1
  buffer_load_dwordx4 a[172:175], v1, s[8:11], s77 offen offset:3072 sc1
  s_add_u32 s77, s82, 28672
  buffer_load_dwordx4 a[176:179], v1, s[8:11], s77 offen offset:0 sc1
  buffer_load_dwordx4 a[180:183], v1, s[8:11], s77 offen offset:1024 sc1
  buffer_load_dwordx4 a[184:187], v1, s[8:11], s77 offen offset:2048 sc1
  buffer_load_dwordx4 a[188:191], v1, s[8:11], s77 offen offset:3072 sc1
  s_waitcnt vmcnt(8)
  v_mov_b32 v225, s90
  s_waitcnt lgkmcnt(0)
  s_barrier
  ds_read2st64_b32 v[228:229], v225 offset0:0 offset1:16
  ds_read2st64_b32 v[230:231], v225 offset0:32 offset1:48
  s_waitcnt lgkmcnt(0)
  v_or3_b32 v224, v228, v229, v230
  v_or_b32 v224, v224, v231
  s_nop 0
  v_readfirstlane_b32 s90, v224
  s_nop 0
  s_cmp_lg_u32 s90, 0
  s_cbranch_scc1 Lfallback_f
Lnorm_f:
  s_lshl_b32 s83, s5, 10
  s_add_u32 s83, s83, 39084032
  s_lshl_b32 s76, s6, 5
  s_add_u32 s83, s83, s76
  s_cmp_eq_u32 s3, 0
  s_cselect_b32 s83, s83, 0x7ff00000
  v_min_u32 v4, 1, v0
  v_lshlrev_b32 v4, 27, v4
  v_mov_b32 v5, 1
  buffer_store_dword v5, v4, s[8:11], s83 offen sc1
  s_add_u32 s77, s82, 49152
  buffer_load_dwordx4 a[0:3], v1, s[8:11], s77 offen offset:0 sc1
  buffer_load_dwordx4 a[4:7], v1, s[8:11], s77 offen offset:1024 sc1
  buffer_load_dwordx4 a[16:19], v1, s[8:11], s77 offen offset:2048 sc1
  buffer_load_dwordx4 a[20:23], v1, s[8:11], s77 offen offset:3072 sc1
  s_add_u32 s77, s82, 53248
  buffer_load_dwordx4 a[32:35], v1, s[8:11], s77 offen offset:0 sc1
  buffer_load_dwordx4 a[36:39], v1, s[8:11], s77 offen offset:1024 sc1
  buffer_load_dwordx4 a[48:51], v1, s[8:11], s77 offen offset:2048 sc1
  buffer_load_dwordx4 a[52:55], v1, s[8:11], s77 offen offset:3072 sc1
  s_and_b32 s76, s2, 7
  s_lshl_b32 s79, s76, 2
  s_bfe_u32 s77, s2, 0x20003
  s_add_u32 s79, s79, s77
  s_lshr_b32 s85, s79, 1
  s_lshl_b32 s86, s80, 1
  s_and_b32 s77, s77, 1
  s_add_u32 s86, s86, s77
  s_mov_b32 s20, 0x33333333
  s_bitcmp0_b32 s2, 4
  s_cselect_b32 s20, s20, 0xcccccccc
  s_lshr_b32 s76, s2, 3
  s_bitset0_b32 s20, s76
  s_mov_b32 s21, s20
  s_lshl_b32 s81, s79, 2
  s_add_u32 s81, s81, s3
  s_sub_u32 s88, 15, s85
  s_min_u32 s88, s88, s85
  s_lshl_b32 s83, s88, 10
  s_add_u32 s83, s83, 39084032
  s_cmp_eq_u32 s3, 0
  s_cselect_b32 s83, s83, 0x7ff00000
  v_and_b32 v4, 31, v0
  v_lshlrev_b32 v4, 5, v4
  v_lshlrev_b32 v7, 5, v0
  s_mul_i32 s76, s5, 12288
  s_add_u32 s76, s76, 38868992
  buffer_load_dwordx4 v[128:131], v7, s[8:11], s76 offen offset:2048 sc1
  buffer_load_dwordx4 v[132:135], v7, s[8:11], s76 offen offset:2064 sc1
  buffer_load_dwordx4 v[136:139], v7, s[8:11], s76 offen offset:0 sc1
  buffer_load_dwordx4 v[140:143], v7, s[8:11], s76 offen offset:16 sc1
  v_lshrrev_b32 v6, 4, v0
  v_lshlrev_b32 v2, 4, v6
  v_and_b32 v7, 15, v0
  v_lshlrev_b32 v3, 10, v7
  v_lshl_add_u32 v3, v6, 3, v3
  s_mul_i32 s78, s5, 12288
  s_lshl_b32 s76, s80, 8
  s_add_u32 s78, s78, s76
  s_add_u32 s78, s78, 38862848
  s_lshl_b32 s16, s79, 19
  s_lshl_b32 s76, s3, 15
  s_add_u32 s16, s16, s76
  s_add_u32 s16, s16, 48234496
  s_add_u32 s76, s3, 1
  s_and_b32 s76, s76, 3
  s_mul_i32 s76, s76, 131072
  s_add_u32 s17, s16, s76
  s_add_u32 s76, s3, 2
  s_and_b32 s76, s76, 3
  s_mul_i32 s76, s76, 131072
  s_add_u32 s18, s16, s76
  s_add_u32 s76, s3, 3
  s_and_b32 s76, s76, 3
  s_mul_i32 s76, s76, 131072
  s_add_u32 s19, s16, s76
  s_add_u32 s76, s3, 0
  s_and_b32 s76, s76, 3
  s_mul_i32 s76, s76, 131072
  s_add_u32 s16, s16, s76
  s_lshl_b32 s90, s3, 15
  s_add_u32 s77, s82, 57344
  buffer_load_dwordx4 a[64:67], v1, s[8:11], s77 offen offset:0 sc1
  v_mov_b32 v56, v208
  v_mov_b32 v57, v209
  v_mov_b32 v58, v210
  v_mov_b32 v59, v211
  v_mov_b32 v60, v212
  v_mov_b32 v61, v213
  v_mov_b32 v62, v214
  buffer_load_dwordx4 a[68:71], v1, s[8:11], s77 offen offset:1024 sc1
  v_mov_b32 v63, v215
  ds_bpermute_b32 v8, v2, v216 offset:0
  ds_bpermute_b32 v9, v2, v216 offset:4
  ds_bpermute_b32 v10, v2, v216 offset:8
  ds_bpermute_b32 v11, v2, v216 offset:12
  ds_bpermute_b32 v12, v2, v216 offset:64
  buffer_load_dwordx4 a[80:83], v1, s[8:11], s77 offen offset:2048 sc1
  ds_bpermute_b32 v13, v2, v216 offset:68
  ds_bpermute_b32 v14, v2, v216 offset:72
  ds_bpermute_b32 v15, v2, v216 offset:76
  ds_bpermute_b32 v16, v2, v216 offset:128
  ds_bpermute_b32 v17, v2, v216 offset:132
  ds_bpermute_b32 v18, v2, v216 offset:136
  ds_bpermute_b32 v19, v2, v216 offset:140
  buffer_load_dwordx4 a[84:87], v1, s[8:11], s77 offen offset:3072 sc1
  ds_bpermute_b32 v20, v2, v216 offset:192
  ds_bpermute_b32 v21, v2, v216 offset:196
  ds_bpermute_b32 v22, v2, v216 offset:200
  ds_bpermute_b32 v23, v2, v216 offset:204
  ds_bpermute_b32 v40, v2, v217 offset:0
  ds_bpermute_b32 v41, v2, v217 offset:4
  s_add_u32 s77, s82, 61440
  buffer_load_dwordx4 a[96:99], v1, s[8:11], s77 offen offset:0 sc1
  ds_bpermute_b32 v42, v2, v217 offset:8
  ds_bpermute_b32 v43, v2, v217 offset:12
  ds_bpermute_b32 v44, v2, v217 offset:64
  ds_bpermute_b32 v45, v2, v217 offset:68
  ds_bpermute_b32 v46, v2, v217 offset:72
  ds_bpermute_b32 v47, v2, v217 offset:76
  ds_bpermute_b32 v48, v2, v217 offset:128
  buffer_load_dwordx4 a[100:103], v1, s[8:11], s77 offen offset:1024 sc1
  ds_bpermute_b32 v49, v2, v217 offset:132
  ds_bpermute_b32 v50, v2, v217 offset:136
  ds_bpermute_b32 v51, v2, v217 offset:140
  ds_bpermute_b32 v52, v2, v217 offset:192
  ds_bpermute_b32 v53, v2, v217 offset:196
  ds_bpermute_b32 v54, v2, v217 offset:200
  buffer_load_dwordx4 a[112:115], v1, s[8:11], s77 offen offset:2048 sc1
  ds_bpermute_b32 v55, v2, v217 offset:204
  ds_bpermute_b32 v24, v2, v218 offset:0
  ds_bpermute_b32 v25, v2, v218 offset:4
  ds_bpermute_b32 v26, v2, v218 offset:8
  ds_bpermute_b32 v27, v2, v218 offset:12
  ds_bpermute_b32 v28, v2, v218 offset:64
  ds_bpermute_b32 v29, v2, v218 offset:68
  buffer_load_dwordx4 a[116:119], v1, s[8:11], s77 offen offset:3072 sc1
  ds_bpermute_b32 v30, v2, v218 offset:72
  ds_bpermute_b32 v31, v2, v218 offset:76
  ds_bpermute_b32 v32, v2, v218 offset:128
  ds_bpermute_b32 v33, v2, v218 offset:132
  ds_bpermute_b32 v34, v2, v218 offset:136
  ds_bpermute_b32 v35, v2, v218 offset:140
  s_cmp_lg_u32 s0, 0
  s_cbranch_scc1 Lw8_f
  s_add_u32 s77, s82, 32768
  buffer_load_dwordx4 a[8:11], v1, s[8:11], s77 offen offset:0 sc1
  buffer_load_dwordx4 a[12:15], v1, s[8:11], s77 offen offset:1024 sc1
  buffer_load_dwordx4 a[24:27], v1, s[8:11], s77 offen offset:2048 sc1
  buffer_load_dwordx4 a[28:31], v1, s[8:11], s77 offen offset:3072 sc1
  s_add_u32 s77, s82, 36864
  buffer_load_dwordx4 a[40:43], v1, s[8:11], s77 offen offset:0 sc1
  buffer_load_dwordx4 a[44:47], v1, s[8:11], s77 offen offset:1024 sc1
  buffer_load_dwordx4 a[56:59], v1, s[8:11], s77 offen offset:2048 sc1
  buffer_load_dwordx4 a[60:63], v1, s[8:11], s77 offen offset:3072 sc1
  s_add_u32 s77, s82, 40960
  buffer_load_dwordx4 a[72:75], v1, s[8:11], s77 offen offset:0 sc1
  buffer_load_dwordx4 a[76:79], v1, s[8:11], s77 offen offset:1024 sc1
  buffer_load_dwordx4 a[88:91], v1, s[8:11], s77 offen offset:2048 sc1
  buffer_load_dwordx4 a[92:95], v1, s[8:11], s77 offen offset:3072 sc1
  s_add_u32 s77, s82, 45056
  buffer_load_dwordx4 a[104:107], v1, s[8:11], s77 offen offset:0 sc1
  buffer_load_dwordx4 a[108:111], v1, s[8:11], s77 offen offset:1024 sc1
  buffer_load_dwordx4 a[120:123], v1, s[8:11], s77 offen offset:2048 sc1
  buffer_load_dwordx4 a[124:127], v1, s[8:11], s77 offen offset:3072 sc1
Lw8_f:
  s_add_u32 m0, s90, 0
  s_add_u32 s77, s82, 73728
  buffer_load_dwordx4 v1, s[8:11], s77 offen offset:0 sc1 lds
  ds_bpermute_b32 v36, v2, v218 offset:192
  ds_bpermute_b32 v37, v2, v218 offset:196
  ds_bpermute_b32 v38, v2, v218 offset:200
  ds_bpermute_b32 v39, v2, v218 offset:204
  s_waitcnt lgkmcnt(0)
  v_add_f32 v24, 1.0, v24
  v_add_f32 v25, 1.0, v25
  buffer_load_dwordx4 v1, s[8:11], s77 offen offset:1024 sc1 lds
  v_cvt_pk_bf16_f32 v6, v24, v25
  v_lshlrev_b32 v24, 16, v6
  v_and_b32 v25, 0xffff0000, v6
  v_add_f32 v26, 1.0, v26
  v_add_f32 v27, 1.0, v27
  v_cvt_pk_bf16_f32 v6, v26, v27
  v_lshlrev_b32 v26, 16, v6
  buffer_load_dwordx4 v1, s[8:11], s77 offen offset:2048 sc1 lds
  v_and_b32 v27, 0xffff0000, v6
  v_add_f32 v28, 1.0, v28
  v_add_f32 v29, 1.0, v29
  v_cvt_pk_bf16_f32 v6, v28, v29
  v_lshlrev_b32 v28, 16, v6
  v_and_b32 v29, 0xffff0000, v6
  buffer_load_dwordx4 v1, s[8:11], s77 offen offset:3072 sc1 lds
  v_add_f32 v30, 1.0, v30
  v_add_f32 v31, 1.0, v31
  v_cvt_pk_bf16_f32 v6, v30, v31
  v_lshlrev_b32 v30, 16, v6
  v_and_b32 v31, 0xffff0000, v6
  v_add_f32 v32, 1.0, v32
  v_add_f32 v33, 1.0, v33
  s_add_u32 m0, s90, 4096
  s_add_u32 s77, s82, 77824
  buffer_load_dwordx4 v1, s[8:11], s77 offen offset:0 sc1 lds
  v_cvt_pk_bf16_f32 v6, v32, v33
  v_lshlrev_b32 v32, 16, v6
  v_and_b32 v33, 0xffff0000, v6
  v_add_f32 v34, 1.0, v34
  v_add_f32 v35, 1.0, v35
  v_cvt_pk_bf16_f32 v6, v34, v35
  buffer_load_dwordx4 v1, s[8:11], s77 offen offset:1024 sc1 lds
  v_lshlrev_b32 v34, 16, v6
  v_and_b32 v35, 0xffff0000, v6
  v_add_f32 v36, 1.0, v36
  v_add_f32 v37, 1.0, v37
  v_cvt_pk_bf16_f32 v6, v36, v37
  v_lshlrev_b32 v36, 16, v6
  v_and_b32 v37, 0xffff0000, v6
  buffer_load_dwordx4 v1, s[8:11], s77 offen offset:2048 sc1 lds
  v_add_f32 v38, 1.0, v38
  v_add_f32 v39, 1.0, v39
  v_cvt_pk_bf16_f32 v6, v38, v39
  v_lshlrev_b32 v38, 16, v6
  v_and_b32 v39, 0xffff0000, v6
  s_waitcnt vmcnt(15)
  v_add_f32 v128, 1.0, v128
  buffer_load_dwordx4 v1, s[8:11], s77 offen offset:3072 sc1 lds
  v_add_f32 v129, 1.0, v129
  v_add_f32 v130, 1.0, v130
  v_add_f32 v131, 1.0, v131
  v_add_f32 v132, 1.0, v132
  v_add_f32 v133, 1.0, v133
  v_add_f32 v134, 1.0, v134
  s_add_u32 m0, s90, 8192
  s_add_u32 s77, s82, 81920
  buffer_load_dwordx4 v1, s[8:11], s77 offen offset:0 sc1 lds
  v_add_f32 v135, 1.0, v135
  v_cvt_pk_bf16_f32 v244, v128, v129
  v_cvt_pk_bf16_f32 v248, v136, v137
  v_mov_b32 v252, 0x3f803f80
  v_cvt_pk_bf16_f32 v245, v130, v131
  v_cvt_pk_bf16_f32 v249, v138, v139
  v_mov_b32 v253, 0x3f803f80
  buffer_load_dwordx4 v1, s[8:11], s77 offen offset:1024 sc1 lds
  v_cvt_pk_bf16_f32 v246, v132, v133
  v_cvt_pk_bf16_f32 v250, v140, v141
  v_mov_b32 v254, 0x3f803f80
  v_cvt_pk_bf16_f32 v247, v134, v135
  v_cvt_pk_bf16_f32 v251, v142, v143
  v_mov_b32 v255, 0x3f803f80
  buffer_load_dwordx4 v1, s[8:11], s77 offen offset:2048 sc1 lds
  v_lshlrev_b32 v128, 16, v244
  v_and_b32 v129, 0xffff0000, v244
  v_lshlrev_b32 v130, 16, v245
  v_and_b32 v131, 0xffff0000, v245
  v_lshlrev_b32 v132, 16, v246
  v_and_b32 v133, 0xffff0000, v246
  v_lshlrev_b32 v134, 16, v247
  buffer_load_dwordx4 v1, s[8:11], s77 offen offset:3072 sc1 lds
  v_and_b32 v135, 0xffff0000, v247
  v_pk_add_f32 v[144:145], v[128:129], v[130:131]
  v_pk_mul_f32 v[146:147], v[128:129], v[128:129]
  v_pk_mul_f32 v[148:149], v[128:129], v[136:137]
  v_pk_add_f32 v[150:151], v[136:137], v[138:139]
  v_pk_mul_f32 v[152:153], v[136:137], v[136:137]
  s_add_u32 m0, s90, 12288
  s_add_u32 s77, s82, 86016
  buffer_load_dwordx4 v1, s[8:11], s77 offen offset:0 sc1 lds
  v_pk_fma_f32 v[146:147], v[130:131], v[130:131], v[146:147]
  v_pk_fma_f32 v[148:149], v[130:131], v[138:139], v[148:149]
  v_pk_fma_f32 v[152:153], v[138:139], v[138:139], v[152:153]
  v_pk_add_f32 v[144:145], v[144:145], v[132:133]
  v_pk_add_f32 v[150:151], v[150:151], v[140:141]
  v_pk_fma_f32 v[146:147], v[132:133], v[132:133], v[146:147]
  v_pk_fma_f32 v[148:149], v[132:133], v[140:141], v[148:149]
  buffer_load_dwordx4 v1, s[8:11], s77 offen offset:1024 sc1 lds
  v_pk_fma_f32 v[152:153], v[140:141], v[140:141], v[152:153]
  v_pk_add_f32 v[144:145], v[144:145], v[134:135]
  v_pk_add_f32 v[150:151], v[150:151], v[142:143]
  v_pk_fma_f32 v[146:147], v[134:135], v[134:135], v[146:147]
  v_pk_fma_f32 v[148:149], v[134:135], v[142:143], v[148:149]
  v_pk_fma_f32 v[152:153], v[142:143], v[142:143], v[152:153]
  v_add_f32 v144, v144, v145
  buffer_load_dwordx4 v1, s[8:11], s77 offen offset:2048 sc1 lds
  v_add_f32 v146, v146, v147
  v_add_f32 v148, v148, v149
  v_add_f32 v150, v150, v151
  v_add_f32 v152, v152, v153
  v_add_f32_dpp v144, v144, v144 quad_perm:[1,0,3,2] row_mask:0xf bank_mask:0xf
  v_add_f32_dpp v146, v146, v146 quad_perm:[1,0,3,2] row_mask:0xf bank_mask:0xf
  buffer_load_dwordx4 v1, s[8:11], s77 offen offset:3072 sc1 lds
  v_add_f32_dpp v148, v148, v148 quad_perm:[1,0,3,2] row_mask:0xf bank_mask:0xf
  v_add_f32_dpp v150, v150, v150 quad_perm:[1,0,3,2] row_mask:0xf bank_mask:0xf
  v_add_f32_dpp v152, v152, v152 quad_perm:[1,0,3,2] row_mask:0xf bank_mask:0xf
  v_add_f32_dpp v144, v144, v144 quad_perm:[2,3,0,1] row_mask:0xf bank_mask:0xf
  v_add_f32_dpp v146, v146, v146 quad_perm:[2,3,0,1] row_mask:0xf bank_mask:0xf
  v_add_f32_dpp v148, v148, v148 quad_perm:[2,3,0,1] row_mask:0xf bank_mask:0xf
  v_add_f32_dpp v150, v150, v150 quad_perm:[2,3,0,1] row_mask:0xf bank_mask:0xf
  s_add_u32 m0, s90, 16384
  s_add_u32 s77, s82, 90112
  buffer_load_dwordx4 v1, s[8:11], s77 offen offset:0 sc1 lds
  v_add_f32_dpp v152, v152, v152 quad_perm:[2,3,0,1] row_mask:0xf bank_mask:0xf
  v_add_f32_dpp v144, v144, v144 row_ror:4 row_mask:0xf bank_mask:0xf
  v_add_f32_dpp v146, v146, v146 row_ror:4 row_mask:0xf bank_mask:0xf
  v_add_f32_dpp v148, v148, v148 row_ror:4 row_mask:0xf bank_mask:0xf
  v_add_f32_dpp v150, v150, v150 row_ror:4 row_mask:0xf bank_mask:0xf
  v_add_f32_dpp v152, v152, v152 row_ror:4 row_mask:0xf bank_mask:0xf
  buffer_load_dwordx4 v1, s[8:11], s77 offen offset:1024 sc1 lds
  v_add_f32_dpp v144, v144, v144 row_ror:8 row_mask:0xf bank_mask:0xf
  v_add_f32_dpp v146, v146, v146 row_ror:8 row_mask:0xf bank_mask:0xf
  v_add_f32_dpp v148, v148, v148 row_ror:8 row_mask:0xf bank_mask:0xf
  v_add_f32_dpp v150, v150, v150 row_ror:8 row_mask:0xf bank_mask:0xf
  v_add_f32_dpp v152, v152, v152 row_ror:8 row_mask:0xf bank_mask:0xf
  v_mov_b32 v145, v144
  v_mov_b32 v147, v146
  buffer_load_dwordx4 v1, s[8:11], s77 offen offset:2048 sc1 lds
  v_mov_b32 v149, v148
  v_mov_b32 v151, v150
  v_mov_b32 v153, v152
  v_permlane16_swap_b32 v144, v145
  v_permlane16_swap_b32 v146, v147
  v_permlane16_swap_b32 v148, v149
  v_permlane16_swap_b32 v150, v151
  buffer_load_dwordx4 v1, s[8:11], s77 offen offset:3072 sc1 lds
  v_permlane16_swap_b32 v152, v153
  v_add_f32 v144, v144, v145
  v_add_f32 v146, v146, v147
  v_add_f32 v148, v148, v149
  v_add_f32 v150, v150, v151
  v_add_f32 v152, v152, v153
  s_add_u32 m0, s90, 20480
  s_add_u32 s77, s82, 94208
  buffer_load_dwordx4 v1, s[8:11], s77 offen offset:0 sc1 lds
  v_mov_b32 v145, v144
  v_mov_b32 v147, v146
  v_mov_b32 v149, v148
  v_mov_b32 v151, v150
  v_mov_b32 v153, v152
  v_permlane32_swap_b32 v144, v145
  v_permlane32_swap_b32 v146, v147
  buffer_load_dwordx4 v1, s[8:11], s77 offen offset:1024 sc1 lds
  v_permlane32_swap_b32 v148, v149
  v_permlane32_swap_b32 v150, v151
  v_permlane32_swap_b32 v152, v153
  v_add_f32 v144, v144, v145
  v_add_f32 v146, v146, v147
  v_add_f32 v148, v148, v149
  buffer_load_dwordx4 v1, s[8:11], s77 offen offset:2048 sc1 lds
  v_add_f32 v150, v150, v151
  v_add_f32 v152, v152, v153
  v_readfirstlane_b32 s24, v144
  v_readfirstlane_b32 s25, v146
  v_readfirstlane_b32 s26, v148
  v_readfirstlane_b32 s27, v150
  v_readfirstlane_b32 s28, v152
  buffer_load_dwordx4 v1, s[8:11], s77 offen offset:3072 sc1 lds
  s_mov_b32 s30, 0xc0135761
  s_mov_b32 s31, s30
  s_mov_b32 s32, 0xbdd2d3e8
  s_mov_b32 s33, s32
  s_mov_b32 s34, 1.0
  s_mov_b32 s35, 1.0
  buffer_load_dword v5, v4, s[8:11], s83 offen sc1
  s_waitcnt vmcnt(0)
  s_cmp_lg_u32 s3, 0
  s_cbranch_scc1 Lokf_6
  v_cmp_ne_u32 vcc, 1, v5
  s_nop 0
  s_cmp_lg_u64 vcc, 0
  s_cbranch_scc0 Lokf_6
  s_mov_b32 s84, 0x80000
Lspf_6:
  s_sub_u32 s84, s84, 1
  s_cbranch_scc1 Lokf_6
  s_sleep 1
  buffer_load_dword v5, v4, s[8:11], s83 offen sc1
  s_waitcnt vmcnt(0)
  v_cmp_ne_u32 vcc, 1, v5
  s_nop 0
  s_cmp_lg_u64 vcc, 0
  s_cbranch_scc1 Lspf_6
Lokf_6:
  s_barrier
  buffer_load_dwordx4 v[128:131], v1, s[8:11], s16 offen offset:0 sc1
  buffer_load_dwordx4 v[132:135], v1, s[8:11], s17 offen offset:0 sc1
  buffer_load_dwordx4 v[136:139], v1, s[8:11], s18 offen offset:0 sc1
  buffer_load_dwordx4 v[140:143], v1, s[8:11], s19 offen offset:0 sc1
  buffer_load_dwordx4 v[144:147], v1, s[8:11], s16 offen offset:1024 sc1
  buffer_load_dwordx4 v[148:151], v1, s[8:11], s17 offen offset:1024 sc1
  buffer_load_dwordx4 v[152:155], v1, s[8:11], s18 offen offset:1024 sc1
  buffer_load_dwordx4 v[156:159], v1, s[8:11], s19 offen offset:1024 sc1
  buffer_load_dwordx4 v[160:163], v1, s[8:11], s16 offen offset:2048 sc1
  buffer_load_dwordx4 v[164:167], v1, s[8:11], s17 offen offset:2048 sc1
  buffer_load_dwordx4 v[168:171], v1, s[8:11], s18 offen offset:2048 sc1
  buffer_load_dwordx4 v[172:175], v1, s[8:11], s19 offen offset:2048 sc1
  buffer_load_dwordx4 v[176:179], v1, s[8:11], s16 offen offset:3072 sc1
  s_add_u32 s16, s16, 4096
  buffer_load_dwordx4 v[180:183], v1, s[8:11], s17 offen offset:3072 sc1
  s_add_u32 s17, s17, 4096
  buffer_load_dwordx4 v[184:187], v1, s[8:11], s18 offen offset:3072 sc1
  s_add_u32 s18, s18, 4096
  buffer_load_dwordx4 v[188:191], v1, s[8:11], s19 offen offset:3072 sc1
  s_add_u32 s19, s19, 4096
  v_add_u32 v4, s90, v1
  s_lshl_b32 s76, s3, 13
  s_add_u32 s76, s76, 131072
  v_add_u32 v5, s76, v1
  s_lshl_b32 s90, s3, 12
  s_mul_i32 s89, s86, 114688
  s_add_u32 s89, s89, s90
  s_add_u32 s89, s89, 46137344
  s_waitcnt vmcnt(12)
  v_mfma_f32_16x16x32_bf16 v[64:67], a[192:195], v[128:131], 0
  buffer_load_dwordx4 v[192:195], v1, s[8:11], s16 offen offset:0 sc1
  v_mfma_f32_16x16x32_bf16 v[68:71], a[192:195], v[132:135], 0
  v_mfma_f32_16x16x32_bf16 v[72:75], a[192:195], v[136:139], 0
  v_mfma_f32_16x16x32_bf16 v[76:79], a[192:195], v[140:143], 0
  v_mfma_f32_16x16x32_bf16 v[80:83], a[196:199], v[128:131], 0
  buffer_load_dwordx4 v[196:199], v1, s[8:11], s17 offen offset:0 sc1
  v_mfma_f32_16x16x32_bf16 v[84:87], a[196:199], v[132:135], 0
  v_mfma_f32_16x16x32_bf16 v[88:91], a[196:199], v[136:139], 0
  v_mfma_f32_16x16x32_bf16 v[92:95], a[196:199], v[140:143], 0
  v_mfma_f32_16x16x32_bf16 v[96:99], a[200:203], v[128:131], 0
  buffer_load_dwordx4 v[200:203], v1, s[8:11], s18 offen offset:0 sc1
  v_mfma_f32_16x16x32_bf16 v[100:103], a[200:203], v[132:135], 0
  v_mfma_f32_16x16x32_bf16 v[104:107], a[200:203], v[136:139], 0
  v_mfma_f32_16x16x32_bf16 v[108:111], a[200:203], v[140:143], 0
  v_mfma_f32_16x16x32_bf16 v[112:115], a[204:207], v[128:131], 0
  buffer_load_dwordx4 v[204:207], v1, s[8:11], s19 offen offset:0 sc1
  v_mfma_f32_16x16x32_bf16 v[116:119], a[204:207], v[132:135], 0
  v_mfma_f32_16x16x32_bf16 v[120:123], a[204:207], v[136:139], 0
  v_mfma_f32_16x16x32_bf16 v[124:127], a[204:207], v[140:143], 0
  s_waitcnt vmcnt(12)
  v_mfma_f32_16x16x32_bf16 v[64:67], a[208:211], v[144:147], v[64:67]
  buffer_load_dwordx4 v[208:211], v1, s[8:11], s16 offen offset:1024 sc1
  v_mfma_f32_16x16x32_bf16 v[68:71], a[208:211], v[148:151], v[68:71]
  v_mfma_f32_16x16x32_bf16 v[72:75], a[208:211], v[152:155], v[72:75]
  buffer_load_dwordx4 v[212:215], v1, s[8:11], s17 offen offset:1024 sc1
  v_mfma_f32_16x16x32_bf16 v[76:79], a[208:211], v[156:159], v[76:79]
  v_mfma_f32_16x16x32_bf16 v[80:83], a[212:215], v[144:147], v[80:83]
  buffer_load_dwordx4 v[216:219], v1, s[8:11], s18 offen offset:1024 sc1
  v_mfma_f32_16x16x32_bf16 v[84:87], a[212:215], v[148:151], v[84:87]
  v_mfma_f32_16x16x32_bf16 v[88:91], a[212:215], v[152:155], v[88:91]
  buffer_load_dwordx4 v[220:223], v1, s[8:11], s19 offen offset:1024 sc1
  v_mfma_f32_16x16x32_bf16 v[92:95], a[212:215], v[156:159], v[92:95]
  v_mfma_f32_16x16x32_bf16 v[96:99], a[216:219], v[144:147], v[96:99]
  ds_read_b128 a[192:195], v5 offset:0
  v_mfma_f32_16x16x32_bf16 v[100:103], a[216:219], v[148:151], v[100:103]
  v_mfma_f32_16x16x32_bf16 v[104:107], a[216:219], v[152:155], v[104:107]
  ds_read_b128 a[196:199], v5 offset:1024
  v_mfma_f32_16x16x32_bf16 v[108:111], a[216:219], v[156:159], v[108:111]
  v_mfma_f32_16x16x32_bf16 v[112:115], a[220:223], v[144:147], v[112:115]
  ds_read_b128 a[200:203], v5 offset:2048
  v_mfma_f32_16x16x32_bf16 v[116:119], a[220:223], v[148:151], v[116:119]
  v_mfma_f32_16x16x32_bf16 v[120:123], a[220:223], v[152:155], v[120:123]
  ds_read_b128 a[204:207], v5 offset:3072
  v_mfma_f32_16x16x32_bf16 v[124:127], a[220:223], v[156:159], v[124:127]
  s_waitcnt vmcnt(12)
  v_mfma_f32_16x16x32_bf16 v[64:67], a[224:227], v[160:163], v[64:67]
  buffer_load_dwordx4 v[224:227], v1, s[8:11], s16 offen offset:2048 sc1
  v_mfma_f32_16x16x32_bf16 v[68:71], a[224:227], v[164:167], v[68:71]
  v_mfma_f32_16x16x32_bf16 v[72:75], a[224:227], v[168:171], v[72:75]
  buffer_load_dwordx4 v[228:231], v1, s[8:11], s17 offen offset:2048 sc1
  v_mfma_f32_16x16x32_bf16 v[76:79], a[224:227], v[172:175], v[76:79]
  v_mfma_f32_16x16x32_bf16 v[80:83], a[228:231], v[160:163], v[80:83]
  buffer_load_dwordx4 v[232:235], v1, s[8:11], s18 offen offset:2048 sc1
  v_mfma_f32_16x16x32_bf16 v[84:87], a[228:231], v[164:167], v[84:87]
  v_mfma_f32_16x16x32_bf16 v[88:91], a[228:231], v[168:171], v[88:91]
  buffer_load_dwordx4 v[236:239], v1, s[8:11], s19 offen offset:2048 sc1
  v_mfma_f32_16x16x32_bf16 v[92:95], a[228:231], v[172:175], v[92:95]
  v_mfma_f32_16x16x32_bf16 v[96:99], a[232:235], v[160:163], v[96:99]
  ds_read_b128 a[208:211], v5 offset:4096
  v_mfma_f32_16x16x32_bf16 v[100:103], a[232:235], v[164:167], v[100:103]
  v_mfma_f32_16x16x32_bf16 v[104:107], a[232:235], v[168:171], v[104:107]
  ds_read_b128 a[212:215], v5 offset:5120
  v_mfma_f32_16x16x32_bf16 v[108:111], a[232:235], v[172:175], v[108:111]
  v_mfma_f32_16x16x32_bf16 v[112:115], a[236:239], v[160:163], v[112:115]
  ds_read_b128 a[216:219], v5 offset:6144
  v_mfma_f32_16x16x32_bf16 v[116:119], a[236:239], v[164:167], v[116:119]
  v_mfma_f32_16x16x32_bf16 v[120:123], a[236:239], v[168:171], v[120:123]
  ds_read_b128 a[220:223], v5 offset:7168
  v_mfma_f32_16x16x32_bf16 v[124:127], a[236:239], v[172:175], v[124:127]
  s_waitcnt vmcnt(12)
  v_mfma_f32_16x16x32_bf16 v[64:67], a[240:243], v[176:179], v[64:67]
  buffer_load_dwordx4 v[128:131], v1, s[8:11], s16 offen offset:3072 sc1
  s_add_u32 s16, s16, 4096
  v_mfma_f32_16x16x32_bf16 v[68:71], a[240:243], v[180:183], v[68:71]
  v_mfma_f32_16x16x32_bf16 v[72:75], a[240:243], v[184:187], v[72:75]
  buffer_load_dwordx4 v[132:135], v1, s[8:11], s17 offen offset:3072 sc1
  s_add_u32 s17, s17, 4096
  v_mfma_f32_16x16x32_bf16 v[76:79], a[240:243], v[188:191], v[76:79]
  v_mfma_f32_16x16x32_bf16 v[80:83], a[244:247], v[176:179], v[80:83]
  buffer_load_dwordx4 v[136:139], v1, s[8:11], s18 offen offset:3072 sc1
  s_add_u32 s18, s18, 4096
  v_mfma_f32_16x16x32_bf16 v[84:87], a[244:247], v[180:183], v[84:87]
  v_mfma_f32_16x16x32_bf16 v[88:91], a[244:247], v[184:187], v[88:91]
  buffer_load_dwordx4 v[140:143], v1, s[8:11], s19 offen offset:3072 sc1
  s_add_u32 s19, s19, 4096
  v_mfma_f32_16x16x32_bf16 v[92:95], a[244:247], v[188:191], v[92:95]
  v_mfma_f32_16x16x32_bf16 v[96:99], a[248:251], v[176:179], v[96:99]
  ds_read_b128 a[224:227], v4 offset:0
  v_mfma_f32_16x16x32_bf16 v[100:103], a[248:251], v[180:183], v[100:103]
  v_mfma_f32_16x16x32_bf16 v[104:107], a[248:251], v[184:187], v[104:107]
  ds_read_b128 a[228:231], v4 offset:1024
  v_mfma_f32_16x16x32_bf16 v[108:111], a[248:251], v[188:191], v[108:111]
  v_mfma_f32_16x16x32_bf16 v[112:115], a[252:255], v[176:179], v[112:115]
  ds_read_b128 a[232:235], v4 offset:2048
  v_mfma_f32_16x16x32_bf16 v[116:119], a[252:255], v[180:183], v[116:119]
  v_mfma_f32_16x16x32_bf16 v[120:123], a[252:255], v[184:187], v[120:123]
  ds_read_b128 a[236:239], v4 offset:3072
  v_mfma_f32_16x16x32_bf16 v[124:127], a[252:255], v[188:191], v[124:127]
  s_waitcnt vmcnt(12)
  v_mfma_f32_16x16x32_bf16 v[64:67], a[128:131], v[192:195], v[64:67]
  buffer_load_dwordx4 v[144:147], v1, s[8:11], s16 offen offset:0 sc1
  v_mfma_f32_16x16x32_bf16 v[68:71], a[128:131], v[196:199], v[68:71]
  v_mfma_f32_16x16x32_bf16 v[72:75], a[128:131], v[200:203], v[72:75]
  buffer_load_dwordx4 v[148:151], v1, s[8:11], s17 offen offset:0 sc1
  v_mfma_f32_16x16x32_bf16 v[76:79], a[128:131], v[204:207], v[76:79]
  v_mfma_f32_16x16x32_bf16 v[80:83], a[132:135], v[192:195], v[80:83]
  buffer_load_dwordx4 v[152:155], v1, s[8:11], s18 offen offset:0 sc1
  v_mfma_f32_16x16x32_bf16 v[84:87], a[132:135], v[196:199], v[84:87]
  v_mfma_f32_16x16x32_bf16 v[88:91], a[132:135], v[200:203], v[88:91]
  buffer_load_dwordx4 v[156:159], v1, s[8:11], s19 offen offset:0 sc1
  v_mfma_f32_16x16x32_bf16 v[92:95], a[132:135], v[204:207], v[92:95]
  v_mfma_f32_16x16x32_bf16 v[96:99], a[136:139], v[192:195], v[96:99]
  ds_read_b128 a[240:243], v4 offset:4096
  v_mfma_f32_16x16x32_bf16 v[100:103], a[136:139], v[196:199], v[100:103]
  v_mfma_f32_16x16x32_bf16 v[104:107], a[136:139], v[200:203], v[104:107]
  ds_read_b128 a[244:247], v4 offset:5120
  v_mfma_f32_16x16x32_bf16 v[108:111], a[136:139], v[204:207], v[108:111]
  v_mfma_f32_16x16x32_bf16 v[112:115], a[140:143], v[192:195], v[112:115]
  ds_read_b128 a[248:251], v4 offset:6144
  v_mfma_f32_16x16x32_bf16 v[116:119], a[140:143], v[196:199], v[116:119]
  v_mfma_f32_16x16x32_bf16 v[120:123], a[140:143], v[200:203], v[120:123]
  ds_read_b128 a[252:255], v4 offset:7168
  v_mfma_f32_16x16x32_bf16 v[124:127], a[140:143], v[204:207], v[124:127]
  s_waitcnt vmcnt(12)
  v_mfma_f32_16x16x32_bf16 v[64:67], a[144:147], v[208:211], v[64:67]
  buffer_load_dwordx4 v[160:163], v1, s[8:11], s16 offen offset:1024 sc1
  v_mfma_f32_16x16x32_bf16 v[68:71], a[144:147], v[212:215], v[68:71]
  v_mfma_f32_16x16x32_bf16 v[72:75], a[144:147], v[216:219], v[72:75]
  buffer_load_dwordx4 v[164:167], v1, s[8:11], s17 offen offset:1024 sc1
  v_mfma_f32_16x16x32_bf16 v[76:79], a[144:147], v[220:223], v[76:79]
  v_mfma_f32_16x16x32_bf16 v[80:83], a[148:151], v[208:211], v[80:83]
  buffer_load_dwordx4 v[168:171], v1, s[8:11], s18 offen offset:1024 sc1
  v_mfma_f32_16x16x32_bf16 v[84:87], a[148:151], v[212:215], v[84:87]
  v_mfma_f32_16x16x32_bf16 v[88:91], a[148:151], v[216:219], v[88:91]
  buffer_load_dwordx4 v[172:175], v1, s[8:11], s19 offen offset:1024 sc1
  v_mfma_f32_16x16x32_bf16 v[92:95], a[148:151], v[220:223], v[92:95]
  v_mfma_f32_16x16x32_bf16 v[96:99], a[152:155], v[208:211], v[96:99]
  ds_read_b128 a[128:131], v4 offset:8192
  v_mfma_f32_16x16x32_bf16 v[100:103], a[152:155], v[212:215], v[100:103]
  v_mfma_f32_16x16x32_bf16 v[104:107], a[152:155], v[216:219], v[104:107]
  ds_read_b128 a[132:135], v4 offset:9216
  v_mfma_f32_16x16x32_bf16 v[108:111], a[152:155], v[220:223], v[108:111]
  v_mfma_f32_16x16x32_bf16 v[112:115], a[156:159], v[208:211], v[112:115]
  ds_read_b128 a[136:139], v4 offset:10240
  v_mfma_f32_16x16x32_bf16 v[116:119], a[156:159], v[212:215], v[116:119]
  v_mfma_f32_16x16x32_bf16 v[120:123], a[156:159], v[216:219], v[120:123]
  ds_read_b128 a[140:143], v4 offset:11264
  v_mfma_f32_16x16x32_bf16 v[124:127], a[156:159], v[220:223], v[124:127]
  s_waitcnt vmcnt(12)
  v_mfma_f32_16x16x32_bf16 v[64:67], a[160:163], v[224:227], v[64:67]
  buffer_load_dwordx4 v[176:179], v1, s[8:11], s16 offen offset:2048 sc1
  v_mfma_f32_16x16x32_bf16 v[68:71], a[160:163], v[228:231], v[68:71]
  v_mfma_f32_16x16x32_bf16 v[72:75], a[160:163], v[232:235], v[72:75]
  buffer_load_dwordx4 v[180:183], v1, s[8:11], s17 offen offset:2048 sc1
  v_mfma_f32_16x16x32_bf16 v[76:79], a[160:163], v[236:239], v[76:79]
  v_mfma_f32_16x16x32_bf16 v[80:83], a[164:167], v[224:227], v[80:83]
  buffer_load_dwordx4 v[184:187], v1, s[8:11], s18 offen offset:2048 sc1
  v_mfma_f32_16x16x32_bf16 v[84:87], a[164:167], v[228:231], v[84:87]
  v_mfma_f32_16x16x32_bf16 v[88:91], a[164:167], v[232:235], v[88:91]
  buffer_load_dwordx4 v[188:191], v1, s[8:11], s19 offen offset:2048 sc1
  v_mfma_f32_16x16x32_bf16 v[92:95], a[164:167], v[236:239], v[92:95]
  v_mfma_f32_16x16x32_bf16 v[96:99], a[168:171], v[224:227], v[96:99]
  ds_read_b128 a[144:147], v4 offset:12288
  v_mfma_f32_16x16x32_bf16 v[100:103], a[168:171], v[228:231], v[100:103]
  v_mfma_f32_16x16x32_bf16 v[104:107], a[168:171], v[232:235], v[104:107]
  ds_read_b128 a[148:151], v4 offset:13312
  v_mfma_f32_16x16x32_bf16 v[108:111], a[168:171], v[236:239], v[108:111]
  v_mfma_f32_16x16x32_bf16 v[112:115], a[172:175], v[224:227], v[112:115]
  ds_read_b128 a[152:155], v4 offset:14336
  v_mfma_f32_16x16x32_bf16 v[116:119], a[172:175], v[228:231], v[116:119]
  v_mfma_f32_16x16x32_bf16 v[120:123], a[172:175], v[232:235], v[120:123]
  ds_read_b128 a[156:159], v4 offset:15360
  v_mfma_f32_16x16x32_bf16 v[124:127], a[172:175], v[236:239], v[124:127]
  s_waitcnt vmcnt(12)
  v_mfma_f32_16x16x32_bf16 v[64:67], a[176:179], v[128:131], v[64:67]
  buffer_load_dwordx4 v[192:195], v1, s[8:11], s16 offen offset:3072 sc1
  s_add_u32 s16, s16, 4096
  v_mfma_f32_16x16x32_bf16 v[68:71], a[176:179], v[132:135], v[68:71]
  v_mfma_f32_16x16x32_bf16 v[72:75], a[176:179], v[136:139], v[72:75]
  buffer_load_dwordx4 v[196:199], v1, s[8:11], s17 offen offset:3072 sc1
  s_add_u32 s17, s17, 4096
  v_mfma_f32_16x16x32_bf16 v[76:79], a[176:179], v[140:143], v[76:79]
  v_mfma_f32_16x16x32_bf16 v[80:83], a[180:183], v[128:131], v[80:83]
  buffer_load_dwordx4 v[200:203], v1, s[8:11], s18 offen offset:3072 sc1
  s_add_u32 s18, s18, 4096
  v_mfma_f32_16x16x32_bf16 v[84:87], a[180:183], v[132:135], v[84:87]
  v_mfma_f32_16x16x32_bf16 v[88:91], a[180:183], v[136:139], v[88:91]
  buffer_load_dwordx4 v[204:207], v1, s[8:11], s19 offen offset:3072 sc1
  s_add_u32 s19, s19, 4096
  v_mfma_f32_16x16x32_bf16 v[92:95], a[180:183], v[140:143], v[92:95]
  v_mfma_f32_16x16x32_bf16 v[96:99], a[184:187], v[128:131], v[96:99]
  ds_read_b128 a[160:163], v4 offset:16384
  v_mfma_f32_16x16x32_bf16 v[100:103], a[184:187], v[132:135], v[100:103]
  v_mfma_f32_16x16x32_bf16 v[104:107], a[184:187], v[136:139], v[104:107]
  ds_read_b128 a[164:167], v4 offset:17408
  v_mfma_f32_16x16x32_bf16 v[108:111], a[184:187], v[140:143], v[108:111]
  v_mfma_f32_16x16x32_bf16 v[112:115], a[188:191], v[128:131], v[112:115]
  ds_read_b128 a[168:171], v4 offset:18432
  v_mfma_f32_16x16x32_bf16 v[116:119], a[188:191], v[132:135], v[116:119]
  v_mfma_f32_16x16x32_bf16 v[120:123], a[188:191], v[136:139], v[120:123]
  ds_read_b128 a[172:175], v4 offset:19456
  v_mfma_f32_16x16x32_bf16 v[124:127], a[188:191], v[140:143], v[124:127]
  s_waitcnt vmcnt(12)
  v_mfma_f32_16x16x32_bf16 v[64:67], a[8:11], v[144:147], v[64:67]
  buffer_load_dwordx4 v[208:211], v1, s[8:11], s16 offen offset:0 sc1
  v_mfma_f32_16x16x32_bf16 v[68:71], a[8:11], v[148:151], v[68:71]
  v_mfma_f32_16x16x32_bf16 v[72:75], a[8:11], v[152:155], v[72:75]
  buffer_load_dwordx4 v[212:215], v1, s[8:11], s17 offen offset:0 sc1
  v_mfma_f32_16x16x32_bf16 v[76:79], a[8:11], v[156:159], v[76:79]
  v_mfma_f32_16x16x32_bf16 v[80:83], a[12:15], v[144:147], v[80:83]
  buffer_load_dwordx4 v[216:219], v1, s[8:11], s18 offen offset:0 sc1
  v_mfma_f32_16x16x32_bf16 v[84:87], a[12:15], v[148:151], v[84:87]
  v_mfma_f32_16x16x32_bf16 v[88:91], a[12:15], v[152:155], v[88:91]
  buffer_load_dwordx4 v[220:223], v1, s[8:11], s19 offen offset:0 sc1
  v_mfma_f32_16x16x32_bf16 v[92:95], a[12:15], v[156:159], v[92:95]
  v_mfma_f32_16x16x32_bf16 v[96:99], a[24:27], v[144:147], v[96:99]
  ds_read_b128 a[176:179], v4 offset:20480
  v_mfma_f32_16x16x32_bf16 v[100:103], a[24:27], v[148:151], v[100:103]
  v_mfma_f32_16x16x32_bf16 v[104:107], a[24:27], v[152:155], v[104:107]
  ds_read_b128 a[180:183], v4 offset:21504
  v_mfma_f32_16x16x32_bf16 v[108:111], a[24:27], v[156:159], v[108:111]
  v_mfma_f32_16x16x32_bf16 v[112:115], a[28:31], v[144:147], v[112:115]
  ds_read_b128 a[184:187], v4 offset:22528
  v_mfma_f32_16x16x32_bf16 v[116:119], a[28:31], v[148:151], v[116:119]
  v_mfma_f32_16x16x32_bf16 v[120:123], a[28:31], v[152:155], v[120:123]
  ds_read_b128 a[188:191], v4 offset:23552
  v_mfma_f32_16x16x32_bf16 v[124:127], a[28:31], v[156:159], v[124:127]
  s_waitcnt vmcnt(12)
  v_mfma_f32_16x16x32_bf16 v[64:67], a[40:43], v[160:163], v[64:67]
  buffer_load_dwordx4 v[224:227], v1, s[8:11], s16 offen offset:1024 sc1
  v_mfma_f32_16x16x32_bf16 v[68:71], a[40:43], v[164:167], v[68:71]
  v_mfma_f32_16x16x32_bf16 v[72:75], a[40:43], v[168:171], v[72:75]
  buffer_load_dwordx4 v[228:231], v1, s[8:11], s17 offen offset:1024 sc1
  v_mfma_f32_16x16x32_bf16 v[76:79], a[40:43], v[172:175], v[76:79]
  v_mfma_f32_16x16x32_bf16 v[80:83], a[44:47], v[160:163], v[80:83]
  buffer_load_dwordx4 v[232:235], v1, s[8:11], s18 offen offset:1024 sc1
  v_mfma_f32_16x16x32_bf16 v[84:87], a[44:47], v[164:167], v[84:87]
  v_mfma_f32_16x16x32_bf16 v[88:91], a[44:47], v[168:171], v[88:91]
  buffer_load_dwordx4 v[236:239], v1, s[8:11], s19 offen offset:1024 sc1
  v_mfma_f32_16x16x32_bf16 v[92:95], a[44:47], v[172:175], v[92:95]
  v_mfma_f32_16x16x32_bf16 v[96:99], a[56:59], v[160:163], v[96:99]
  s_add_u32 s77, s82, 98304
  buffer_load_dwordx4 a[8:11], v1, s[8:11], s77 offen offset:0 sc1
  v_mfma_f32_16x16x32_bf16 v[100:103], a[56:59], v[164:167], v[100:103]
  v_mfma_f32_16x16x32_bf16 v[104:107], a[56:59], v[168:171], v[104:107]
  buffer_load_dwordx4 a[12:15], v1, s[8:11], s77 offen offset:1024 sc1
  v_mfma_f32_16x16x32_bf16 v[108:111], a[56:59], v[172:175], v[108:111]
  v_mfma_f32_16x16x32_bf16 v[112:115], a[60:63], v[160:163], v[112:115]
  buffer_load_dwordx4 a[24:27], v1, s[8:11], s77 offen offset:2048 sc1
  v_mfma_f32_16x16x32_bf16 v[116:119], a[60:63], v[164:167], v[116:119]
  v_mfma_f32_16x16x32_bf16 v[120:123], a[60:63], v[168:171], v[120:123]
  buffer_load_dwordx4 a[28:31], v1, s[8:11], s77 offen offset:3072 sc1
  v_mfma_f32_16x16x32_bf16 v[124:127], a[60:63], v[172:175], v[124:127]
  s_waitcnt vmcnt(16)
  v_mfma_f32_16x16x32_bf16 v[64:67], a[72:75], v[176:179], v[64:67]
  buffer_load_dwordx4 v[128:131], v1, s[8:11], s16 offen offset:2048 sc1
  v_mfma_f32_16x16x32_bf16 v[68:71], a[72:75], v[180:183], v[68:71]
  v_mfma_f32_16x16x32_bf16 v[72:75], a[72:75], v[184:187], v[72:75]
  buffer_load_dwordx4 v[132:135], v1, s[8:11], s17 offen offset:2048 sc1
  v_mfma_f32_16x16x32_bf16 v[76:79], a[72:75], v[188:191], v[76:79]
  v_mfma_f32_16x16x32_bf16 v[80:83], a[76:79], v[176:179], v[80:83]
  buffer_load_dwordx4 v[136:139], v1, s[8:11], s18 offen offset:2048 sc1
  v_mfma_f32_16x16x32_bf16 v[84:87], a[76:79], v[180:183], v[84:87]
  v_mfma_f32_16x16x32_bf16 v[88:91], a[76:79], v[184:187], v[88:91]
  buffer_load_dwordx4 v[140:143], v1, s[8:11], s19 offen offset:2048 sc1
  v_mfma_f32_16x16x32_bf16 v[92:95], a[76:79], v[188:191], v[92:95]
  v_mfma_f32_16x16x32_bf16 v[96:99], a[88:91], v[176:179], v[96:99]
  s_add_u32 s77, s82, 102400
  buffer_load_dwordx4 a[40:43], v1, s[8:11], s77 offen offset:0 sc1
  v_mfma_f32_16x16x32_bf16 v[100:103], a[88:91], v[180:183], v[100:103]
  v_mfma_f32_16x16x32_bf16 v[104:107], a[88:91], v[184:187], v[104:107]
  buffer_load_dwordx4 a[44:47], v1, s[8:11], s77 offen offset:1024 sc1
  v_mfma_f32_16x16x32_bf16 v[108:111], a[88:91], v[188:191], v[108:111]
  v_mfma_f32_16x16x32_bf16 v[112:115], a[92:95], v[176:179], v[112:115]
  buffer_load_dwordx4 a[56:59], v1, s[8:11], s77 offen offset:2048 sc1
  v_mfma_f32_16x16x32_bf16 v[116:119], a[92:95], v[180:183], v[116:119]
  v_mfma_f32_16x16x32_bf16 v[120:123], a[92:95], v[184:187], v[120:123]
  buffer_load_dwordx4 a[60:63], v1, s[8:11], s77 offen offset:3072 sc1
  v_mfma_f32_16x16x32_bf16 v[124:127], a[92:95], v[188:191], v[124:127]
  s_waitcnt vmcnt(20)
  v_mfma_f32_16x16x32_bf16 v[64:67], a[104:107], v[192:195], v[64:67]
  buffer_load_dwordx4 v[144:147], v1, s[8:11], s16 offen offset:3072 sc1
  s_add_u32 s16, s16, 4096
  v_mfma_f32_16x16x32_bf16 v[68:71], a[104:107], v[196:199], v[68:71]
  v_mfma_f32_16x16x32_bf16 v[72:75], a[104:107], v[200:203], v[72:75]
  buffer_load_dwordx4 v[148:151], v1, s[8:11], s17 offen offset:3072 sc1
  s_add_u32 s17, s17, 4096
  v_mfma_f32_16x16x32_bf16 v[76:79], a[104:107], v[204:207], v[76:79]
  v_mfma_f32_16x16x32_bf16 v[80:83], a[108:111], v[192:195], v[80:83]
  buffer_load_dwordx4 v[152:155], v1, s[8:11], s18 offen offset:3072 sc1
  s_add_u32 s18, s18, 4096
  v_mfma_f32_16x16x32_bf16 v[84:87], a[108:111], v[196:199], v[84:87]
  v_mfma_f32_16x16x32_bf16 v[88:91], a[108:111], v[200:203], v[88:91]
  buffer_load_dwordx4 v[156:159], v1, s[8:11], s19 offen offset:3072 sc1
  s_add_u32 s19, s19, 4096
  v_mfma_f32_16x16x32_bf16 v[92:95], a[108:111], v[204:207], v[92:95]
  v_mfma_f32_16x16x32_bf16 v[96:99], a[120:123], v[192:195], v[96:99]
  s_add_u32 s77, s82, 106496
  buffer_load_dwordx4 a[72:75], v1, s[8:11], s77 offen offset:0 sc1
  v_mfma_f32_16x16x32_bf16 v[100:103], a[120:123], v[196:199], v[100:103]
  v_mfma_f32_16x16x32_bf16 v[104:107], a[120:123], v[200:203], v[104:107]
  buffer_load_dwordx4 a[76:79], v1, s[8:11], s77 offen offset:1024 sc1
  v_mfma_f32_16x16x32_bf16 v[108:111], a[120:123], v[204:207], v[108:111]
  v_mfma_f32_16x16x32_bf16 v[112:115], a[124:127], v[192:195], v[112:115]
  buffer_load_dwordx4 a[88:91], v1, s[8:11], s77 offen offset:2048 sc1
  v_mfma_f32_16x16x32_bf16 v[116:119], a[124:127], v[196:199], v[116:119]
  v_mfma_f32_16x16x32_bf16 v[120:123], a[124:127], v[200:203], v[120:123]
  buffer_load_dwordx4 a[92:95], v1, s[8:11], s77 offen offset:3072 sc1
  v_mfma_f32_16x16x32_bf16 v[124:127], a[124:127], v[204:207], v[124:127]
  s_waitcnt vmcnt(24)
  v_mfma_f32_16x16x32_bf16 v[64:67], a[0:3], v[208:211], v[64:67]
  buffer_load_dwordx4 v[160:163], v1, s[8:11], s16 offen offset:0 sc1
  v_mfma_f32_16x16x32_bf16 v[68:71], a[0:3], v[212:215], v[68:71]
  v_mfma_f32_16x16x32_bf16 v[72:75], a[0:3], v[216:219], v[72:75]
  buffer_load_dwordx4 v[164:167], v1, s[8:11], s17 offen offset:0 sc1
  v_mfma_f32_16x16x32_bf16 v[76:79], a[0:3], v[220:223], v[76:79]
  v_mfma_f32_16x16x32_bf16 v[80:83], a[4:7], v[208:211], v[80:83]
  buffer_load_dwordx4 v[168:171], v1, s[8:11], s18 offen offset:0 sc1
  v_mfma_f32_16x16x32_bf16 v[84:87], a[4:7], v[212:215], v[84:87]
  v_mfma_f32_16x16x32_bf16 v[88:91], a[4:7], v[216:219], v[88:91]
  buffer_load_dwordx4 v[172:175], v1, s[8:11], s19 offen offset:0 sc1
  v_mfma_f32_16x16x32_bf16 v[92:95], a[4:7], v[220:223], v[92:95]
  v_mfma_f32_16x16x32_bf16 v[96:99], a[16:19], v[208:211], v[96:99]
  s_add_u32 s77, s82, 110592
  buffer_load_dwordx4 a[104:107], v1, s[8:11], s77 offen offset:0 sc1
  v_mfma_f32_16x16x32_bf16 v[100:103], a[16:19], v[212:215], v[100:103]
  v_mfma_f32_16x16x32_bf16 v[104:107], a[16:19], v[216:219], v[104:107]
  buffer_load_dwordx4 a[108:111], v1, s[8:11], s77 offen offset:1024 sc1
  v_mfma_f32_16x16x32_bf16 v[108:111], a[16:19], v[220:223], v[108:111]
  v_mfma_f32_16x16x32_bf16 v[112:115], a[20:23], v[208:211], v[112:115]
  buffer_load_dwordx4 a[120:123], v1, s[8:11], s77 offen offset:2048 sc1
  v_mfma_f32_16x16x32_bf16 v[116:119], a[20:23], v[212:215], v[116:119]
  v_mfma_f32_16x16x32_bf16 v[120:123], a[20:23], v[216:219], v[120:123]
  buffer_load_dwordx4 a[124:127], v1, s[8:11], s77 offen offset:3072 sc1
  v_mfma_f32_16x16x32_bf16 v[124:127], a[20:23], v[220:223], v[124:127]
  s_waitcnt vmcnt(28)
  v_mfma_f32_16x16x32_bf16 v[64:67], a[32:35], v[224:227], v[64:67]
  buffer_load_dwordx4 v[176:179], v1, s[8:11], s16 offen offset:1024 sc1
  v_mfma_f32_16x16x32_bf16 v[68:71], a[32:35], v[228:231], v[68:71]
  v_mfma_f32_16x16x32_bf16 v[72:75], a[32:35], v[232:235], v[72:75]
  buffer_load_dwordx4 v[180:183], v1, s[8:11], s17 offen offset:1024 sc1
  v_mfma_f32_16x16x32_bf16 v[76:79], a[32:35], v[236:239], v[76:79]
  v_mfma_f32_16x16x32_bf16 v[80:83], a[36:39], v[224:227], v[80:83]
  buffer_load_dwordx4 v[184:187], v1, s[8:11], s18 offen offset:1024 sc1
  v_mfma_f32_16x16x32_bf16 v[84:87], a[36:39], v[228:231], v[84:87]
  v_mfma_f32_16x16x32_bf16 v[88:91], a[36:39], v[232:235], v[88:91]
  buffer_load_dwordx4 v[188:191], v1, s[8:11], s19 offen offset:1024 sc1
  v_mfma_f32_16x16x32_bf16 v[92:95], a[36:39], v[236:239], v[92:95]
  v_mfma_f32_16x16x32_bf16 v[96:99], a[48:51], v[224:227], v[96:99]
  s_add_u32 s77, s82, 114688
  buffer_load_dwordx4 a[0:3], v1, s[8:11], s77 offen offset:0 sc1
  v_mfma_f32_16x16x32_bf16 v[100:103], a[48:51], v[228:231], v[100:103]
  v_mfma_f32_16x16x32_bf16 v[104:107], a[48:51], v[232:235], v[104:107]
  buffer_load_dwordx4 a[4:7], v1, s[8:11], s77 offen offset:1024 sc1
  v_mfma_f32_16x16x32_bf16 v[108:111], a[48:51], v[236:239], v[108:111]
  v_mfma_f32_16x16x32_bf16 v[112:115], a[52:55], v[224:227], v[112:115]
  buffer_load_dwordx4 a[16:19], v1, s[8:11], s77 offen offset:2048 sc1
  v_mfma_f32_16x16x32_bf16 v[116:119], a[52:55], v[228:231], v[116:119]
  v_mfma_f32_16x16x32_bf16 v[120:123], a[52:55], v[232:235], v[120:123]
  buffer_load_dwordx4 a[20:23], v1, s[8:11], s77 offen offset:3072 sc1
  v_mfma_f32_16x16x32_bf16 v[124:127], a[52:55], v[236:239], v[124:127]
  s_waitcnt vmcnt(28)
  v_mfma_f32_16x16x32_bf16 v[64:67], a[64:67], v[128:131], v[64:67]
  buffer_load_dwordx4 v[192:195], v1, s[8:11], s16 offen offset:2048 sc1
  v_mfma_f32_16x16x32_bf16 v[68:71], a[64:67], v[132:135], v[68:71]
  v_mfma_f32_16x16x32_bf16 v[72:75], a[64:67], v[136:139], v[72:75]
  buffer_load_dwordx4 v[196:199], v1, s[8:11], s17 offen offset:2048 sc1
  v_mfma_f32_16x16x32_bf16 v[76:79], a[64:67], v[140:143], v[76:79]
  v_mfma_f32_16x16x32_bf16 v[80:83], a[68:71], v[128:131], v[80:83]
  buffer_load_dwordx4 v[200:203], v1, s[8:11], s18 offen offset:2048 sc1
  v_mfma_f32_16x16x32_bf16 v[84:87], a[68:71], v[132:135], v[84:87]
  v_mfma_f32_16x16x32_bf16 v[88:91], a[68:71], v[136:139], v[88:91]
  buffer_load_dwordx4 v[204:207], v1, s[8:11], s19 offen offset:2048 sc1
  v_mfma_f32_16x16x32_bf16 v[92:95], a[68:71], v[140:143], v[92:95]
  v_mfma_f32_16x16x32_bf16 v[96:99], a[80:83], v[128:131], v[96:99]
  s_add_u32 s77, s82, 118784
  buffer_load_dwordx4 a[32:35], v1, s[8:11], s77 offen offset:0 sc1
  v_mfma_f32_16x16x32_bf16 v[100:103], a[80:83], v[132:135], v[100:103]
  v_mfma_f32_16x16x32_bf16 v[104:107], a[80:83], v[136:139], v[104:107]
  buffer_load_dwordx4 a[36:39], v1, s[8:11], s77 offen offset:1024 sc1
  v_mfma_f32_16x16x32_bf16 v[108:111], a[80:83], v[140:143], v[108:111]
  v_mfma_f32_16x16x32_bf16 v[112:115], a[84:87], v[128:131], v[112:115]
  buffer_load_dwordx4 a[48:51], v1, s[8:11], s77 offen offset:2048 sc1
  v_mfma_f32_16x16x32_bf16 v[116:119], a[84:87], v[132:135], v[116:119]
  v_mfma_f32_16x16x32_bf16 v[120:123], a[84:87], v[136:139], v[120:123]
  buffer_load_dwordx4 a[52:55], v1, s[8:11], s77 offen offset:3072 sc1
  v_mfma_f32_16x16x32_bf16 v[124:127], a[84:87], v[140:143], v[124:127]
  s_waitcnt vmcnt(28)
  v_mfma_f32_16x16x32_bf16 v[64:67], a[96:99], v[144:147], v[64:67]
  buffer_load_dwordx4 v[208:211], v1, s[8:11], s16 offen offset:3072 sc1
  s_add_u32 s16, s16, 4096
  v_mfma_f32_16x16x32_bf16 v[68:71], a[96:99], v[148:151], v[68:71]
  v_mfma_f32_16x16x32_bf16 v[72:75], a[96:99], v[152:155], v[72:75]
  buffer_load_dwordx4 v[212:215], v1, s[8:11], s17 offen offset:3072 sc1
  s_add_u32 s17, s17, 4096
  v_mfma_f32_16x16x32_bf16 v[76:79], a[96:99], v[156:159], v[76:79]
  v_mfma_f32_16x16x32_bf16 v[80:83], a[100:103], v[144:147], v[80:83]
  buffer_load_dwordx4 v[216:219], v1, s[8:11], s18 offen offset:3072 sc1
  s_add_u32 s18, s18, 4096
  v_mfma_f32_16x16x32_bf16 v[84:87], a[100:103], v[148:151], v[84:87]
  v_mfma_f32_16x16x32_bf16 v[88:91], a[100:103], v[152:155], v[88:91]
  buffer_load_dwordx4 v[220:223], v1, s[8:11], s19 offen offset:3072 sc1
  s_add_u32 s19, s19, 4096
  v_mfma_f32_16x16x32_bf16 v[92:95], a[100:103], v[156:159], v[92:95]
  v_mfma_f32_16x16x32_bf16 v[96:99], a[112:115], v[144:147], v[96:99]
  s_add_u32 s77, s82, 122880
  buffer_load_dwordx4 a[64:67], v1, s[8:11], s77 offen offset:0 sc1
  v_mfma_f32_16x16x32_bf16 v[100:103], a[112:115], v[148:151], v[100:103]
  v_mfma_f32_16x16x32_bf16 v[104:107], a[112:115], v[152:155], v[104:107]
  buffer_load_dwordx4 a[68:71], v1, s[8:11], s77 offen offset:1024 sc1
  v_mfma_f32_16x16x32_bf16 v[108:111], a[112:115], v[156:159], v[108:111]
  v_mfma_f32_16x16x32_bf16 v[112:115], a[116:119], v[144:147], v[112:115]
  buffer_load_dwordx4 a[80:83], v1, s[8:11], s77 offen offset:2048 sc1
  v_mfma_f32_16x16x32_bf16 v[116:119], a[116:119], v[148:151], v[116:119]
  v_mfma_f32_16x16x32_bf16 v[120:123], a[116:119], v[152:155], v[120:123]
  buffer_load_dwordx4 a[84:87], v1, s[8:11], s77 offen offset:3072 sc1
  v_mfma_f32_16x16x32_bf16 v[124:127], a[116:119], v[156:159], v[124:127]
  s_waitcnt vmcnt(28) lgkmcnt(15)
  v_mfma_f32_16x16x32_bf16 v[64:67], a[192:195], v[160:163], v[64:67]
  buffer_load_dwordx4 v[224:227], v1, s[8:11], s16 offen offset:0 sc1
  v_mfma_f32_16x16x32_bf16 v[68:71], a[192:195], v[164:167], v[68:71]
  v_mfma_f32_16x16x32_bf16 v[72:75], a[192:195], v[168:171], v[72:75]
  buffer_load_dwordx4 v[228:231], v1, s[8:11], s17 offen offset:0 sc1
  v_mfma_f32_16x16x32_bf16 v[76:79], a[192:195], v[172:175], v[76:79]
  v_mfma_f32_16x16x32_bf16 v[80:83], a[196:199], v[160:163], v[80:83]
  buffer_load_dwordx4 v[232:235], v1, s[8:11], s18 offen offset:0 sc1
  v_mfma_f32_16x16x32_bf16 v[84:87], a[196:199], v[164:167], v[84:87]
  v_mfma_f32_16x16x32_bf16 v[88:91], a[196:199], v[168:171], v[88:91]
  buffer_load_dwordx4 v[236:239], v1, s[8:11], s19 offen offset:0 sc1
  v_mfma_f32_16x16x32_bf16 v[92:95], a[196:199], v[172:175], v[92:95]
  v_mfma_f32_16x16x32_bf16 v[96:99], a[200:203], v[160:163], v[96:99]
  s_add_u32 s77, s82, 126976
  buffer_load_dwordx4 a[96:99], v1, s[8:11], s77 offen offset:0 sc1
  v_mfma_f32_16x16x32_bf16 v[100:103], a[200:203], v[164:167], v[100:103]
  v_mfma_f32_16x16x32_bf16 v[104:107], a[200:203], v[168:171], v[104:107]
  buffer_load_dwordx4 a[100:103], v1, s[8:11], s77 offen offset:1024 sc1
  v_mfma_f32_16x16x32_bf16 v[108:111], a[200:203], v[172:175], v[108:111]
  v_mfma_f32_16x16x32_bf16 v[112:115], a[204:207], v[160:163], v[112:115]
  buffer_load_dwordx4 a[112:115], v1, s[8:11], s77 offen offset:2048 sc1
  v_mfma_f32_16x16x32_bf16 v[116:119], a[204:207], v[164:167], v[116:119]
  v_mfma_f32_16x16x32_bf16 v[120:123], a[204:207], v[168:171], v[120:123]
  buffer_load_dwordx4 a[116:119], v1, s[8:11], s77 offen offset:3072 sc1
  v_mfma_f32_16x16x32_bf16 v[124:127], a[204:207], v[172:175], v[124:127]
  s_waitcnt vmcnt(28)
  v_mfma_f32_16x16x32_bf16 v[64:67], a[208:211], v[176:179], v[64:67]
  buffer_load_dwordx4 v[128:131], v1, s[8:11], s16 offen offset:1024 sc1
  v_mfma_f32_16x16x32_bf16 v[68:71], a[208:211], v[180:183], v[68:71]
  v_mfma_f32_16x16x32_bf16 v[72:75], a[208:211], v[184:187], v[72:75]
  v_mfma_f32_16x16x32_bf16 v[76:79], a[208:211], v[188:191], v[76:79]
  v_mfma_f32_16x16x32_bf16 v[80:83], a[212:215], v[176:179], v[80:83]
  buffer_load_dwordx4 v[132:135], v1, s[8:11], s17 offen offset:1024 sc1
  v_mfma_f32_16x16x32_bf16 v[84:87], a[212:215], v[180:183], v[84:87]
  v_mfma_f32_16x16x32_bf16 v[88:91], a[212:215], v[184:187], v[88:91]
  v_mfma_f32_16x16x32_bf16 v[92:95], a[212:215], v[188:191], v[92:95]
  v_mfma_f32_16x16x32_bf16 v[96:99], a[216:219], v[176:179], v[96:99]
  buffer_load_dwordx4 v[136:139], v1, s[8:11], s18 offen offset:1024 sc1
  v_mfma_f32_16x16x32_bf16 v[100:103], a[216:219], v[180:183], v[100:103]
  v_mfma_f32_16x16x32_bf16 v[104:107], a[216:219], v[184:187], v[104:107]
  v_mfma_f32_16x16x32_bf16 v[108:111], a[216:219], v[188:191], v[108:111]
  v_mfma_f32_16x16x32_bf16 v[112:115], a[220:223], v[176:179], v[112:115]
  buffer_load_dwordx4 v[140:143], v1, s[8:11], s19 offen offset:1024 sc1
  v_mfma_f32_16x16x32_bf16 v[116:119], a[220:223], v[180:183], v[116:119]
  v_mfma_f32_16x16x32_bf16 v[120:123], a[220:223], v[184:187], v[120:123]
  v_mfma_f32_16x16x32_bf16 v[124:127], a[220:223], v[188:191], v[124:127]
  s_waitcnt vmcnt(24)
  v_mfma_f32_16x16x32_bf16 v[64:67], a[224:227], v[192:195], v[64:67]
  buffer_load_dwordx4 v[144:147], v1, s[8:11], s16 offen offset:2048 sc1
  v_mfma_f32_16x16x32_bf16 v[68:71], a[224:227], v[196:199], v[68:71]
  v_mfma_f32_16x16x32_bf16 v[72:75], a[224:227], v[200:203], v[72:75]
  v_mfma_f32_16x16x32_bf16 v[76:79], a[224:227], v[204:207], v[76:79]
  v_mfma_f32_16x16x32_bf16 v[80:83], a[228:231], v[192:195], v[80:83]
  buffer_load_dwordx4 v[148:151], v1, s[8:11], s17 offen offset:2048 sc1
  v_mfma_f32_16x16x32_bf16 v[84:87], a[228:231], v[196:199], v[84:87]
  v_mfma_f32_16x16x32_bf16 v[88:91], a[228:231], v[200:203], v[88:91]
  v_mfma_f32_16x16x32_bf16 v[92:95], a[228:231], v[204:207], v[92:95]
  v_mfma_f32_16x16x32_bf16 v[96:99], a[232:235], v[192:195], v[96:99]
  buffer_load_dwordx4 v[152:155], v1, s[8:11], s18 offen offset:2048 sc1
  v_mfma_f32_16x16x32_bf16 v[100:103], a[232:235], v[196:199], v[100:103]
  v_mfma_f32_16x16x32_bf16 v[104:107], a[232:235], v[200:203], v[104:107]
  v_mfma_f32_16x16x32_bf16 v[108:111], a[232:235], v[204:207], v[108:111]
  v_mfma_f32_16x16x32_bf16 v[112:115], a[236:239], v[192:195], v[112:115]
  buffer_load_dwordx4 v[156:159], v1, s[8:11], s19 offen offset:2048 sc1
  v_mfma_f32_16x16x32_bf16 v[116:119], a[236:239], v[196:199], v[116:119]
  v_mfma_f32_16x16x32_bf16 v[120:123], a[236:239], v[200:203], v[120:123]
  v_mfma_f32_16x16x32_bf16 v[124:127], a[236:239], v[204:207], v[124:127]
  s_waitcnt vmcnt(20)
  v_mfma_f32_16x16x32_bf16 v[64:67], a[240:243], v[208:211], v[64:67]
  buffer_load_dwordx4 v[160:163], v1, s[8:11], s16 offen offset:3072 sc1
  s_add_u32 s16, s16, 4096
  v_mfma_f32_16x16x32_bf16 v[68:71], a[240:243], v[212:215], v[68:71]
  v_mfma_f32_16x16x32_bf16 v[72:75], a[240:243], v[216:219], v[72:75]
  v_mfma_f32_16x16x32_bf16 v[76:79], a[240:243], v[220:223], v[76:79]
  v_mfma_f32_16x16x32_bf16 v[80:83], a[244:247], v[208:211], v[80:83]
  buffer_load_dwordx4 v[164:167], v1, s[8:11], s17 offen offset:3072 sc1
  s_add_u32 s17, s17, 4096
  v_mfma_f32_16x16x32_bf16 v[84:87], a[244:247], v[212:215], v[84:87]
  v_mfma_f32_16x16x32_bf16 v[88:91], a[244:247], v[216:219], v[88:91]
  v_mfma_f32_16x16x32_bf16 v[92:95], a[244:247], v[220:223], v[92:95]
  v_mfma_f32_16x16x32_bf16 v[96:99], a[248:251], v[208:211], v[96:99]
  buffer_load_dwordx4 v[168:171], v1, s[8:11], s18 offen offset:3072 sc1
  s_add_u32 s18, s18, 4096
  v_mfma_f32_16x16x32_bf16 v[100:103], a[248:251], v[212:215], v[100:103]
  v_mfma_f32_16x16x32_bf16 v[104:107], a[248:251], v[216:219], v[104:107]
  v_mfma_f32_16x16x32_bf16 v[108:111], a[248:251], v[220:223], v[108:111]
  v_mfma_f32_16x16x32_bf16 v[112:115], a[252:255], v[208:211], v[112:115]
  buffer_load_dwordx4 v[172:175], v1, s[8:11], s19 offen offset:3072 sc1
  s_add_u32 s19, s19, 4096
  v_mfma_f32_16x16x32_bf16 v[116:119], a[252:255], v[212:215], v[116:119]
  v_mfma_f32_16x16x32_bf16 v[120:123], a[252:255], v[216:219], v[120:123]
  v_mfma_f32_16x16x32_bf16 v[124:127], a[252:255], v[220:223], v[124:127]
  s_waitcnt vmcnt(16) lgkmcnt(12)
  v_mfma_f32_16x16x32_bf16 v[64:67], a[128:131], v[224:227], v[64:67]
  buffer_load_dwordx4 v[176:179], v1, s[8:11], s16 offen offset:0 sc1
  v_mfma_f32_16x16x32_bf16 v[68:71], a[128:131], v[228:231], v[68:71]
  buffer_load_dwordx4 v[180:183], v1, s[8:11], s17 offen offset:0 sc1
  v_mfma_f32_16x16x32_bf16 v[72:75], a[128:131], v[232:235], v[72:75]
  v_mfma_f32_16x16x32_bf16 v[76:79], a[128:131], v[236:239], v[76:79]
  buffer_load_dwordx4 v[184:187], v1, s[8:11], s18 offen offset:0 sc1
  v_mfma_f32_16x16x32_bf16 v[80:83], a[132:135], v[224:227], v[80:83]
  v_mfma_f32_16x16x32_bf16 v[84:87], a[132:135], v[228:231], v[84:87]
  buffer_load_dwordx4 v[188:191], v1, s[8:11], s19 offen offset:0 sc1
  v_mfma_f32_16x16x32_bf16 v[88:91], a[132:135], v[232:235], v[88:91]
  v_mfma_f32_16x16x32_bf16 v[92:95], a[132:135], v[236:239], v[92:95]
  s_barrier
  v_mfma_f32_16x16x32_bf16 v[96:99], a[136:139], v[224:227], v[96:99]
  s_add_u32 s76, s3, 0
  s_and_b32 s76, s76, 3
  s_mul_i32 s76, s76, 12288
  s_add_u32 s76, s76, 114688
  v_add_u32 v6, s76, v1
  v_mfma_f32_16x16x32_bf16 v[100:103], a[136:139], v[228:231], v[100:103]
  v_mfma_f32_16x16x32_bf16 v[104:107], a[136:139], v[232:235], v[104:107]
  s_add_u32 s76, s3, 1
  s_and_b32 s76, s76, 3
  s_mul_i32 s76, s76, 12288
  s_add_u32 s76, s76, 114688
  v_add_u32 v4, s76, v1
  v_mfma_f32_16x16x32_bf16 v[108:111], a[136:139], v[236:239], v[108:111]
  v_mfma_f32_16x16x32_bf16 v[112:115], a[140:143], v[224:227], v[112:115]
  s_add_u32 s76, s3, 2
  s_and_b32 s76, s76, 3
  s_mul_i32 s76, s76, 12288
  s_add_u32 s76, s76, 114688
  v_add_u32 v5, s76, v1
  v_mfma_f32_16x16x32_bf16 v[116:119], a[140:143], v[228:231], v[116:119]
  v_mfma_f32_16x16x32_bf16 v[120:123], a[140:143], v[232:235], v[120:123]
  s_add_u32 s76, s3, 3
  s_and_b32 s76, s76, 3
  s_mul_i32 s76, s76, 12288
  s_add_u32 s76, s76, 114688
  v_add_u32 v7, s76, v1
  v_mfma_f32_16x16x32_bf16 v[124:127], a[140:143], v[236:239], v[124:127]
  s_waitcnt vmcnt(12) lgkmcnt(8)
  v_mfma_f32_16x16x32_bf16 v[64:67], a[144:147], v[128:131], v[64:67]
  buffer_load_dwordx4 v[192:195], v1, s[8:11], s16 offen offset:1024 sc1
  v_mfma_f32_16x16x32_bf16 v[68:71], a[144:147], v[132:135], v[68:71]
  v_mfma_f32_16x16x32_bf16 v[72:75], a[144:147], v[136:139], v[72:75]
  v_mfma_f32_16x16x32_bf16 v[76:79], a[144:147], v[140:143], v[76:79]
  v_mfma_f32_16x16x32_bf16 v[80:83], a[148:151], v[128:131], v[80:83]
  buffer_load_dwordx4 v[196:199], v1, s[8:11], s17 offen offset:1024 sc1
  v_mfma_f32_16x16x32_bf16 v[84:87], a[148:151], v[132:135], v[84:87]
  v_mfma_f32_16x16x32_bf16 v[88:91], a[148:151], v[136:139], v[88:91]
  v_mfma_f32_16x16x32_bf16 v[92:95], a[148:151], v[140:143], v[92:95]
  v_mfma_f32_16x16x32_bf16 v[96:99], a[152:155], v[128:131], v[96:99]
  buffer_load_dwordx4 v[200:203], v1, s[8:11], s18 offen offset:1024 sc1
  v_mfma_f32_16x16x32_bf16 v[100:103], a[152:155], v[132:135], v[100:103]
  v_mfma_f32_16x16x32_bf16 v[104:107], a[152:155], v[136:139], v[104:107]
  v_mfma_f32_16x16x32_bf16 v[108:111], a[152:155], v[140:143], v[108:111]
  v_mfma_f32_16x16x32_bf16 v[112:115], a[156:159], v[128:131], v[112:115]
  buffer_load_dwordx4 v[204:207], v1, s[8:11], s19 offen offset:1024 sc1
  v_mfma_f32_16x16x32_bf16 v[116:119], a[156:159], v[132:135], v[116:119]
  v_mfma_f32_16x16x32_bf16 v[120:123], a[156:159], v[136:139], v[120:123]
  v_mfma_f32_16x16x32_bf16 v[124:127], a[156:159], v[140:143], v[124:127]
  s_waitcnt vmcnt(12) lgkmcnt(4)
  v_mfma_f32_16x16x32_bf16 v[64:67], a[160:163], v[144:147], v[64:67]
  buffer_load_dwordx4 v[208:211], v1, s[8:11], s16 offen offset:2048 sc1
  v_mfma_f32_16x16x32_bf16 v[68:71], a[160:163], v[148:151], v[68:71]
  v_mfma_f32_16x16x32_bf16 v[72:75], a[160:163], v[152:155], v[72:75]
  v_mfma_f32_16x16x32_bf16 v[76:79], a[160:163], v[156:159], v[76:79]
  v_mfma_f32_16x16x32_bf16 v[80:83], a[164:167], v[144:147], v[80:83]
  buffer_load_dwordx4 v[212:215], v1, s[8:11], s17 offen offset:2048 sc1
  v_mfma_f32_16x16x32_bf16 v[84:87], a[164:167], v[148:151], v[84:87]
  v_mfma_f32_16x16x32_bf16 v[88:91], a[164:167], v[152:155], v[88:91]
  v_mfma_f32_16x16x32_bf16 v[92:95], a[164:167], v[156:159], v[92:95]
  v_mfma_f32_16x16x32_bf16 v[96:99], a[168:171], v[144:147], v[96:99]
  buffer_load_dwordx4 v[216:219], v1, s[8:11], s18 offen offset:2048 sc1
  v_mfma_f32_16x16x32_bf16 v[100:103], a[168:171], v[148:151], v[100:103]
  v_mfma_f32_16x16x32_bf16 v[104:107], a[168:171], v[152:155], v[104:107]
  v_mfma_f32_16x16x32_bf16 v[108:111], a[168:171], v[156:159], v[108:111]
  v_mfma_f32_16x16x32_bf16 v[112:115], a[172:175], v[144:147], v[112:115]
  buffer_load_dwordx4 v[220:223], v1, s[8:11], s19 offen offset:2048 sc1
  v_mfma_f32_16x16x32_bf16 v[116:119], a[172:175], v[148:151], v[116:119]
  v_mfma_f32_16x16x32_bf16 v[120:123], a[172:175], v[152:155], v[120:123]
  v_mfma_f32_16x16x32_bf16 v[124:127], a[172:175], v[156:159], v[124:127]
  s_waitcnt vmcnt(12) lgkmcnt(0)
  v_mfma_f32_16x16x32_bf16 v[64:67], a[176:179], v[160:163], v[64:67]
  buffer_load_dwordx4 v[224:227], v1, s[8:11], s16 offen offset:3072 sc1
  s_add_u32 s16, s16, 4096
  v_mfma_f32_16x16x32_bf16 v[68:71], a[176:179], v[164:167], v[68:71]
  v_mfma_f32_16x16x32_bf16 v[72:75], a[176:179], v[168:171], v[72:75]
  v_mfma_f32_16x16x32_bf16 v[76:79], a[176:179], v[172:175], v[76:79]
  v_mfma_f32_16x16x32_bf16 v[80:83], a[180:183], v[160:163], v[80:83]
  buffer_load_dwordx4 v[228:231], v1, s[8:11], s17 offen offset:3072 sc1
  s_add_u32 s17, s17, 4096
  v_mfma_f32_16x16x32_bf16 v[84:87], a[180:183], v[164:167], v[84:87]
  v_mfma_f32_16x16x32_bf16 v[88:91], a[180:183], v[168:171], v[88:91]
  v_mfma_f32_16x16x32_bf16 v[92:95], a[180:183], v[172:175], v[92:95]
  v_mfma_f32_16x16x32_bf16 v[96:99], a[184:187], v[160:163], v[96:99]
  buffer_load_dwordx4 v[232:235], v1, s[8:11], s18 offen offset:3072 sc1
  s_add_u32 s18, s18, 4096
  v_mfma_f32_16x16x32_bf16 v[100:103], a[184:187], v[164:167], v[100:103]
  v_mfma_f32_16x16x32_bf16 v[104:107], a[184:187], v[168:171], v[104:107]
  v_mfma_f32_16x16x32_bf16 v[108:111], a[184:187], v[172:175], v[108:111]
  v_mfma_f32_16x16x32_bf16 v[112:115], a[188:191], v[160:163], v[112:115]
  buffer_load_dwordx4 v[236:239], v1, s[8:11], s19 offen offset:3072 sc1
  s_add_u32 s19, s19, 4096
  v_mfma_f32_16x16x32_bf16 v[116:119], a[188:191], v[164:167], v[116:119]
  v_mfma_f32_16x16x32_bf16 v[120:123], a[188:191], v[168:171], v[120:123]
  v_mfma_f32_16x16x32_bf16 v[124:127], a[188:191], v[172:175], v[124:127]
  s_waitcnt vmcnt(12)
  v_mfma_f32_16x16x32_bf16 v[64:67], a[8:11], v[176:179], v[64:67]
  buffer_load_dwordx4 v[128:131], v1, s[8:11], s16 offen offset:0 sc1
  v_mfma_f32_16x16x32_bf16 v[68:71], a[8:11], v[180:183], v[68:71]
  v_mfma_f32_16x16x32_bf16 v[72:75], a[8:11], v[184:187], v[72:75]
  v_mfma_f32_16x16x32_bf16 v[76:79], a[8:11], v[188:191], v[76:79]
  v_mfma_f32_16x16x32_bf16 v[80:83], a[12:15], v[176:179], v[80:83]
  buffer_load_dwordx4 v[132:135], v1, s[8:11], s17 offen offset:0 sc1
  v_mfma_f32_16x16x32_bf16 v[84:87], a[12:15], v[180:183], v[84:87]
  v_mfma_f32_16x16x32_bf16 v[88:91], a[12:15], v[184:187], v[88:91]
  v_mfma_f32_16x16x32_bf16 v[92:95], a[12:15], v[188:191], v[92:95]
  v_mfma_f32_16x16x32_bf16 v[96:99], a[24:27], v[176:179], v[96:99]
  buffer_load_dwordx4 v[136:139], v1, s[8:11], s18 offen offset:0 sc1
  v_mfma_f32_16x16x32_bf16 v[100:103], a[24:27], v[180:183], v[100:103]
  v_mfma_f32_16x16x32_bf16 v[104:107], a[24:27], v[184:187], v[104:107]
  v_mfma_f32_16x16x32_bf16 v[108:111], a[24:27], v[188:191], v[108:111]
  v_mfma_f32_16x16x32_bf16 v[112:115], a[28:31], v[176:179], v[112:115]
  buffer_load_dwordx4 v[140:143], v1, s[8:11], s19 offen offset:0 sc1
  v_mfma_f32_16x16x32_bf16 v[116:119], a[28:31], v[180:183], v[116:119]
  v_mfma_f32_16x16x32_bf16 v[120:123], a[28:31], v[184:187], v[120:123]
  v_mfma_f32_16x16x32_bf16 v[124:127], a[28:31], v[188:191], v[124:127]
  s_waitcnt vmcnt(12)
  v_mfma_f32_16x16x32_bf16 v[64:67], a[40:43], v[192:195], v[64:67]
  buffer_load_dwordx4 v[144:147], v1, s[8:11], s16 offen offset:1024 sc1
  v_mfma_f32_16x16x32_bf16 v[68:71], a[40:43], v[196:199], v[68:71]
  v_mfma_f32_16x16x32_bf16 v[72:75], a[40:43], v[200:203], v[72:75]
  v_mfma_f32_16x16x32_bf16 v[76:79], a[40:43], v[204:207], v[76:79]
  v_mfma_f32_16x16x32_bf16 v[80:83], a[44:47], v[192:195], v[80:83]
  buffer_load_dwordx4 v[148:151], v1, s[8:11], s17 offen offset:1024 sc1
  v_mfma_f32_16x16x32_bf16 v[84:87], a[44:47], v[196:199], v[84:87]
  v_mfma_f32_16x16x32_bf16 v[88:91], a[44:47], v[200:203], v[88:91]
  v_mfma_f32_16x16x32_bf16 v[92:95], a[44:47], v[204:207], v[92:95]
  v_mfma_f32_16x16x32_bf16 v[96:99], a[56:59], v[192:195], v[96:99]
  buffer_load_dwordx4 v[152:155], v1, s[8:11], s18 offen offset:1024 sc1
  v_mfma_f32_16x16x32_bf16 v[100:103], a[56:59], v[196:199], v[100:103]
  v_mfma_f32_16x16x32_bf16 v[104:107], a[56:59], v[200:203], v[104:107]
  v_mfma_f32_16x16x32_bf16 v[108:111], a[56:59], v[204:207], v[108:111]
  v_mfma_f32_16x16x32_bf16 v[112:115], a[60:63], v[192:195], v[112:115]
  buffer_load_dwordx4 v[156:159], v1, s[8:11], s19 offen offset:1024 sc1
  v_mfma_f32_16x16x32_bf16 v[116:119], a[60:63], v[196:199], v[116:119]
  v_mfma_f32_16x16x32_bf16 v[120:123], a[60:63], v[200:203], v[120:123]
  v_mfma_f32_16x16x32_bf16 v[124:127], a[60:63], v[204:207], v[124:127]
  s_waitcnt vmcnt(12)
  v_mfma_f32_16x16x32_bf16 v[64:67], a[72:75], v[208:211], v[64:67]
  buffer_load_dwordx4 v[160:163], v1, s[8:11], s16 offen offset:2048 sc1
  v_mfma_f32_16x16x32_bf16 v[68:71], a[72:75], v[212:215], v[68:71]
  v_mfma_f32_16x16x32_bf16 v[72:75], a[72:75], v[216:219], v[72:75]
  v_mfma_f32_16x16x32_bf16 v[76:79], a[72:75], v[220:223], v[76:79]
  v_mfma_f32_16x16x32_bf16 v[80:83], a[76:79], v[208:211], v[80:83]
  buffer_load_dwordx4 v[164:167], v1, s[8:11], s17 offen offset:2048 sc1
  v_mfma_f32_16x16x32_bf16 v[84:87], a[76:79], v[212:215], v[84:87]
  v_mfma_f32_16x16x32_bf16 v[88:91], a[76:79], v[216:219], v[88:91]
  v_mfma_f32_16x16x32_bf16 v[92:95], a[76:79], v[220:223], v[92:95]
  v_mfma_f32_16x16x32_bf16 v[96:99], a[88:91], v[208:211], v[96:99]
  buffer_load_dwordx4 v[168:171], v1, s[8:11], s18 offen offset:2048 sc1
  v_mfma_f32_16x16x32_bf16 v[100:103], a[88:91], v[212:215], v[100:103]
  v_mfma_f32_16x16x32_bf16 v[104:107], a[88:91], v[216:219], v[104:107]
  v_mfma_f32_16x16x32_bf16 v[108:111], a[88:91], v[220:223], v[108:111]
  v_mfma_f32_16x16x32_bf16 v[112:115], a[92:95], v[208:211], v[112:115]
  buffer_load_dwordx4 v[172:175], v1, s[8:11], s19 offen offset:2048 sc1
  v_mfma_f32_16x16x32_bf16 v[116:119], a[92:95], v[212:215], v[116:119]
  v_mfma_f32_16x16x32_bf16 v[120:123], a[92:95], v[216:219], v[120:123]
  v_mfma_f32_16x16x32_bf16 v[124:127], a[92:95], v[220:223], v[124:127]
  s_waitcnt vmcnt(12)
  v_mfma_f32_16x16x32_bf16 v[64:67], a[104:107], v[224:227], v[64:67]
  buffer_load_dwordx4 v[176:179], v1, s[8:11], s16 offen offset:3072 sc1
  s_add_u32 s16, s16, 4096
  v_mfma_f32_16x16x32_bf16 v[68:71], a[104:107], v[228:231], v[68:71]
  v_mfma_f32_16x16x32_bf16 v[72:75], a[104:107], v[232:235], v[72:75]
  v_mfma_f32_16x16x32_bf16 v[76:79], a[104:107], v[236:239], v[76:79]
  v_mfma_f32_16x16x32_bf16 v[80:83], a[108:111], v[224:227], v[80:83]
  buffer_load_dwordx4 v[180:183], v1, s[8:11], s17 offen offset:3072 sc1
  s_add_u32 s17, s17, 4096
  v_mfma_f32_16x16x32_bf16 v[84:87], a[108:111], v[228:231], v[84:87]
  v_mfma_f32_16x16x32_bf16 v[88:91], a[108:111], v[232:235], v[88:91]
  v_mfma_f32_16x16x32_bf16 v[92:95], a[108:111], v[236:239], v[92:95]
  v_mfma_f32_16x16x32_bf16 v[96:99], a[120:123], v[224:227], v[96:99]
  buffer_load_dwordx4 v[184:187], v1, s[8:11], s18 offen offset:3072 sc1
  s_add_u32 s18, s18, 4096
  v_mfma_f32_16x16x32_bf16 v[100:103], a[120:123], v[228:231], v[100:103]
  v_mfma_f32_16x16x32_bf16 v[104:107], a[120:123], v[232:235], v[104:107]
  v_mfma_f32_16x16x32_bf16 v[108:111], a[120:123], v[236:239], v[108:111]
  v_mfma_f32_16x16x32_bf16 v[112:115], a[124:127], v[224:227], v[112:115]
  buffer_load_dwordx4 v[188:191], v1, s[8:11], s19 offen offset:3072 sc1
  s_add_u32 s19, s19, 4096
  v_mfma_f32_16x16x32_bf16 v[116:119], a[124:127], v[228:231], v[116:119]
  v_mfma_f32_16x16x32_bf16 v[120:123], a[124:127], v[232:235], v[120:123]
  v_mfma_f32_16x16x32_bf16 v[124:127], a[124:127], v[236:239], v[124:127]
  s_waitcnt vmcnt(12)
  v_mfma_f32_16x16x32_bf16 v[64:67], a[0:3], v[128:131], v[64:67]
  s_add_u32 m0, s90, 0
  s_add_u32 s84, s89, 0
  buffer_load_dwordx4 v1, s[8:11], s84 offen offset:0 sc1 lds
  v_mfma_f32_16x16x32_bf16 v[68:71], a[0:3], v[132:135], v[68:71]
  v_mfma_f32_16x16x32_bf16 v[72:75], a[0:3], v[136:139], v[72:75]
  v_mfma_f32_16x16x32_bf16 v[76:79], a[0:3], v[140:143], v[76:79]
  v_mfma_f32_16x16x32_bf16 v[80:83], a[4:7], v[128:131], v[80:83]
  buffer_load_dwordx4 v1, s[8:11], s84 offen offset:1024 sc1 lds
  v_mfma_f32_16x16x32_bf16 v[84:87], a[4:7], v[132:135], v[84:87]
  v_mfma_f32_16x16x32_bf16 v[88:91], a[4:7], v[136:139], v[88:91]
  v_mfma_f32_16x16x32_bf16 v[92:95], a[4:7], v[140:143], v[92:95]
  v_mfma_f32_16x16x32_bf16 v[96:99], a[16:19], v[128:131], v[96:99]
  buffer_load_dwordx4 v1, s[8:11], s84 offen offset:2048 sc1 lds
  v_mfma_f32_16x16x32_bf16 v[100:103], a[16:19], v[132:135], v[100:103]
  v_mfma_f32_16x16x32_bf16 v[104:107], a[16:19], v[136:139], v[104:107]
  v_mfma_f32_16x16x32_bf16 v[108:111], a[16:19], v[140:143], v[108:111]
  v_mfma_f32_16x16x32_bf16 v[112:115], a[20:23], v[128:131], v[112:115]
  buffer_load_dwordx4 v1, s[8:11], s84 offen offset:3072 sc1 lds
  v_mfma_f32_16x16x32_bf16 v[116:119], a[20:23], v[132:135], v[116:119]
  v_mfma_f32_16x16x32_bf16 v[120:123], a[20:23], v[136:139], v[120:123]
  v_mfma_f32_16x16x32_bf16 v[124:127], a[20:23], v[140:143], v[124:127]
  s_waitcnt vmcnt(12)
  v_mfma_f32_16x16x32_bf16 v[64:67], a[32:35], v[144:147], v[64:67]
  s_add_u32 m0, s90, 16384
  s_add_u32 s84, s89, 16384
  buffer_load_dwordx4 v1, s[8:11], s84 offen offset:0 sc1 lds
  v_mfma_f32_16x16x32_bf16 v[68:71], a[32:35], v[148:151], v[68:71]
  v_mfma_f32_16x16x32_bf16 v[72:75], a[32:35], v[152:155], v[72:75]
  v_mfma_f32_16x16x32_bf16 v[76:79], a[32:35], v[156:159], v[76:79]
  v_mfma_f32_16x16x32_bf16 v[80:83], a[36:39], v[144:147], v[80:83]
  buffer_load_dwordx4 v1, s[8:11], s84 offen offset:1024 sc1 lds
  v_mfma_f32_16x16x32_bf16 v[84:87], a[36:39], v[148:151], v[84:87]
  v_mfma_f32_16x16x32_bf16 v[88:91], a[36:39], v[152:155], v[88:91]
  v_mfma_f32_16x16x32_bf16 v[92:95], a[36:39], v[156:159], v[92:95]
  v_mfma_f32_16x16x32_bf16 v[96:99], a[48:51], v[144:147], v[96:99]
  buffer_load_dwordx4 v1, s[8:11], s84 offen offset:2048 sc1 lds
  v_mfma_f32_16x16x32_bf16 v[100:103], a[48:51], v[148:151], v[100:103]
  v_mfma_f32_16x16x32_bf16 v[104:107], a[48:51], v[152:155], v[104:107]
  v_mfma_f32_16x16x32_bf16 v[108:111], a[48:51], v[156:159], v[108:111]
  v_mfma_f32_16x16x32_bf16 v[112:115], a[52:55], v[144:147], v[112:115]
  buffer_load_dwordx4 v1, s[8:11], s84 offen offset:3072 sc1 lds
  v_mfma_f32_16x16x32_bf16 v[116:119], a[52:55], v[148:151], v[116:119]
  v_mfma_f32_16x16x32_bf16 v[120:123], a[52:55], v[152:155], v[120:123]
  v_mfma_f32_16x16x32_bf16 v[124:127], a[52:55], v[156:159], v[124:127]
  s_waitcnt vmcnt(12)
  v_mfma_f32_16x16x32_bf16 v[64:67], a[64:67], v[160:163], v[64:67]
  s_add_u32 m0, s90, 32768
  s_add_u32 s84, s89, 32768
  buffer_load_dwordx4 v1, s[8:11], s84 offen offset:0 sc1 lds
  v_mfma_f32_16x16x32_bf16 v[68:71], a[64:67], v[164:167], v[68:71]
  v_mfma_f32_16x16x32_bf16 v[72:75], a[64:67], v[168:171], v[72:75]
  v_mfma_f32_16x16x32_bf16 v[76:79], a[64:67], v[172:175], v[76:79]
  v_mfma_f32_16x16x32_bf16 v[80:83], a[68:71], v[160:163], v[80:83]
  buffer_load_dwordx4 v1, s[8:11], s84 offen offset:1024 sc1 lds
  v_mfma_f32_16x16x32_bf16 v[84:87], a[68:71], v[164:167], v[84:87]
  v_mfma_f32_16x16x32_bf16 v[88:91], a[68:71], v[168:171], v[88:91]
  v_mfma_f32_16x16x32_bf16 v[92:95], a[68:71], v[172:175], v[92:95]
  v_mfma_f32_16x16x32_bf16 v[96:99], a[80:83], v[160:163], v[96:99]
  buffer_load_dwordx4 v1, s[8:11], s84 offen offset:2048 sc1 lds
  v_mfma_f32_16x16x32_bf16 v[100:103], a[80:83], v[164:167], v[100:103]
  v_mfma_f32_16x16x32_bf16 v[104:107], a[80:83], v[168:171], v[104:107]
  v_mfma_f32_16x16x32_bf16 v[108:111], a[80:83], v[172:175], v[108:111]
  v_mfma_f32_16x16x32_bf16 v[112:115], a[84:87], v[160:163], v[112:115]
  buffer_load_dwordx4 v1, s[8:11], s84 offen offset:3072 sc1 lds
  v_mfma_f32_16x16x32_bf16 v[116:119], a[84:87], v[164:167], v[116:119]
  v_mfma_f32_16x16x32_bf16 v[120:123], a[84:87], v[168:171], v[120:123]
  v_mfma_f32_16x16x32_bf16 v[124:127], a[84:87], v[172:175], v[124:127]
  s_waitcnt vmcnt(12)
  v_mfma_f32_16x16x32_bf16 v[64:67], a[96:99], v[176:179], v[64:67]
  s_add_u32 m0, s90, 49152
  s_add_u32 s84, s89, 49152
  buffer_load_dwordx4 v1, s[8:11], s84 offen offset:0 sc1 lds
  v_mfma_f32_16x16x32_bf16 v[68:71], a[96:99], v[180:183], v[68:71]
  v_mfma_f32_16x16x32_bf16 v[72:75], a[96:99], v[184:187], v[72:75]
  v_mfma_f32_16x16x32_bf16 v[76:79], a[96:99], v[188:191], v[76:79]
  v_mfma_f32_16x16x32_bf16 v[80:83], a[100:103], v[176:179], v[80:83]
  buffer_load_dwordx4 v1, s[8:11], s84 offen offset:1024 sc1 lds
  v_mfma_f32_16x16x32_bf16 v[84:87], a[100:103], v[180:183], v[84:87]
  v_mfma_f32_16x16x32_bf16 v[88:91], a[100:103], v[184:187], v[88:91]
  v_mfma_f32_16x16x32_bf16 v[92:95], a[100:103], v[188:191], v[92:95]
  v_mfma_f32_16x16x32_bf16 v[96:99], a[112:115], v[176:179], v[96:99]
  buffer_load_dwordx4 v1, s[8:11], s84 offen offset:2048 sc1 lds
  v_mfma_f32_16x16x32_bf16 v[100:103], a[112:115], v[180:183], v[100:103]
  v_mfma_f32_16x16x32_bf16 v[104:107], a[112:115], v[184:187], v[104:107]
  v_mfma_f32_16x16x32_bf16 v[108:111], a[112:115], v[188:191], v[108:111]
  v_mfma_f32_16x16x32_bf16 v[112:115], a[116:119], v[176:179], v[112:115]
  buffer_load_dwordx4 v1, s[8:11], s84 offen offset:3072 sc1 lds
  v_mfma_f32_16x16x32_bf16 v[116:119], a[116:119], v[180:183], v[116:119]
  v_mfma_f32_16x16x32_bf16 v[120:123], a[116:119], v[184:187], v[120:123]
  v_mfma_f32_16x16x32_bf16 v[124:127], a[116:119], v[188:191], v[124:127]
  ds_write_b128 v4, v[68:71] offset:0
  ds_write_b128 v4, v[84:87] offset:1024
  s_add_u32 m0, s90, 65536
  s_add_u32 s84, s89, 65536
  buffer_load_dwordx4 v1, s[8:11], s84 offen offset:0 sc1 lds
  ds_write_b128 v4, v[100:103] offset:2048
  ds_write_b128 v4, v[116:119] offset:3072
  ds_write_b128 v5, v[72:75] offset:4096
  ds_write_b128 v5, v[88:91] offset:5120
  ds_write_b128 v5, v[104:107] offset:6144
  ds_write_b128 v5, v[120:123] offset:7168
  buffer_load_dwordx4 v1, s[8:11], s84 offen offset:1024 sc1 lds
  ds_write_b128 v7, v[76:79] offset:8192
  ds_write_b128 v7, v[92:95] offset:9216
  ds_write_b128 v7, v[108:111] offset:10240
  ds_write_b128 v7, v[124:127] offset:11264
  s_waitcnt lgkmcnt(0)
  s_barrier
  ds_read_b128 v[68:71], v6 offset:0
  buffer_load_dwordx4 v1, s[8:11], s84 offen offset:2048 sc1 lds
  ds_read_b128 v[72:75], v6 offset:4096
  ds_read_b128 v[76:79], v6 offset:8192
  ds_read_b128 v[84:87], v6 offset:1024
  ds_read_b128 v[88:91], v6 offset:5120
  ds_read_b128 v[92:95], v6 offset:9216
  ds_read_b128 v[100:103], v6 offset:2048
  ds_read_b128 v[104:107], v6 offset:6144
  buffer_load_dwordx4 v1, s[8:11], s84 offen offset:3072 sc1 lds
  ds_read_b128 v[108:111], v6 offset:10240
  ds_read_b128 v[116:119], v6 offset:3072
  ds_read_b128 v[120:123], v6 offset:7168
  ds_read_b128 v[124:127], v6 offset:11264
  v_lshlrev_b32 v128, 16, v56
  v_and_b32 v129, 0xffff0000, v56
  v_lshlrev_b32 v130, 16, v57
  s_add_u32 m0, s90, 81920
  s_add_u32 s84, s89, 81920
  buffer_load_dwordx4 v1, s[8:11], s84 offen offset:0 sc1 lds
  v_and_b32 v131, 0xffff0000, v57
  v_lshlrev_b32 v132, 16, v58
  v_and_b32 v133, 0xffff0000, v58
  v_lshlrev_b32 v134, 16, v59
  v_and_b32 v135, 0xffff0000, v59
  v_lshlrev_b32 v136, 16, v60
  v_and_b32 v137, 0xffff0000, v60
  buffer_load_dwordx4 v1, s[8:11], s84 offen offset:1024 sc1 lds
  v_lshlrev_b32 v138, 16, v61
  v_and_b32 v139, 0xffff0000, v61
  v_lshlrev_b32 v140, 16, v62
  v_and_b32 v141, 0xffff0000, v62
  v_lshlrev_b32 v142, 16, v63
  v_and_b32 v143, 0xffff0000, v63
  s_lshl_b32 s76, s81, 14
  buffer_load_dwordx4 v1, s[8:11], s84 offen offset:2048 sc1 lds
  s_lshl_b32 s77, s80, 11
  s_add_u32 s76, s76, s77
  s_add_u32 s83, s76, 35651584
  s_waitcnt lgkmcnt(9)
  v_pk_add_f32 v[64:65], v[64:65], v[68:69]
  v_pk_add_f32 v[72:73], v[72:73], v[76:77]
  buffer_load_dwordx4 v1, s[8:11], s84 offen offset:3072 sc1 lds
  v_pk_add_f32 v[66:67], v[66:67], v[70:71]
  v_pk_add_f32 v[74:75], v[74:75], v[78:79]
  v_pk_add_f32 v[64:65], v[64:65], v[72:73]
  v_pk_add_f32 v[66:67], v[66:67], v[74:75]
  v_pk_fma_f32 v[128:129], v[64:65], v[8:9], v[128:129]
  v_pk_fma_f32 v[130:131], v[66:67], v[10:11], v[130:131]
  v_cvt_pk_bf16_f32 v56, v128, v129
  s_add_u32 m0, s90, 98304
  s_add_u32 s84, s89, 98304
  buffer_load_dwordx4 v1, s[8:11], s84 offen offset:0 sc1 lds
  v_lshlrev_b32 v128, 16, v56
  v_and_b32 v129, 0xffff0000, v56
  v_cvt_pk_bf16_f32 v57, v130, v131
  v_lshlrev_b32 v130, 16, v57
  v_and_b32 v131, 0xffff0000, v57
  v_pk_mul_f32 v[144:145], v[128:129], v[24:25]
  v_pk_mul_f32 v[146:147], v[130:131], v[26:27]
  buffer_load_dwordx4 v1, s[8:11], s84 offen offset:1024 sc1 lds
  v_cvt_pk_bf16_f32 v160, v144, v145
  v_cvt_pk_bf16_f32 v161, v146, v147
  s_waitcnt lgkmcnt(6)
  v_pk_add_f32 v[80:81], v[80:81], v[84:85]
  v_pk_add_f32 v[88:89], v[88:89], v[92:93]
  v_pk_add_f32 v[82:83], v[82:83], v[86:87]
  v_pk_add_f32 v[90:91], v[90:91], v[94:95]
  buffer_load_dwordx4 v1, s[8:11], s84 offen offset:2048 sc1 lds
  v_pk_add_f32 v[80:81], v[80:81], v[88:89]
  v_pk_add_f32 v[82:83], v[82:83], v[90:91]
  v_pk_fma_f32 v[132:133], v[80:81], v[12:13], v[132:133]
  v_pk_fma_f32 v[134:135], v[82:83], v[14:15], v[134:135]
  v_cvt_pk_bf16_f32 v58, v132, v133
  v_lshlrev_b32 v132, 16, v58
  v_and_b32 v133, 0xffff0000, v58
  buffer_load_dwordx4 v1, s[8:11], s84 offen offset:3072 sc1 lds
  v_cvt_pk_bf16_f32 v59, v134, v135
  v_lshlrev_b32 v134, 16, v59
  v_and_b32 v135, 0xffff0000, v59
  v_pk_mul_f32 v[148:149], v[132:133], v[28:29]
  v_pk_mul_f32 v[150:151], v[134:135], v[30:31]
  v_cvt_pk_bf16_f32 v162, v148, v149
  v_cvt_pk_bf16_f32 v163, v150, v151
  buffer_store_dwordx4 v[160:163], v1, s[8:11], s83 offen offset:0 sc1
  s_waitcnt lgkmcnt(3)
  v_pk_add_f32 v[96:97], v[96:97], v[100:101]
  v_pk_add_f32 v[104:105], v[104:105], v[108:109]
  v_pk_add_f32 v[98:99], v[98:99], v[102:103]
  v_pk_add_f32 v[106:107], v[106:107], v[110:111]
  v_pk_add_f32 v[96:97], v[96:97], v[104:105]
  v_pk_add_f32 v[98:99], v[98:99], v[106:107]
  v_pk_fma_f32 v[136:137], v[96:97], v[16:17], v[136:137]
  v_pk_fma_f32 v[138:139], v[98:99], v[18:19], v[138:139]
  v_cvt_pk_bf16_f32 v60, v136, v137
  v_lshlrev_b32 v136, 16, v60
  v_and_b32 v137, 0xffff0000, v60
  v_cvt_pk_bf16_f32 v61, v138, v139
  v_lshlrev_b32 v138, 16, v61
  v_and_b32 v139, 0xffff0000, v61
  v_pk_mul_f32 v[152:153], v[136:137], v[32:33]
  v_pk_mul_f32 v[154:155], v[138:139], v[34:35]
  v_cvt_pk_bf16_f32 v164, v152, v153
  v_cvt_pk_bf16_f32 v165, v154, v155
  s_waitcnt lgkmcnt(0)
  v_pk_add_f32 v[112:113], v[112:113], v[116:117]
  v_pk_add_f32 v[120:121], v[120:121], v[124:125]
  v_pk_add_f32 v[114:115], v[114:115], v[118:119]
  v_pk_add_f32 v[122:123], v[122:123], v[126:127]
  v_pk_add_f32 v[112:113], v[112:113], v[120:121]
  v_pk_add_f32 v[114:115], v[114:115], v[122:123]
  v_pk_fma_f32 v[140:141], v[112:113], v[20:21], v[140:141]
  v_pk_fma_f32 v[142:143], v[114:115], v[22:23], v[142:143]
  v_cvt_pk_bf16_f32 v62, v140, v141
  v_lshlrev_b32 v140, 16, v62
  v_and_b32 v141, 0xffff0000, v62
  v_cvt_pk_bf16_f32 v63, v142, v143
  v_lshlrev_b32 v142, 16, v63
  v_and_b32 v143, 0xffff0000, v63
  v_pk_mul_f32 v[156:157], v[140:141], v[36:37]
  v_pk_mul_f32 v[158:159], v[142:143], v[38:39]
  v_cvt_pk_bf16_f32 v166, v156, v157
  v_cvt_pk_bf16_f32 v167, v158, v159
  buffer_store_dwordx4 v[164:167], v1, s[8:11], s83 offen offset:1024 sc1
  v_pk_add_f32 v[168:169], v[128:129], v[130:131]
  v_pk_mul_f32 v[170:171], v[128:129], v[128:129]
  v_pk_add_f32 v[172:173], v[144:145], v[146:147]
  v_pk_mul_f32 v[174:175], v[144:145], v[144:145]
  v_pk_mul_f32 v[176:177], v[24:25], v[144:145]
  v_pk_mul_f32 v[178:179], v[40:41], v[144:145]
  v_pk_fma_f32 v[170:171], v[130:131], v[130:131], v[170:171]
  v_pk_fma_f32 v[174:175], v[146:147], v[146:147], v[174:175]
  v_pk_fma_f32 v[176:177], v[26:27], v[146:147], v[176:177]
  v_pk_fma_f32 v[178:179], v[42:43], v[146:147], v[178:179]
  v_pk_add_f32 v[168:169], v[168:169], v[132:133]
  v_pk_add_f32 v[172:173], v[172:173], v[148:149]
  v_pk_fma_f32 v[170:171], v[132:133], v[132:133], v[170:171]
  v_pk_fma_f32 v[174:175], v[148:149], v[148:149], v[174:175]
  v_pk_fma_f32 v[176:177], v[28:29], v[148:149], v[176:177]
  v_pk_fma_f32 v[178:179], v[44:45], v[148:149], v[178:179]
  v_pk_add_f32 v[168:169], v[168:169], v[134:135]
  v_pk_add_f32 v[172:173], v[172:173], v[150:151]
  v_pk_fma_f32 v[170:171], v[134:135], v[134:135], v[170:171]
  v_pk_fma_f32 v[174:175], v[150:151], v[150:151], v[174:175]
  v_pk_fma_f32 v[176:177], v[30:31], v[150:151], v[176:177]
  v_pk_fma_f32 v[178:179], v[46:47], v[150:151], v[178:179]
  v_pk_add_f32 v[168:169], v[168:169], v[136:137]
  v_pk_add_f32 v[172:173], v[172:173], v[152:153]
  v_pk_fma_f32 v[170:171], v[136:137], v[136:137], v[170:171]
  v_pk_fma_f32 v[174:175], v[152:153], v[152:153], v[174:175]
  v_pk_fma_f32 v[176:177], v[32:33], v[152:153], v[176:177]
  v_pk_fma_f32 v[178:179], v[48:49], v[152:153], v[178:179]
  v_pk_add_f32 v[168:169], v[168:169], v[138:139]
  v_pk_add_f32 v[172:173], v[172:173], v[154:155]
  v_pk_fma_f32 v[170:171], v[138:139], v[138:139], v[170:171]
  v_pk_fma_f32 v[174:175], v[154:155], v[154:155], v[174:175]
  v_pk_fma_f32 v[176:177], v[34:35], v[154:155], v[176:177]
  v_pk_fma_f32 v[178:179], v[50:51], v[154:155], v[178:179]
  v_pk_add_f32 v[168:169], v[168:169], v[140:141]
  v_pk_add_f32 v[172:173], v[172:173], v[156:157]
  v_pk_fma_f32 v[170:171], v[140:141], v[140:141], v[170:171]
  v_pk_fma_f32 v[174:175], v[156:157], v[156:157], v[174:175]
  v_pk_fma_f32 v[176:177], v[36:37], v[156:157], v[176:177]
  v_pk_fma_f32 v[178:179], v[52:53], v[156:157], v[178:179]
  v_pk_add_f32 v[168:169], v[168:169], v[142:143]
  v_pk_add_f32 v[172:173], v[172:173], v[158:159]
  v_pk_fma_f32 v[170:171], v[142:143], v[142:143], v[170:171]
  v_pk_fma_f32 v[174:175], v[158:159], v[158:159], v[174:175]
  v_pk_fma_f32 v[176:177], v[38:39], v[158:159], v[176:177]
  v_pk_fma_f32 v[178:179], v[54:55], v[158:159], v[178:179]
  v_add_f32 v168, v168, v169
  v_add_f32 v170, v170, v171
  v_add_f32 v172, v172, v173
  v_add_f32 v174, v174, v175
  v_add_f32 v176, v176, v177
  v_add_f32 v178, v178, v179
  v_permlane16_swap_b32 v168, v170
  v_permlane16_swap_b32 v172, v174
  v_permlane16_swap_b32 v176, v178
  v_add_f32 v168, v168, v170
  v_add_f32 v172, v172, v174
  v_add_f32 v176, v176, v178
  v_mov_b32 v178, v176
  v_permlane32_swap_b32 v168, v172
  s_nop 0
  v_permlane32_swap_b32 v176, v178
  v_add_f32 v168, v168, v172
  v_add_f32 v169, v176, v178
  s_lshl_b32 s76, s81, 12
  s_lshr_b32 s77, s80, 1
  s_lshl_b32 s77, s77, 10
  s_add_u32 s76, s76, s77
  s_and_b32 s77, s80, 1
  s_lshl_b32 s77, s77, 3
  s_add_u32 s76, s76, s77
  s_add_u32 s76, s76, 37748736
  buffer_store_dwordx2 v[168:169], v1, s[8:11], s76 offen sc1
  s_mul_i32 s82, s80, 229376
  s_mul_i32 s76, s3, 57344
  s_add_u32 s82, s82, s76
  s_add_u32 s82, s82, 44040192
  s_and_b32 s87, s86, 1
  s_lshl_b32 s88, s85, 2
  s_add_u32 s88, s88, s3
  v_lshrrev_b32 v14, 4, v0
  v_and_b32 v15, 15, v0
  s_lshl_b32 s76, s87, 10
  v_add_u32 v8, s76, v1
  s_cmp_eq_u32 s87, 0
  s_cselect_b32 s76, 6144, 0
  v_add_u32 v9, s76, v1
  s_lshl_b32 s76, s3, 11
  v_add_u32 v10, s76, v1
  v_min_u32 v11, 2, v15
  v_lshlrev_b32 v11, 10, v11
  v_lshl_add_u32 v11, v14, 3, v11
  v_add_u32 v11, 114688, v11
  s_lshl_b32 s40, s88, 15
  s_add_u32 s40, s40, 35651584
  s_add_u32 s41, s40, 16384
  s_lshl_b32 s42, s88, 13
  s_add_u32 s42, s42, 37748736
  s_add_u32 s43, s42, 4096
  s_mov_b32 s12, s94
  s_mov_b32 s13, s95
  s_mov_b32 s14, 0xe00
  s_mov_b32 s15, 0x20000
  v_lshlrev_b32 v6, 3, v14
  s_mul_i32 s76, s86, 224
  s_lshl_b32 s77, s87, 5
  s_add_u32 s77, s77, s76
  buffer_load_dwordx2 v[200:201], v6, s[12:15], s77 offen offset:0
  buffer_load_dwordx2 v[202:203], v6, s[12:15], s77 offen offset:32
  buffer_load_dwordx2 v[204:205], v6, s[12:15], s77 offen offset:64
  buffer_load_dwordx2 v[206:207], v6, s[12:15], s77 offen offset:96
  buffer_load_dwordx2 v[208:209], v6, s[12:15], s77 offen offset:128
  buffer_load_dwordx2 v[210:211], v6, s[12:15], s77 offen offset:160
  s_cmp_eq_u32 s87, 0
  s_cselect_b32 s77, 192, 0
  s_add_u32 s77, s77, s76
  buffer_load_dwordx2 v[212:213], v6, s[12:15], s77 offen
  s_and_b32 s83, s2, 7
  s_lshl_b32 s83, s83, 10
  s_add_u32 s83, s83, 39092224
  s_lshr_b32 s76, s2, 3
  s_lshl_b32 s76, s76, 5
  s_add_u32 s83, s83, s76
  s_cmp_eq_u32 s3, 0
  s_cselect_b32 s83, s83, 0x7ff00000
  v_min_u32 v4, 1, v0
  v_lshlrev_b32 v4, 27, v4
  v_mov_b32 v5, 1
  s_waitcnt vmcnt(7)
  s_barrier
  buffer_store_dword v5, v4, s[8:11], s83 offen sc1
  s_and_b32 s83, s2, 7
  s_lshl_b32 s83, s83, 10
  s_add_u32 s83, s83, 39092224
  s_cmp_eq_u32 s3, 0
  s_cselect_b32 s83, s83, 0x7ff00000
  v_and_b32 v4, 31, v0
  v_lshlrev_b32 v4, 5, v4
  buffer_load_dwordx4 a[192:195], v1, s[8:11], s82 offen offset:0 sc1
  buffer_load_dwordx4 a[196:199], v1, s[8:11], s82 offen offset:1024 sc1
  buffer_load_dwordx4 a[200:203], v1, s[8:11], s82 offen offset:2048 sc1
  buffer_load_dwordx4 a[204:207], v1, s[8:11], s82 offen offset:3072 sc1
  s_add_u32 s82, s82, 4096
  buffer_load_dwordx4 a[208:211], v1, s[8:11], s82 offen offset:0 sc1
  buffer_load_dwordx4 a[212:215], v1, s[8:11], s82 offen offset:1024 sc1
  buffer_load_dwordx4 a[216:219], v1, s[8:11], s82 offen offset:2048 sc1
  buffer_load_dwordx4 a[220:223], v1, s[8:11], s82 offen offset:3072 sc1
  s_add_u32 s82, s82, 4096
  v_add_u32 v6, 114688, v1
  ds_write_b128 v6, v[244:247] offset:0
  ds_write_b128 v6, v[248:251] offset:1024
  ds_write_b128 v6, v[252:255] offset:2048
  s_waitcnt lgkmcnt(0)
  s_barrier
  buffer_load_dword v5, v4, s[8:11], s83 offen sc1
  ds_read_b128 v[128:131], v10 offset:0
  ds_read_b128 v[132:135], v10 offset:1024
  ds_read_b64 v[136:137], v11 offset:0
  ds_read_b64 v[138:139], v11 offset:32
  ds_read_b128 v[140:143], v10 offset:7168
  ds_read_b128 v[144:147], v10 offset:8192
  ds_read_b64 v[148:149], v11 offset:64
  ds_read_b64 v[150:151], v11 offset:96
  s_waitcnt lgkmcnt(4)
  v_mfma_f32_16x16x32_bf16 v[120:123], v[128:131], v[136:139], 0
  v_mfma_f32_16x16x32_bf16 v[124:127], v[132:135], v[136:139], 0
  ds_read_b128 v[152:155], v10 offset:14336
  ds_read_b128 v[156:159], v10 offset:15360
  ds_read_b64 v[160:161], v11 offset:128
  ds_read_b64 v[162:163], v11 offset:160
  s_waitcnt lgkmcnt(4)
  v_mfma_f32_16x16x32_bf16 v[120:123], v[140:143], v[148:151], v[120:123]
  v_mfma_f32_16x16x32_bf16 v[124:127], v[144:147], v[148:151], v[124:127]
  ds_read_b128 v[128:131], v10 offset:21504
  ds_read_b128 v[132:135], v10 offset:22528
  ds_read_b64 v[136:137], v11 offset:192
  ds_read_b64 v[138:139], v11 offset:224
  buffer_load_dwordx4 a[224:227], v1, s[8:11], s82 offen offset:0 sc1
  s_waitcnt lgkmcnt(4)
  v_mfma_f32_16x16x32_bf16 v[120:123], v[152:155], v[160:163], v[120:123]
  v_mfma_f32_16x16x32_bf16 v[124:127], v[156:159], v[160:163], v[124:127]
  ds_read_b128 v[140:143], v10 offset:28672
  ds_read_b128 v[144:147], v10 offset:29696
  ds_read_b64 v[148:149], v11 offset:256
  ds_read_b64 v[150:151], v11 offset:288
  s_waitcnt lgkmcnt(4)
  v_mfma_f32_16x16x32_bf16 v[120:123], v[128:131], v[136:139], v[120:123]
  v_mfma_f32_16x16x32_bf16 v[124:127], v[132:135], v[136:139], v[124:127]
  ds_read_b128 v[152:155], v10 offset:35840
  ds_read_b128 v[156:159], v10 offset:36864
  ds_read_b64 v[160:161], v11 offset:320
  ds_read_b64 v[162:163], v11 offset:352
  buffer_load_dwordx4 a[228:231], v1, s[8:11], s82 offen offset:1024 sc1
  s_waitcnt lgkmcnt(4)
  v_mfma_f32_16x16x32_bf16 v[120:123], v[140:143], v[148:151], v[120:123]
  v_mfma_f32_16x16x32_bf16 v[124:127], v[144:147], v[148:151], v[124:127]
  ds_read_b128 v[128:131], v10 offset:43008
  ds_read_b128 v[132:135], v10 offset:44032
  ds_read_b64 v[136:137], v11 offset:384
  ds_read_b64 v[138:139], v11 offset:416
  s_waitcnt lgkmcnt(4)
  v_mfma_f32_16x16x32_bf16 v[120:123], v[152:155], v[160:163], v[120:123]
  v_mfma_f32_16x16x32_bf16 v[124:127], v[156:159], v[160:163], v[124:127]
  ds_read_b128 v[140:143], v10 offset:50176
  ds_read_b128 v[144:147], v10 offset:51200
  ds_read_b64 v[148:149], v11 offset:448
  ds_read_b64 v[150:151], v11 offset:480
  buffer_load_dwordx4 a[232:235], v1, s[8:11], s82 offen offset:2048 sc1
  s_waitcnt lgkmcnt(4)
  v_mfma_f32_16x16x32_bf16 v[120:123], v[128:131], v[136:139], v[120:123]
  v_mfma_f32_16x16x32_bf16 v[124:127], v[132:135], v[136:139], v[124:127]
  v_add_u32 v10, 57344, v10
  ds_read_b128 v[152:155], v10 offset:0
  ds_read_b128 v[156:159], v10 offset:1024
  ds_read_b64 v[160:161], v11 offset:512
  ds_read_b64 v[162:163], v11 offset:544
  s_waitcnt lgkmcnt(4)
  v_mfma_f32_16x16x32_bf16 v[120:123], v[140:143], v[148:151], v[120:123]
  v_mfma_f32_16x16x32_bf16 v[124:127], v[144:147], v[148:151], v[124:127]
  ds_read_b128 v[128:131], v10 offset:7168
  ds_read_b128 v[132:135], v10 offset:8192
  ds_read_b64 v[136:137], v11 offset:576
  ds_read_b64 v[138:139], v11 offset:608
  buffer_load_dwordx4 a[236:239], v1, s[8:11], s82 offen offset:3072 sc1
  s_add_u32 s82, s82, 4096
  s_waitcnt lgkmcnt(4)
  v_mfma_f32_16x16x32_bf16 v[120:123], v[152:155], v[160:163], v[120:123]
  v_mfma_f32_16x16x32_bf16 v[124:127], v[156:159], v[160:163], v[124:127]
  ds_read_b128 v[140:143], v10 offset:14336
  ds_read_b128 v[144:147], v10 offset:15360
  ds_read_b64 v[148:149], v11 offset:640
  ds_read_b64 v[150:151], v11 offset:672
  s_waitcnt lgkmcnt(4)
  v_mfma_f32_16x16x32_bf16 v[120:123], v[128:131], v[136:139], v[120:123]
  v_mfma_f32_16x16x32_bf16 v[124:127], v[132:135], v[136:139], v[124:127]
  ds_read_b128 v[152:155], v10 offset:21504
  ds_read_b128 v[156:159], v10 offset:22528
  ds_read_b64 v[160:161], v11 offset:704
  ds_read_b64 v[162:163], v11 offset:736
  buffer_load_dwordx4 a[240:243], v1, s[8:11], s82 offen offset:0 sc1
  s_waitcnt lgkmcnt(4)
  v_mfma_f32_16x16x32_bf16 v[120:123], v[140:143], v[148:151], v[120:123]
  v_mfma_f32_16x16x32_bf16 v[124:127], v[144:147], v[148:151], v[124:127]
  ds_read_b128 v[128:131], v10 offset:28672
  ds_read_b128 v[132:135], v10 offset:29696
  ds_read_b64 v[136:137], v11 offset:768
  ds_read_b64 v[138:139], v11 offset:800
  s_waitcnt lgkmcnt(4)
  v_mfma_f32_16x16x32_bf16 v[120:123], v[152:155], v[160:163], v[120:123]
  v_mfma_f32_16x16x32_bf16 v[124:127], v[156:159], v[160:163], v[124:127]
  ds_read_b128 v[140:143], v10 offset:35840
  ds_read_b128 v[144:147], v10 offset:36864
  ds_read_b64 v[148:149], v11 offset:832
  ds_read_b64 v[150:151], v11 offset:864
  buffer_load_dwordx4 a[244:247], v1, s[8:11], s82 offen offset:1024 sc1
  s_waitcnt lgkmcnt(4)
  v_mfma_f32_16x16x32_bf16 v[120:123], v[128:131], v[136:139], v[120:123]
  v_mfma_f32_16x16x32_bf16 v[124:127], v[132:135], v[136:139], v[124:127]
  ds_read_b128 v[152:155], v10 offset:43008
  ds_read_b128 v[156:159], v10 offset:44032
  ds_read_b64 v[160:161], v11 offset:896
  ds_read_b64 v[162:163], v11 offset:928
  s_waitcnt lgkmcnt(4)
  v_mfma_f32_16x16x32_bf16 v[120:123], v[140:143], v[148:151], v[120:123]
  v_mfma_f32_16x16x32_bf16 v[124:127], v[144:147], v[148:151], v[124:127]
  ds_read_b128 v[128:131], v10 offset:50176
  ds_read_b128 v[132:135], v10 offset:51200
  ds_read_b64 v[136:137], v11 offset:960
  ds_read_b64 v[138:139], v11 offset:992
  buffer_load_dwordx4 a[248:251], v1, s[8:11], s82 offen offset:2048 sc1
  s_waitcnt lgkmcnt(4)
  v_mfma_f32_16x16x32_bf16 v[120:123], v[152:155], v[160:163], v[120:123]
  v_mfma_f32_16x16x32_bf16 v[124:127], v[156:159], v[160:163], v[124:127]
  s_waitcnt lgkmcnt(0)
  v_mfma_f32_16x16x32_bf16 v[120:123], v[128:131], v[136:139], v[120:123]
  v_mfma_f32_16x16x32_bf16 v[124:127], v[132:135], v[136:139], v[124:127]
  buffer_load_dwordx4 a[252:255], v1, s[8:11], s82 offen offset:3072 sc1
  s_add_u32 s82, s82, 4096
  v_lshlrev_b32 v6, 9, v15
  v_lshl_add_u32 v6, v14, 4, v6
  s_lshl_b32 s76, s3, 7
  s_add_u32 s76, s76, 117760
  v_add_u32 v6, s76, v6
  v_lshlrev_b32 v13, 4, v14
  s_lshl_b32 s76, s87, 6
  s_add_u32 s76, s76, 117760
  v_add_u32 v12, s76, v13
  s_cmp_eq_u32 s87, 0
  s_cselect_b32 s76, 384, 0
  s_add_u32 s76, s76, 117760
  v_add_u32 v13, s76, v13
  ds_write_b128 v6, v[120:123] offset:0
  ds_write_b128 v6, v[124:127] offset:64
  v_lshlrev_b32 v7, 3, v0
  s_waitcnt lgkmcnt(0)
  s_waitcnt vmcnt(8)
  s_cmp_lg_u32 s3, 0
  s_cbranch_scc1 Lokf_7
  v_cmp_ne_u32 vcc, 1, v5
  s_nop 0
  s_and_b64 vcc, vcc, s[20:21]
  s_cbranch_scc0 Lokf_7
  s_mov_b32 s84, 0x80000
Lspf_7:
  s_sub_u32 s84, s84, 1
  s_cbranch_scc1 Lokf_7
  s_sleep 1
  buffer_load_dword v5, v4, s[8:11], s83 offen sc1
  s_waitcnt vmcnt(0)
  v_cmp_ne_u32 vcc, 1, v5
  s_nop 0
  s_and_b64 vcc, vcc, s[20:21]
  s_cbranch_scc1 Lspf_7
Lokf_7:
  s_barrier
  buffer_load_dwordx4 a[0:3], v1, s[8:11], s40 offen offset:0 sc1
  buffer_load_dwordx4 a[4:7], v1, s[8:11], s41 offen offset:0 sc1
  buffer_load_dwordx4 a[8:11], v1, s[8:11], s40 offen offset:1024 sc1
  buffer_load_dwordx4 a[12:15], v1, s[8:11], s41 offen offset:1024 sc1
  buffer_load_dwordx4 a[16:19], v1, s[8:11], s40 offen offset:2048 sc1
  buffer_load_dwordx4 a[20:23], v1, s[8:11], s41 offen offset:2048 sc1
  buffer_load_dwordx4 a[24:27], v1, s[8:11], s40 offen offset:3072 sc1
  s_add_u32 s40, s40, 4096
  buffer_load_dwordx4 a[28:31], v1, s[8:11], s41 offen offset:3072 sc1
  s_add_u32 s41, s41, 4096
  ds_read_b128 v[128:131], v8 offset:0
  ds_read_b128 v[132:135], v8 offset:1024
  ds_read_b128 v[136:139], v8 offset:2048
  ds_read_b128 v[140:143], v8 offset:3072
  s_waitcnt lgkmcnt(2)
  s_waitcnt vmcnt(6)
  v_mfma_f32_16x16x32_bf16 v[64:67], v[128:131], a[0:3], 0
  ds_read_b128 v[144:147], v8 offset:4096
  v_mfma_f32_16x16x32_bf16 v[68:71], v[128:131], a[4:7], 0
  buffer_load_dwordx4 a[32:35], v1, s[8:11], s40 offen offset:0 sc1
  v_mfma_f32_16x16x32_bf16 v[72:75], v[132:135], a[0:3], 0
  ds_read_b128 v[148:151], v8 offset:5120
  v_mfma_f32_16x16x32_bf16 v[76:79], v[132:135], a[4:7], 0
  buffer_load_dwordx4 a[36:39], v1, s[8:11], s41 offen offset:0 sc1
  s_waitcnt lgkmcnt(2)
  v_mfma_f32_16x16x32_bf16 v[80:83], v[136:139], a[0:3], 0
  ds_read_b128 v[152:155], v9 offset:0
  v_mfma_f32_16x16x32_bf16 v[84:87], v[136:139], a[4:7], 0
  v_mfma_f32_16x16x32_bf16 v[88:91], v[140:143], a[0:3], 0
  ds_read_b128 v[156:159], v8 offset:7168
  v_mfma_f32_16x16x32_bf16 v[92:95], v[140:143], a[4:7], 0
  buffer_load_dwordx4 a[40:43], v1, s[8:11], s40 offen offset:1024 sc1
  s_waitcnt lgkmcnt(2)
  v_mfma_f32_16x16x32_bf16 v[96:99], v[144:147], a[0:3], 0
  ds_read_b128 v[128:131], v8 offset:8192
  v_mfma_f32_16x16x32_bf16 v[100:103], v[144:147], a[4:7], 0
  buffer_load_dwordx4 a[44:47], v1, s[8:11], s41 offen offset:1024 sc1
  v_mfma_f32_16x16x32_bf16 v[104:107], v[148:151], a[0:3], 0
  ds_read_b128 v[132:135], v8 offset:9216
  v_mfma_f32_16x16x32_bf16 v[108:111], v[148:151], a[4:7], 0
  s_waitcnt lgkmcnt(2)
  v_mfma_f32_16x16x32_bf16 v[112:115], v[152:155], a[0:3], 0
  ds_read_b128 v[136:139], v8 offset:10240
  v_mfma_f32_16x16x32_bf16 v[116:119], v[152:155], a[4:7], 0
  buffer_load_dwordx4 a[48:51], v1, s[8:11], s40 offen offset:2048 sc1
  s_waitcnt vmcnt(9)
  v_mfma_f32_16x16x32_bf16 v[64:67], v[156:159], a[8:11], v[64:67]
  ds_read_b128 v[140:143], v8 offset:11264
  v_mfma_f32_16x16x32_bf16 v[68:71], v[156:159], a[12:15], v[68:71]
  buffer_load_dwordx4 a[52:55], v1, s[8:11], s41 offen offset:2048 sc1
  s_waitcnt lgkmcnt(2)
  v_mfma_f32_16x16x32_bf16 v[72:75], v[128:131], a[8:11], v[72:75]
  ds_read_b128 v[144:147], v8 offset:12288
  v_mfma_f32_16x16x32_bf16 v[76:79], v[128:131], a[12:15], v[76:79]
  v_mfma_f32_16x16x32_bf16 v[80:83], v[132:135], a[8:11], v[80:83]
  ds_read_b128 v[148:151], v9 offset:7168
  v_mfma_f32_16x16x32_bf16 v[84:87], v[132:135], a[12:15], v[84:87]
  buffer_load_dwordx4 a[56:59], v1, s[8:11], s40 offen offset:3072 sc1
  s_add_u32 s40, s40, 4096
  s_waitcnt lgkmcnt(2)
  v_mfma_f32_16x16x32_bf16 v[88:91], v[136:139], a[8:11], v[88:91]
  ds_read_b128 v[152:155], v8 offset:14336
  v_mfma_f32_16x16x32_bf16 v[92:95], v[136:139], a[12:15], v[92:95]
  buffer_load_dwordx4 a[60:63], v1, s[8:11], s41 offen offset:3072 sc1
  s_add_u32 s41, s41, 4096
  v_mfma_f32_16x16x32_bf16 v[96:99], v[140:143], a[8:11], v[96:99]
  ds_read_b128 v[156:159], v8 offset:15360
  v_mfma_f32_16x16x32_bf16 v[100:103], v[140:143], a[12:15], v[100:103]
  s_waitcnt lgkmcnt(2)
  v_mfma_f32_16x16x32_bf16 v[104:107], v[144:147], a[8:11], v[104:107]
  ds_read_b128 v[128:131], v8 offset:16384
  v_mfma_f32_16x16x32_bf16 v[108:111], v[144:147], a[12:15], v[108:111]
  buffer_load_dwordx4 v[160:163], v1, s[8:11], s42 offen offset:0 sc1
  v_mfma_f32_16x16x32_bf16 v[112:115], v[148:151], a[8:11], v[112:115]
  ds_read_b128 v[132:135], v8 offset:17408
  v_mfma_f32_16x16x32_bf16 v[116:119], v[148:151], a[12:15], v[116:119]
  buffer_load_dwordx4 v[164:167], v1, s[8:11], s42 offen offset:1024 sc1
  s_waitcnt lgkmcnt(2)
  s_waitcnt vmcnt(12)
  v_mfma_f32_16x16x32_bf16 v[64:67], v[152:155], a[16:19], v[64:67]
  ds_read_b128 v[136:139], v8 offset:18432
  v_mfma_f32_16x16x32_bf16 v[68:71], v[152:155], a[20:23], v[68:71]
  v_mfma_f32_16x16x32_bf16 v[72:75], v[156:159], a[16:19], v[72:75]
  ds_read_b128 v[140:143], v8 offset:19456
  v_mfma_f32_16x16x32_bf16 v[76:79], v[156:159], a[20:23], v[76:79]
  buffer_load_dwordx4 v[168:171], v1, s[8:11], s42 offen offset:2048 sc1
  s_waitcnt lgkmcnt(2)
  v_mfma_f32_16x16x32_bf16 v[80:83], v[128:131], a[16:19], v[80:83]
  ds_read_b128 v[144:147], v9 offset:14336
  v_mfma_f32_16x16x32_bf16 v[84:87], v[128:131], a[20:23], v[84:87]
  buffer_load_dwordx4 v[172:175], v1, s[8:11], s42 offen offset:3072 sc1
  v_mfma_f32_16x16x32_bf16 v[88:91], v[132:135], a[16:19], v[88:91]
  ds_read_b128 v[148:151], v8 offset:21504
  v_mfma_f32_16x16x32_bf16 v[92:95], v[132:135], a[20:23], v[92:95]
  s_waitcnt lgkmcnt(2)
  v_mfma_f32_16x16x32_bf16 v[96:99], v[136:139], a[16:19], v[96:99]
  ds_read_b128 v[152:155], v8 offset:22528
  v_mfma_f32_16x16x32_bf16 v[100:103], v[136:139], a[20:23], v[100:103]
  buffer_load_dwordx4 v[176:179], v1, s[8:11], s43 offen offset:0 sc1
  v_mfma_f32_16x16x32_bf16 v[104:107], v[140:143], a[16:19], v[104:107]
  ds_read_b128 v[156:159], v8 offset:23552
  v_mfma_f32_16x16x32_bf16 v[108:111], v[140:143], a[20:23], v[108:111]
  buffer_load_dwordx4 v[180:183], v1, s[8:11], s43 offen offset:1024 sc1
  s_waitcnt lgkmcnt(2)
  v_mfma_f32_16x16x32_bf16 v[112:115], v[144:147], a[16:19], v[112:115]
  ds_read_b128 v[128:131], v8 offset:24576
  v_mfma_f32_16x16x32_bf16 v[116:119], v[144:147], a[20:23], v[116:119]
  s_waitcnt vmcnt(14)
  v_mfma_f32_16x16x32_bf16 v[64:67], v[148:151], a[24:27], v[64:67]
  ds_read_b128 v[132:135], v8 offset:25600
  v_mfma_f32_16x16x32_bf16 v[68:71], v[148:151], a[28:31], v[68:71]
  buffer_load_dwordx4 v[184:187], v1, s[8:11], s43 offen offset:2048 sc1
  s_waitcnt lgkmcnt(2)
  v_mfma_f32_16x16x32_bf16 v[72:75], v[152:155], a[24:27], v[72:75]
  ds_read_b128 v[136:139], v8 offset:26624
  v_mfma_f32_16x16x32_bf16 v[76:79], v[152:155], a[28:31], v[76:79]
  buffer_load_dwordx4 v[188:191], v1, s[8:11], s43 offen offset:3072 sc1
  v_mfma_f32_16x16x32_bf16 v[80:83], v[156:159], a[24:27], v[80:83]
  ds_read_b128 v[140:143], v9 offset:21504
  v_mfma_f32_16x16x32_bf16 v[84:87], v[156:159], a[28:31], v[84:87]
  s_waitcnt lgkmcnt(2)
  v_mfma_f32_16x16x32_bf16 v[88:91], v[128:131], a[24:27], v[88:91]
  ds_read_b128 v[144:147], v8 offset:28672
  v_mfma_f32_16x16x32_bf16 v[92:95], v[128:131], a[28:31], v[92:95]
  buffer_load_dwordx4 a[64:67], v1, s[8:11], s40 offen offset:0 sc1
  v_mfma_f32_16x16x32_bf16 v[96:99], v[132:135], a[24:27], v[96:99]
  ds_read_b128 v[148:151], v8 offset:29696
  v_mfma_f32_16x16x32_bf16 v[100:103], v[132:135], a[28:31], v[100:103]
  buffer_load_dwordx4 a[68:71], v1, s[8:11], s41 offen offset:0 sc1
  s_waitcnt lgkmcnt(2)
  v_mfma_f32_16x16x32_bf16 v[104:107], v[136:139], a[24:27], v[104:107]
  ds_read_b128 v[152:155], v8 offset:30720
  v_mfma_f32_16x16x32_bf16 v[108:111], v[136:139], a[28:31], v[108:111]
  v_mfma_f32_16x16x32_bf16 v[112:115], v[140:143], a[24:27], v[112:115]
  ds_read_b128 v[156:159], v8 offset:31744
  v_mfma_f32_16x16x32_bf16 v[116:119], v[140:143], a[28:31], v[116:119]
  buffer_load_dwordx4 a[72:75], v1, s[8:11], s40 offen offset:1024 sc1
  s_waitcnt lgkmcnt(2)
  s_waitcnt vmcnt(17)
  v_mfma_f32_16x16x32_bf16 v[64:67], v[144:147], a[32:35], v[64:67]
  ds_read_b128 v[128:131], v8 offset:32768
  v_mfma_f32_16x16x32_bf16 v[68:71], v[144:147], a[36:39], v[68:71]
  buffer_load_dwordx4 a[76:79], v1, s[8:11], s41 offen offset:1024 sc1
  v_mfma_f32_16x16x32_bf16 v[72:75], v[148:151], a[32:35], v[72:75]
  ds_read_b128 v[132:135], v8 offset:33792
  v_mfma_f32_16x16x32_bf16 v[76:79], v[148:151], a[36:39], v[76:79]
  s_waitcnt lgkmcnt(2)
  v_mfma_f32_16x16x32_bf16 v[80:83], v[152:155], a[32:35], v[80:83]
  ds_read_b128 v[136:139], v9 offset:28672
  v_mfma_f32_16x16x32_bf16 v[84:87], v[152:155], a[36:39], v[84:87]
  buffer_load_dwordx4 a[80:83], v1, s[8:11], s40 offen offset:2048 sc1
  v_mfma_f32_16x16x32_bf16 v[88:91], v[156:159], a[32:35], v[88:91]
  ds_read_b128 v[140:143], v8 offset:35840
  v_mfma_f32_16x16x32_bf16 v[92:95], v[156:159], a[36:39], v[92:95]
  buffer_load_dwordx4 a[84:87], v1, s[8:11], s41 offen offset:2048 sc1
  s_waitcnt lgkmcnt(2)
  v_mfma_f32_16x16x32_bf16 v[96:99], v[128:131], a[32:35], v[96:99]
  ds_read_b128 v[144:147], v8 offset:36864
  v_mfma_f32_16x16x32_bf16 v[100:103], v[128:131], a[36:39], v[100:103]
  v_mfma_f32_16x16x32_bf16 v[104:107], v[132:135], a[32:35], v[104:107]
  ds_read_b128 v[148:151], v8 offset:37888
  v_mfma_f32_16x16x32_bf16 v[108:111], v[132:135], a[36:39], v[108:111]
  buffer_load_dwordx4 a[88:91], v1, s[8:11], s40 offen offset:3072 sc1
  s_add_u32 s40, s40, 4096
  s_waitcnt lgkmcnt(2)
  v_mfma_f32_16x16x32_bf16 v[112:115], v[136:139], a[32:35], v[112:115]
  ds_read_b128 v[152:155], v8 offset:38912
  v_mfma_f32_16x16x32_bf16 v[116:119], v[136:139], a[36:39], v[116:119]
  buffer_load_dwordx4 a[92:95], v1, s[8:11], s41 offen offset:3072 sc1
  s_add_u32 s41, s41, 4096
  s_waitcnt vmcnt(20)
  v_mfma_f32_16x16x32_bf16 v[64:67], v[140:143], a[40:43], v[64:67]
  ds_read_b128 v[156:159], v8 offset:39936
  v_mfma_f32_16x16x32_bf16 v[68:71], v[140:143], a[44:47], v[68:71]
  s_waitcnt lgkmcnt(2)
  v_mfma_f32_16x16x32_bf16 v[72:75], v[144:147], a[40:43], v[72:75]
  ds_read_b128 v[128:131], v8 offset:40960
  v_mfma_f32_16x16x32_bf16 v[76:79], v[144:147], a[44:47], v[76:79]
  buffer_load_dwordx4 a[96:99], v1, s[8:11], s40 offen offset:0 sc1
  v_mfma_f32_16x16x32_bf16 v[80:83], v[148:151], a[40:43], v[80:83]
  ds_read_b128 v[132:135], v9 offset:35840
  v_mfma_f32_16x16x32_bf16 v[84:87], v[148:151], a[44:47], v[84:87]
  buffer_load_dwordx4 a[100:103], v1, s[8:11], s41 offen offset:0 sc1
  s_waitcnt lgkmcnt(2)
  v_mfma_f32_16x16x32_bf16 v[88:91], v[152:155], a[40:43], v[88:91]
  ds_read_b128 v[136:139], v8 offset:43008
  v_mfma_f32_16x16x32_bf16 v[92:95], v[152:155], a[44:47], v[92:95]
  v_mfma_f32_16x16x32_bf16 v[96:99], v[156:159], a[40:43], v[96:99]
  ds_read_b128 v[140:143], v8 offset:44032
  v_mfma_f32_16x16x32_bf16 v[100:103], v[156:159], a[44:47], v[100:103]
  buffer_load_dwordx4 a[104:107], v1, s[8:11], s40 offen offset:1024 sc1
  s_waitcnt lgkmcnt(2)
  v_mfma_f32_16x16x32_bf16 v[104:107], v[128:131], a[40:43], v[104:107]
  ds_read_b128 v[144:147], v8 offset:45056
  v_mfma_f32_16x16x32_bf16 v[108:111], v[128:131], a[44:47], v[108:111]
  buffer_load_dwordx4 a[108:111], v1, s[8:11], s41 offen offset:1024 sc1
  v_mfma_f32_16x16x32_bf16 v[112:115], v[132:135], a[40:43], v[112:115]
  ds_read_b128 v[148:151], v8 offset:46080
  v_mfma_f32_16x16x32_bf16 v[116:119], v[132:135], a[44:47], v[116:119]
  s_waitcnt lgkmcnt(2)
  s_waitcnt vmcnt(22)
  v_mfma_f32_16x16x32_bf16 v[64:67], v[136:139], a[48:51], v[64:67]
  ds_read_b128 v[152:155], v8 offset:47104
  v_mfma_f32_16x16x32_bf16 v[68:71], v[136:139], a[52:55], v[68:71]
  buffer_load_dwordx4 a[112:115], v1, s[8:11], s40 offen offset:2048 sc1
  v_mfma_f32_16x16x32_bf16 v[72:75], v[140:143], a[48:51], v[72:75]
  ds_read_b128 v[156:159], v8 offset:48128
  v_mfma_f32_16x16x32_bf16 v[76:79], v[140:143], a[52:55], v[76:79]
  buffer_load_dwordx4 a[116:119], v1, s[8:11], s41 offen offset:2048 sc1
  s_waitcnt lgkmcnt(2)
  v_mfma_f32_16x16x32_bf16 v[80:83], v[144:147], a[48:51], v[80:83]
  ds_read_b128 v[128:131], v9 offset:43008
  v_mfma_f32_16x16x32_bf16 v[84:87], v[144:147], a[52:55], v[84:87]
  v_mfma_f32_16x16x32_bf16 v[88:91], v[148:151], a[48:51], v[88:91]
  ds_read_b128 v[132:135], v8 offset:50176
  v_mfma_f32_16x16x32_bf16 v[92:95], v[148:151], a[52:55], v[92:95]
  buffer_load_dwordx4 a[120:123], v1, s[8:11], s40 offen offset:3072 sc1
  s_add_u32 s40, s40, 4096
  s_waitcnt lgkmcnt(2)
  v_mfma_f32_16x16x32_bf16 v[96:99], v[152:155], a[48:51], v[96:99]
  ds_read_b128 v[136:139], v8 offset:51200
  v_mfma_f32_16x16x32_bf16 v[100:103], v[152:155], a[52:55], v[100:103]
  buffer_load_dwordx4 a[124:127], v1, s[8:11], s41 offen offset:3072 sc1
  s_add_u32 s41, s41, 4096
  v_mfma_f32_16x16x32_bf16 v[104:107], v[156:159], a[48:51], v[104:107]
  ds_read_b128 v[140:143], v8 offset:52224
  v_mfma_f32_16x16x32_bf16 v[108:111], v[156:159], a[52:55], v[108:111]
  s_waitcnt lgkmcnt(2)
  v_mfma_f32_16x16x32_bf16 v[112:115], v[128:131], a[48:51], v[112:115]
  ds_read_b128 v[144:147], v8 offset:53248
  v_mfma_f32_16x16x32_bf16 v[116:119], v[128:131], a[52:55], v[116:119]
  s_waitcnt vmcnt(24)
  v_mfma_f32_16x16x32_bf16 v[64:67], v[132:135], a[56:59], v[64:67]
  ds_read_b128 v[148:151], v8 offset:54272
  v_mfma_f32_16x16x32_bf16 v[68:71], v[132:135], a[60:63], v[68:71]
  s_waitcnt lgkmcnt(2)
  v_mfma_f32_16x16x32_bf16 v[72:75], v[136:139], a[56:59], v[72:75]
  ds_read_b128 v[152:155], v8 offset:55296
  s_waitcnt vmcnt(16)
  v_add_f32 v160, v160, v162
  v_mfma_f32_16x16x32_bf16 v[76:79], v[136:139], a[60:63], v[76:79]
  buffer_load_dwordx4 a[128:131], v1, s[8:11], s82 offen offset:0 sc1
  v_add_f32 v161, v161, v163
  v_mfma_f32_16x16x32_bf16 v[80:83], v[140:143], a[56:59], v[80:83]
  ds_read_b128 v[156:159], v9 offset:50176
  v_add_f32 v160, v160, v164
  v_mfma_f32_16x16x32_bf16 v[84:87], v[140:143], a[60:63], v[84:87]
  v_add_f32 v161, v161, v165
  v_add_f32 v160, v160, v166
  v_add_f32 v161, v161, v167
  v_add_f32 v160, v160, v168
  v_add_f32 v161, v161, v169
  v_add_f32 v160, v160, v170
  v_add_f32 v161, v161, v171
  v_add_u32 v8, 57344, v8
  s_waitcnt lgkmcnt(2)
  v_mfma_f32_16x16x32_bf16 v[88:91], v[144:147], a[56:59], v[88:91]
  ds_read_b128 v[128:131], v8 offset:0
  v_add_u32 v9, 57344, v9
  v_mfma_f32_16x16x32_bf16 v[92:95], v[144:147], a[60:63], v[92:95]
  v_add_f32 v160, v160, v172
  v_add_f32 v161, v161, v173
  v_mfma_f32_16x16x32_bf16 v[96:99], v[148:151], a[56:59], v[96:99]
  ds_read_b128 v[132:135], v8 offset:1024
  buffer_load_dwordx4 a[132:135], v1, s[8:11], s82 offen offset:1024 sc1
  v_mfma_f32_16x16x32_bf16 v[100:103], v[148:151], a[60:63], v[100:103]
  v_add_f32 v160, v160, v174
  s_waitcnt lgkmcnt(2)
  v_mfma_f32_16x16x32_bf16 v[104:107], v[152:155], a[56:59], v[104:107]
  ds_read_b128 v[136:139], v8 offset:2048
  v_add_f32 v161, v161, v175
  v_mfma_f32_16x16x32_bf16 v[108:111], v[152:155], a[60:63], v[108:111]
  v_mfma_f32_16x16x32_bf16 v[112:115], v[156:159], a[56:59], v[112:115]
  ds_read_b128 v[140:143], v8 offset:3072
  v_mov_b32 v162, v160
  v_mfma_f32_16x16x32_bf16 v[116:119], v[156:159], a[60:63], v[116:119]
  buffer_load_dwordx4 a[136:139], v1, s[8:11], s82 offen offset:2048 sc1
  s_waitcnt lgkmcnt(2)
  s_waitcnt vmcnt(17)
  v_mfma_f32_16x16x32_bf16 v[64:67], v[128:131], a[64:67], v[64:67]
  ds_read_b128 v[144:147], v8 offset:4096
  v_mov_b32 v165, v161
  v_mfma_f32_16x16x32_bf16 v[68:71], v[128:131], a[68:71], v[68:71]
  v_permlane16_swap_b32 v160, v162
  v_mfma_f32_16x16x32_bf16 v[72:75], v[132:135], a[64:67], v[72:75]
  ds_read_b128 v[148:151], v8 offset:5120
  v_permlane16_swap_b32 v161, v165
  v_mfma_f32_16x16x32_bf16 v[76:79], v[132:135], a[68:71], v[76:79]
  v_mov_b32 v163, v160
  s_waitcnt lgkmcnt(2)
  v_mfma_f32_16x16x32_bf16 v[80:83], v[136:139], a[64:67], v[80:83]
  ds_read_b128 v[152:155], v9 offset:0
  buffer_load_dwordx4 a[140:143], v1, s[8:11], s82 offen offset:3072 sc1
  s_add_u32 s82, s82, 4096
  v_mfma_f32_16x16x32_bf16 v[84:87], v[136:139], a[68:71], v[84:87]
  v_mov_b32 v164, v162
  v_mfma_f32_16x16x32_bf16 v[88:91], v[140:143], a[64:67], v[88:91]
  ds_read_b128 v[156:159], v8 offset:7168
  v_permlane32_swap_b32 v160, v163
  v_mfma_f32_16x16x32_bf16 v[92:95], v[140:143], a[68:71], v[92:95]
  s_waitcnt lgkmcnt(2)
  v_mfma_f32_16x16x32_bf16 v[96:99], v[144:147], a[64:67], v[96:99]
  ds_read_b128 v[128:131], v8 offset:8192
  v_permlane32_swap_b32 v162, v164
  v_mfma_f32_16x16x32_bf16 v[100:103], v[144:147], a[68:71], v[100:103]
  buffer_load_dwordx4 a[144:147], v1, s[8:11], s82 offen offset:0 sc1
  v_mul_f32 v166, 0x3b000000, v160
  v_mfma_f32_16x16x32_bf16 v[104:107], v[148:151], a[64:67], v[104:107]
  ds_read_b128 v[132:135], v8 offset:9216
  v_mfma_f32_16x16x32_bf16 v[108:111], v[148:151], a[68:71], v[108:111]
  v_mul_f32 v168, 0x3b000000, v162
  s_waitcnt lgkmcnt(2)
  v_mfma_f32_16x16x32_bf16 v[112:115], v[152:155], a[64:67], v[112:115]
  ds_read_b128 v[136:139], v8 offset:10240
  v_fma_f32 v168, -v166, v166, v168
  v_mfma_f32_16x16x32_bf16 v[116:119], v[152:155], a[68:71], v[116:119]
  v_add_f32 v168, 0x3727c5ac, v168
  s_waitcnt vmcnt(17)
  v_mfma_f32_16x16x32_bf16 v[64:67], v[156:159], a[72:75], v[64:67]
  ds_read_b128 v[140:143], v8 offset:11264
  buffer_load_dwordx4 a[148:151], v1, s[8:11], s82 offen offset:1024 sc1
  v_mfma_f32_16x16x32_bf16 v[68:71], v[156:159], a[76:79], v[68:71]
  s_waitcnt lgkmcnt(2)
  v_mfma_f32_16x16x32_bf16 v[72:75], v[128:131], a[72:75], v[72:75]
  ds_read_b128 v[144:147], v8 offset:12288
  v_mfma_f32_16x16x32_bf16 v[76:79], v[128:131], a[76:79], v[76:79]
  v_rsq_f32 v167, v168
  v_mfma_f32_16x16x32_bf16 v[80:83], v[132:135], a[72:75], v[80:83]
  ds_read_b128 v[148:151], v9 offset:7168
  v_fma_f32 v168, -v166, s24, v163
  v_mfma_f32_16x16x32_bf16 v[84:87], v[132:135], a[76:79], v[84:87]
  buffer_load_dwordx4 a[152:155], v1, s[8:11], s82 offen offset:2048 sc1
  s_waitcnt lgkmcnt(2)
  v_mfma_f32_16x16x32_bf16 v[88:91], v[136:139], a[72:75], v[88:91]
  ds_read_b128 v[152:155], v8 offset:14336
  v_mul_f32 v169, s25, v166
  v_mfma_f32_16x16x32_bf16 v[92:95], v[136:139], a[76:79], v[92:95]
  v_fma_f32 v169, -2.0, v161, v169
  v_fma_f32 v169, v169, v166, v164
  v_mfma_f32_16x16x32_bf16 v[96:99], v[140:143], a[72:75], v[96:99]
  ds_read_b128 v[156:159], v8 offset:15360
  v_fma_f32 v170, -v166, s26, v165
  v_mfma_f32_16x16x32_bf16 v[100:103], v[140:143], a[76:79], v[100:103]
  v_fma_f32 v168, v168, v167, s27
  s_waitcnt lgkmcnt(2)
  v_mfma_f32_16x16x32_bf16 v[104:107], v[144:147], a[72:75], v[104:107]
  ds_read_b128 v[128:131], v8 offset:16384
  buffer_load_dwordx4 a[156:159], v1, s[8:11], s82 offen offset:3072 sc1
  s_add_u32 s82, s82, 4096
  v_mfma_f32_16x16x32_bf16 v[108:111], v[144:147], a[76:79], v[108:111]
  v_mul_f32 v168, 0x3b000000, v168
  v_mfma_f32_16x16x32_bf16 v[112:115], v[148:151], a[72:75], v[112:115]
  ds_read_b128 v[132:135], v8 offset:17408
  v_mul_f32 v169, v169, v167
  v_mfma_f32_16x16x32_bf16 v[116:119], v[148:151], a[76:79], v[116:119]
  s_waitcnt lgkmcnt(2)
  s_waitcnt vmcnt(18)
  v_mfma_f32_16x16x32_bf16 v[64:67], v[152:155], a[80:83], v[64:67]
  ds_read_b128 v[136:139], v8 offset:18432
  v_fma_f32 v169, 2.0, v170, v169
  v_mfma_f32_16x16x32_bf16 v[68:71], v[152:155], a[84:87], v[68:71]
  buffer_load_dwordx4 a[160:163], v1, s[8:11], s82 offen offset:0 sc1
  v_fma_f32 v169, v169, v167, s28
  v_mfma_f32_16x16x32_bf16 v[72:75], v[156:159], a[80:83], v[72:75]
  ds_read_b128 v[140:143], v8 offset:19456
  v_mfma_f32_16x16x32_bf16 v[76:79], v[156:159], a[84:87], v[76:79]
  v_mul_f32 v169, 0x3b000000, v169
  s_waitcnt lgkmcnt(2)
  v_mfma_f32_16x16x32_bf16 v[80:83], v[128:131], a[80:83], v[80:83]
  ds_read_b128 v[144:147], v9 offset:14336
  v_fma_f32 v169, -v168, v168, v169
  v_mfma_f32_16x16x32_bf16 v[84:87], v[128:131], a[84:87], v[84:87]
  v_add_f32 v169, 0x3727c5ac, v169
  v_mfma_f32_16x16x32_bf16 v[88:91], v[132:135], a[80:83], v[88:91]
  ds_read_b128 v[148:151], v8 offset:21504
  buffer_load_dwordx4 a[164:167], v1, s[8:11], s82 offen offset:1024 sc1
  v_mfma_f32_16x16x32_bf16 v[92:95], v[132:135], a[84:87], v[92:95]
  s_waitcnt lgkmcnt(2)
  v_mfma_f32_16x16x32_bf16 v[96:99], v[136:139], a[80:83], v[96:99]
  ds_read_b128 v[152:155], v8 offset:22528
  v_mfma_f32_16x16x32_bf16 v[100:103], v[136:139], a[84:87], v[100:103]
  v_rsq_f32 v194, v169
  v_mfma_f32_16x16x32_bf16 v[104:107], v[140:143], a[80:83], v[104:107]
  ds_read_b128 v[156:159], v8 offset:23552
  v_mul_f32 v166, -1.0, v166
  v_mfma_f32_16x16x32_bf16 v[108:111], v[140:143], a[84:87], v[108:111]
  buffer_load_dwordx4 a[168:171], v1, s[8:11], s82 offen offset:2048 sc1
  s_waitcnt lgkmcnt(2)
  v_mfma_f32_16x16x32_bf16 v[112:115], v[144:147], a[80:83], v[112:115]
  ds_read_b128 v[128:131], v8 offset:24576
  v_mul_f32 v192, v167, v194
  v_mfma_f32_16x16x32_bf16 v[116:119], v[144:147], a[84:87], v[116:119]
  v_mul_f32 v195, v168, v194
  s_waitcnt vmcnt(19)
  v_mfma_f32_16x16x32_bf16 v[64:67], v[148:151], a[88:91], v[64:67]
  ds_read_b128 v[132:135], v8 offset:25600
  v_mul_f32 v193, v166, v192
  v_mfma_f32_16x16x32_bf16 v[68:71], v[148:151], a[92:95], v[68:71]
  v_mul_f32 v195, -1.0, v195
  s_waitcnt lgkmcnt(2)
  v_mfma_f32_16x16x32_bf16 v[72:75], v[152:155], a[88:91], v[72:75]
  ds_read_b128 v[136:139], v8 offset:26624
  buffer_load_dwordx4 a[172:175], v1, s[8:11], s82 offen offset:3072 sc1
  s_add_u32 s82, s82, 4096
  v_mfma_f32_16x16x32_bf16 v[76:79], v[152:155], a[92:95], v[76:79]
  v_add_f32 v176, v176, v178
  v_add_f32 v177, v177, v179
  v_mfma_f32_16x16x32_bf16 v[80:83], v[156:159], a[88:91], v[80:83]
  ds_read_b128 v[140:143], v9 offset:21504
  v_add_f32 v176, v176, v180
  v_mfma_f32_16x16x32_bf16 v[84:87], v[156:159], a[92:95], v[84:87]
  s_waitcnt lgkmcnt(2)
  v_mfma_f32_16x16x32_bf16 v[88:91], v[128:131], a[88:91], v[88:91]
  ds_read_b128 v[144:147], v8 offset:28672
  v_add_f32 v177, v177, v181
  v_mfma_f32_16x16x32_bf16 v[92:95], v[128:131], a[92:95], v[92:95]
  buffer_load_dwordx4 a[176:179], v1, s[8:11], s82 offen offset:0 sc1
  v_add_f32 v176, v176, v182
  v_mfma_f32_16x16x32_bf16 v[96:99], v[132:135], a[88:91], v[96:99]
  ds_read_b128 v[148:151], v8 offset:29696
  v_mfma_f32_16x16x32_bf16 v[100:103], v[132:135], a[92:95], v[100:103]
  v_add_f32 v177, v177, v183
  s_waitcnt lgkmcnt(2)
  v_mfma_f32_16x16x32_bf16 v[104:107], v[136:139], a[88:91], v[104:107]
  ds_read_b128 v[152:155], v8 offset:30720
  v_add_f32 v176, v176, v184
  v_mfma_f32_16x16x32_bf16 v[108:111], v[136:139], a[92:95], v[108:111]
  v_mfma_f32_16x16x32_bf16 v[112:115], v[140:143], a[88:91], v[112:115]
  ds_read_b128 v[156:159], v8 offset:31744
  buffer_load_dwordx4 a[180:183], v1, s[8:11], s82 offen offset:1024 sc1
  v_mfma_f32_16x16x32_bf16 v[116:119], v[140:143], a[92:95], v[116:119]
  s_waitcnt lgkmcnt(2)
  s_waitcnt vmcnt(20)
  v_mfma_f32_16x16x32_bf16 v[64:67], v[144:147], a[96:99], v[64:67]
  ds_read_b128 v[128:131], v8 offset:32768
  v_add_f32 v177, v177, v185
  v_mfma_f32_16x16x32_bf16 v[68:71], v[144:147], a[100:103], v[68:71]
  v_add_f32 v176, v176, v186
  v_add_f32 v177, v177, v187
  v_mfma_f32_16x16x32_bf16 v[72:75], v[148:151], a[96:99], v[72:75]
  ds_read_b128 v[132:135], v8 offset:33792
  v_add_f32 v176, v176, v188
  v_mfma_f32_16x16x32_bf16 v[76:79], v[148:151], a[100:103], v[76:79]
  buffer_load_dwordx4 a[184:187], v1, s[8:11], s82 offen offset:2048 sc1
  s_waitcnt lgkmcnt(2)
  v_mfma_f32_16x16x32_bf16 v[80:83], v[152:155], a[96:99], v[80:83]
  ds_read_b128 v[136:139], v9 offset:28672
  v_add_f32 v177, v177, v189
  v_mfma_f32_16x16x32_bf16 v[84:87], v[152:155], a[100:103], v[84:87]
  v_add_f32 v176, v176, v190
  v_mfma_f32_16x16x32_bf16 v[88:91], v[156:159], a[96:99], v[88:91]
  ds_read_b128 v[140:143], v8 offset:35840
  v_add_f32 v177, v177, v191
  v_mfma_f32_16x16x32_bf16 v[92:95], v[156:159], a[100:103], v[92:95]
  s_waitcnt lgkmcnt(2)
  v_mfma_f32_16x16x32_bf16 v[96:99], v[128:131], a[96:99], v[96:99]
  ds_read_b128 v[144:147], v8 offset:36864
  buffer_load_dwordx4 a[188:191], v1, s[8:11], s82 offen offset:3072 sc1
  s_add_u32 s82, s82, 4096
  v_mfma_f32_16x16x32_bf16 v[100:103], v[128:131], a[100:103], v[100:103]
  v_mov_b32 v178, v176
  v_mov_b32 v181, v177
  v_mfma_f32_16x16x32_bf16 v[104:107], v[132:135], a[96:99], v[104:107]
  ds_read_b128 v[148:151], v8 offset:37888
  v_permlane16_swap_b32 v176, v178
  v_mfma_f32_16x16x32_bf16 v[108:111], v[132:135], a[100:103], v[108:111]
  s_waitcnt lgkmcnt(2)
  v_mfma_f32_16x16x32_bf16 v[112:115], v[136:139], a[96:99], v[112:115]
  ds_read_b128 v[152:155], v8 offset:38912
  v_permlane16_swap_b32 v177, v181
  v_mfma_f32_16x16x32_bf16 v[116:119], v[136:139], a[100:103], v[116:119]
  v_mov_b32 v179, v176
  s_waitcnt vmcnt(20)
  v_mfma_f32_16x16x32_bf16 v[64:67], v[140:143], a[104:107], v[64:67]
  ds_read_b128 v[156:159], v8 offset:39936
  v_mfma_f32_16x16x32_bf16 v[68:71], v[140:143], a[108:111], v[68:71]
  v_mov_b32 v180, v178
  s_waitcnt lgkmcnt(2)
  v_mfma_f32_16x16x32_bf16 v[72:75], v[144:147], a[104:107], v[72:75]
  ds_read_b128 v[128:131], v8 offset:40960
  v_permlane32_swap_b32 v176, v179
  v_mfma_f32_16x16x32_bf16 v[76:79], v[144:147], a[108:111], v[76:79]
  v_mfma_f32_16x16x32_bf16 v[80:83], v[148:151], a[104:107], v[80:83]
  ds_read_b128 v[132:135], v9 offset:35840
  v_permlane32_swap_b32 v178, v180
  v_mfma_f32_16x16x32_bf16 v[84:87], v[148:151], a[108:111], v[84:87]
  v_mul_f32 v182, 0x3b000000, v176
  s_waitcnt lgkmcnt(2)
  v_mfma_f32_16x16x32_bf16 v[88:91], v[152:155], a[104:107], v[88:91]
  ds_read_b128 v[136:139], v8 offset:43008
  v_mfma_f32_16x16x32_bf16 v[92:95], v[152:155], a[108:111], v[92:95]
  s_mov_b32 s12, s96
  v_mul_f32 v184, 0x3b000000, v178
  v_mfma_f32_16x16x32_bf16 v[96:99], v[156:159], a[104:107], v[96:99]
  ds_read_b128 v[140:143], v8 offset:44032
  v_fma_f32 v184, -v182, v182, v184
  v_mfma_f32_16x16x32_bf16 v[100:103], v[156:159], a[108:111], v[100:103]
  s_mov_b32 s13, s97
  s_waitcnt lgkmcnt(2)
  v_mfma_f32_16x16x32_bf16 v[104:107], v[128:131], a[104:107], v[104:107]
  ds_read_b128 v[144:147], v8 offset:45056
  v_add_f32 v184, 0x3727c5ac, v184
  v_mfma_f32_16x16x32_bf16 v[108:111], v[128:131], a[108:111], v[108:111]
  s_mov_b32 s14, 0x400
  v_mfma_f32_16x16x32_bf16 v[112:115], v[132:135], a[104:107], v[112:115]
  ds_read_b128 v[148:151], v8 offset:46080
  v_mfma_f32_16x16x32_bf16 v[116:119], v[132:135], a[108:111], v[116:119]
  s_mov_b32 s15, 0x20000
  s_waitcnt lgkmcnt(2)
  s_waitcnt vmcnt(18)
  v_mfma_f32_16x16x32_bf16 v[64:67], v[136:139], a[112:115], v[64:67]
  ds_read_b128 v[152:155], v8 offset:47104
  v_mfma_f32_16x16x32_bf16 v[68:71], v[136:139], a[116:119], v[68:71]
  v_lshlrev_b32 v6, 3, v14
  v_mfma_f32_16x16x32_bf16 v[72:75], v[140:143], a[112:115], v[72:75]
  ds_read_b128 v[156:159], v8 offset:48128
  v_mfma_f32_16x16x32_bf16 v[76:79], v[140:143], a[116:119], v[76:79]
  s_add_u32 s76, s78, 10240
  s_waitcnt lgkmcnt(2)
  v_mfma_f32_16x16x32_bf16 v[80:83], v[144:147], a[112:115], v[80:83]
  ds_read_b128 v[128:131], v9 offset:43008
  v_mfma_f32_16x16x32_bf16 v[84:87], v[144:147], a[116:119], v[84:87]
  buffer_load_dwordx4 v[16:19], v2, s[8:11], s76 offen offset:0 sc1
  v_mfma_f32_16x16x32_bf16 v[88:91], v[148:151], a[112:115], v[88:91]
  ds_read_b128 v[132:135], v8 offset:50176
  v_mfma_f32_16x16x32_bf16 v[92:95], v[148:151], a[116:119], v[92:95]
  buffer_load_dwordx4 v[20:23], v2, s[8:11], s76 offen offset:64 sc1
  v_rsq_f32 v183, v184
  s_waitcnt lgkmcnt(2)
  v_mfma_f32_16x16x32_bf16 v[96:99], v[152:155], a[112:115], v[96:99]
  ds_read_b128 v[136:139], v8 offset:51200
  v_fma_f32 v184, -v182, s24, v179
  v_mfma_f32_16x16x32_bf16 v[100:103], v[152:155], a[116:119], v[100:103]
  buffer_load_dwordx4 v[24:27], v2, s[8:11], s76 offen offset:128 sc1
  v_mul_f32 v185, s25, v182
  v_mfma_f32_16x16x32_bf16 v[104:107], v[156:159], a[112:115], v[104:107]
  ds_read_b128 v[140:143], v8 offset:52224
  v_fma_f32 v185, -2.0, v177, v185
  v_mfma_f32_16x16x32_bf16 v[108:111], v[156:159], a[116:119], v[108:111]
  buffer_load_dwordx4 v[28:31], v2, s[8:11], s76 offen offset:192 sc1
  s_waitcnt lgkmcnt(2)
  v_mfma_f32_16x16x32_bf16 v[112:115], v[128:131], a[112:115], v[112:115]
  ds_read_b128 v[144:147], v8 offset:53248
  v_fma_f32 v185, v185, v182, v180
  v_mfma_f32_16x16x32_bf16 v[116:119], v[128:131], a[116:119], v[116:119]
  s_lshl_b32 s76, s80, 7
  s_waitcnt vmcnt(20)
  v_mfma_f32_16x16x32_bf16 v[64:67], v[132:135], a[120:123], v[64:67]
  ds_read_b128 v[148:151], v8 offset:54272
  v_fma_f32 v186, -v182, s26, v181
  v_mfma_f32_16x16x32_bf16 v[68:71], v[132:135], a[124:127], v[68:71]
  buffer_load_dwordx2 v[32:33], v6, s[12:15], s76 offen offset:0
  v_fma_f32 v184, v184, v183, s27
  s_waitcnt lgkmcnt(2)
  v_mfma_f32_16x16x32_bf16 v[72:75], v[136:139], a[120:123], v[72:75]
  ds_read_b128 v[152:155], v8 offset:55296
  v_mul_f32 v184, 0x3b000000, v184
  v_mfma_f32_16x16x32_bf16 v[76:79], v[136:139], a[124:127], v[76:79]
  buffer_load_dwordx2 v[34:35], v6, s[12:15], s76 offen offset:32
  v_mul_f32 v185, v185, v183
  v_mfma_f32_16x16x32_bf16 v[80:83], v[140:143], a[120:123], v[80:83]
  ds_read_b128 v[156:159], v9 offset:50176
  v_fma_f32 v185, 2.0, v186, v185
  v_mfma_f32_16x16x32_bf16 v[84:87], v[140:143], a[124:127], v[84:87]
  buffer_load_dwordx2 v[36:37], v6, s[12:15], s76 offen offset:64
  s_waitcnt lgkmcnt(2)
  v_mfma_f32_16x16x32_bf16 v[88:91], v[144:147], a[120:123], v[88:91]
  v_fma_f32 v185, v185, v183, s28
  v_mul_f32 v185, 0x3b000000, v185
  v_mfma_f32_16x16x32_bf16 v[92:95], v[144:147], a[124:127], v[92:95]
  buffer_load_dwordx2 v[38:39], v6, s[12:15], s76 offen offset:96
  v_fma_f32 v185, -v184, v184, v185
  v_mfma_f32_16x16x32_bf16 v[96:99], v[148:151], a[120:123], v[96:99]
  v_add_f32 v185, 0x3727c5ac, v185
  v_mfma_f32_16x16x32_bf16 v[100:103], v[148:151], a[124:127], v[100:103]
  s_waitcnt lgkmcnt(0)
  v_mfma_f32_16x16x32_bf16 v[104:107], v[152:155], a[120:123], v[104:107]
  v_rsq_f32 v198, v185
  v_mfma_f32_16x16x32_bf16 v[108:111], v[152:155], a[124:127], v[108:111]
  v_mul_f32 v182, -1.0, v182
  v_mul_f32 v196, v183, v198
  v_mfma_f32_16x16x32_bf16 v[112:115], v[156:159], a[120:123], v[112:115]
  v_mul_f32 v199, v184, v198
  v_mul_f32 v197, v182, v196
  v_mfma_f32_16x16x32_bf16 v[116:119], v[156:159], a[124:127], v[116:119]
  v_mul_f32 v199, -1.0, v199
  ds_read_b128 v[128:131], v13 offset:0
  ds_read_b128 v[132:135], v13 offset:512
  ds_read_b128 v[136:139], v13 offset:1024
  ds_read_b128 v[140:143], v12 offset:0
  ds_read_b128 v[144:147], v12 offset:512
  ds_read_b128 v[148:151], v12 offset:1024
  v_mov_b32 v176, s30
  v_mov_b32 v177, s30
  s_mul_i32 s76, s88, 114688
  s_add_u32 s76, s76, 65011712
  s_mul_i32 s77, s86, 7
  s_add_u32 s77, s77, s87
  s_lshl_b32 s77, s77, 9
  s_add_u32 s40, s76, s77
  s_add_u32 s41, s40, 57344
  s_or_b32 s77, s86, 1
  s_mul_i32 s77, s77, 7
  s_sub_u32 s77, s77, 1
  s_lshl_b32 s77, s77, 9
  s_add_u32 s42, s76, s77
  s_lshl_b32 s77, s87, 3
  s_add_u32 s42, s42, s77
  s_add_u32 s43, s42, 57344
  ds_read_b128 v[152:155], v12 offset:64
  ds_read_b128 v[156:159], v12 offset:576
  ds_read_b128 v[160:163], v12 offset:1088
  v_lshlrev_b32 v164, 16, v212
  v_and_b32 v165, 0xffff0000, v212
  v_lshlrev_b32 v166, 16, v213
  v_and_b32 v167, 0xffff0000, v213
  s_waitcnt lgkmcnt(6)
  v_pk_fma_f32 v[168:169], v[136:137], v[194:195], v[164:165] op_sel:[0,1,0] op_sel_hi:[1,1,1]
  v_pk_fma_f32 v[170:171], v[138:139], v[194:195], v[166:167] op_sel:[0,1,0] op_sel_hi:[1,1,1]
  v_pk_fma_f32 v[172:173], v[136:137], v[198:199], v[164:165] op_sel:[0,1,0] op_sel_hi:[1,1,1]
  v_pk_fma_f32 v[174:175], v[138:139], v[198:199], v[166:167] op_sel:[0,1,0] op_sel_hi:[1,1,1]
  v_pk_fma_f32 v[168:169], v[132:133], v[194:195], v[168:169] op_sel:[0,0,0] op_sel_hi:[1,0,1]
  v_pk_fma_f32 v[170:171], v[134:135], v[194:195], v[170:171] op_sel:[0,0,0] op_sel_hi:[1,0,1]
  v_pk_fma_f32 v[172:173], v[132:133], v[198:199], v[172:173] op_sel:[0,0,0] op_sel_hi:[1,0,1]
  v_pk_fma_f32 v[174:175], v[134:135], v[198:199], v[174:175] op_sel:[0,0,0] op_sel_hi:[1,0,1]
  v_pk_fma_f32 v[168:169], v[128:129], v[192:193], v[168:169] op_sel:[0,1,0] op_sel_hi:[1,1,1]
  v_pk_fma_f32 v[170:171], v[130:131], v[192:193], v[170:171] op_sel:[0,1,0] op_sel_hi:[1,1,1]
  v_pk_fma_f32 v[172:173], v[128:129], v[196:197], v[172:173] op_sel:[0,1,0] op_sel_hi:[1,1,1]
  v_pk_fma_f32 v[174:175], v[130:131], v[196:197], v[174:175] op_sel:[0,1,0] op_sel_hi:[1,1,1]
  v_pk_fma_f32 v[112:113], v[112:113], v[192:193], v[168:169] op_sel:[0,0,0] op_sel_hi:[1,0,1]
  v_pk_fma_f32 v[114:115], v[114:115], v[192:193], v[170:171] op_sel:[0,0,0] op_sel_hi:[1,0,1]
  v_pk_fma_f32 v[116:117], v[116:117], v[196:197], v[172:173] op_sel:[0,0,0] op_sel_hi:[1,0,1]
  v_pk_fma_f32 v[118:119], v[118:119], v[196:197], v[174:175] op_sel:[0,0,0] op_sel_hi:[1,0,1]
  v_pk_mul_f32 v[168:169], v[112:113], v[112:113]
  v_pk_mul_f32 v[170:171], v[114:115], v[114:115]
  v_pk_mul_f32 v[172:173], v[116:117], v[116:117]
  v_pk_mul_f32 v[174:175], v[118:119], v[118:119]
  v_pk_fma_f32 v[168:169], v[168:169], s[32:33], v[176:177]
  v_pk_fma_f32 v[170:171], v[170:171], s[32:33], v[176:177]
  v_pk_fma_f32 v[172:173], v[172:173], s[32:33], v[176:177]
  v_pk_fma_f32 v[174:175], v[174:175], s[32:33], v[176:177]
  v_pk_mul_f32 v[168:169], v[168:169], v[112:113]
  v_pk_mul_f32 v[170:171], v[170:171], v[114:115]
  v_pk_mul_f32 v[172:173], v[172:173], v[116:117]
  v_pk_mul_f32 v[174:175], v[174:175], v[118:119]
  v_exp_f32 v168, v168
  v_exp_f32 v169, v169
  v_exp_f32 v170, v170
  v_exp_f32 v171, v171
  v_exp_f32 v172, v172
  v_exp_f32 v173, v173
  v_exp_f32 v174, v174
  v_exp_f32 v175, v175
  v_pk_add_f32 v[168:169], v[168:169], s[34:35]
  v_pk_add_f32 v[170:171], v[170:171], s[34:35]
  v_pk_add_f32 v[172:173], v[172:173], s[34:35]
  v_pk_add_f32 v[174:175], v[174:175], s[34:35]
  v_rcp_f32 v168, v168
  v_rcp_f32 v169, v169
  v_rcp_f32 v170, v170
  v_rcp_f32 v171, v171
  v_rcp_f32 v172, v172
  v_rcp_f32 v173, v173
  v_rcp_f32 v174, v174
  v_rcp_f32 v175, v175
  v_pk_mul_f32 v[112:113], v[112:113], v[168:169]
  v_pk_mul_f32 v[114:115], v[114:115], v[170:171]
  v_pk_mul_f32 v[116:117], v[116:117], v[172:173]
  v_pk_mul_f32 v[118:119], v[118:119], v[174:175]
  v_cvt_pk_bf16_f32 v240, v112, v113
  v_cvt_pk_bf16_f32 v241, v114, v115
  v_cvt_pk_bf16_f32 v242, v116, v117
  v_cvt_pk_bf16_f32 v243, v118, v119
  buffer_store_dwordx2 v[240:241], v1, s[8:11], s42 offen sc1
  buffer_store_dwordx2 v[242:243], v1, s[8:11], s43 offen sc1
  ds_read_b128 v[128:131], v12 offset:128
  ds_read_b128 v[132:135], v12 offset:640
  ds_read_b128 v[136:139], v12 offset:1152
  v_lshlrev_b32 v164, 16, v200
  v_and_b32 v165, 0xffff0000, v200
  v_lshlrev_b32 v166, 16, v201
  v_and_b32 v167, 0xffff0000, v201
  s_waitcnt lgkmcnt(6)
  v_pk_fma_f32 v[168:169], v[148:149], v[194:195], v[164:165] op_sel:[0,1,0] op_sel_hi:[1,1,1]
  v_pk_fma_f32 v[170:171], v[150:151], v[194:195], v[166:167] op_sel:[0,1,0] op_sel_hi:[1,1,1]
  v_pk_fma_f32 v[172:173], v[148:149], v[198:199], v[164:165] op_sel:[0,1,0] op_sel_hi:[1,1,1]
  v_pk_fma_f32 v[174:175], v[150:151], v[198:199], v[166:167] op_sel:[0,1,0] op_sel_hi:[1,1,1]
  v_pk_fma_f32 v[168:169], v[144:145], v[194:195], v[168:169] op_sel:[0,0,0] op_sel_hi:[1,0,1]
  v_pk_fma_f32 v[170:171], v[146:147], v[194:195], v[170:171] op_sel:[0,0,0] op_sel_hi:[1,0,1]
  v_pk_fma_f32 v[172:173], v[144:145], v[198:199], v[172:173] op_sel:[0,0,0] op_sel_hi:[1,0,1]
  v_pk_fma_f32 v[174:175], v[146:147], v[198:199], v[174:175] op_sel:[0,0,0] op_sel_hi:[1,0,1]
  v_pk_fma_f32 v[168:169], v[140:141], v[192:193], v[168:169] op_sel:[0,1,0] op_sel_hi:[1,1,1]
  v_pk_fma_f32 v[170:171], v[142:143], v[192:193], v[170:171] op_sel:[0,1,0] op_sel_hi:[1,1,1]
  v_pk_fma_f32 v[172:173], v[140:141], v[196:197], v[172:173] op_sel:[0,1,0] op_sel_hi:[1,1,1]
  v_pk_fma_f32 v[174:175], v[142:143], v[196:197], v[174:175] op_sel:[0,1,0] op_sel_hi:[1,1,1]
  v_pk_fma_f32 v[64:65], v[64:65], v[192:193], v[168:169] op_sel:[0,0,0] op_sel_hi:[1,0,1]
  v_pk_fma_f32 v[66:67], v[66:67], v[192:193], v[170:171] op_sel:[0,0,0] op_sel_hi:[1,0,1]
  v_pk_fma_f32 v[68:69], v[68:69], v[196:197], v[172:173] op_sel:[0,0,0] op_sel_hi:[1,0,1]
  v_pk_fma_f32 v[70:71], v[70:71], v[196:197], v[174:175] op_sel:[0,0,0] op_sel_hi:[1,0,1]
  v_pk_mul_f32 v[168:169], v[64:65], v[64:65]
  v_pk_mul_f32 v[170:171], v[66:67], v[66:67]
  v_pk_mul_f32 v[172:173], v[68:69], v[68:69]
  v_pk_mul_f32 v[174:175], v[70:71], v[70:71]
  v_pk_fma_f32 v[168:169], v[168:169], s[32:33], v[176:177]
  v_pk_fma_f32 v[170:171], v[170:171], s[32:33], v[176:177]
  v_pk_fma_f32 v[172:173], v[172:173], s[32:33], v[176:177]
  v_pk_fma_f32 v[174:175], v[174:175], s[32:33], v[176:177]
  v_pk_mul_f32 v[168:169], v[168:169], v[64:65]
  v_pk_mul_f32 v[170:171], v[170:171], v[66:67]
  v_pk_mul_f32 v[172:173], v[172:173], v[68:69]
  v_pk_mul_f32 v[174:175], v[174:175], v[70:71]
  v_exp_f32 v168, v168
  v_exp_f32 v169, v169
  v_exp_f32 v170, v170
  v_exp_f32 v171, v171
  v_exp_f32 v172, v172
  v_exp_f32 v173, v173
  v_exp_f32 v174, v174
  v_exp_f32 v175, v175
  v_pk_add_f32 v[168:169], v[168:169], s[34:35]
  v_pk_add_f32 v[170:171], v[170:171], s[34:35]
  v_pk_add_f32 v[172:173], v[172:173], s[34:35]
  v_pk_add_f32 v[174:175], v[174:175], s[34:35]
  v_rcp_f32 v168, v168
  v_rcp_f32 v169, v169
  v_rcp_f32 v170, v170
  v_rcp_f32 v171, v171
  v_rcp_f32 v172, v172
  v_rcp_f32 v173, v173
  v_rcp_f32 v174, v174
  v_rcp_f32 v175, v175
  v_pk_mul_f32 v[64:65], v[64:65], v[168:169]
  v_pk_mul_f32 v[66:67], v[66:67], v[170:171]
  v_pk_mul_f32 v[68:69], v[68:69], v[172:173]
  v_pk_mul_f32 v[70:71], v[70:71], v[174:175]
  v_cvt_pk_bf16_f32 v216, v64, v65
  v_cvt_pk_bf16_f32 v217, v66, v67
  v_cvt_pk_bf16_f32 v228, v68, v69
  v_cvt_pk_bf16_f32 v229, v70, v71
  ds_read_b128 v[140:143], v12 offset:192
  ds_read_b128 v[144:147], v12 offset:704
  ds_read_b128 v[148:151], v12 offset:1216
  v_lshlrev_b32 v164, 16, v202
  v_and_b32 v165, 0xffff0000, v202
  v_lshlrev_b32 v166, 16, v203
  v_and_b32 v167, 0xffff0000, v203
  s_waitcnt lgkmcnt(6)
  v_pk_fma_f32 v[168:169], v[160:161], v[194:195], v[164:165] op_sel:[0,1,0] op_sel_hi:[1,1,1]
  v_pk_fma_f32 v[170:171], v[162:163], v[194:195], v[166:167] op_sel:[0,1,0] op_sel_hi:[1,1,1]
  v_pk_fma_f32 v[172:173], v[160:161], v[198:199], v[164:165] op_sel:[0,1,0] op_sel_hi:[1,1,1]
  v_pk_fma_f32 v[174:175], v[162:163], v[198:199], v[166:167] op_sel:[0,1,0] op_sel_hi:[1,1,1]
  v_pk_fma_f32 v[168:169], v[156:157], v[194:195], v[168:169] op_sel:[0,0,0] op_sel_hi:[1,0,1]
  v_pk_fma_f32 v[170:171], v[158:159], v[194:195], v[170:171] op_sel:[0,0,0] op_sel_hi:[1,0,1]
  v_pk_fma_f32 v[172:173], v[156:157], v[198:199], v[172:173] op_sel:[0,0,0] op_sel_hi:[1,0,1]
  v_pk_fma_f32 v[174:175], v[158:159], v[198:199], v[174:175] op_sel:[0,0,0] op_sel_hi:[1,0,1]
  v_pk_fma_f32 v[168:169], v[152:153], v[192:193], v[168:169] op_sel:[0,1,0] op_sel_hi:[1,1,1]
  v_pk_fma_f32 v[170:171], v[154:155], v[192:193], v[170:171] op_sel:[0,1,0] op_sel_hi:[1,1,1]
  v_pk_fma_f32 v[172:173], v[152:153], v[196:197], v[172:173] op_sel:[0,1,0] op_sel_hi:[1,1,1]
  v_pk_fma_f32 v[174:175], v[154:155], v[196:197], v[174:175] op_sel:[0,1,0] op_sel_hi:[1,1,1]
  v_pk_fma_f32 v[72:73], v[72:73], v[192:193], v[168:169] op_sel:[0,0,0] op_sel_hi:[1,0,1]
  v_pk_fma_f32 v[74:75], v[74:75], v[192:193], v[170:171] op_sel:[0,0,0] op_sel_hi:[1,0,1]
  v_pk_fma_f32 v[76:77], v[76:77], v[196:197], v[172:173] op_sel:[0,0,0] op_sel_hi:[1,0,1]
  v_pk_fma_f32 v[78:79], v[78:79], v[196:197], v[174:175] op_sel:[0,0,0] op_sel_hi:[1,0,1]
  v_pk_mul_f32 v[168:169], v[72:73], v[72:73]
  v_pk_mul_f32 v[170:171], v[74:75], v[74:75]
  v_pk_mul_f32 v[172:173], v[76:77], v[76:77]
  v_pk_mul_f32 v[174:175], v[78:79], v[78:79]
  v_pk_fma_f32 v[168:169], v[168:169], s[32:33], v[176:177]
  v_pk_fma_f32 v[170:171], v[170:171], s[32:33], v[176:177]
  v_pk_fma_f32 v[172:173], v[172:173], s[32:33], v[176:177]
  v_pk_fma_f32 v[174:175], v[174:175], s[32:33], v[176:177]
  v_pk_mul_f32 v[168:169], v[168:169], v[72:73]
  v_pk_mul_f32 v[170:171], v[170:171], v[74:75]
  v_pk_mul_f32 v[172:173], v[172:173], v[76:77]
  v_pk_mul_f32 v[174:175], v[174:175], v[78:79]
  v_exp_f32 v168, v168
  v_exp_f32 v169, v169
  v_exp_f32 v170, v170
  v_exp_f32 v171, v171
  v_exp_f32 v172, v172
  v_exp_f32 v173, v173
  v_exp_f32 v174, v174
  v_exp_f32 v175, v175
  v_pk_add_f32 v[168:169], v[168:169], s[34:35]
  v_pk_add_f32 v[170:171], v[170:171], s[34:35]
  v_pk_add_f32 v[172:173], v[172:173], s[34:35]
  v_pk_add_f32 v[174:175], v[174:175], s[34:35]
  v_rcp_f32 v168, v168
  v_rcp_f32 v169, v169
  v_rcp_f32 v170, v170
  v_rcp_f32 v171, v171
  v_rcp_f32 v172, v172
  v_rcp_f32 v173, v173
  v_rcp_f32 v174, v174
  v_rcp_f32 v175, v175
  v_pk_mul_f32 v[72:73], v[72:73], v[168:169]
  v_pk_mul_f32 v[74:75], v[74:75], v[170:171]
  v_pk_mul_f32 v[76:77], v[76:77], v[172:173]
  v_pk_mul_f32 v[78:79], v[78:79], v[174:175]
  v_cvt_pk_bf16_f32 v218, v72, v73
  v_cvt_pk_bf16_f32 v219, v74, v75
  v_cvt_pk_bf16_f32 v230, v76, v77
  v_cvt_pk_bf16_f32 v231, v78, v79
  buffer_store_dwordx4 v[216:219], v1, s[8:11], s40 offen offset:0 sc1
  buffer_store_dwordx4 v[228:231], v1, s[8:11], s41 offen offset:0 sc1
  ds_read_b128 v[152:155], v12 offset:256
  ds_read_b128 v[156:159], v12 offset:768
  ds_read_b128 v[160:163], v12 offset:1280
  v_lshlrev_b32 v164, 16, v204
  v_and_b32 v165, 0xffff0000, v204
  v_lshlrev_b32 v166, 16, v205
  v_and_b32 v167, 0xffff0000, v205
  s_waitcnt lgkmcnt(6)
  v_pk_fma_f32 v[168:169], v[136:137], v[194:195], v[164:165] op_sel:[0,1,0] op_sel_hi:[1,1,1]
  v_pk_fma_f32 v[170:171], v[138:139], v[194:195], v[166:167] op_sel:[0,1,0] op_sel_hi:[1,1,1]
  v_pk_fma_f32 v[172:173], v[136:137], v[198:199], v[164:165] op_sel:[0,1,0] op_sel_hi:[1,1,1]
  v_pk_fma_f32 v[174:175], v[138:139], v[198:199], v[166:167] op_sel:[0,1,0] op_sel_hi:[1,1,1]
  v_pk_fma_f32 v[168:169], v[132:133], v[194:195], v[168:169] op_sel:[0,0,0] op_sel_hi:[1,0,1]
  v_pk_fma_f32 v[170:171], v[134:135], v[194:195], v[170:171] op_sel:[0,0,0] op_sel_hi:[1,0,1]
  v_pk_fma_f32 v[172:173], v[132:133], v[198:199], v[172:173] op_sel:[0,0,0] op_sel_hi:[1,0,1]
  v_pk_fma_f32 v[174:175], v[134:135], v[198:199], v[174:175] op_sel:[0,0,0] op_sel_hi:[1,0,1]
  v_pk_fma_f32 v[168:169], v[128:129], v[192:193], v[168:169] op_sel:[0,1,0] op_sel_hi:[1,1,1]
  v_pk_fma_f32 v[170:171], v[130:131], v[192:193], v[170:171] op_sel:[0,1,0] op_sel_hi:[1,1,1]
  v_pk_fma_f32 v[172:173], v[128:129], v[196:197], v[172:173] op_sel:[0,1,0] op_sel_hi:[1,1,1]
  v_pk_fma_f32 v[174:175], v[130:131], v[196:197], v[174:175] op_sel:[0,1,0] op_sel_hi:[1,1,1]
  v_pk_fma_f32 v[80:81], v[80:81], v[192:193], v[168:169] op_sel:[0,0,0] op_sel_hi:[1,0,1]
  v_pk_fma_f32 v[82:83], v[82:83], v[192:193], v[170:171] op_sel:[0,0,0] op_sel_hi:[1,0,1]
  v_pk_fma_f32 v[84:85], v[84:85], v[196:197], v[172:173] op_sel:[0,0,0] op_sel_hi:[1,0,1]
  v_pk_fma_f32 v[86:87], v[86:87], v[196:197], v[174:175] op_sel:[0,0,0] op_sel_hi:[1,0,1]
  v_pk_mul_f32 v[168:169], v[80:81], v[80:81]
  v_pk_mul_f32 v[170:171], v[82:83], v[82:83]
  v_pk_mul_f32 v[172:173], v[84:85], v[84:85]
  v_pk_mul_f32 v[174:175], v[86:87], v[86:87]
  v_pk_fma_f32 v[168:169], v[168:169], s[32:33], v[176:177]
  v_pk_fma_f32 v[170:171], v[170:171], s[32:33], v[176:177]
  v_pk_fma_f32 v[172:173], v[172:173], s[32:33], v[176:177]
  v_pk_fma_f32 v[174:175], v[174:175], s[32:33], v[176:177]
  v_pk_mul_f32 v[168:169], v[168:169], v[80:81]
  v_pk_mul_f32 v[170:171], v[170:171], v[82:83]
  v_pk_mul_f32 v[172:173], v[172:173], v[84:85]
  v_pk_mul_f32 v[174:175], v[174:175], v[86:87]
  v_exp_f32 v168, v168
  v_exp_f32 v169, v169
  v_exp_f32 v170, v170
  v_exp_f32 v171, v171
  v_exp_f32 v172, v172
  v_exp_f32 v173, v173
  v_exp_f32 v174, v174
  v_exp_f32 v175, v175
  v_pk_add_f32 v[168:169], v[168:169], s[34:35]
  v_pk_add_f32 v[170:171], v[170:171], s[34:35]
  v_pk_add_f32 v[172:173], v[172:173], s[34:35]
  v_pk_add_f32 v[174:175], v[174:175], s[34:35]
  v_rcp_f32 v168, v168
  v_rcp_f32 v169, v169
  v_rcp_f32 v170, v170
  v_rcp_f32 v171, v171
  v_rcp_f32 v172, v172
  v_rcp_f32 v173, v173
  v_rcp_f32 v174, v174
  v_rcp_f32 v175, v175
  v_pk_mul_f32 v[80:81], v[80:81], v[168:169]
  v_pk_mul_f32 v[82:83], v[82:83], v[170:171]
  v_pk_mul_f32 v[84:85], v[84:85], v[172:173]
  v_pk_mul_f32 v[86:87], v[86:87], v[174:175]
  v_cvt_pk_bf16_f32 v220, v80, v81
  v_cvt_pk_bf16_f32 v221, v82, v83
  v_cvt_pk_bf16_f32 v232, v84, v85
  v_cvt_pk_bf16_f32 v233, v86, v87
  ds_read_b128 v[128:131], v12 offset:320
  ds_read_b128 v[132:135], v12 offset:832
  ds_read_b128 v[136:139], v12 offset:1344
  v_lshlrev_b32 v164, 16, v206
  v_and_b32 v165, 0xffff0000, v206
  v_lshlrev_b32 v166, 16, v207
  v_and_b32 v167, 0xffff0000, v207
  s_waitcnt lgkmcnt(6)
  v_pk_fma_f32 v[168:169], v[148:149], v[194:195], v[164:165] op_sel:[0,1,0] op_sel_hi:[1,1,1]
  v_pk_fma_f32 v[170:171], v[150:151], v[194:195], v[166:167] op_sel:[0,1,0] op_sel_hi:[1,1,1]
  v_pk_fma_f32 v[172:173], v[148:149], v[198:199], v[164:165] op_sel:[0,1,0] op_sel_hi:[1,1,1]
  v_pk_fma_f32 v[174:175], v[150:151], v[198:199], v[166:167] op_sel:[0,1,0] op_sel_hi:[1,1,1]
  v_pk_fma_f32 v[168:169], v[144:145], v[194:195], v[168:169] op_sel:[0,0,0] op_sel_hi:[1,0,1]
  v_pk_fma_f32 v[170:171], v[146:147], v[194:195], v[170:171] op_sel:[0,0,0] op_sel_hi:[1,0,1]
  v_pk_fma_f32 v[172:173], v[144:145], v[198:199], v[172:173] op_sel:[0,0,0] op_sel_hi:[1,0,1]
  v_pk_fma_f32 v[174:175], v[146:147], v[198:199], v[174:175] op_sel:[0,0,0] op_sel_hi:[1,0,1]
  v_pk_fma_f32 v[168:169], v[140:141], v[192:193], v[168:169] op_sel:[0,1,0] op_sel_hi:[1,1,1]
  v_pk_fma_f32 v[170:171], v[142:143], v[192:193], v[170:171] op_sel:[0,1,0] op_sel_hi:[1,1,1]
  v_pk_fma_f32 v[172:173], v[140:141], v[196:197], v[172:173] op_sel:[0,1,0] op_sel_hi:[1,1,1]
  v_pk_fma_f32 v[174:175], v[142:143], v[196:197], v[174:175] op_sel:[0,1,0] op_sel_hi:[1,1,1]
  v_pk_fma_f32 v[88:89], v[88:89], v[192:193], v[168:169] op_sel:[0,0,0] op_sel_hi:[1,0,1]
  v_pk_fma_f32 v[90:91], v[90:91], v[192:193], v[170:171] op_sel:[0,0,0] op_sel_hi:[1,0,1]
  v_pk_fma_f32 v[92:93], v[92:93], v[196:197], v[172:173] op_sel:[0,0,0] op_sel_hi:[1,0,1]
  v_pk_fma_f32 v[94:95], v[94:95], v[196:197], v[174:175] op_sel:[0,0,0] op_sel_hi:[1,0,1]
  v_pk_mul_f32 v[168:169], v[88:89], v[88:89]
  v_pk_mul_f32 v[170:171], v[90:91], v[90:91]
  v_pk_mul_f32 v[172:173], v[92:93], v[92:93]
  v_pk_mul_f32 v[174:175], v[94:95], v[94:95]
  v_pk_fma_f32 v[168:169], v[168:169], s[32:33], v[176:177]
  v_pk_fma_f32 v[170:171], v[170:171], s[32:33], v[176:177]
  v_pk_fma_f32 v[172:173], v[172:173], s[32:33], v[176:177]
  v_pk_fma_f32 v[174:175], v[174:175], s[32:33], v[176:177]
  v_pk_mul_f32 v[168:169], v[168:169], v[88:89]
  v_pk_mul_f32 v[170:171], v[170:171], v[90:91]
  v_pk_mul_f32 v[172:173], v[172:173], v[92:93]
  v_pk_mul_f32 v[174:175], v[174:175], v[94:95]
  v_exp_f32 v168, v168
  v_exp_f32 v169, v169
  v_exp_f32 v170, v170
  v_exp_f32 v171, v171
  v_exp_f32 v172, v172
  v_exp_f32 v173, v173
  v_exp_f32 v174, v174
  v_exp_f32 v175, v175
  v_pk_add_f32 v[168:169], v[168:169], s[34:35]
  v_pk_add_f32 v[170:171], v[170:171], s[34:35]
  v_pk_add_f32 v[172:173], v[172:173], s[34:35]
  v_pk_add_f32 v[174:175], v[174:175], s[34:35]
  v_rcp_f32 v168, v168
  v_rcp_f32 v169, v169
  v_rcp_f32 v170, v170
  v_rcp_f32 v171, v171
  v_rcp_f32 v172, v172
  v_rcp_f32 v173, v173
  v_rcp_f32 v174, v174
  v_rcp_f32 v175, v175
  v_pk_mul_f32 v[88:89], v[88:89], v[168:169]
  v_pk_mul_f32 v[90:91], v[90:91], v[170:171]
  v_pk_mul_f32 v[92:93], v[92:93], v[172:173]
  v_pk_mul_f32 v[94:95], v[94:95], v[174:175]
  v_cvt_pk_bf16_f32 v222, v88, v89
  v_cvt_pk_bf16_f32 v223, v90, v91
  v_cvt_pk_bf16_f32 v234, v92, v93
  v_cvt_pk_bf16_f32 v235, v94, v95
  buffer_store_dwordx4 v[220:223], v1, s[8:11], s40 offen offset:1024 sc1
  buffer_store_dwordx4 v[232:235], v1, s[8:11], s41 offen offset:1024 sc1
  v_lshlrev_b32 v164, 16, v208
  v_and_b32 v165, 0xffff0000, v208
  v_lshlrev_b32 v166, 16, v209
  v_and_b32 v167, 0xffff0000, v209
  s_waitcnt lgkmcnt(3)
  v_pk_fma_f32 v[168:169], v[160:161], v[194:195], v[164:165] op_sel:[0,1,0] op_sel_hi:[1,1,1]
  v_pk_fma_f32 v[170:171], v[162:163], v[194:195], v[166:167] op_sel:[0,1,0] op_sel_hi:[1,1,1]
  v_pk_fma_f32 v[172:173], v[160:161], v[198:199], v[164:165] op_sel:[0,1,0] op_sel_hi:[1,1,1]
  v_pk_fma_f32 v[174:175], v[162:163], v[198:199], v[166:167] op_sel:[0,1,0] op_sel_hi:[1,1,1]
  v_pk_fma_f32 v[168:169], v[156:157], v[194:195], v[168:169] op_sel:[0,0,0] op_sel_hi:[1,0,1]
  v_pk_fma_f32 v[170:171], v[158:159], v[194:195], v[170:171] op_sel:[0,0,0] op_sel_hi:[1,0,1]
  v_pk_fma_f32 v[172:173], v[156:157], v[198:199], v[172:173] op_sel:[0,0,0] op_sel_hi:[1,0,1]
  v_pk_fma_f32 v[174:175], v[158:159], v[198:199], v[174:175] op_sel:[0,0,0] op_sel_hi:[1,0,1]
  v_pk_fma_f32 v[168:169], v[152:153], v[192:193], v[168:169] op_sel:[0,1,0] op_sel_hi:[1,1,1]
  v_pk_fma_f32 v[170:171], v[154:155], v[192:193], v[170:171] op_sel:[0,1,0] op_sel_hi:[1,1,1]
  v_pk_fma_f32 v[172:173], v[152:153], v[196:197], v[172:173] op_sel:[0,1,0] op_sel_hi:[1,1,1]
  v_pk_fma_f32 v[174:175], v[154:155], v[196:197], v[174:175] op_sel:[0,1,0] op_sel_hi:[1,1,1]
  v_pk_fma_f32 v[96:97], v[96:97], v[192:193], v[168:169] op_sel:[0,0,0] op_sel_hi:[1,0,1]
  v_pk_fma_f32 v[98:99], v[98:99], v[192:193], v[170:171] op_sel:[0,0,0] op_sel_hi:[1,0,1]
  v_pk_fma_f32 v[100:101], v[100:101], v[196:197], v[172:173] op_sel:[0,0,0] op_sel_hi:[1,0,1]
  v_pk_fma_f32 v[102:103], v[102:103], v[196:197], v[174:175] op_sel:[0,0,0] op_sel_hi:[1,0,1]
  v_pk_mul_f32 v[168:169], v[96:97], v[96:97]
  v_pk_mul_f32 v[170:171], v[98:99], v[98:99]
  v_pk_mul_f32 v[172:173], v[100:101], v[100:101]
  v_pk_mul_f32 v[174:175], v[102:103], v[102:103]
  v_pk_fma_f32 v[168:169], v[168:169], s[32:33], v[176:177]
  v_pk_fma_f32 v[170:171], v[170:171], s[32:33], v[176:177]
  v_pk_fma_f32 v[172:173], v[172:173], s[32:33], v[176:177]
  v_pk_fma_f32 v[174:175], v[174:175], s[32:33], v[176:177]
  v_pk_mul_f32 v[168:169], v[168:169], v[96:97]
  v_pk_mul_f32 v[170:171], v[170:171], v[98:99]
  v_pk_mul_f32 v[172:173], v[172:173], v[100:101]
  v_pk_mul_f32 v[174:175], v[174:175], v[102:103]
  v_exp_f32 v168, v168
  v_exp_f32 v169, v169
  v_exp_f32 v170, v170
  v_exp_f32 v171, v171
  v_exp_f32 v172, v172
  v_exp_f32 v173, v173
  v_exp_f32 v174, v174
  v_exp_f32 v175, v175
  v_pk_add_f32 v[168:169], v[168:169], s[34:35]
  v_pk_add_f32 v[170:171], v[170:171], s[34:35]
  v_pk_add_f32 v[172:173], v[172:173], s[34:35]
  v_pk_add_f32 v[174:175], v[174:175], s[34:35]
  v_rcp_f32 v168, v168
  v_rcp_f32 v169, v169
  v_rcp_f32 v170, v170
  v_rcp_f32 v171, v171
  v_rcp_f32 v172, v172
  v_rcp_f32 v173, v173
  v_rcp_f32 v174, v174
  v_rcp_f32 v175, v175
  v_pk_mul_f32 v[96:97], v[96:97], v[168:169]
  v_pk_mul_f32 v[98:99], v[98:99], v[170:171]
  v_pk_mul_f32 v[100:101], v[100:101], v[172:173]
  v_pk_mul_f32 v[102:103], v[102:103], v[174:175]
  v_cvt_pk_bf16_f32 v224, v96, v97
  v_cvt_pk_bf16_f32 v225, v98, v99
  v_cvt_pk_bf16_f32 v236, v100, v101
  v_cvt_pk_bf16_f32 v237, v102, v103
  v_lshlrev_b32 v164, 16, v210
  v_and_b32 v165, 0xffff0000, v210
  v_lshlrev_b32 v166, 16, v211
  v_and_b32 v167, 0xffff0000, v211
  s_waitcnt lgkmcnt(0)
  v_pk_fma_f32 v[168:169], v[136:137], v[194:195], v[164:165] op_sel:[0,1,0] op_sel_hi:[1,1,1]
  v_pk_fma_f32 v[170:171], v[138:139], v[194:195], v[166:167] op_sel:[0,1,0] op_sel_hi:[1,1,1]
  v_pk_fma_f32 v[172:173], v[136:137], v[198:199], v[164:165] op_sel:[0,1,0] op_sel_hi:[1,1,1]
  v_pk_fma_f32 v[174:175], v[138:139], v[198:199], v[166:167] op_sel:[0,1,0] op_sel_hi:[1,1,1]
  v_pk_fma_f32 v[168:169], v[132:133], v[194:195], v[168:169] op_sel:[0,0,0] op_sel_hi:[1,0,1]
  v_pk_fma_f32 v[170:171], v[134:135], v[194:195], v[170:171] op_sel:[0,0,0] op_sel_hi:[1,0,1]
  v_pk_fma_f32 v[172:173], v[132:133], v[198:199], v[172:173] op_sel:[0,0,0] op_sel_hi:[1,0,1]
  v_pk_fma_f32 v[174:175], v[134:135], v[198:199], v[174:175] op_sel:[0,0,0] op_sel_hi:[1,0,1]
  v_pk_fma_f32 v[168:169], v[128:129], v[192:193], v[168:169] op_sel:[0,1,0] op_sel_hi:[1,1,1]
  v_pk_fma_f32 v[170:171], v[130:131], v[192:193], v[170:171] op_sel:[0,1,0] op_sel_hi:[1,1,1]
  v_pk_fma_f32 v[172:173], v[128:129], v[196:197], v[172:173] op_sel:[0,1,0] op_sel_hi:[1,1,1]
  v_pk_fma_f32 v[174:175], v[130:131], v[196:197], v[174:175] op_sel:[0,1,0] op_sel_hi:[1,1,1]
  v_pk_fma_f32 v[104:105], v[104:105], v[192:193], v[168:169] op_sel:[0,0,0] op_sel_hi:[1,0,1]
  v_pk_fma_f32 v[106:107], v[106:107], v[192:193], v[170:171] op_sel:[0,0,0] op_sel_hi:[1,0,1]
  v_pk_fma_f32 v[108:109], v[108:109], v[196:197], v[172:173] op_sel:[0,0,0] op_sel_hi:[1,0,1]
  v_pk_fma_f32 v[110:111], v[110:111], v[196:197], v[174:175] op_sel:[0,0,0] op_sel_hi:[1,0,1]
  v_pk_mul_f32 v[168:169], v[104:105], v[104:105]
  v_pk_mul_f32 v[170:171], v[106:107], v[106:107]
  v_pk_mul_f32 v[172:173], v[108:109], v[108:109]
  v_pk_mul_f32 v[174:175], v[110:111], v[110:111]
  v_pk_fma_f32 v[168:169], v[168:169], s[32:33], v[176:177]
  v_pk_fma_f32 v[170:171], v[170:171], s[32:33], v[176:177]
  v_pk_fma_f32 v[172:173], v[172:173], s[32:33], v[176:177]
  v_pk_fma_f32 v[174:175], v[174:175], s[32:33], v[176:177]
  v_pk_mul_f32 v[168:169], v[168:169], v[104:105]
  v_pk_mul_f32 v[170:171], v[170:171], v[106:107]
  v_pk_mul_f32 v[172:173], v[172:173], v[108:109]
  v_pk_mul_f32 v[174:175], v[174:175], v[110:111]
  v_exp_f32 v168, v168
  v_exp_f32 v169, v169
  v_exp_f32 v170, v170
  v_exp_f32 v171, v171
  v_exp_f32 v172, v172
  v_exp_f32 v173, v173
  v_exp_f32 v174, v174
  v_exp_f32 v175, v175
  v_pk_add_f32 v[168:169], v[168:169], s[34:35]
  v_pk_add_f32 v[170:171], v[170:171], s[34:35]
  v_pk_add_f32 v[172:173], v[172:173], s[34:35]
  v_pk_add_f32 v[174:175], v[174:175], s[34:35]
  v_rcp_f32 v168, v168
  v_rcp_f32 v169, v169
  v_rcp_f32 v170, v170
  v_rcp_f32 v171, v171
  v_rcp_f32 v172, v172
  v_rcp_f32 v173, v173
  v_rcp_f32 v174, v174
  v_rcp_f32 v175, v175
  v_pk_mul_f32 v[104:105], v[104:105], v[168:169]
  v_pk_mul_f32 v[106:107], v[106:107], v[170:171]
  v_pk_mul_f32 v[108:109], v[108:109], v[172:173]
  v_pk_mul_f32 v[110:111], v[110:111], v[174:175]
  v_cvt_pk_bf16_f32 v226, v104, v105
  v_cvt_pk_bf16_f32 v227, v106, v107
  v_cvt_pk_bf16_f32 v238, v108, v109
  v_cvt_pk_bf16_f32 v239, v110, v111
  buffer_store_dwordx4 v[224:227], v1, s[8:11], s40 offen offset:2048 sc1
  buffer_store_dwordx4 v[236:239], v1, s[8:11], s41 offen offset:2048 sc1
  buffer_load_dwordx4 a[8:11], v1, s[8:11], s82 offen offset:0 sc1
  buffer_load_dwordx4 a[12:15], v1, s[8:11], s82 offen offset:1024 sc1
  buffer_load_dwordx4 a[24:27], v1, s[8:11], s82 offen offset:2048 sc1
  buffer_load_dwordx4 a[28:31], v1, s[8:11], s82 offen offset:3072 sc1
  s_add_u32 s82, s82, 4096
  buffer_load_dwordx4 a[40:43], v1, s[8:11], s82 offen offset:0 sc1
  buffer_load_dwordx4 a[44:47], v1, s[8:11], s82 offen offset:1024 sc1
  buffer_load_dwordx4 a[56:59], v1, s[8:11], s82 offen offset:2048 sc1
  buffer_load_dwordx4 a[60:63], v1, s[8:11], s82 offen offset:3072 sc1
  s_add_u32 s82, s82, 4096
  s_mul_i32 s16, s79, 229376
  s_mul_i32 s76, s3, 14336
  s_add_u32 s16, s16, s76
  s_add_u32 s16, s16, 65011712
  s_add_u32 s76, s3, 1
  s_and_b32 s76, s76, 3
  s_mul_i32 s76, s76, 57344
  s_add_u32 s17, s16, s76
  s_add_u32 s76, s3, 2
  s_and_b32 s76, s76, 3
  s_mul_i32 s76, s76, 57344
  s_add_u32 s18, s16, s76
  s_add_u32 s76, s3, 3
  s_and_b32 s76, s76, 3
  s_mul_i32 s76, s76, 57344
  s_add_u32 s19, s16, s76
  s_add_u32 s76, s3, 0
  s_and_b32 s76, s76, 3
  s_mul_i32 s76, s76, 57344
  s_add_u32 s16, s16, s76
  s_mov_b32 s12, s98
  s_mov_b32 s13, s99
  s_mov_b32 s14, 0x200000
  s_mov_b32 s15, 0x20000
  s_waitcnt vmcnt(16)
  s_mul_i32 s76, s3, 2304
  v_mul_u32_u24 v8, 144, v15
  v_lshl_add_u32 v8, v14, 3, v8
  v_add_u32 v8, s76, v8
  v_lshrrev_b32 v3, 3, v0
  v_and_b32 v2, 7, v0
  v_lshlrev_b32 v2, 4, v2
  v_mul_u32_u24 v9, 144, v3
  v_add3_u32 v9, v9, v2, s76
  v_lshl_add_u32 v3, v3, 10, v2
  v_lshlrev_b32 v40, 16, v32
  v_and_b32 v41, 0xffff0000, v32
  v_lshlrev_b32 v42, 16, v33
  v_and_b32 v43, 0xffff0000, v33
  v_lshlrev_b32 v44, 16, v34
  v_and_b32 v45, 0xffff0000, v34
  v_lshlrev_b32 v46, 16, v35
  v_and_b32 v47, 0xffff0000, v35
  v_lshlrev_b32 v48, 16, v36
  v_and_b32 v49, 0xffff0000, v36
  v_lshlrev_b32 v50, 16, v37
  v_and_b32 v51, 0xffff0000, v37
  v_lshlrev_b32 v52, 16, v38
  v_and_b32 v53, 0xffff0000, v38
  v_lshlrev_b32 v54, 16, v39
  v_and_b32 v55, 0xffff0000, v39
  v_lshlrev_b32 v32, 16, v56
  v_and_b32 v33, 0xffff0000, v56
  v_pk_fma_f32 v[40:41], v[40:41], v[16:17], v[32:33]
  v_lshlrev_b32 v32, 16, v57
  v_and_b32 v33, 0xffff0000, v57
  v_pk_fma_f32 v[42:43], v[42:43], v[18:19], v[32:33]
  v_lshlrev_b32 v32, 16, v58
  v_and_b32 v33, 0xffff0000, v58
  v_pk_fma_f32 v[44:45], v[44:45], v[20:21], v[32:33]
  v_lshlrev_b32 v32, 16, v59
  v_and_b32 v33, 0xffff0000, v59
  v_pk_fma_f32 v[46:47], v[46:47], v[22:23], v[32:33]
  v_lshlrev_b32 v32, 16, v60
  v_and_b32 v33, 0xffff0000, v60
  v_pk_fma_f32 v[48:49], v[48:49], v[24:25], v[32:33]
  v_lshlrev_b32 v32, 16, v61
  v_and_b32 v33, 0xffff0000, v61
  v_pk_fma_f32 v[50:51], v[50:51], v[26:27], v[32:33]
  v_lshlrev_b32 v32, 16, v62
  v_and_b32 v33, 0xffff0000, v62
  v_pk_fma_f32 v[52:53], v[52:53], v[28:29], v[32:33]
  v_lshlrev_b32 v32, 16, v63
  v_and_b32 v33, 0xffff0000, v63
  v_pk_fma_f32 v[54:55], v[54:55], v[30:31], v[32:33]
  s_and_b32 s83, s2, 7
  s_lshl_b32 s83, s83, 10
  s_add_u32 s83, s83, 39100416
  s_lshr_b32 s76, s2, 3
  s_lshl_b32 s76, s76, 5
  s_add_u32 s83, s83, s76
  s_cmp_eq_u32 s3, 0
  s_cselect_b32 s83, s83, 0x7ff00000
  v_min_u32 v4, 1, v0
  v_lshlrev_b32 v4, 27, v4
  v_mov_b32 v5, 1
  s_waitcnt vmcnt(8)
  s_barrier
  buffer_store_dword v5, v4, s[8:11], s83 offen sc1
  s_and_b32 s83, s2, 7
  s_lshl_b32 s83, s83, 10
  s_add_u32 s83, s83, 39100416
  s_cmp_eq_u32 s3, 0
  s_cselect_b32 s83, s83, 0x7ff00000
  v_and_b32 v4, 31, v0
  v_lshlrev_b32 v4, 5, v4
  buffer_load_dwordx4 a[72:75], v1, s[8:11], s82 offen offset:0 sc1
  buffer_load_dwordx4 a[76:79], v1, s[8:11], s82 offen offset:1024 sc1
  buffer_load_dwordx4 a[88:91], v1, s[8:11], s82 offen offset:2048 sc1
  buffer_load_dwordx4 a[92:95], v1, s[8:11], s82 offen offset:3072 sc1
  s_add_u32 s82, s82, 4096
  buffer_load_dwordx4 a[104:107], v1, s[8:11], s82 offen offset:0 sc1
  buffer_load_dwordx4 a[108:111], v1, s[8:11], s82 offen offset:1024 sc1
  buffer_load_dwordx4 a[120:123], v1, s[8:11], s82 offen offset:2048 sc1
  buffer_load_dwordx4 a[124:127], v1, s[8:11], s82 offen offset:3072 sc1
  s_add_u32 s82, s82, 4096
  buffer_load_dwordx4 a[0:3], v1, s[8:11], s82 offen offset:0 sc1
  buffer_load_dwordx4 a[4:7], v1, s[8:11], s82 offen offset:1024 sc1
  buffer_load_dwordx4 a[16:19], v1, s[8:11], s82 offen offset:2048 sc1
  buffer_load_dwordx4 a[20:23], v1, s[8:11], s82 offen offset:3072 sc1
  s_add_u32 s82, s82, 4096
  buffer_load_dwordx4 a[32:35], v1, s[8:11], s82 offen offset:0 sc1
  buffer_load_dwordx4 a[36:39], v1, s[8:11], s82 offen offset:1024 sc1
  buffer_load_dwordx4 a[48:51], v1, s[8:11], s82 offen offset:2048 sc1
  buffer_load_dwordx4 a[52:55], v1, s[8:11], s82 offen offset:3072 sc1
  s_add_u32 s82, s82, 4096
  buffer_load_dword v5, v4, s[8:11], s83 offen sc1
  s_waitcnt vmcnt(0)
  s_cmp_lg_u32 s3, 0
  s_cbranch_scc1 Lokf_8
  v_cmp_ne_u32 vcc, 1, v5
  s_nop 0
  s_and_b64 vcc, vcc, s[20:21]
  s_cbranch_scc0 Lokf_8
  s_mov_b32 s84, 0x80000
Lspf_8:
  s_sub_u32 s84, s84, 1
  s_cbranch_scc1 Lokf_8
  s_sleep 1
  buffer_load_dword v5, v4, s[8:11], s83 offen sc1
  s_waitcnt vmcnt(0)
  v_cmp_ne_u32 vcc, 1, v5
  s_nop 0
  s_and_b64 vcc, vcc, s[20:21]
  s_cbranch_scc1 Lspf_8
Lokf_8:
  s_barrier
  buffer_load_dwordx4 v[128:131], v1, s[8:11], s16 offen offset:0 sc1
  buffer_load_dwordx4 v[132:135], v1, s[8:11], s17 offen offset:0 sc1
  buffer_load_dwordx4 v[136:139], v1, s[8:11], s18 offen offset:0 sc1
  buffer_load_dwordx4 v[140:143], v1, s[8:11], s19 offen offset:0 sc1
  buffer_load_dwordx4 v[144:147], v1, s[8:11], s16 offen offset:1024 sc1
  buffer_load_dwordx4 v[148:151], v1, s[8:11], s17 offen offset:1024 sc1
  buffer_load_dwordx4 v[152:155], v1, s[8:11], s18 offen offset:1024 sc1
  buffer_load_dwordx4 v[156:159], v1, s[8:11], s19 offen offset:1024 sc1
  buffer_load_dwordx4 v[160:163], v1, s[8:11], s16 offen offset:2048 sc1
  buffer_load_dwordx4 v[164:167], v1, s[8:11], s17 offen offset:2048 sc1
  buffer_load_dwordx4 v[168:171], v1, s[8:11], s18 offen offset:2048 sc1
  buffer_load_dwordx4 v[172:175], v1, s[8:11], s19 offen offset:2048 sc1
  buffer_load_dwordx4 v[176:179], v1, s[8:11], s16 offen offset:3072 sc1
  s_add_u32 s16, s16, 4096
  buffer_load_dwordx4 v[180:183], v1, s[8:11], s17 offen offset:3072 sc1
  s_add_u32 s17, s17, 4096
  buffer_load_dwordx4 v[184:187], v1, s[8:11], s18 offen offset:3072 sc1
  s_add_u32 s18, s18, 4096
  buffer_load_dwordx4 v[188:191], v1, s[8:11], s19 offen offset:3072 sc1
  s_add_u32 s19, s19, 4096
  s_waitcnt vmcnt(12)
  v_mfma_f32_16x16x32_bf16 v[64:67], a[192:195], v[128:131], 0
  buffer_load_dwordx4 v[192:195], v1, s[8:11], s16 offen offset:0 sc1
  v_mfma_f32_16x16x32_bf16 v[68:71], a[192:195], v[132:135], 0
  v_mfma_f32_16x16x32_bf16 v[72:75], a[192:195], v[136:139], 0
  v_mfma_f32_16x16x32_bf16 v[76:79], a[192:195], v[140:143], 0
  v_mfma_f32_16x16x32_bf16 v[80:83], a[196:199], v[128:131], 0
  buffer_load_dwordx4 v[196:199], v1, s[8:11], s17 offen offset:0 sc1
  v_mfma_f32_16x16x32_bf16 v[84:87], a[196:199], v[132:135], 0
  v_mfma_f32_16x16x32_bf16 v[88:91], a[196:199], v[136:139], 0
  v_mfma_f32_16x16x32_bf16 v[92:95], a[196:199], v[140:143], 0
  v_mfma_f32_16x16x32_bf16 v[96:99], a[200:203], v[128:131], 0
  buffer_load_dwordx4 v[200:203], v1, s[8:11], s18 offen offset:0 sc1
  v_mfma_f32_16x16x32_bf16 v[100:103], a[200:203], v[132:135], 0
  v_mfma_f32_16x16x32_bf16 v[104:107], a[200:203], v[136:139], 0
  v_mfma_f32_16x16x32_bf16 v[108:111], a[200:203], v[140:143], 0
  v_mfma_f32_16x16x32_bf16 v[112:115], a[204:207], v[128:131], 0
  buffer_load_dwordx4 v[204:207], v1, s[8:11], s19 offen offset:0 sc1
  v_mfma_f32_16x16x32_bf16 v[116:119], a[204:207], v[132:135], 0
  v_mfma_f32_16x16x32_bf16 v[120:123], a[204:207], v[136:139], 0
  v_mfma_f32_16x16x32_bf16 v[124:127], a[204:207], v[140:143], 0
  s_waitcnt vmcnt(12)
  v_mfma_f32_16x16x32_bf16 v[64:67], a[208:211], v[144:147], v[64:67]
  buffer_load_dwordx4 v[208:211], v1, s[8:11], s16 offen offset:1024 sc1
  v_mfma_f32_16x16x32_bf16 v[68:71], a[208:211], v[148:151], v[68:71]
  v_mfma_f32_16x16x32_bf16 v[72:75], a[208:211], v[152:155], v[72:75]
  v_mfma_f32_16x16x32_bf16 v[76:79], a[208:211], v[156:159], v[76:79]
  v_mfma_f32_16x16x32_bf16 v[80:83], a[212:215], v[144:147], v[80:83]
  buffer_load_dwordx4 v[212:215], v1, s[8:11], s17 offen offset:1024 sc1
  v_mfma_f32_16x16x32_bf16 v[84:87], a[212:215], v[148:151], v[84:87]
  v_mfma_f32_16x16x32_bf16 v[88:91], a[212:215], v[152:155], v[88:91]
  v_mfma_f32_16x16x32_bf16 v[92:95], a[212:215], v[156:159], v[92:95]
  v_mfma_f32_16x16x32_bf16 v[96:99], a[216:219], v[144:147], v[96:99]
  buffer_load_dwordx4 v[216:219], v1, s[8:11], s18 offen offset:1024 sc1
  v_mfma_f32_16x16x32_bf16 v[100:103], a[216:219], v[148:151], v[100:103]
  v_mfma_f32_16x16x32_bf16 v[104:107], a[216:219], v[152:155], v[104:107]
  v_mfma_f32_16x16x32_bf16 v[108:111], a[216:219], v[156:159], v[108:111]
  v_mfma_f32_16x16x32_bf16 v[112:115], a[220:223], v[144:147], v[112:115]
  buffer_load_dwordx4 v[220:223], v1, s[8:11], s19 offen offset:1024 sc1
  v_mfma_f32_16x16x32_bf16 v[116:119], a[220:223], v[148:151], v[116:119]
  v_mfma_f32_16x16x32_bf16 v[120:123], a[220:223], v[152:155], v[120:123]
  v_mfma_f32_16x16x32_bf16 v[124:127], a[220:223], v[156:159], v[124:127]
  s_waitcnt vmcnt(12)
  v_mfma_f32_16x16x32_bf16 v[64:67], a[224:227], v[160:163], v[64:67]
  buffer_load_dwordx4 v[224:227], v1, s[8:11], s16 offen offset:2048 sc1
  v_mfma_f32_16x16x32_bf16 v[68:71], a[224:227], v[164:167], v[68:71]
  v_mfma_f32_16x16x32_bf16 v[72:75], a[224:227], v[168:171], v[72:75]
  v_mfma_f32_16x16x32_bf16 v[76:79], a[224:227], v[172:175], v[76:79]
  v_mfma_f32_16x16x32_bf16 v[80:83], a[228:231], v[160:163], v[80:83]
  buffer_load_dwordx4 v[228:231], v1, s[8:11], s17 offen offset:2048 sc1
  v_mfma_f32_16x16x32_bf16 v[84:87], a[228:231], v[164:167], v[84:87]
  v_mfma_f32_16x16x32_bf16 v[88:91], a[228:231], v[168:171], v[88:91]
  v_mfma_f32_16x16x32_bf16 v[92:95], a[228:231], v[172:175], v[92:95]
  v_mfma_f32_16x16x32_bf16 v[96:99], a[232:235], v[160:163], v[96:99]
  buffer_load_dwordx4 v[232:235], v1, s[8:11], s18 offen offset:2048 sc1
  v_mfma_f32_16x16x32_bf16 v[100:103], a[232:235], v[164:167], v[100:103]
  v_mfma_f32_16x16x32_bf16 v[104:107], a[232:235], v[168:171], v[104:107]
  v_mfma_f32_16x16x32_bf16 v[108:111], a[232:235], v[172:175], v[108:111]
  v_mfma_f32_16x16x32_bf16 v[112:115], a[236:239], v[160:163], v[112:115]
  buffer_load_dwordx4 v[236:239], v1, s[8:11], s19 offen offset:2048 sc1
  v_mfma_f32_16x16x32_bf16 v[116:119], a[236:239], v[164:167], v[116:119]
  v_mfma_f32_16x16x32_bf16 v[120:123], a[236:239], v[168:171], v[120:123]
  v_mfma_f32_16x16x32_bf16 v[124:127], a[236:239], v[172:175], v[124:127]
  s_waitcnt vmcnt(12)
  v_mfma_f32_16x16x32_bf16 v[64:67], a[240:243], v[176:179], v[64:67]
  buffer_load_dwordx4 v[128:131], v1, s[8:11], s16 offen offset:3072 sc1
  s_add_u32 s16, s16, 4096
  v_mfma_f32_16x16x32_bf16 v[68:71], a[240:243], v[180:183], v[68:71]
  v_mfma_f32_16x16x32_bf16 v[72:75], a[240:243], v[184:187], v[72:75]
  v_mfma_f32_16x16x32_bf16 v[76:79], a[240:243], v[188:191], v[76:79]
  v_mfma_f32_16x16x32_bf16 v[80:83], a[244:247], v[176:179], v[80:83]
  buffer_load_dwordx4 v[132:135], v1, s[8:11], s17 offen offset:3072 sc1
  s_add_u32 s17, s17, 4096
  v_mfma_f32_16x16x32_bf16 v[84:87], a[244:247], v[180:183], v[84:87]
  v_mfma_f32_16x16x32_bf16 v[88:91], a[244:247], v[184:187], v[88:91]
  v_mfma_f32_16x16x32_bf16 v[92:95], a[244:247], v[188:191], v[92:95]
  v_mfma_f32_16x16x32_bf16 v[96:99], a[248:251], v[176:179], v[96:99]
  buffer_load_dwordx4 v[136:139], v1, s[8:11], s18 offen offset:3072 sc1
  s_add_u32 s18, s18, 4096
  v_mfma_f32_16x16x32_bf16 v[100:103], a[248:251], v[180:183], v[100:103]
  v_mfma_f32_16x16x32_bf16 v[104:107], a[248:251], v[184:187], v[104:107]
  v_mfma_f32_16x16x32_bf16 v[108:111], a[248:251], v[188:191], v[108:111]
  v_mfma_f32_16x16x32_bf16 v[112:115], a[252:255], v[176:179], v[112:115]
  buffer_load_dwordx4 v[140:143], v1, s[8:11], s19 offen offset:3072 sc1
  s_add_u32 s19, s19, 4096
  v_mfma_f32_16x16x32_bf16 v[116:119], a[252:255], v[180:183], v[116:119]
  v_mfma_f32_16x16x32_bf16 v[120:123], a[252:255], v[184:187], v[120:123]
  v_mfma_f32_16x16x32_bf16 v[124:127], a[252:255], v[188:191], v[124:127]
  s_waitcnt vmcnt(12)
  v_mfma_f32_16x16x32_bf16 v[64:67], a[128:131], v[192:195], v[64:67]
  buffer_load_dwordx4 v[144:147], v1, s[8:11], s16 offen offset:0 sc1
  v_mfma_f32_16x16x32_bf16 v[68:71], a[128:131], v[196:199], v[68:71]
  v_mfma_f32_16x16x32_bf16 v[72:75], a[128:131], v[200:203], v[72:75]
  v_mfma_f32_16x16x32_bf16 v[76:79], a[128:131], v[204:207], v[76:79]
  v_mfma_f32_16x16x32_bf16 v[80:83], a[132:135], v[192:195], v[80:83]
  buffer_load_dwordx4 v[148:151], v1, s[8:11], s17 offen offset:0 sc1
  v_mfma_f32_16x16x32_bf16 v[84:87], a[132:135], v[196:199], v[84:87]
  v_mfma_f32_16x16x32_bf16 v[88:91], a[132:135], v[200:203], v[88:91]
  v_mfma_f32_16x16x32_bf16 v[92:95], a[132:135], v[204:207], v[92:95]
  v_mfma_f32_16x16x32_bf16 v[96:99], a[136:139], v[192:195], v[96:99]
  buffer_load_dwordx4 v[152:155], v1, s[8:11], s18 offen offset:0 sc1
  v_mfma_f32_16x16x32_bf16 v[100:103], a[136:139], v[196:199], v[100:103]
  v_mfma_f32_16x16x32_bf16 v[104:107], a[136:139], v[200:203], v[104:107]
  v_mfma_f32_16x16x32_bf16 v[108:111], a[136:139], v[204:207], v[108:111]
  v_mfma_f32_16x16x32_bf16 v[112:115], a[140:143], v[192:195], v[112:115]
  buffer_load_dwordx4 v[156:159], v1, s[8:11], s19 offen offset:0 sc1
  v_mfma_f32_16x16x32_bf16 v[116:119], a[140:143], v[196:199], v[116:119]
  v_mfma_f32_16x16x32_bf16 v[120:123], a[140:143], v[200:203], v[120:123]
  v_mfma_f32_16x16x32_bf16 v[124:127], a[140:143], v[204:207], v[124:127]
  s_waitcnt vmcnt(12)
  v_mfma_f32_16x16x32_bf16 v[64:67], a[144:147], v[208:211], v[64:67]
  buffer_load_dwordx4 v[160:163], v1, s[8:11], s16 offen offset:1024 sc1
  v_mfma_f32_16x16x32_bf16 v[68:71], a[144:147], v[212:215], v[68:71]
  v_mfma_f32_16x16x32_bf16 v[72:75], a[144:147], v[216:219], v[72:75]
  v_mfma_f32_16x16x32_bf16 v[76:79], a[144:147], v[220:223], v[76:79]
  v_mfma_f32_16x16x32_bf16 v[80:83], a[148:151], v[208:211], v[80:83]
  buffer_load_dwordx4 v[164:167], v1, s[8:11], s17 offen offset:1024 sc1
  v_mfma_f32_16x16x32_bf16 v[84:87], a[148:151], v[212:215], v[84:87]
  v_mfma_f32_16x16x32_bf16 v[88:91], a[148:151], v[216:219], v[88:91]
  v_mfma_f32_16x16x32_bf16 v[92:95], a[148:151], v[220:223], v[92:95]
  v_mfma_f32_16x16x32_bf16 v[96:99], a[152:155], v[208:211], v[96:99]
  buffer_load_dwordx4 v[168:171], v1, s[8:11], s18 offen offset:1024 sc1
  v_mfma_f32_16x16x32_bf16 v[100:103], a[152:155], v[212:215], v[100:103]
  v_mfma_f32_16x16x32_bf16 v[104:107], a[152:155], v[216:219], v[104:107]
  v_mfma_f32_16x16x32_bf16 v[108:111], a[152:155], v[220:223], v[108:111]
  v_mfma_f32_16x16x32_bf16 v[112:115], a[156:159], v[208:211], v[112:115]
  buffer_load_dwordx4 v[172:175], v1, s[8:11], s19 offen offset:1024 sc1
  v_mfma_f32_16x16x32_bf16 v[116:119], a[156:159], v[212:215], v[116:119]
  v_mfma_f32_16x16x32_bf16 v[120:123], a[156:159], v[216:219], v[120:123]
  v_mfma_f32_16x16x32_bf16 v[124:127], a[156:159], v[220:223], v[124:127]
  s_waitcnt vmcnt(12)
  v_mfma_f32_16x16x32_bf16 v[64:67], a[160:163], v[224:227], v[64:67]
  buffer_load_dwordx4 v[176:179], v1, s[8:11], s16 offen offset:2048 sc1
  v_mfma_f32_16x16x32_bf16 v[68:71], a[160:163], v[228:231], v[68:71]
  v_mfma_f32_16x16x32_bf16 v[72:75], a[160:163], v[232:235], v[72:75]
  v_mfma_f32_16x16x32_bf16 v[76:79], a[160:163], v[236:239], v[76:79]
  v_mfma_f32_16x16x32_bf16 v[80:83], a[164:167], v[224:227], v[80:83]
  buffer_load_dwordx4 v[180:183], v1, s[8:11], s17 offen offset:2048 sc1
  v_mfma_f32_16x16x32_bf16 v[84:87], a[164:167], v[228:231], v[84:87]
  v_mfma_f32_16x16x32_bf16 v[88:91], a[164:167], v[232:235], v[88:91]
  v_mfma_f32_16x16x32_bf16 v[92:95], a[164:167], v[236:239], v[92:95]
  v_mfma_f32_16x16x32_bf16 v[96:99], a[168:171], v[224:227], v[96:99]
  buffer_load_dwordx4 v[184:187], v1, s[8:11], s18 offen offset:2048 sc1
  v_mfma_f32_16x16x32_bf16 v[100:103], a[168:171], v[228:231], v[100:103]
  v_mfma_f32_16x16x32_bf16 v[104:107], a[168:171], v[232:235], v[104:107]
  v_mfma_f32_16x16x32_bf16 v[108:111], a[168:171], v[236:239], v[108:111]
  v_mfma_f32_16x16x32_bf16 v[112:115], a[172:175], v[224:227], v[112:115]
  buffer_load_dwordx4 v[188:191], v1, s[8:11], s19 offen offset:2048 sc1
  v_mfma_f32_16x16x32_bf16 v[116:119], a[172:175], v[228:231], v[116:119]
  v_mfma_f32_16x16x32_bf16 v[120:123], a[172:175], v[232:235], v[120:123]
  v_mfma_f32_16x16x32_bf16 v[124:127], a[172:175], v[236:239], v[124:127]
  s_waitcnt vmcnt(12)
  v_mfma_f32_16x16x32_bf16 v[64:67], a[176:179], v[128:131], v[64:67]
  buffer_load_dwordx4 v[192:195], v1, s[8:11], s16 offen offset:3072 sc1
  s_add_u32 s16, s16, 4096
  v_mfma_f32_16x16x32_bf16 v[68:71], a[176:179], v[132:135], v[68:71]
  v_mfma_f32_16x16x32_bf16 v[72:75], a[176:179], v[136:139], v[72:75]
  v_mfma_f32_16x16x32_bf16 v[76:79], a[176:179], v[140:143], v[76:79]
  v_mfma_f32_16x16x32_bf16 v[80:83], a[180:183], v[128:131], v[80:83]
  buffer_load_dwordx4 v[196:199], v1, s[8:11], s17 offen offset:3072 sc1
  s_add_u32 s17, s17, 4096
  v_mfma_f32_16x16x32_bf16 v[84:87], a[180:183], v[132:135], v[84:87]
  v_mfma_f32_16x16x32_bf16 v[88:91], a[180:183], v[136:139], v[88:91]
  v_mfma_f32_16x16x32_bf16 v[92:95], a[180:183], v[140:143], v[92:95]
  v_mfma_f32_16x16x32_bf16 v[96:99], a[184:187], v[128:131], v[96:99]
  buffer_load_dwordx4 v[200:203], v1, s[8:11], s18 offen offset:3072 sc1
  s_add_u32 s18, s18, 4096
  v_mfma_f32_16x16x32_bf16 v[100:103], a[184:187], v[132:135], v[100:103]
  v_mfma_f32_16x16x32_bf16 v[104:107], a[184:187], v[136:139], v[104:107]
  v_mfma_f32_16x16x32_bf16 v[108:111], a[184:187], v[140:143], v[108:111]
  v_mfma_f32_16x16x32_bf16 v[112:115], a[188:191], v[128:131], v[112:115]
  buffer_load_dwordx4 v[204:207], v1, s[8:11], s19 offen offset:3072 sc1
  s_add_u32 s19, s19, 4096
  v_mfma_f32_16x16x32_bf16 v[116:119], a[188:191], v[132:135], v[116:119]
  v_mfma_f32_16x16x32_bf16 v[120:123], a[188:191], v[136:139], v[120:123]
  v_mfma_f32_16x16x32_bf16 v[124:127], a[188:191], v[140:143], v[124:127]
  s_waitcnt vmcnt(12)
  v_mfma_f32_16x16x32_bf16 v[64:67], a[8:11], v[144:147], v[64:67]
  buffer_load_dwordx4 v[208:211], v1, s[8:11], s16 offen offset:0 sc1
  v_mfma_f32_16x16x32_bf16 v[68:71], a[8:11], v[148:151], v[68:71]
  v_mfma_f32_16x16x32_bf16 v[72:75], a[8:11], v[152:155], v[72:75]
  v_mfma_f32_16x16x32_bf16 v[76:79], a[8:11], v[156:159], v[76:79]
  v_mfma_f32_16x16x32_bf16 v[80:83], a[12:15], v[144:147], v[80:83]
  buffer_load_dwordx4 v[212:215], v1, s[8:11], s17 offen offset:0 sc1
  v_mfma_f32_16x16x32_bf16 v[84:87], a[12:15], v[148:151], v[84:87]
  v_mfma_f32_16x16x32_bf16 v[88:91], a[12:15], v[152:155], v[88:91]
  v_mfma_f32_16x16x32_bf16 v[92:95], a[12:15], v[156:159], v[92:95]
  v_mfma_f32_16x16x32_bf16 v[96:99], a[24:27], v[144:147], v[96:99]
  buffer_load_dwordx4 v[216:219], v1, s[8:11], s18 offen offset:0 sc1
  v_mfma_f32_16x16x32_bf16 v[100:103], a[24:27], v[148:151], v[100:103]
  v_mfma_f32_16x16x32_bf16 v[104:107], a[24:27], v[152:155], v[104:107]
  v_mfma_f32_16x16x32_bf16 v[108:111], a[24:27], v[156:159], v[108:111]
  v_mfma_f32_16x16x32_bf16 v[112:115], a[28:31], v[144:147], v[112:115]
  buffer_load_dwordx4 v[220:223], v1, s[8:11], s19 offen offset:0 sc1
  v_mfma_f32_16x16x32_bf16 v[116:119], a[28:31], v[148:151], v[116:119]
  v_mfma_f32_16x16x32_bf16 v[120:123], a[28:31], v[152:155], v[120:123]
  v_mfma_f32_16x16x32_bf16 v[124:127], a[28:31], v[156:159], v[124:127]
  s_waitcnt vmcnt(12)
  v_mfma_f32_16x16x32_bf16 v[64:67], a[40:43], v[160:163], v[64:67]
  buffer_load_dwordx4 v[224:227], v1, s[8:11], s16 offen offset:1024 sc1
  v_mfma_f32_16x16x32_bf16 v[68:71], a[40:43], v[164:167], v[68:71]
  v_mfma_f32_16x16x32_bf16 v[72:75], a[40:43], v[168:171], v[72:75]
  v_mfma_f32_16x16x32_bf16 v[76:79], a[40:43], v[172:175], v[76:79]
  v_mfma_f32_16x16x32_bf16 v[80:83], a[44:47], v[160:163], v[80:83]
  buffer_load_dwordx4 v[228:231], v1, s[8:11], s17 offen offset:1024 sc1
  v_mfma_f32_16x16x32_bf16 v[84:87], a[44:47], v[164:167], v[84:87]
  v_mfma_f32_16x16x32_bf16 v[88:91], a[44:47], v[168:171], v[88:91]
  v_mfma_f32_16x16x32_bf16 v[92:95], a[44:47], v[172:175], v[92:95]
  v_mfma_f32_16x16x32_bf16 v[96:99], a[56:59], v[160:163], v[96:99]
  buffer_load_dwordx4 v[232:235], v1, s[8:11], s18 offen offset:1024 sc1
  v_mfma_f32_16x16x32_bf16 v[100:103], a[56:59], v[164:167], v[100:103]
  v_mfma_f32_16x16x32_bf16 v[104:107], a[56:59], v[168:171], v[104:107]
  v_mfma_f32_16x16x32_bf16 v[108:111], a[56:59], v[172:175], v[108:111]
  v_mfma_f32_16x16x32_bf16 v[112:115], a[60:63], v[160:163], v[112:115]
  buffer_load_dwordx4 v[236:239], v1, s[8:11], s19 offen offset:1024 sc1
  v_mfma_f32_16x16x32_bf16 v[116:119], a[60:63], v[164:167], v[116:119]
  v_mfma_f32_16x16x32_bf16 v[120:123], a[60:63], v[168:171], v[120:123]
  v_mfma_f32_16x16x32_bf16 v[124:127], a[60:63], v[172:175], v[124:127]
  s_waitcnt vmcnt(12)
  v_mfma_f32_16x16x32_bf16 v[64:67], a[72:75], v[176:179], v[64:67]
  v_mfma_f32_16x16x32_bf16 v[68:71], a[72:75], v[180:183], v[68:71]
  v_mfma_f32_16x16x32_bf16 v[72:75], a[72:75], v[184:187], v[72:75]
  v_mfma_f32_16x16x32_bf16 v[76:79], a[72:75], v[188:191], v[76:79]
  v_mfma_f32_16x16x32_bf16 v[80:83], a[76:79], v[176:179], v[80:83]
  v_mfma_f32_16x16x32_bf16 v[84:87], a[76:79], v[180:183], v[84:87]
  v_mfma_f32_16x16x32_bf16 v[88:91], a[76:79], v[184:187], v[88:91]
  v_mfma_f32_16x16x32_bf16 v[92:95], a[76:79], v[188:191], v[92:95]
  v_mfma_f32_16x16x32_bf16 v[96:99], a[88:91], v[176:179], v[96:99]
  v_mfma_f32_16x16x32_bf16 v[100:103], a[88:91], v[180:183], v[100:103]
  v_mfma_f32_16x16x32_bf16 v[104:107], a[88:91], v[184:187], v[104:107]
  v_mfma_f32_16x16x32_bf16 v[108:111], a[88:91], v[188:191], v[108:111]
  v_mfma_f32_16x16x32_bf16 v[112:115], a[92:95], v[176:179], v[112:115]
  v_mfma_f32_16x16x32_bf16 v[116:119], a[92:95], v[180:183], v[116:119]
  v_mfma_f32_16x16x32_bf16 v[120:123], a[92:95], v[184:187], v[120:123]
  v_mfma_f32_16x16x32_bf16 v[124:127], a[92:95], v[188:191], v[124:127]
  s_waitcnt vmcnt(8)
  v_mfma_f32_16x16x32_bf16 v[64:67], a[104:107], v[192:195], v[64:67]
  s_add_u32 s76, s3, 0
  s_and_b32 s76, s76, 3
  s_mul_i32 s76, s76, 12288
  s_add_u32 s76, s76, 114688
  v_add_u32 v6, s76, v1
  v_mfma_f32_16x16x32_bf16 v[68:71], a[104:107], v[196:199], v[68:71]
  v_mfma_f32_16x16x32_bf16 v[72:75], a[104:107], v[200:203], v[72:75]
  v_mfma_f32_16x16x32_bf16 v[76:79], a[104:107], v[204:207], v[76:79]
  v_mfma_f32_16x16x32_bf16 v[80:83], a[108:111], v[192:195], v[80:83]
  s_add_u32 s76, s3, 1
  s_and_b32 s76, s76, 3
  s_mul_i32 s76, s76, 12288
  s_add_u32 s76, s76, 114688
  v_add_u32 v4, s76, v1
  v_mfma_f32_16x16x32_bf16 v[84:87], a[108:111], v[196:199], v[84:87]
  v_mfma_f32_16x16x32_bf16 v[88:91], a[108:111], v[200:203], v[88:91]
  v_mfma_f32_16x16x32_bf16 v[92:95], a[108:111], v[204:207], v[92:95]
  v_mfma_f32_16x16x32_bf16 v[96:99], a[120:123], v[192:195], v[96:99]
  s_add_u32 s76, s3, 2
  s_and_b32 s76, s76, 3
  s_mul_i32 s76, s76, 12288
  s_add_u32 s76, s76, 114688
  v_add_u32 v5, s76, v1
  v_mfma_f32_16x16x32_bf16 v[100:103], a[120:123], v[196:199], v[100:103]
  v_mfma_f32_16x16x32_bf16 v[104:107], a[120:123], v[200:203], v[104:107]
  v_mfma_f32_16x16x32_bf16 v[108:111], a[120:123], v[204:207], v[108:111]
  v_mfma_f32_16x16x32_bf16 v[112:115], a[124:127], v[192:195], v[112:115]
  s_add_u32 s76, s3, 3
  s_and_b32 s76, s76, 3
  s_mul_i32 s76, s76, 12288
  s_add_u32 s76, s76, 114688
  v_add_u32 v7, s76, v1
  v_mfma_f32_16x16x32_bf16 v[116:119], a[124:127], v[196:199], v[116:119]
  v_mfma_f32_16x16x32_bf16 v[120:123], a[124:127], v[200:203], v[120:123]
  v_mfma_f32_16x16x32_bf16 v[124:127], a[124:127], v[204:207], v[124:127]
  s_waitcnt vmcnt(4)
  v_mfma_f32_16x16x32_bf16 v[64:67], a[0:3], v[208:211], v[64:67]
  v_mfma_f32_16x16x32_bf16 v[68:71], a[0:3], v[212:215], v[68:71]
  v_mfma_f32_16x16x32_bf16 v[72:75], a[0:3], v[216:219], v[72:75]
  v_mfma_f32_16x16x32_bf16 v[76:79], a[0:3], v[220:223], v[76:79]
  v_mfma_f32_16x16x32_bf16 v[80:83], a[4:7], v[208:211], v[80:83]
  v_mfma_f32_16x16x32_bf16 v[84:87], a[4:7], v[212:215], v[84:87]
  v_mfma_f32_16x16x32_bf16 v[88:91], a[4:7], v[216:219], v[88:91]
  v_mfma_f32_16x16x32_bf16 v[92:95], a[4:7], v[220:223], v[92:95]
  v_mfma_f32_16x16x32_bf16 v[96:99], a[16:19], v[208:211], v[96:99]
  v_mfma_f32_16x16x32_bf16 v[100:103], a[16:19], v[212:215], v[100:103]
  v_mfma_f32_16x16x32_bf16 v[104:107], a[16:19], v[216:219], v[104:107]
  v_mfma_f32_16x16x32_bf16 v[108:111], a[16:19], v[220:223], v[108:111]
  v_mfma_f32_16x16x32_bf16 v[112:115], a[20:23], v[208:211], v[112:115]
  v_mfma_f32_16x16x32_bf16 v[116:119], a[20:23], v[212:215], v[116:119]
  v_mfma_f32_16x16x32_bf16 v[120:123], a[20:23], v[216:219], v[120:123]
  v_mfma_f32_16x16x32_bf16 v[124:127], a[20:23], v[220:223], v[124:127]
  s_waitcnt vmcnt(0)
  v_mfma_f32_16x16x32_bf16 v[64:67], a[32:35], v[224:227], v[64:67]
  v_mfma_f32_16x16x32_bf16 v[68:71], a[32:35], v[228:231], v[68:71]
  v_mfma_f32_16x16x32_bf16 v[72:75], a[32:35], v[232:235], v[72:75]
  v_mfma_f32_16x16x32_bf16 v[76:79], a[32:35], v[236:239], v[76:79]
  v_mfma_f32_16x16x32_bf16 v[80:83], a[36:39], v[224:227], v[80:83]
  v_mfma_f32_16x16x32_bf16 v[84:87], a[36:39], v[228:231], v[84:87]
  v_mfma_f32_16x16x32_bf16 v[88:91], a[36:39], v[232:235], v[88:91]
  v_mfma_f32_16x16x32_bf16 v[92:95], a[36:39], v[236:239], v[92:95]
  v_mfma_f32_16x16x32_bf16 v[96:99], a[48:51], v[224:227], v[96:99]
  v_mfma_f32_16x16x32_bf16 v[100:103], a[48:51], v[228:231], v[100:103]
  v_mfma_f32_16x16x32_bf16 v[104:107], a[48:51], v[232:235], v[104:107]
  v_mfma_f32_16x16x32_bf16 v[108:111], a[48:51], v[236:239], v[108:111]
  v_mfma_f32_16x16x32_bf16 v[112:115], a[52:55], v[224:227], v[112:115]
  v_mfma_f32_16x16x32_bf16 v[116:119], a[52:55], v[228:231], v[116:119]
  v_mfma_f32_16x16x32_bf16 v[120:123], a[52:55], v[232:235], v[120:123]
  v_mfma_f32_16x16x32_bf16 v[124:127], a[52:55], v[236:239], v[124:127]
  ds_write_b128 v4, v[68:71] offset:0
  ds_write_b128 v4, v[84:87] offset:1024
  ds_write_b128 v4, v[100:103] offset:2048
  s_nop 2
  ds_write_b128 v4, v[116:119] offset:3072
  ds_write_b128 v5, v[72:75] offset:4096
  ds_write_b128 v5, v[88:91] offset:5120
  ds_write_b128 v5, v[104:107] offset:6144
  ds_write_b128 v5, v[120:123] offset:7168
  ds_write_b128 v7, v[76:79] offset:8192
  ds_write_b128 v7, v[92:95] offset:9216
  ds_write_b128 v7, v[108:111] offset:10240
  ds_write_b128 v7, v[124:127] offset:11264
  s_waitcnt lgkmcnt(0)
  s_barrier
  ds_read_b128 v[68:71], v6 offset:0
  ds_read_b128 v[72:75], v6 offset:4096
  ds_read_b128 v[76:79], v6 offset:8192
  ds_read_b128 v[84:87], v6 offset:1024
  ds_read_b128 v[88:91], v6 offset:5120
  ds_read_b128 v[92:95], v6 offset:9216
  ds_read_b128 v[100:103], v6 offset:2048
  ds_read_b128 v[104:107], v6 offset:6144
  ds_read_b128 v[108:111], v6 offset:10240
  ds_read_b128 v[116:119], v6 offset:3072
  ds_read_b128 v[120:123], v6 offset:7168
  ds_read_b128 v[124:127], v6 offset:11264
  s_lshl_b32 s76, s81, 14
  s_lshl_b32 s77, s80, 7
  s_add_u32 s76, s76, s77
  s_waitcnt lgkmcnt(9)
  v_pk_add_f32 v[64:65], v[64:65], v[68:69]
  v_pk_add_f32 v[72:73], v[72:73], v[76:77]
  v_pk_add_f32 v[66:67], v[66:67], v[70:71]
  v_pk_add_f32 v[74:75], v[74:75], v[78:79]
  v_pk_add_f32 v[64:65], v[64:65], v[72:73]
  v_pk_add_f32 v[66:67], v[66:67], v[74:75]
  v_pk_fma_f32 v[40:41], v[64:65], v[16:17], v[40:41]
  v_pk_fma_f32 v[42:43], v[66:67], v[18:19], v[42:43]
  v_cvt_pk_bf16_f32 v56, v40, v41
  v_cvt_pk_bf16_f32 v57, v42, v43
  ds_write_b64 v8, v[56:57] offset:0
  s_waitcnt lgkmcnt(7)
  v_pk_add_f32 v[80:81], v[80:81], v[84:85]
  v_pk_add_f32 v[88:89], v[88:89], v[92:93]
  v_pk_add_f32 v[82:83], v[82:83], v[86:87]
  v_pk_add_f32 v[90:91], v[90:91], v[94:95]
  v_pk_add_f32 v[80:81], v[80:81], v[88:89]
  v_pk_add_f32 v[82:83], v[82:83], v[90:91]
  v_pk_fma_f32 v[44:45], v[80:81], v[20:21], v[44:45]
  v_pk_fma_f32 v[46:47], v[82:83], v[22:23], v[46:47]
  v_cvt_pk_bf16_f32 v58, v44, v45
  v_cvt_pk_bf16_f32 v59, v46, v47
  ds_write_b64 v8, v[58:59] offset:32
  s_waitcnt lgkmcnt(5)
  v_pk_add_f32 v[96:97], v[96:97], v[100:101]
  v_pk_add_f32 v[104:105], v[104:105], v[108:109]
  v_pk_add_f32 v[98:99], v[98:99], v[102:103]
  v_pk_add_f32 v[106:107], v[106:107], v[110:111]
  v_pk_add_f32 v[96:97], v[96:97], v[104:105]
  v_pk_add_f32 v[98:99], v[98:99], v[106:107]
  v_pk_fma_f32 v[48:49], v[96:97], v[24:25], v[48:49]
  v_pk_fma_f32 v[50:51], v[98:99], v[26:27], v[50:51]
  v_cvt_pk_bf16_f32 v60, v48, v49
  v_cvt_pk_bf16_f32 v61, v50, v51
  ds_write_b64 v8, v[60:61] offset:64
  s_waitcnt lgkmcnt(3)
  v_pk_add_f32 v[112:113], v[112:113], v[116:117]
  v_pk_add_f32 v[120:121], v[120:121], v[124:125]
  v_pk_add_f32 v[114:115], v[114:115], v[118:119]
  v_pk_add_f32 v[122:123], v[122:123], v[126:127]
  v_pk_add_f32 v[112:113], v[112:113], v[120:121]
  v_pk_add_f32 v[114:115], v[114:115], v[122:123]
  v_pk_fma_f32 v[52:53], v[112:113], v[28:29], v[52:53]
  v_pk_fma_f32 v[54:55], v[114:115], v[30:31], v[54:55]
  v_cvt_pk_bf16_f32 v62, v52, v53
  v_cvt_pk_bf16_f32 v63, v54, v55
  ds_write_b64 v8, v[62:63] offset:96
  s_waitcnt lgkmcnt(0)
  ds_read_b128 v[56:59], v9 offset:0
  ds_read_b128 v[60:63], v9 offset:1152
  s_waitcnt lgkmcnt(1)
  buffer_store_dwordx4 v[56:59], v3, s[12:15], s76 offen sc1
  s_add_u32 s76, s76, 8192
  s_waitcnt lgkmcnt(0)
  buffer_store_dwordx4 v[60:63], v3, s[12:15], s76 offen sc1
  s_add_u32 s76, s76, 8192
Lend_f:
  s_endpgm
Lfallback_f:
  s_waitcnt vmcnt(0)
  s_mov_b32 s0, 0
  v_accvgpr_write_b32 a0, 0
  v_accvgpr_write_b32 a1, 0
  v_accvgpr_write_b32 a2, 0
  v_accvgpr_write_b32 a3, 0
  v_accvgpr_write_b32 a4, 0
  v_accvgpr_write_b32 a5, 0
  v_accvgpr_write_b32 a6, 0
  v_accvgpr_write_b32 a7, 0
  v_accvgpr_write_b32 a8, 0
  v_accvgpr_write_b32 a9, 0
  v_accvgpr_write_b32 a10, 0
  v_accvgpr_write_b32 a11, 0
  v_accvgpr_write_b32 a12, 0
  v_accvgpr_write_b32 a13, 0
  v_accvgpr_write_b32 a14, 0
  v_accvgpr_write_b32 a15, 0
  v_accvgpr_write_b32 a16, 0
  v_accvgpr_write_b32 a17, 0
  v_accvgpr_write_b32 a18, 0
  v_accvgpr_write_b32 a19, 0
  v_accvgpr_write_b32 a20, 0
  v_accvgpr_write_b32 a21, 0
  v_accvgpr_write_b32 a22, 0
  v_accvgpr_write_b32 a23, 0
  v_accvgpr_write_b32 a24, 0
  v_accvgpr_write_b32 a25, 0
  v_accvgpr_write_b32 a26, 0
  v_accvgpr_write_b32 a27, 0
  v_accvgpr_write_b32 a28, 0
  v_accvgpr_write_b32 a29, 0
  v_accvgpr_write_b32 a30, 0
  v_accvgpr_write_b32 a31, 0
  v_accvgpr_write_b32 a32, 0
  v_accvgpr_write_b32 a33, 0
  v_accvgpr_write_b32 a34, 0
  v_accvgpr_write_b32 a35, 0
  v_accvgpr_write_b32 a36, 0
  v_accvgpr_write_b32 a37, 0
  v_accvgpr_write_b32 a38, 0
  v_accvgpr_write_b32 a39, 0
  v_accvgpr_write_b32 a40, 0
  v_accvgpr_write_b32 a41, 0
  v_accvgpr_write_b32 a42, 0
  v_accvgpr_write_b32 a43, 0
  v_accvgpr_write_b32 a44, 0
  v_accvgpr_write_b32 a45, 0
  v_accvgpr_write_b32 a46, 0
  v_accvgpr_write_b32 a47, 0
  v_accvgpr_write_b32 a48, 0
  v_accvgpr_write_b32 a49, 0
  v_accvgpr_write_b32 a50, 0
  v_accvgpr_write_b32 a51, 0
  v_accvgpr_write_b32 a52, 0
  v_accvgpr_write_b32 a53, 0
  v_accvgpr_write_b32 a54, 0
  v_accvgpr_write_b32 a55, 0
  v_accvgpr_write_b32 a56, 0
  v_accvgpr_write_b32 a57, 0
  v_accvgpr_write_b32 a58, 0
  v_accvgpr_write_b32 a59, 0
  v_accvgpr_write_b32 a60, 0
  v_accvgpr_write_b32 a61, 0
  v_accvgpr_write_b32 a62, 0
  v_accvgpr_write_b32 a63, 0
  v_accvgpr_write_b32 a64, 0
  v_accvgpr_write_b32 a65, 0
  v_accvgpr_write_b32 a66, 0
  v_accvgpr_write_b32 a67, 0
  v_accvgpr_write_b32 a68, 0
  v_accvgpr_write_b32 a69, 0
  v_accvgpr_write_b32 a70, 0
  v_accvgpr_write_b32 a71, 0
  v_accvgpr_write_b32 a72, 0
  v_accvgpr_write_b32 a73, 0
  v_accvgpr_write_b32 a74, 0
  v_accvgpr_write_b32 a75, 0
  v_accvgpr_write_b32 a76, 0
  v_accvgpr_write_b32 a77, 0
  v_accvgpr_write_b32 a78, 0
  v_accvgpr_write_b32 a79, 0
  v_accvgpr_write_b32 a80, 0
  v_accvgpr_write_b32 a81, 0
  v_accvgpr_write_b32 a82, 0
  v_accvgpr_write_b32 a83, 0
  v_accvgpr_write_b32 a84, 0
  v_accvgpr_write_b32 a85, 0
  v_accvgpr_write_b32 a86, 0
  v_accvgpr_write_b32 a87, 0
  v_accvgpr_write_b32 a88, 0
  v_accvgpr_write_b32 a89, 0
  v_accvgpr_write_b32 a90, 0
  v_accvgpr_write_b32 a91, 0
  v_accvgpr_write_b32 a92, 0
  v_accvgpr_write_b32 a93, 0
  v_accvgpr_write_b32 a94, 0
  v_accvgpr_write_b32 a95, 0
  v_accvgpr_write_b32 a96, 0
  v_accvgpr_write_b32 a97, 0
  v_accvgpr_write_b32 a98, 0
  v_accvgpr_write_b32 a99, 0
  v_accvgpr_write_b32 a100, 0
  v_accvgpr_write_b32 a101, 0
  v_accvgpr_write_b32 a102, 0
  v_accvgpr_write_b32 a103, 0
  v_accvgpr_write_b32 a104, 0
  v_accvgpr_write_b32 a105, 0
  v_accvgpr_write_b32 a106, 0
  v_accvgpr_write_b32 a107, 0
  v_accvgpr_write_b32 a108, 0
  v_accvgpr_write_b32 a109, 0
  v_accvgpr_write_b32 a110, 0
  v_accvgpr_write_b32 a111, 0
  v_accvgpr_write_b32 a112, 0
  v_accvgpr_write_b32 a113, 0
  v_accvgpr_write_b32 a114, 0
  v_accvgpr_write_b32 a115, 0
  v_accvgpr_write_b32 a116, 0
  v_accvgpr_write_b32 a117, 0
  v_accvgpr_write_b32 a118, 0
  v_accvgpr_write_b32 a119, 0
  v_accvgpr_write_b32 a120, 0
  v_accvgpr_write_b32 a121, 0
  v_accvgpr_write_b32 a122, 0
  v_accvgpr_write_b32 a123, 0
  v_accvgpr_write_b32 a124, 0
  v_accvgpr_write_b32 a125, 0
  v_accvgpr_write_b32 a126, 0
  v_accvgpr_write_b32 a127, 0
  v_mov_b32 v16, 0
  v_mov_b32 v17, 0
  v_mov_b32 v18, 0
  v_mov_b32 v19, 0
  v_mov_b32 v20, 0
  v_mov_b32 v21, 0
  v_mov_b32 v22, 0
  v_mov_b32 v23, 0
  v_mov_b32 v24, 0
  v_mov_b32 v25, 0
  v_mov_b32 v26, 0
  v_mov_b32 v27, 0
  v_mov_b32 v28, 0
  v_mov_b32 v29, 0
  v_mov_b32 v30, 0
  v_mov_b32 v31, 0
  v_mov_b32 v240, 0xff800000
  v_mov_b32 v241, 0xff800000
  v_mov_b32 v242, 0xff800000
  v_mov_b32 v243, 0xff800000
  s_mov_b32 s86, 0
  s_lshr_b32 s87, s14, 14
  v_mov_b32 v2, v1
  v_mov_b32 v3, v1
Lfb_f:
  s_barrier
  s_lshr_b32 s78, s86, 1
  s_lshl_b32 s78, s78, 15
  s_and_b32 s76, s86, 1
  s_lshl_b32 s76, s76, 13
  s_add_u32 s78, s78, s76
  s_lshl_b32 s76, s3, 11
  s_add_u32 s78, s78, s76
  s_mov_b32 m0, s76
  s_add_u32 s76, s76, 16384
  buffer_load_dwordx4 v1, s[12:15], s78 offen sc1 lds
  buffer_load_dwordx4 v1, s[12:15], s78 offen offset:1024 sc1 lds
  s_mov_b32 m0, s76
  s_add_u32 s78, s78, 16384
  buffer_load_dwordx4 v1, s[12:15], s78 offen sc1 lds
  buffer_load_dwordx4 v1, s[12:15], s78 offen offset:1024 sc1 lds
  s_waitcnt vmcnt(0)
  s_barrier
  ds_read_b128 a[128:131], v2 offset:0
  ds_read_b128 a[132:135], v2 offset:1024
  ds_read_b128 a[136:139], v2 offset:2048
  ds_read_b128 a[140:143], v2 offset:3072
  ds_read_b128 a[144:147], v2 offset:4096
  ds_read_b128 a[148:151], v2 offset:5120
  ds_read_b128 a[152:155], v2 offset:6144
  ds_read_b128 a[156:159], v2 offset:7168
  ds_read_b128 a[160:163], v3 offset:16384
  ds_read_b128 a[164:167], v3 offset:17408
  ds_read_b128 a[168:171], v3 offset:18432
  ds_read_b128 a[172:175], v3 offset:19456
  ds_read_b128 a[176:179], v3 offset:20480
  ds_read_b128 a[180:183], v3 offset:21504
  ds_read_b128 a[184:187], v3 offset:22528
  ds_read_b128 a[188:191], v3 offset:23552
  s_waitcnt lgkmcnt(0)
  s_cmp_gt_u32 s86, s89
  s_cbranch_scc1 Lfbs0_f
  v_mov_b32 v192, 0
  v_mov_b32 v193, 0
  v_mov_b32 v194, 0
  v_mov_b32 v195, 0
  v_mov_b32 v196, 0
  v_mov_b32 v197, 0
  v_mov_b32 v198, 0
  v_mov_b32 v199, 0
  v_mov_b32 v200, 0
  v_mov_b32 v201, 0
  v_mov_b32 v202, 0
  v_mov_b32 v203, 0
  v_mov_b32 v204, 0
  v_mov_b32 v205, 0
  v_mov_b32 v206, 0
  v_mov_b32 v207, 0
  s_cmp_lg_u32 s86, s89
  s_cbranch_scc1 Lfbm0_f
  v_cndmask_b32 v192, v255, v192, s[24:25]
  v_cndmask_b32 v204, v255, v204, s[24:25]
  v_mov_b32 v196, v255
  v_cndmask_b32 v193, v255, v193, s[26:27]
  v_cndmask_b32 v205, v255, v205, s[26:27]
  v_mov_b32 v197, v255
  v_cndmask_b32 v194, v255, v194, s[32:33]
  v_cndmask_b32 v206, v255, v206, s[32:33]
  v_mov_b32 v198, v255
  v_cndmask_b32 v195, v255, v195, s[34:35]
  v_cndmask_b32 v207, v255, v207, s[34:35]
  v_mov_b32 v199, v255
Lfbm0_f:
  s_nop 1
  v_mfma_f32_16x16x32_bf16 v[80:83], a[128:131], v[64:67], v[192:195]
  v_mfma_f32_16x16x32_bf16 v[80:83], a[132:135], v[96:99], v[80:83]
  v_mfma_f32_16x16x32_bf16 v[80:83], a[136:139], v[128:131], v[80:83]
  v_mfma_f32_16x16x32_bf16 v[80:83], a[140:143], v[160:163], v[80:83]
  v_mfma_f32_16x16x32_bf16 v[84:87], a[128:131], v[68:71], v[200:203]
  v_mfma_f32_16x16x32_bf16 v[84:87], a[132:135], v[100:103], v[84:87]
  v_mfma_f32_16x16x32_bf16 v[84:87], a[136:139], v[132:135], v[84:87]
  v_mfma_f32_16x16x32_bf16 v[84:87], a[140:143], v[164:167], v[84:87]
  v_mfma_f32_16x16x32_bf16 v[112:115], a[144:147], v[64:67], v[196:199]
  v_mfma_f32_16x16x32_bf16 v[112:115], a[148:151], v[96:99], v[112:115]
  v_mfma_f32_16x16x32_bf16 v[112:115], a[152:155], v[128:131], v[112:115]
  v_mfma_f32_16x16x32_bf16 v[112:115], a[156:159], v[160:163], v[112:115]
  v_mfma_f32_16x16x32_bf16 v[116:119], a[144:147], v[68:71], v[204:207]
  v_mfma_f32_16x16x32_bf16 v[116:119], a[148:151], v[100:103], v[116:119]
  v_mfma_f32_16x16x32_bf16 v[116:119], a[152:155], v[132:135], v[116:119]
  v_mfma_f32_16x16x32_bf16 v[116:119], a[156:159], v[164:167], v[116:119]
  s_nop 7
  v_max3_f32 v224, v80, v81, v82
  v_max3_f32 v224, v224, v83, v112
  v_max3_f32 v224, v224, v113, v114
  v_max3_f32 v224, v224, v115, v240
  v_mov_b32 v225, v224
  s_nop 1
  v_permlane16_swap_b32 v224, v225
  v_max_f32 v224, v224, v225
  v_mov_b32 v225, v224
  s_nop 1
  v_permlane32_swap_b32 v224, v225
  v_max_f32 v224, v224, v225
  v_sub_f32 v225, v240, v224
  v_exp_f32 v225, v225
  v_mov_b32 v240, v224
  v_sub_f32 v80, v80, v224
  v_sub_f32 v81, v81, v224
  v_sub_f32 v82, v82, v224
  v_sub_f32 v83, v83, v224
  v_sub_f32 v112, v112, v224
  v_sub_f32 v113, v113, v224
  v_sub_f32 v114, v114, v224
  v_sub_f32 v115, v115, v224
  v_mul_f32 v16, v225, v16
  v_mul_f32 v17, v225, v17
  v_mul_f32 v18, v225, v18
  v_mul_f32 v19, v225, v19
  v_accvgpr_read_b32 v228, a0
  v_accvgpr_read_b32 v229, a1
  v_accvgpr_read_b32 v230, a2
  v_accvgpr_read_b32 v231, a3
  v_mul_f32 v228, v225, v228
  v_mul_f32 v229, v225, v229
  v_mul_f32 v230, v225, v230
  v_mul_f32 v231, v225, v231
  v_accvgpr_write_b32 a0, v228
  v_accvgpr_write_b32 a1, v229
  v_accvgpr_write_b32 a2, v230
  v_accvgpr_write_b32 a3, v231
  v_accvgpr_read_b32 v228, a16
  v_accvgpr_read_b32 v229, a17
  v_accvgpr_read_b32 v230, a18
  v_accvgpr_read_b32 v231, a19
  v_mul_f32 v228, v225, v228
  v_mul_f32 v229, v225, v229
  v_mul_f32 v230, v225, v230
  v_mul_f32 v231, v225, v231
  v_accvgpr_write_b32 a16, v228
  v_accvgpr_write_b32 a17, v229
  v_accvgpr_write_b32 a18, v230
  v_accvgpr_write_b32 a19, v231
  v_accvgpr_read_b32 v228, a32
  v_accvgpr_read_b32 v229, a33
  v_accvgpr_read_b32 v230, a34
  v_accvgpr_read_b32 v231, a35
  v_mul_f32 v228, v225, v228
  v_mul_f32 v229, v225, v229
  v_mul_f32 v230, v225, v230
  v_mul_f32 v231, v225, v231
  v_accvgpr_write_b32 a32, v228
  v_accvgpr_write_b32 a33, v229
  v_accvgpr_write_b32 a34, v230
  v_accvgpr_write_b32 a35, v231
  v_accvgpr_read_b32 v228, a48
  v_accvgpr_read_b32 v229, a49
  v_accvgpr_read_b32 v230, a50
  v_accvgpr_read_b32 v231, a51
  v_mul_f32 v228, v225, v228
  v_mul_f32 v229, v225, v229
  v_mul_f32 v230, v225, v230
  v_mul_f32 v231, v225, v231
  v_accvgpr_write_b32 a48, v228
  v_accvgpr_write_b32 a49, v229
  v_accvgpr_write_b32 a50, v230
  v_accvgpr_write_b32 a51, v231
  v_accvgpr_read_b32 v228, a64
  v_accvgpr_read_b32 v229, a65
  v_accvgpr_read_b32 v230, a66
  v_accvgpr_read_b32 v231, a67
  v_mul_f32 v228, v225, v228
  v_mul_f32 v229, v225, v229
  v_mul_f32 v230, v225, v230
  v_mul_f32 v231, v225, v231
  v_accvgpr_write_b32 a64, v228
  v_accvgpr_write_b32 a65, v229
  v_accvgpr_write_b32 a66, v230
  v_accvgpr_write_b32 a67, v231
  v_accvgpr_read_b32 v228, a80
  v_accvgpr_read_b32 v229, a81
  v_accvgpr_read_b32 v230, a82
  v_accvgpr_read_b32 v231, a83
  v_mul_f32 v228, v225, v228
  v_mul_f32 v229, v225, v229
  v_mul_f32 v230, v225, v230
  v_mul_f32 v231, v225, v231
  v_accvgpr_write_b32 a80, v228
  v_accvgpr_write_b32 a81, v229
  v_accvgpr_write_b32 a82, v230
  v_accvgpr_write_b32 a83, v231
  v_accvgpr_read_b32 v228, a96
  v_accvgpr_read_b32 v229, a97
  v_accvgpr_read_b32 v230, a98
  v_accvgpr_read_b32 v231, a99
  v_mul_f32 v228, v225, v228
  v_mul_f32 v229, v225, v229
  v_mul_f32 v230, v225, v230
  v_mul_f32 v231, v225, v231
  v_accvgpr_write_b32 a96, v228
  v_accvgpr_write_b32 a97, v229
  v_accvgpr_write_b32 a98, v230
  v_accvgpr_write_b32 a99, v231
  v_accvgpr_read_b32 v228, a112
  v_accvgpr_read_b32 v229, a113
  v_accvgpr_read_b32 v230, a114
  v_accvgpr_read_b32 v231, a115
  v_mul_f32 v228, v225, v228
  v_mul_f32 v229, v225, v229
  v_mul_f32 v230, v225, v230
  v_mul_f32 v231, v225, v231
  v_accvgpr_write_b32 a112, v228
  v_accvgpr_write_b32 a113, v229
  v_accvgpr_write_b32 a114, v230
  v_accvgpr_write_b32 a115, v231
  v_max3_f32 v224, v84, v85, v86
  v_max3_f32 v224, v224, v87, v116
  v_max3_f32 v224, v224, v117, v118
  v_max3_f32 v224, v224, v119, v241
  v_mov_b32 v225, v224
  s_nop 1
  v_permlane16_swap_b32 v224, v225
  v_max_f32 v224, v224, v225
  v_mov_b32 v225, v224
  s_nop 1
  v_permlane32_swap_b32 v224, v225
  v_max_f32 v224, v224, v225
  v_sub_f32 v225, v241, v224
  v_exp_f32 v225, v225
  v_mov_b32 v241, v224
  v_sub_f32 v84, v84, v224
  v_sub_f32 v85, v85, v224
  v_sub_f32 v86, v86, v224
  v_sub_f32 v87, v87, v224
  v_sub_f32 v116, v116, v224
  v_sub_f32 v117, v117, v224
  v_sub_f32 v118, v118, v224
  v_sub_f32 v119, v119, v224
  v_mul_f32 v20, v225, v20
  v_mul_f32 v21, v225, v21
  v_mul_f32 v22, v225, v22
  v_mul_f32 v23, v225, v23
  v_accvgpr_read_b32 v228, a4
  v_accvgpr_read_b32 v229, a5
  v_accvgpr_read_b32 v230, a6
  v_accvgpr_read_b32 v231, a7
  v_mul_f32 v228, v225, v228
  v_mul_f32 v229, v225, v229
  v_mul_f32 v230, v225, v230
  v_mul_f32 v231, v225, v231
  v_accvgpr_write_b32 a4, v228
  v_accvgpr_write_b32 a5, v229
  v_accvgpr_write_b32 a6, v230
  v_accvgpr_write_b32 a7, v231
  v_accvgpr_read_b32 v228, a20
  v_accvgpr_read_b32 v229, a21
  v_accvgpr_read_b32 v230, a22
  v_accvgpr_read_b32 v231, a23
  v_mul_f32 v228, v225, v228
  v_mul_f32 v229, v225, v229
  v_mul_f32 v230, v225, v230
  v_mul_f32 v231, v225, v231
  v_accvgpr_write_b32 a20, v228
  v_accvgpr_write_b32 a21, v229
  v_accvgpr_write_b32 a22, v230
  v_accvgpr_write_b32 a23, v231
  v_accvgpr_read_b32 v228, a36
  v_accvgpr_read_b32 v229, a37
  v_accvgpr_read_b32 v230, a38
  v_accvgpr_read_b32 v231, a39
  v_mul_f32 v228, v225, v228
  v_mul_f32 v229, v225, v229
  v_mul_f32 v230, v225, v230
  v_mul_f32 v231, v225, v231
  v_accvgpr_write_b32 a36, v228
  v_accvgpr_write_b32 a37, v229
  v_accvgpr_write_b32 a38, v230
  v_accvgpr_write_b32 a39, v231
  v_accvgpr_read_b32 v228, a52
  v_accvgpr_read_b32 v229, a53
  v_accvgpr_read_b32 v230, a54
  v_accvgpr_read_b32 v231, a55
  v_mul_f32 v228, v225, v228
  v_mul_f32 v229, v225, v229
  v_mul_f32 v230, v225, v230
  v_mul_f32 v231, v225, v231
  v_accvgpr_write_b32 a52, v228
  v_accvgpr_write_b32 a53, v229
  v_accvgpr_write_b32 a54, v230
  v_accvgpr_write_b32 a55, v231
  v_accvgpr_read_b32 v228, a68
  v_accvgpr_read_b32 v229, a69
  v_accvgpr_read_b32 v230, a70
  v_accvgpr_read_b32 v231, a71
  v_mul_f32 v228, v225, v228
  v_mul_f32 v229, v225, v229
  v_mul_f32 v230, v225, v230
  v_mul_f32 v231, v225, v231
  v_accvgpr_write_b32 a68, v228
  v_accvgpr_write_b32 a69, v229
  v_accvgpr_write_b32 a70, v230
  v_accvgpr_write_b32 a71, v231
  v_accvgpr_read_b32 v228, a84
  v_accvgpr_read_b32 v229, a85
  v_accvgpr_read_b32 v230, a86
  v_accvgpr_read_b32 v231, a87
  v_mul_f32 v228, v225, v228
  v_mul_f32 v229, v225, v229
  v_mul_f32 v230, v225, v230
  v_mul_f32 v231, v225, v231
  v_accvgpr_write_b32 a84, v228
  v_accvgpr_write_b32 a85, v229
  v_accvgpr_write_b32 a86, v230
  v_accvgpr_write_b32 a87, v231
  v_accvgpr_read_b32 v228, a100
  v_accvgpr_read_b32 v229, a101
  v_accvgpr_read_b32 v230, a102
  v_accvgpr_read_b32 v231, a103
  v_mul_f32 v228, v225, v228
  v_mul_f32 v229, v225, v229
  v_mul_f32 v230, v225, v230
  v_mul_f32 v231, v225, v231
  v_accvgpr_write_b32 a100, v228
  v_accvgpr_write_b32 a101, v229
  v_accvgpr_write_b32 a102, v230
  v_accvgpr_write_b32 a103, v231
  v_accvgpr_read_b32 v228, a116
  v_accvgpr_read_b32 v229, a117
  v_accvgpr_read_b32 v230, a118
  v_accvgpr_read_b32 v231, a119
  v_mul_f32 v228, v225, v228
  v_mul_f32 v229, v225, v229
  v_mul_f32 v230, v225, v230
  v_mul_f32 v231, v225, v231
  v_accvgpr_write_b32 a116, v228
  v_accvgpr_write_b32 a117, v229
  v_accvgpr_write_b32 a118, v230
  v_accvgpr_write_b32 a119, v231
  v_exp_f32 v80, v80
  v_exp_f32 v81, v81
  v_exp_f32 v82, v82
  v_exp_f32 v83, v83
  v_exp_f32 v112, v112
  v_exp_f32 v113, v113
  v_exp_f32 v114, v114
  v_exp_f32 v115, v115
  v_exp_f32 v84, v84
  v_exp_f32 v85, v85
  v_exp_f32 v86, v86
  v_exp_f32 v87, v87
  v_exp_f32 v116, v116
  v_exp_f32 v117, v117
  v_exp_f32 v118, v118
  v_exp_f32 v119, v119
  v_cvt_pk_bf16_f32 v32, v80, v81
  v_cvt_pk_bf16_f32 v33, v82, v83
  v_cvt_pk_bf16_f32 v34, v112, v113
  v_cvt_pk_bf16_f32 v35, v114, v115
  v_cvt_pk_bf16_f32 v36, v84, v85
  v_cvt_pk_bf16_f32 v37, v86, v87
  v_cvt_pk_bf16_f32 v38, v116, v117
  v_cvt_pk_bf16_f32 v39, v118, v119
  v_mfma_f32_16x16x32_bf16 a[0:3], a[160:163], v[32:35], a[0:3]
  s_nop 0
  v_mfma_f32_16x16x32_bf16 a[4:7], a[160:163], v[36:39], a[4:7]
  v_mfma_f32_16x16x32_bf16 a[16:19], a[164:167], v[32:35], a[16:19]
  v_mfma_f32_16x16x32_bf16 a[20:23], a[164:167], v[36:39], a[20:23]
  v_mfma_f32_16x16x32_bf16 a[32:35], a[168:171], v[32:35], a[32:35]
  v_mfma_f32_16x16x32_bf16 a[36:39], a[168:171], v[36:39], a[36:39]
  v_mfma_f32_16x16x32_bf16 a[48:51], a[172:175], v[32:35], a[48:51]
  v_mfma_f32_16x16x32_bf16 a[52:55], a[172:175], v[36:39], a[52:55]
  v_mfma_f32_16x16x32_bf16 a[64:67], a[176:179], v[32:35], a[64:67]
  v_mfma_f32_16x16x32_bf16 a[68:71], a[176:179], v[36:39], a[68:71]
  v_mfma_f32_16x16x32_bf16 a[80:83], a[180:183], v[32:35], a[80:83]
  v_mfma_f32_16x16x32_bf16 a[84:87], a[180:183], v[36:39], a[84:87]
  v_mfma_f32_16x16x32_bf16 a[96:99], a[184:187], v[32:35], a[96:99]
  v_mfma_f32_16x16x32_bf16 a[100:103], a[184:187], v[36:39], a[100:103]
  v_mfma_f32_16x16x32_bf16 a[112:115], a[188:191], v[32:35], a[112:115]
  v_mfma_f32_16x16x32_bf16 a[116:119], a[188:191], v[36:39], a[116:119]
  v_mfma_f32_16x16x32_bf16 v[16:19], v[12:15], v[32:35], v[16:19]
  v_mfma_f32_16x16x32_bf16 v[20:23], v[12:15], v[36:39], v[20:23]
  s_nop 7
Lfbs0_f:
  s_cmp_gt_u32 s86, s88
  s_cbranch_scc1 Lfbs1_f
  v_mov_b32 v208, 0
  v_mov_b32 v209, 0
  v_mov_b32 v210, 0
  v_mov_b32 v211, 0
  v_mov_b32 v212, 0
  v_mov_b32 v213, 0
  v_mov_b32 v214, 0
  v_mov_b32 v215, 0
  v_mov_b32 v216, 0
  v_mov_b32 v217, 0
  v_mov_b32 v218, 0
  v_mov_b32 v219, 0
  v_mov_b32 v220, 0
  v_mov_b32 v221, 0
  v_mov_b32 v222, 0
  v_mov_b32 v223, 0
  s_cmp_lg_u32 s86, s88
  s_cbranch_scc1 Lfbm1_f
  v_cndmask_b32 v208, v255, v208, s[24:25]
  v_cndmask_b32 v220, v255, v220, s[24:25]
  v_mov_b32 v212, v255
  v_cndmask_b32 v209, v255, v209, s[26:27]
  v_cndmask_b32 v221, v255, v221, s[26:27]
  v_mov_b32 v213, v255
  v_cndmask_b32 v210, v255, v210, s[32:33]
  v_cndmask_b32 v222, v255, v222, s[32:33]
  v_mov_b32 v214, v255
  v_cndmask_b32 v211, v255, v211, s[34:35]
  v_cndmask_b32 v223, v255, v223, s[34:35]
  v_mov_b32 v215, v255
Lfbm1_f:
  s_nop 1
  v_mfma_f32_16x16x32_bf16 v[88:91], a[128:131], v[72:75], v[208:211]
  v_mfma_f32_16x16x32_bf16 v[88:91], a[132:135], v[104:107], v[88:91]
  v_mfma_f32_16x16x32_bf16 v[88:91], a[136:139], v[136:139], v[88:91]
  v_mfma_f32_16x16x32_bf16 v[88:91], a[140:143], v[168:171], v[88:91]
  v_mfma_f32_16x16x32_bf16 v[92:95], a[128:131], v[76:79], v[216:219]
  v_mfma_f32_16x16x32_bf16 v[92:95], a[132:135], v[108:111], v[92:95]
  v_mfma_f32_16x16x32_bf16 v[92:95], a[136:139], v[140:143], v[92:95]
  v_mfma_f32_16x16x32_bf16 v[92:95], a[140:143], v[172:175], v[92:95]
  v_mfma_f32_16x16x32_bf16 v[120:123], a[144:147], v[72:75], v[212:215]
  v_mfma_f32_16x16x32_bf16 v[120:123], a[148:151], v[104:107], v[120:123]
  v_mfma_f32_16x16x32_bf16 v[120:123], a[152:155], v[136:139], v[120:123]
  v_mfma_f32_16x16x32_bf16 v[120:123], a[156:159], v[168:171], v[120:123]
  v_mfma_f32_16x16x32_bf16 v[124:127], a[144:147], v[76:79], v[220:223]
  v_mfma_f32_16x16x32_bf16 v[124:127], a[148:151], v[108:111], v[124:127]
  v_mfma_f32_16x16x32_bf16 v[124:127], a[152:155], v[140:143], v[124:127]
  v_mfma_f32_16x16x32_bf16 v[124:127], a[156:159], v[172:175], v[124:127]
  s_nop 7
  v_max3_f32 v224, v88, v89, v90
  v_max3_f32 v224, v224, v91, v120
  v_max3_f32 v224, v224, v121, v122
  v_max3_f32 v224, v224, v123, v242
  v_mov_b32 v225, v224
  s_nop 1
  v_permlane16_swap_b32 v224, v225
  v_max_f32 v224, v224, v225
  v_mov_b32 v225, v224
  s_nop 1
  v_permlane32_swap_b32 v224, v225
  v_max_f32 v224, v224, v225
  v_sub_f32 v225, v242, v224
  v_exp_f32 v225, v225
  v_mov_b32 v242, v224
  v_sub_f32 v88, v88, v224
  v_sub_f32 v89, v89, v224
  v_sub_f32 v90, v90, v224
  v_sub_f32 v91, v91, v224
  v_sub_f32 v120, v120, v224
  v_sub_f32 v121, v121, v224
  v_sub_f32 v122, v122, v224
  v_sub_f32 v123, v123, v224
  v_mul_f32 v24, v225, v24
  v_mul_f32 v25, v225, v25
  v_mul_f32 v26, v225, v26
  v_mul_f32 v27, v225, v27
  v_accvgpr_read_b32 v228, a8
  v_accvgpr_read_b32 v229, a9
  v_accvgpr_read_b32 v230, a10
  v_accvgpr_read_b32 v231, a11
  v_mul_f32 v228, v225, v228
  v_mul_f32 v229, v225, v229
  v_mul_f32 v230, v225, v230
  v_mul_f32 v231, v225, v231
  v_accvgpr_write_b32 a8, v228
  v_accvgpr_write_b32 a9, v229
  v_accvgpr_write_b32 a10, v230
  v_accvgpr_write_b32 a11, v231
  v_accvgpr_read_b32 v228, a24
  v_accvgpr_read_b32 v229, a25
  v_accvgpr_read_b32 v230, a26
  v_accvgpr_read_b32 v231, a27
  v_mul_f32 v228, v225, v228
  v_mul_f32 v229, v225, v229
  v_mul_f32 v230, v225, v230
  v_mul_f32 v231, v225, v231
  v_accvgpr_write_b32 a24, v228
  v_accvgpr_write_b32 a25, v229
  v_accvgpr_write_b32 a26, v230
  v_accvgpr_write_b32 a27, v231
  v_accvgpr_read_b32 v228, a40
  v_accvgpr_read_b32 v229, a41
  v_accvgpr_read_b32 v230, a42
  v_accvgpr_read_b32 v231, a43
  v_mul_f32 v228, v225, v228
  v_mul_f32 v229, v225, v229
  v_mul_f32 v230, v225, v230
  v_mul_f32 v231, v225, v231
  v_accvgpr_write_b32 a40, v228
  v_accvgpr_write_b32 a41, v229
  v_accvgpr_write_b32 a42, v230
  v_accvgpr_write_b32 a43, v231
  v_accvgpr_read_b32 v228, a56
  v_accvgpr_read_b32 v229, a57
  v_accvgpr_read_b32 v230, a58
  v_accvgpr_read_b32 v231, a59
  v_mul_f32 v228, v225, v228
  v_mul_f32 v229, v225, v229
  v_mul_f32 v230, v225, v230
  v_mul_f32 v231, v225, v231
  v_accvgpr_write_b32 a56, v228
  v_accvgpr_write_b32 a57, v229
  v_accvgpr_write_b32 a58, v230
  v_accvgpr_write_b32 a59, v231
  v_accvgpr_read_b32 v228, a72
  v_accvgpr_read_b32 v229, a73
  v_accvgpr_read_b32 v230, a74
  v_accvgpr_read_b32 v231, a75
  v_mul_f32 v228, v225, v228
  v_mul_f32 v229, v225, v229
  v_mul_f32 v230, v225, v230
  v_mul_f32 v231, v225, v231
  v_accvgpr_write_b32 a72, v228
  v_accvgpr_write_b32 a73, v229
  v_accvgpr_write_b32 a74, v230
  v_accvgpr_write_b32 a75, v231
  v_accvgpr_read_b32 v228, a88
  v_accvgpr_read_b32 v229, a89
  v_accvgpr_read_b32 v230, a90
  v_accvgpr_read_b32 v231, a91
  v_mul_f32 v228, v225, v228
  v_mul_f32 v229, v225, v229
  v_mul_f32 v230, v225, v230
  v_mul_f32 v231, v225, v231
  v_accvgpr_write_b32 a88, v228
  v_accvgpr_write_b32 a89, v229
  v_accvgpr_write_b32 a90, v230
  v_accvgpr_write_b32 a91, v231
  v_accvgpr_read_b32 v228, a104
  v_accvgpr_read_b32 v229, a105
  v_accvgpr_read_b32 v230, a106
  v_accvgpr_read_b32 v231, a107
  v_mul_f32 v228, v225, v228
  v_mul_f32 v229, v225, v229
  v_mul_f32 v230, v225, v230
  v_mul_f32 v231, v225, v231
  v_accvgpr_write_b32 a104, v228
  v_accvgpr_write_b32 a105, v229
  v_accvgpr_write_b32 a106, v230
  v_accvgpr_write_b32 a107, v231
  v_accvgpr_read_b32 v228, a120
  v_accvgpr_read_b32 v229, a121
  v_accvgpr_read_b32 v230, a122
  v_accvgpr_read_b32 v231, a123
  v_mul_f32 v228, v225, v228
  v_mul_f32 v229, v225, v229
  v_mul_f32 v230, v225, v230
  v_mul_f32 v231, v225, v231
  v_accvgpr_write_b32 a120, v228
  v_accvgpr_write_b32 a121, v229
  v_accvgpr_write_b32 a122, v230
  v_accvgpr_write_b32 a123, v231
  v_max3_f32 v224, v92, v93, v94
  v_max3_f32 v224, v224, v95, v124
  v_max3_f32 v224, v224, v125, v126
  v_max3_f32 v224, v224, v127, v243
  v_mov_b32 v225, v224
  s_nop 1
  v_permlane16_swap_b32 v224, v225
  v_max_f32 v224, v224, v225
  v_mov_b32 v225, v224
  s_nop 1
  v_permlane32_swap_b32 v224, v225
  v_max_f32 v224, v224, v225
  v_sub_f32 v225, v243, v224
  v_exp_f32 v225, v225
  v_mov_b32 v243, v224
  v_sub_f32 v92, v92, v224
  v_sub_f32 v93, v93, v224
  v_sub_f32 v94, v94, v224
  v_sub_f32 v95, v95, v224
  v_sub_f32 v124, v124, v224
  v_sub_f32 v125, v125, v224
  v_sub_f32 v126, v126, v224
  v_sub_f32 v127, v127, v224
  v_mul_f32 v28, v225, v28
  v_mul_f32 v29, v225, v29
  v_mul_f32 v30, v225, v30
  v_mul_f32 v31, v225, v31
  v_accvgpr_read_b32 v228, a12
  v_accvgpr_read_b32 v229, a13
  v_accvgpr_read_b32 v230, a14
  v_accvgpr_read_b32 v231, a15
  v_mul_f32 v228, v225, v228
  v_mul_f32 v229, v225, v229
  v_mul_f32 v230, v225, v230
  v_mul_f32 v231, v225, v231
  v_accvgpr_write_b32 a12, v228
  v_accvgpr_write_b32 a13, v229
  v_accvgpr_write_b32 a14, v230
  v_accvgpr_write_b32 a15, v231
  v_accvgpr_read_b32 v228, a28
  v_accvgpr_read_b32 v229, a29
  v_accvgpr_read_b32 v230, a30
  v_accvgpr_read_b32 v231, a31
  v_mul_f32 v228, v225, v228
  v_mul_f32 v229, v225, v229
  v_mul_f32 v230, v225, v230
  v_mul_f32 v231, v225, v231
  v_accvgpr_write_b32 a28, v228
  v_accvgpr_write_b32 a29, v229
  v_accvgpr_write_b32 a30, v230
  v_accvgpr_write_b32 a31, v231
  v_accvgpr_read_b32 v228, a44
  v_accvgpr_read_b32 v229, a45
  v_accvgpr_read_b32 v230, a46
  v_accvgpr_read_b32 v231, a47
  v_mul_f32 v228, v225, v228
  v_mul_f32 v229, v225, v229
  v_mul_f32 v230, v225, v230
  v_mul_f32 v231, v225, v231
  v_accvgpr_write_b32 a44, v228
  v_accvgpr_write_b32 a45, v229
  v_accvgpr_write_b32 a46, v230
  v_accvgpr_write_b32 a47, v231
  v_accvgpr_read_b32 v228, a60
  v_accvgpr_read_b32 v229, a61
  v_accvgpr_read_b32 v230, a62
  v_accvgpr_read_b32 v231, a63
  v_mul_f32 v228, v225, v228
  v_mul_f32 v229, v225, v229
  v_mul_f32 v230, v225, v230
  v_mul_f32 v231, v225, v231
  v_accvgpr_write_b32 a60, v228
  v_accvgpr_write_b32 a61, v229
  v_accvgpr_write_b32 a62, v230
  v_accvgpr_write_b32 a63, v231
  v_accvgpr_read_b32 v228, a76
  v_accvgpr_read_b32 v229, a77
  v_accvgpr_read_b32 v230, a78
  v_accvgpr_read_b32 v231, a79
  v_mul_f32 v228, v225, v228
  v_mul_f32 v229, v225, v229
  v_mul_f32 v230, v225, v230
  v_mul_f32 v231, v225, v231
  v_accvgpr_write_b32 a76, v228
  v_accvgpr_write_b32 a77, v229
  v_accvgpr_write_b32 a78, v230
  v_accvgpr_write_b32 a79, v231
  v_accvgpr_read_b32 v228, a92
  v_accvgpr_read_b32 v229, a93
  v_accvgpr_read_b32 v230, a94
  v_accvgpr_read_b32 v231, a95
  v_mul_f32 v228, v225, v228
  v_mul_f32 v229, v225, v229
  v_mul_f32 v230, v225, v230
  v_mul_f32 v231, v225, v231
  v_accvgpr_write_b32 a92, v228
  v_accvgpr_write_b32 a93, v229
  v_accvgpr_write_b32 a94, v230
  v_accvgpr_write_b32 a95, v231
  v_accvgpr_read_b32 v228, a108
  v_accvgpr_read_b32 v229, a109
  v_accvgpr_read_b32 v230, a110
  v_accvgpr_read_b32 v231, a111
  v_mul_f32 v228, v225, v228
  v_mul_f32 v229, v225, v229
  v_mul_f32 v230, v225, v230
  v_mul_f32 v231, v225, v231
  v_accvgpr_write_b32 a108, v228
  v_accvgpr_write_b32 a109, v229
  v_accvgpr_write_b32 a110, v230
  v_accvgpr_write_b32 a111, v231
  v_accvgpr_read_b32 v228, a124
  v_accvgpr_read_b32 v229, a125
  v_accvgpr_read_b32 v230, a126
  v_accvgpr_read_b32 v231, a127
  v_mul_f32 v228, v225, v228
  v_mul_f32 v229, v225, v229
  v_mul_f32 v230, v225, v230
  v_mul_f32 v231, v225, v231
  v_accvgpr_write_b32 a124, v228
  v_accvgpr_write_b32 a125, v229
  v_accvgpr_write_b32 a126, v230
  v_accvgpr_write_b32 a127, v231
  v_exp_f32 v88, v88
  v_exp_f32 v89, v89
  v_exp_f32 v90, v90
  v_exp_f32 v91, v91
  v_exp_f32 v120, v120
  v_exp_f32 v121, v121
  v_exp_f32 v122, v122
  v_exp_f32 v123, v123
  v_exp_f32 v92, v92
  v_exp_f32 v93, v93
  v_exp_f32 v94, v94
  v_exp_f32 v95, v95
  v_exp_f32 v124, v124
  v_exp_f32 v125, v125
  v_exp_f32 v126, v126
  v_exp_f32 v127, v127
  v_cvt_pk_bf16_f32 v40, v88, v89
  v_cvt_pk_bf16_f32 v41, v90, v91
  v_cvt_pk_bf16_f32 v42, v120, v121
  v_cvt_pk_bf16_f32 v43, v122, v123
  v_cvt_pk_bf16_f32 v44, v92, v93
  v_cvt_pk_bf16_f32 v45, v94, v95
  v_cvt_pk_bf16_f32 v46, v124, v125
  v_cvt_pk_bf16_f32 v47, v126, v127
  v_mfma_f32_16x16x32_bf16 a[8:11], a[160:163], v[40:43], a[8:11]
  s_nop 0
  v_mfma_f32_16x16x32_bf16 a[12:15], a[160:163], v[44:47], a[12:15]
  v_mfma_f32_16x16x32_bf16 a[24:27], a[164:167], v[40:43], a[24:27]
  v_mfma_f32_16x16x32_bf16 a[28:31], a[164:167], v[44:47], a[28:31]
  v_mfma_f32_16x16x32_bf16 a[40:43], a[168:171], v[40:43], a[40:43]
  v_mfma_f32_16x16x32_bf16 a[44:47], a[168:171], v[44:47], a[44:47]
  v_mfma_f32_16x16x32_bf16 a[56:59], a[172:175], v[40:43], a[56:59]
  v_mfma_f32_16x16x32_bf16 a[60:63], a[172:175], v[44:47], a[60:63]
  v_mfma_f32_16x16x32_bf16 a[72:75], a[176:179], v[40:43], a[72:75]
  v_mfma_f32_16x16x32_bf16 a[76:79], a[176:179], v[44:47], a[76:79]
  v_mfma_f32_16x16x32_bf16 a[88:91], a[180:183], v[40:43], a[88:91]
  v_mfma_f32_16x16x32_bf16 a[92:95], a[180:183], v[44:47], a[92:95]
  v_mfma_f32_16x16x32_bf16 a[104:107], a[184:187], v[40:43], a[104:107]
  v_mfma_f32_16x16x32_bf16 a[108:111], a[184:187], v[44:47], a[108:111]
  v_mfma_f32_16x16x32_bf16 a[120:123], a[188:191], v[40:43], a[120:123]
  v_mfma_f32_16x16x32_bf16 a[124:127], a[188:191], v[44:47], a[124:127]
  v_mfma_f32_16x16x32_bf16 v[24:27], v[12:15], v[40:43], v[24:27]
  v_mfma_f32_16x16x32_bf16 v[28:31], v[12:15], v[44:47], v[28:31]
  s_nop 7
Lfbs1_f:
  s_add_u32 s86, s86, 1
  s_cmp_lt_u32 s86, s87
  s_cbranch_scc1 Lfb_f
  s_waitcnt vmcnt(0)
  v_rcp_f32 v220, v24
  v_rcp_f32 v221, v28
  v_accvgpr_read_b32 v208, a8
  v_accvgpr_read_b32 v209, a9
  v_accvgpr_read_b32 v210, a10
  v_accvgpr_read_b32 v211, a11
  v_accvgpr_read_b32 v212, a24
  v_accvgpr_read_b32 v213, a25
  v_accvgpr_read_b32 v214, a26
  v_accvgpr_read_b32 v215, a27
  v_pk_mul_f32 v[208:209], v[208:209], v[220:221] op_sel:[0,0] op_sel_hi:[1,0]
  v_pk_mul_f32 v[210:211], v[210:211], v[220:221] op_sel:[0,0] op_sel_hi:[1,0]
  v_pk_mul_f32 v[212:213], v[212:213], v[220:221] op_sel:[0,0] op_sel_hi:[1,0]
  v_pk_mul_f32 v[214:215], v[214:215], v[220:221] op_sel:[0,0] op_sel_hi:[1,0]
  v_cvt_pk_bf16_f32 v40, v208, v209
  v_cvt_pk_bf16_f32 v41, v210, v211
  v_cvt_pk_bf16_f32 v42, v212, v213
  v_cvt_pk_bf16_f32 v43, v214, v215
  buffer_store_dwordx4 v[40:43], v1, s[8:11], s38 offen offset:0 sc1
  v_accvgpr_read_b32 v208, a40
  v_accvgpr_read_b32 v209, a41
  v_accvgpr_read_b32 v210, a42
  v_accvgpr_read_b32 v211, a43
  v_accvgpr_read_b32 v212, a56
  v_accvgpr_read_b32 v213, a57
  v_accvgpr_read_b32 v214, a58
  v_accvgpr_read_b32 v215, a59
  v_pk_mul_f32 v[208:209], v[208:209], v[220:221] op_sel:[0,0] op_sel_hi:[1,0]
  v_pk_mul_f32 v[210:211], v[210:211], v[220:221] op_sel:[0,0] op_sel_hi:[1,0]
  v_pk_mul_f32 v[212:213], v[212:213], v[220:221] op_sel:[0,0] op_sel_hi:[1,0]
  v_pk_mul_f32 v[214:215], v[214:215], v[220:221] op_sel:[0,0] op_sel_hi:[1,0]
  v_cvt_pk_bf16_f32 v44, v208, v209
  v_cvt_pk_bf16_f32 v45, v210, v211
  v_cvt_pk_bf16_f32 v46, v212, v213
  v_cvt_pk_bf16_f32 v47, v214, v215
  buffer_store_dwordx4 v[44:47], v1, s[8:11], s38 offen offset:1024 sc1
  v_accvgpr_read_b32 v208, a72
  v_accvgpr_read_b32 v209, a73
  v_accvgpr_read_b32 v210, a74
  v_accvgpr_read_b32 v211, a75
  v_accvgpr_read_b32 v212, a88
  v_accvgpr_read_b32 v213, a89
  v_accvgpr_read_b32 v214, a90
  v_accvgpr_read_b32 v215, a91
  v_pk_mul_f32 v[208:209], v[208:209], v[220:221] op_sel:[0,0] op_sel_hi:[1,0]
  v_pk_mul_f32 v[210:211], v[210:211], v[220:221] op_sel:[0,0] op_sel_hi:[1,0]
  v_pk_mul_f32 v[212:213], v[212:213], v[220:221] op_sel:[0,0] op_sel_hi:[1,0]
  v_pk_mul_f32 v[214:215], v[214:215], v[220:221] op_sel:[0,0] op_sel_hi:[1,0]
  v_cvt_pk_bf16_f32 v40, v208, v209
  v_cvt_pk_bf16_f32 v41, v210, v211
  v_cvt_pk_bf16_f32 v42, v212, v213
  v_cvt_pk_bf16_f32 v43, v214, v215
  buffer_store_dwordx4 v[40:43], v1, s[8:11], s38 offen offset:2048 sc1
  v_accvgpr_read_b32 v208, a104
  v_accvgpr_read_b32 v209, a105
  v_accvgpr_read_b32 v210, a106
  v_accvgpr_read_b32 v211, a107
  v_accvgpr_read_b32 v212, a120
  v_accvgpr_read_b32 v213, a121
  v_accvgpr_read_b32 v214, a122
  v_accvgpr_read_b32 v215, a123
  v_pk_mul_f32 v[208:209], v[208:209], v[220:221] op_sel:[0,0] op_sel_hi:[1,0]
  v_pk_mul_f32 v[210:211], v[210:211], v[220:221] op_sel:[0,0] op_sel_hi:[1,0]
  v_pk_mul_f32 v[212:213], v[212:213], v[220:221] op_sel:[0,0] op_sel_hi:[1,0]
  v_pk_mul_f32 v[214:215], v[214:215], v[220:221] op_sel:[0,0] op_sel_hi:[1,0]
  v_cvt_pk_bf16_f32 v44, v208, v209
  v_cvt_pk_bf16_f32 v45, v210, v211
  v_cvt_pk_bf16_f32 v46, v212, v213
  v_cvt_pk_bf16_f32 v47, v214, v215
  buffer_store_dwordx4 v[44:47], v1, s[8:11], s38 offen offset:3072 sc1
  v_accvgpr_read_b32 v208, a12
  v_accvgpr_read_b32 v209, a13
  v_accvgpr_read_b32 v210, a14
  v_accvgpr_read_b32 v211, a15
  v_accvgpr_read_b32 v212, a28
  v_accvgpr_read_b32 v213, a29
  v_accvgpr_read_b32 v214, a30
  v_accvgpr_read_b32 v215, a31
  v_pk_mul_f32 v[208:209], v[208:209], v[220:221] op_sel:[0,1] op_sel_hi:[1,1]
  v_pk_mul_f32 v[210:211], v[210:211], v[220:221] op_sel:[0,1] op_sel_hi:[1,1]
  v_pk_mul_f32 v[212:213], v[212:213], v[220:221] op_sel:[0,1] op_sel_hi:[1,1]
  v_pk_mul_f32 v[214:215], v[214:215], v[220:221] op_sel:[0,1] op_sel_hi:[1,1]
  v_cvt_pk_bf16_f32 v40, v208, v209
  v_cvt_pk_bf16_f32 v41, v210, v211
  v_cvt_pk_bf16_f32 v42, v212, v213
  v_cvt_pk_bf16_f32 v43, v214, v215
  buffer_store_dwordx4 v[40:43], v1, s[8:11], s39 offen offset:0 sc1
  v_accvgpr_read_b32 v208, a44
  v_accvgpr_read_b32 v209, a45
  v_accvgpr_read_b32 v210, a46
  v_accvgpr_read_b32 v211, a47
  v_accvgpr_read_b32 v212, a60
  v_accvgpr_read_b32 v213, a61
  v_accvgpr_read_b32 v214, a62
  v_accvgpr_read_b32 v215, a63
  v_pk_mul_f32 v[208:209], v[208:209], v[220:221] op_sel:[0,1] op_sel_hi:[1,1]
  v_pk_mul_f32 v[210:211], v[210:211], v[220:221] op_sel:[0,1] op_sel_hi:[1,1]
  v_pk_mul_f32 v[212:213], v[212:213], v[220:221] op_sel:[0,1] op_sel_hi:[1,1]
  v_pk_mul_f32 v[214:215], v[214:215], v[220:221] op_sel:[0,1] op_sel_hi:[1,1]
  v_cvt_pk_bf16_f32 v44, v208, v209
  v_cvt_pk_bf16_f32 v45, v210, v211
  v_cvt_pk_bf16_f32 v46, v212, v213
  v_cvt_pk_bf16_f32 v47, v214, v215
  buffer_store_dwordx4 v[44:47], v1, s[8:11], s39 offen offset:1024 sc1
  v_accvgpr_read_b32 v208, a76
  v_accvgpr_read_b32 v209, a77
  v_accvgpr_read_b32 v210, a78
  v_accvgpr_read_b32 v211, a79
  v_accvgpr_read_b32 v212, a92
  v_accvgpr_read_b32 v213, a93
  v_accvgpr_read_b32 v214, a94
  v_accvgpr_read_b32 v215, a95
  v_pk_mul_f32 v[208:209], v[208:209], v[220:221] op_sel:[0,1] op_sel_hi:[1,1]
  v_pk_mul_f32 v[210:211], v[210:211], v[220:221] op_sel:[0,1] op_sel_hi:[1,1]
  v_pk_mul_f32 v[212:213], v[212:213], v[220:221] op_sel:[0,1] op_sel_hi:[1,1]
  v_pk_mul_f32 v[214:215], v[214:215], v[220:221] op_sel:[0,1] op_sel_hi:[1,1]
  v_cvt_pk_bf16_f32 v40, v208, v209
  v_cvt_pk_bf16_f32 v41, v210, v211
  v_cvt_pk_bf16_f32 v42, v212, v213
  v_cvt_pk_bf16_f32 v43, v214, v215
  buffer_store_dwordx4 v[40:43], v1, s[8:11], s39 offen offset:2048 sc1
  v_accvgpr_read_b32 v208, a108
  v_accvgpr_read_b32 v209, a109
  v_accvgpr_read_b32 v210, a110
  v_accvgpr_read_b32 v211, a111
  v_accvgpr_read_b32 v212, a124
  v_accvgpr_read_b32 v213, a125
  v_accvgpr_read_b32 v214, a126
  v_accvgpr_read_b32 v215, a127
  v_pk_mul_f32 v[208:209], v[208:209], v[220:221] op_sel:[0,1] op_sel_hi:[1,1]
  v_pk_mul_f32 v[210:211], v[210:211], v[220:221] op_sel:[0,1] op_sel_hi:[1,1]
  v_pk_mul_f32 v[212:213], v[212:213], v[220:221] op_sel:[0,1] op_sel_hi:[1,1]
  v_pk_mul_f32 v[214:215], v[214:215], v[220:221] op_sel:[0,1] op_sel_hi:[1,1]
  v_cvt_pk_bf16_f32 v44, v208, v209
  v_cvt_pk_bf16_f32 v45, v210, v211
  v_cvt_pk_bf16_f32 v46, v212, v213
  v_cvt_pk_bf16_f32 v47, v214, v215
  buffer_store_dwordx4 v[44:47], v1, s[8:11], s39 offen offset:3072 sc1
  v_rcp_f32 v248, v16
  v_rcp_f32 v249, v20
  v_accvgpr_read_b32 v224, a0
  v_accvgpr_read_b32 v225, a1
  v_accvgpr_read_b32 v226, a2
  v_accvgpr_read_b32 v227, a3
  v_accvgpr_read_b32 v228, a16
  v_accvgpr_read_b32 v229, a17
  v_accvgpr_read_b32 v230, a18
  v_accvgpr_read_b32 v231, a19
  v_pk_mul_f32 v[224:225], v[224:225], v[248:249] op_sel:[0,0] op_sel_hi:[1,0]
  v_pk_mul_f32 v[226:227], v[226:227], v[248:249] op_sel:[0,0] op_sel_hi:[1,0]
  v_pk_mul_f32 v[228:229], v[228:229], v[248:249] op_sel:[0,0] op_sel_hi:[1,0]
  v_pk_mul_f32 v[230:231], v[230:231], v[248:249] op_sel:[0,0] op_sel_hi:[1,0]
  v_cvt_pk_bf16_f32 v232, v224, v225
  v_cvt_pk_bf16_f32 v233, v226, v227
  v_cvt_pk_bf16_f32 v234, v228, v229
  v_cvt_pk_bf16_f32 v235, v230, v231
  buffer_store_dwordx4 v[232:235], v1, s[8:11], s36 offen offset:0 sc1
  v_accvgpr_read_b32 v224, a32
  v_accvgpr_read_b32 v225, a33
  v_accvgpr_read_b32 v226, a34
  v_accvgpr_read_b32 v227, a35
  v_accvgpr_read_b32 v228, a48
  v_accvgpr_read_b32 v229, a49
  v_accvgpr_read_b32 v230, a50
  v_accvgpr_read_b32 v231, a51
  v_pk_mul_f32 v[224:225], v[224:225], v[248:249] op_sel:[0,0] op_sel_hi:[1,0]
  v_pk_mul_f32 v[226:227], v[226:227], v[248:249] op_sel:[0,0] op_sel_hi:[1,0]
  v_pk_mul_f32 v[228:229], v[228:229], v[248:249] op_sel:[0,0] op_sel_hi:[1,0]
  v_pk_mul_f32 v[230:231], v[230:231], v[248:249] op_sel:[0,0] op_sel_hi:[1,0]
  v_cvt_pk_bf16_f32 v236, v224, v225
  v_cvt_pk_bf16_f32 v237, v226, v227
  v_cvt_pk_bf16_f32 v238, v228, v229
  v_cvt_pk_bf16_f32 v239, v230, v231
  buffer_store_dwordx4 v[236:239], v1, s[8:11], s36 offen offset:1024 sc1
  v_accvgpr_read_b32 v224, a64
  v_accvgpr_read_b32 v225, a65
  v_accvgpr_read_b32 v226, a66
  v_accvgpr_read_b32 v227, a67
  v_accvgpr_read_b32 v228, a80
  v_accvgpr_read_b32 v229, a81
  v_accvgpr_read_b32 v230, a82
  v_accvgpr_read_b32 v231, a83
  v_pk_mul_f32 v[224:225], v[224:225], v[248:249] op_sel:[0,0] op_sel_hi:[1,0]
  v_pk_mul_f32 v[226:227], v[226:227], v[248:249] op_sel:[0,0] op_sel_hi:[1,0]
  v_pk_mul_f32 v[228:229], v[228:229], v[248:249] op_sel:[0,0] op_sel_hi:[1,0]
  v_pk_mul_f32 v[230:231], v[230:231], v[248:249] op_sel:[0,0] op_sel_hi:[1,0]
  v_cvt_pk_bf16_f32 v232, v224, v225
  v_cvt_pk_bf16_f32 v233, v226, v227
  v_cvt_pk_bf16_f32 v234, v228, v229
  v_cvt_pk_bf16_f32 v235, v230, v231
  buffer_store_dwordx4 v[232:235], v1, s[8:11], s36 offen offset:2048 sc1
  v_accvgpr_read_b32 v224, a96
  v_accvgpr_read_b32 v225, a97
  v_accvgpr_read_b32 v226, a98
  v_accvgpr_read_b32 v227, a99
  v_accvgpr_read_b32 v228, a112
  v_accvgpr_read_b32 v229, a113
  v_accvgpr_read_b32 v230, a114
  v_accvgpr_read_b32 v231, a115
  v_pk_mul_f32 v[224:225], v[224:225], v[248:249] op_sel:[0,0] op_sel_hi:[1,0]
  v_pk_mul_f32 v[226:227], v[226:227], v[248:249] op_sel:[0,0] op_sel_hi:[1,0]
  v_pk_mul_f32 v[228:229], v[228:229], v[248:249] op_sel:[0,0] op_sel_hi:[1,0]
  v_pk_mul_f32 v[230:231], v[230:231], v[248:249] op_sel:[0,0] op_sel_hi:[1,0]
  v_cvt_pk_bf16_f32 v236, v224, v225
  v_cvt_pk_bf16_f32 v237, v226, v227
  v_cvt_pk_bf16_f32 v238, v228, v229
  v_cvt_pk_bf16_f32 v239, v230, v231
  buffer_store_dwordx4 v[236:239], v1, s[8:11], s36 offen offset:3072 sc1
  v_accvgpr_read_b32 v224, a4
  v_accvgpr_read_b32 v225, a5
  v_accvgpr_read_b32 v226, a6
  v_accvgpr_read_b32 v227, a7
  v_accvgpr_read_b32 v228, a20
  v_accvgpr_read_b32 v229, a21
  v_accvgpr_read_b32 v230, a22
  v_accvgpr_read_b32 v231, a23
  v_pk_mul_f32 v[224:225], v[224:225], v[248:249] op_sel:[0,1] op_sel_hi:[1,1]
  v_pk_mul_f32 v[226:227], v[226:227], v[248:249] op_sel:[0,1] op_sel_hi:[1,1]
  v_pk_mul_f32 v[228:229], v[228:229], v[248:249] op_sel:[0,1] op_sel_hi:[1,1]
  v_pk_mul_f32 v[230:231], v[230:231], v[248:249] op_sel:[0,1] op_sel_hi:[1,1]
  v_cvt_pk_bf16_f32 v232, v224, v225
  v_cvt_pk_bf16_f32 v233, v226, v227
  v_cvt_pk_bf16_f32 v234, v228, v229
  v_cvt_pk_bf16_f32 v235, v230, v231
  buffer_store_dwordx4 v[232:235], v1, s[8:11], s37 offen offset:0 sc1
  v_accvgpr_read_b32 v224, a36
  v_accvgpr_read_b32 v225, a37
  v_accvgpr_read_b32 v226, a38
  v_accvgpr_read_b32 v227, a39
  v_accvgpr_read_b32 v228, a52
  v_accvgpr_read_b32 v229, a53
  v_accvgpr_read_b32 v230, a54
  v_accvgpr_read_b32 v231, a55
  v_pk_mul_f32 v[224:225], v[224:225], v[248:249] op_sel:[0,1] op_sel_hi:[1,1]
  v_pk_mul_f32 v[226:227], v[226:227], v[248:249] op_sel:[0,1] op_sel_hi:[1,1]
  v_pk_mul_f32 v[228:229], v[228:229], v[248:249] op_sel:[0,1] op_sel_hi:[1,1]
  v_pk_mul_f32 v[230:231], v[230:231], v[248:249] op_sel:[0,1] op_sel_hi:[1,1]
  v_cvt_pk_bf16_f32 v236, v224, v225
  v_cvt_pk_bf16_f32 v237, v226, v227
  v_cvt_pk_bf16_f32 v238, v228, v229
  v_cvt_pk_bf16_f32 v239, v230, v231
  buffer_store_dwordx4 v[236:239], v1, s[8:11], s37 offen offset:1024 sc1
  v_accvgpr_read_b32 v224, a68
  v_accvgpr_read_b32 v225, a69
  v_accvgpr_read_b32 v226, a70
  v_accvgpr_read_b32 v227, a71
  v_accvgpr_read_b32 v228, a84
  v_accvgpr_read_b32 v229, a85
  v_accvgpr_read_b32 v230, a86
  v_accvgpr_read_b32 v231, a87
  v_pk_mul_f32 v[224:225], v[224:225], v[248:249] op_sel:[0,1] op_sel_hi:[1,1]
  v_pk_mul_f32 v[226:227], v[226:227], v[248:249] op_sel:[0,1] op_sel_hi:[1,1]
  v_pk_mul_f32 v[228:229], v[228:229], v[248:249] op_sel:[0,1] op_sel_hi:[1,1]
  v_pk_mul_f32 v[230:231], v[230:231], v[248:249] op_sel:[0,1] op_sel_hi:[1,1]
  v_cvt_pk_bf16_f32 v232, v224, v225
  v_cvt_pk_bf16_f32 v233, v226, v227
  v_cvt_pk_bf16_f32 v234, v228, v229
  v_cvt_pk_bf16_f32 v235, v230, v231
  buffer_store_dwordx4 v[232:235], v1, s[8:11], s37 offen offset:2048 sc1
  v_accvgpr_read_b32 v224, a100
  v_accvgpr_read_b32 v225, a101
  v_accvgpr_read_b32 v226, a102
  v_accvgpr_read_b32 v227, a103
  v_accvgpr_read_b32 v228, a116
  v_accvgpr_read_b32 v229, a117
  v_accvgpr_read_b32 v230, a118
  v_accvgpr_read_b32 v231, a119
  v_pk_mul_f32 v[224:225], v[224:225], v[248:249] op_sel:[0,1] op_sel_hi:[1,1]
  v_pk_mul_f32 v[226:227], v[226:227], v[248:249] op_sel:[0,1] op_sel_hi:[1,1]
  v_pk_mul_f32 v[228:229], v[228:229], v[248:249] op_sel:[0,1] op_sel_hi:[1,1]
  v_pk_mul_f32 v[230:231], v[230:231], v[248:249] op_sel:[0,1] op_sel_hi:[1,1]
  v_cvt_pk_bf16_f32 v236, v224, v225
  v_cvt_pk_bf16_f32 v237, v226, v227
  v_cvt_pk_bf16_f32 v238, v228, v229
  v_cvt_pk_bf16_f32 v239, v230, v231
  buffer_store_dwordx4 v[236:239], v1, s[8:11], s37 offen offset:3072 sc1
  s_add_u32 s77, s82, 16384
  buffer_load_dwordx4 a[128:131], v1, s[8:11], s77 offen offset:0 sc1
  buffer_load_dwordx4 a[132:135], v1, s[8:11], s77 offen offset:1024 sc1
  buffer_load_dwordx4 a[136:139], v1, s[8:11], s77 offen offset:2048 sc1
  buffer_load_dwordx4 a[140:143], v1, s[8:11], s77 offen offset:3072 sc1
  s_add_u32 s77, s82, 20480
  buffer_load_dwordx4 a[144:147], v1, s[8:11], s77 offen offset:0 sc1
  buffer_load_dwordx4 a[148:151], v1, s[8:11], s77 offen offset:1024 sc1
  buffer_load_dwordx4 a[152:155], v1, s[8:11], s77 offen offset:2048 sc1
  buffer_load_dwordx4 a[156:159], v1, s[8:11], s77 offen offset:3072 sc1
  s_add_u32 s77, s82, 24576
  buffer_load_dwordx4 a[160:163], v1, s[8:11], s77 offen offset:0 sc1
  buffer_load_dwordx4 a[164:167], v1, s[8:11], s77 offen offset:1024 sc1
  buffer_load_dwordx4 a[168:171], v1, s[8:11], s77 offen offset:2048 sc1
  buffer_load_dwordx4 a[172:175], v1, s[8:11], s77 offen offset:3072 sc1
  s_add_u32 s77, s82, 28672
  buffer_load_dwordx4 a[176:179], v1, s[8:11], s77 offen offset:0 sc1
  buffer_load_dwordx4 a[180:183], v1, s[8:11], s77 offen offset:1024 sc1
  buffer_load_dwordx4 a[184:187], v1, s[8:11], s77 offen offset:2048 sc1
  buffer_load_dwordx4 a[188:191], v1, s[8:11], s77 offen offset:3072 sc1
  s_mov_b32 s16, s92
  s_mov_b32 s17, s93
  s_mov_b32 s18, 0x200000
  s_mov_b32 s19, 0x20000
  s_and_b32 s79, s2, 7
  s_lshl_b32 s79, s79, 2
  s_bfe_u32 s76, s2, 0x20003
  s_add_u32 s79, s79, s76
  s_lshl_b32 s79, s79, 2
  s_add_u32 s79, s79, s3
  s_lshl_b32 s79, s79, 14
  s_lshl_b32 s76, s80, 7
  s_add_u32 s79, s79, s76
  s_mul_i32 s83, s5, 12288
  s_lshl_b32 s76, s80, 8
  s_add_u32 s83, s83, s76
  s_add_u32 s83, s83, 38866944
  v_lshrrev_b32 v237, 4, v0
  v_and_b32 v236, 15, v0
  v_lshlrev_b32 v236, 10, v236
  v_lshl_add_u32 v236, v237, 3, v236
  v_lshlrev_b32 v237, 2, v0
  buffer_load_dwordx2 v[208:209], v236, s[16:19], s79 offen offset:0
  buffer_load_dwordx2 v[210:211], v236, s[16:19], s79 offen offset:32
  buffer_load_dwordx2 v[212:213], v236, s[16:19], s79 offen offset:64
  buffer_load_dwordx2 v[214:215], v236, s[16:19], s79 offen offset:96
  buffer_load_dword v216, v237, s[8:11], s83 offen offset:0 sc1
  buffer_load_dword v217, v237, s[8:11], s83 offen offset:2048 sc1
  s_add_u32 s83, s83, 4096
  buffer_load_dword v218, v237, s[8:11], s83 offen offset:0 sc1
  s_waitcnt vmcnt(0)
  s_barrier
  s_branch Lnorm_f
Lcode_end_f:
  s_endpgm
.section .rodata,"a"
.p2align 6
.amdhsa_kernel adaLN_cond__compressed_kv_cla__mixer_channel_mlp__prompt_kernel
  .amdhsa_next_free_vgpr 512
  .amdhsa_next_free_sgpr 102
  .amdhsa_accum_offset 256
  .amdhsa_group_segment_fixed_size 0
  .amdhsa_kernarg_size 128
  .amdhsa_user_sgpr_count 2
  .amdhsa_user_sgpr_kernarg_segment_ptr 1
  .amdhsa_system_sgpr_workgroup_id_x 1
.end_amdhsa_kernel
```
